```python
import torch

def _softmax(x, axis=-1):
    return torch.softmax(x, dim=axis)
def _gelu(x):
    return torch.nn.functional.gelu(x, approximate="tanh")
def _silu(x):
    return torch.nn.functional.silu(x)
def _sigmoid(x):
    return torch.sigmoid(x)
def _layernorm(x, axis=-1, eps=1e-5):
    m = x.mean(dim=axis, keepdim=True)
    v = x.var(dim=axis, keepdim=True, unbiased=False)
    return (x - m) / torch.sqrt(v + eps)
def _scatter_add(tgt, idx, src, axis=0):
    return tgt.clone().index_add_(axis, idx, src)
def _segment_sum(src, seg, n):
    out = torch.zeros((n,) + src.shape[1:], dtype=src.dtype)
    return out.index_add_(0, seg, src)
def _pad(x, pw):
    flat = tuple(v for pair in reversed(pw) for v in pair)
    return torch.nn.functional.pad(x, flat)

kernel_name = 'gated_mix__grouped_kv_mqa__sliding_local_dilated__prompt'

def setup_inputs():

    _w = (lambda a: (lambda t: t.to(torch.bfloat16) if t.is_floating_point() else t)(torch.as_tensor(a)))
    def _A_setup():
        B, S, D, H = 1, 2048, 448, 16
        Dh = D // H
        return {
            "x": _w((lambda *s: torch.randn(*s, dtype=torch.bfloat16) * 0.05)(B, S, D)),
            "wq": _w((lambda *s: torch.randn(*s, dtype=torch.bfloat16) * 1.6)(D, H * Dh)),
            "wk": _w((lambda *s: torch.randn(*s, dtype=torch.bfloat16) * 1.6)(D, Dh)),
            "wv": _w((lambda *s: torch.randn(*s, dtype=torch.bfloat16) * 0.2)(D, Dh)),
            "wo": _w((lambda *s: torch.randn(*s, dtype=torch.bfloat16) * 0.2)(H * Dh, D)),
        }
    _A_in = _A_setup()

    def _B_setup():
        B, S, D = 1, 2048, 448
        return {
            "x": _w((lambda *s: torch.randn(*s, dtype=torch.bfloat16) * 0.05)(B, S, D)),
            "wqkv": _w((lambda *s: torch.randn(*s, dtype=torch.bfloat16) * 0.8)(D, 3 * D)),
            "wo": _w((lambda *s: torch.randn(*s, dtype=torch.bfloat16) * 0.05)(D, D)),
        }
    _B_in = _B_setup()

    return {
        "A_x": _A_in["x"],
        "A_wq": _A_in["wq"],
        "A_wk": _A_in["wk"],
        "A_wv": _A_in["wv"],
        "A_wo": _A_in["wo"],
        "B_x": _B_in["x"],
        "B_wqkv": _B_in["wqkv"],
        "B_wo": _B_in["wo"],
        "gate_w": _w((lambda *s: torch.randn(*s, dtype=torch.bfloat16) * 0.05)(448) * 16.0),
    }

def reference(A_x, A_wq, A_wk, A_wv, A_wo, B_x, B_wqkv, B_wo, gate_w):
    def _A_ref(x, wq, wk, wv, wo):
        B, S, D = x.shape
        H = 16
        Dh = D // H
        q = (lambda x, *d: x.permute(*d))((x @ wq).reshape(B, S, H, Dh), 0, 2, 1, 3)
        k = x @ wk
        v = x @ wv
        scores = torch.einsum("bhqd,bkd->bhqk", q, k) * (Dh ** -0.5)
        p = _softmax(scores, axis=-1)
        o = torch.einsum("bhqk,bkd->bhqd", p, v)
        return (lambda x, *d: x.permute(*d))(o, 0, 2, 1, 3).reshape(B, S, H * Dh) @ wo

    def _B_ref(x, wqkv, wo):
        B, S, D = x.shape
        H = 16; Dh = D // H
        W, dil = 8, 2
        qkv = (lambda x, *d: x.permute(*d))((x @ wqkv).reshape(B, S, 3, H, Dh), 2, 0, 3, 1, 4)
        q, k, v = qkv[0], qkv[1], qkv[2]
        scale = Dh ** -0.5
        pos = torch.arange(S)
        off = torch.arange(W) * dil
        idx = pos[:, None] - off[None, :]
        mask = idx >= 0
        idx_c = torch.where(mask, idx, 0).reshape(-1)
        kg = k[:, :, idx_c, :].reshape(B, H, S, W, Dh)
        vg = v[:, :, idx_c, :].reshape(B, H, S, W, Dh)
        logits = torch.einsum("bhsd,bhswd->bhsw", q, kg) * scale
        logits = torch.where(mask[None, None, :, :], logits, -1e9)
        attn = _softmax(logits, axis=-1)
        o = torch.einsum("bhsw,bhswd->bhsd", attn, vg)
        return (lambda x, *d: x.permute(*d))(o, 0, 2, 1, 3).reshape(B, S, D) @ wo

    x = A_x
    g = _sigmoid((x * gate_w).sum(-1, keepdims=True))
    a = _A_ref(x, A_wq, A_wk, A_wv, A_wo)
    b = _B_ref(x, B_wqkv, B_wo)
    return g * a + (1 - g) * b
```

```asm
; @launch kernel=k1_kernel grid=(240,1,1) block=(256,1,1) lds=116736
; @launch kernel=k2_kernel grid=(256,1,1) block=(512,1,1) lds=98304
; @launch kernel=k3_kernel grid=(224,1,1) block=(256,1,1) lds=57344
.amdgcn_target "amdgcn-amd-amdhsa--gfx950"
.text
.globl k1_kernel
.p2align 8
.type k1_kernel,@function
k1_kernel:
    s_lshr_b32 s3, s2, 4
    s_and_b32 s33, s2, 7
    s_lshl_b32 s33, s33, 1
    s_bfe_u32 s34, s2, 0x10003
    s_or_b32 s33, s33, s34
    s_cmp_ge_u32 s3, 15
    s_cbranch_scc1 K1_end
    s_load_dwordx8 s[36:43], s[0:1], 0
    s_load_dwordx2 s[44:45], s[0:1], 48
    s_load_dwordx2 s[46:47], s[0:1], 88
    v_lshrrev_b32 v1, 6, v0
    v_and_b32 v2, 63, v0
    v_and_b32 v3, 31, v0
    v_bfe_u32 v4, v0, 5, 1
    s_waitcnt lgkmcnt(0)
    s_mov_b32 s8, s36
    s_and_b32 s9, s37, 0xffff
    s_mov_b32 s10, 1835008
    s_mov_b32 s11, 0x00020000
    s_mov_b32 s16, s46
    s_and_b32 s17, s47, 0xffff
    s_mov_b32 s18, 11665408
    s_mov_b32 s19, 0x00020000
    s_lshl_b32 s34, s33, 7
    v_lshl_add_u32 v5, v1, 5, v3
    v_add_u32 v5, s34, v5
    s_nop 0
    v_readfirstlane_b32 s35, v1
    s_lshl_b32 s52, s35, 5
    s_add_u32 s52, s52, s34
    s_mul_i32 s52, s52, 896
    s_mul_i32 s53, s35, 29184
    v_lshlrev_b32 v6, 4, v2
    s_add_u32 s54, s52, 0
    buffer_load_dwordx4 v[16:19], v6, s[8:11], s54 offen
    s_add_u32 s54, s52, 1024
    buffer_load_dwordx4 v[20:23], v6, s[8:11], s54 offen
    s_add_u32 s54, s52, 2048
    buffer_load_dwordx4 v[24:27], v6, s[8:11], s54 offen
    s_add_u32 s54, s52, 3072
    buffer_load_dwordx4 v[28:31], v6, s[8:11], s54 offen
    s_add_u32 s54, s52, 4096
    buffer_load_dwordx4 v[32:35], v6, s[8:11], s54 offen
    s_add_u32 s54, s52, 5120
    buffer_load_dwordx4 v[36:39], v6, s[8:11], s54 offen
    s_add_u32 s54, s52, 6144
    buffer_load_dwordx4 v[40:43], v6, s[8:11], s54 offen
    s_add_u32 s54, s52, 7168
    buffer_load_dwordx4 v[44:47], v6, s[8:11], s54 offen
    s_add_u32 s54, s52, 8192
    buffer_load_dwordx4 v[48:51], v6, s[8:11], s54 offen
    s_add_u32 s54, s52, 9216
    buffer_load_dwordx4 v[52:55], v6, s[8:11], s54 offen
    s_add_u32 s54, s52, 10240
    buffer_load_dwordx4 v[56:59], v6, s[8:11], s54 offen
    s_add_u32 s54, s52, 11264
    buffer_load_dwordx4 v[60:63], v6, s[8:11], s54 offen
    s_add_u32 s54, s52, 12288
    buffer_load_dwordx4 v[64:67], v6, s[8:11], s54 offen
    s_add_u32 s54, s52, 13312
    buffer_load_dwordx4 v[68:71], v6, s[8:11], s54 offen
    s_add_u32 s54, s52, 14336
    buffer_load_dwordx4 v[72:75], v6, s[8:11], s54 offen
    s_add_u32 s54, s52, 15360
    buffer_load_dwordx4 v[76:79], v6, s[8:11], s54 offen
    s_add_u32 s54, s52, 16384
    buffer_load_dwordx4 v[80:83], v6, s[8:11], s54 offen
    s_add_u32 s54, s52, 17408
    buffer_load_dwordx4 v[84:87], v6, s[8:11], s54 offen
    s_add_u32 s54, s52, 18432
    buffer_load_dwordx4 v[88:91], v6, s[8:11], s54 offen
    s_add_u32 s54, s52, 19456
    buffer_load_dwordx4 v[92:95], v6, s[8:11], s54 offen
    s_add_u32 s54, s52, 20480
    buffer_load_dwordx4 v[96:99], v6, s[8:11], s54 offen
    s_add_u32 s54, s52, 21504
    buffer_load_dwordx4 v[100:103], v6, s[8:11], s54 offen
    s_add_u32 s54, s52, 22528
    buffer_load_dwordx4 v[104:107], v6, s[8:11], s54 offen
    s_add_u32 s54, s52, 23552
    buffer_load_dwordx4 v[108:111], v6, s[8:11], s54 offen
    s_add_u32 s54, s52, 24576
    buffer_load_dwordx4 v[112:115], v6, s[8:11], s54 offen
    s_add_u32 s54, s52, 25600
    buffer_load_dwordx4 v[116:119], v6, s[8:11], s54 offen
    s_add_u32 s54, s52, 26624
    buffer_load_dwordx4 v[120:123], v6, s[8:11], s54 offen
    s_add_u32 s54, s52, 27648
    buffer_load_dwordx4 v[124:127], v6, s[8:11], s54 offen
    v_bfe_u32 v8, v2, 4, 1
    v_bfe_u32 v9, v2, 2, 2
    v_and_b32 v10, 3, v2
    v_lshl_add_u32 v7, v4, 3, v9
    v_lshlrev_b32 v7, 6, v7
    v_lshl_add_u32 v7, v8, 5, v7
    v_lshl_add_u32 v7, v10, 3, v7
    v_lshlrev_b32 v11, 4, v0
    v_lshlrev_b32 v12, 3, v0
    v_add_u32 v224, 57344, v7
    v_add_u32 v225, 57344, v11
    v_add_u32 v226, 57344, v12
    v_cmp_le_u32 s[30:31], 32, v2
    s_cmp_eq_u32 s3, 0
    s_cbranch_scc1 K1_v0
    s_cmp_eq_u32 s3, 1
    s_cbranch_scc1 K1_v1
    s_cmp_eq_u32 s3, 2
    s_cbranch_scc1 K1_v2
    s_cmp_eq_u32 s3, 3
    s_cbranch_scc1 K1_v3
    s_cmp_eq_u32 s3, 4
    s_cbranch_scc1 K1_v4
    s_cmp_eq_u32 s3, 5
    s_cbranch_scc1 K1_v5
    s_cmp_eq_u32 s3, 6
    s_cbranch_scc1 K1_v6
    s_cmp_eq_u32 s3, 7
    s_cbranch_scc1 K1_v7
    s_cmp_eq_u32 s3, 8
    s_cbranch_scc1 K1_v8
    s_cmp_eq_u32 s3, 9
    s_cbranch_scc1 K1_v9
    s_cmp_eq_u32 s3, 10
    s_cbranch_scc1 K1_v10
    s_cmp_eq_u32 s3, 11
    s_cbranch_scc1 K1_v11
    s_cmp_eq_u32 s3, 12
    s_cbranch_scc1 K1_v12
    s_cmp_eq_u32 s3, 13
    s_cbranch_scc1 K1_v13
    s_cmp_eq_u32 s3, 14
    s_cbranch_scc1 K1_v14
    s_branch K1_end
K1_v0:
    s_mov_b32 s12, s38
    s_and_b32 s13, s39, 0xffff
    s_mov_b32 s14, 401408
    s_mov_b32 s15, 0x00020000
    s_movk_i32 s35, 896
    v_lshrrev_b32 v227, 2, v0
    v_mul_lo_u32 v227, v227, s35
    v_and_b32 v14, 3, v0
    v_lshl_add_u32 v227, v14, 4, v227
    s_mov_b32 s35, 0
    buffer_load_dwordx4 v[128:131], v227, s[12:15], s35 offen
    s_mov_b32 s35, 57344
    buffer_load_dwordx4 v[132:135], v227, s[12:15], s35 offen
    s_mov_b32 s35, 114688
    buffer_load_dwordx4 v[136:139], v227, s[12:15], s35 offen
    s_mov_b32 s35, 172032
    buffer_load_dwordx4 v[140:143], v227, s[12:15], s35 offen
    s_mov_b32 s35, 229376
    buffer_load_dwordx4 v[144:147], v227, s[12:15], s35 offen
    s_mov_b32 s35, 286720
    buffer_load_dwordx4 v[148:151], v227, s[12:15], s35 offen
    s_mov_b32 s35, 344064
    buffer_load_dwordx4 v[152:155], v227, s[12:15], s35 offen
    s_mov_b32 s12, s38
    s_and_b32 s13, s39, 0xffff
    s_mov_b32 s14, 401408
    s_mov_b32 s15, 0x00020000
    s_movk_i32 s35, 896
    v_lshrrev_b32 v227, 2, v0
    v_mul_lo_u32 v227, v227, s35
    v_and_b32 v14, 3, v0
    v_lshl_add_u32 v227, v14, 4, v227
    s_mov_b32 s35, 64
    buffer_load_dwordx4 v[156:159], v227, s[12:15], s35 offen
    s_mov_b32 s35, 57408
    buffer_load_dwordx4 v[160:163], v227, s[12:15], s35 offen
    s_mov_b32 s35, 114752
    buffer_load_dwordx4 v[164:167], v227, s[12:15], s35 offen
    s_mov_b32 s35, 172096
    buffer_load_dwordx4 v[168:171], v227, s[12:15], s35 offen
    s_mov_b32 s35, 229440
    buffer_load_dwordx4 v[172:175], v227, s[12:15], s35 offen
    s_mov_b32 s35, 286784
    buffer_load_dwordx4 v[176:179], v227, s[12:15], s35 offen
    s_mov_b32 s35, 344128
    buffer_load_dwordx4 v[180:183], v227, s[12:15], s35 offen
    s_mov_b32 s54, 0x4924925
    v_add_u32 v13, 0, v2
    v_mul_hi_u32 v14, v13, s54
    v_lshlrev_b32 v13, 4, v13
    v_lshl_add_u32 v13, v14, 4, v13
    v_add_u32 v13, s53, v13
    s_waitcnt vmcnt(41)
    ds_write_b128 v13, v[16:19]
    v_add_u32 v13, 64, v2
    v_mul_hi_u32 v14, v13, s54
    v_lshlrev_b32 v13, 4, v13
    v_lshl_add_u32 v13, v14, 4, v13
    v_add_u32 v13, s53, v13
    s_waitcnt vmcnt(40)
    ds_write_b128 v13, v[20:23]
    v_add_u32 v13, 128, v2
    v_mul_hi_u32 v14, v13, s54
    v_lshlrev_b32 v13, 4, v13
    v_lshl_add_u32 v13, v14, 4, v13
    v_add_u32 v13, s53, v13
    s_waitcnt vmcnt(39)
    ds_write_b128 v13, v[24:27]
    v_add_u32 v13, 192, v2
    v_mul_hi_u32 v14, v13, s54
    v_lshlrev_b32 v13, 4, v13
    v_lshl_add_u32 v13, v14, 4, v13
    v_add_u32 v13, s53, v13
    s_waitcnt vmcnt(38)
    ds_write_b128 v13, v[28:31]
    v_add_u32 v13, 256, v2
    v_mul_hi_u32 v14, v13, s54
    v_lshlrev_b32 v13, 4, v13
    v_lshl_add_u32 v13, v14, 4, v13
    v_add_u32 v13, s53, v13
    s_waitcnt vmcnt(37)
    ds_write_b128 v13, v[32:35]
    v_add_u32 v13, 320, v2
    v_mul_hi_u32 v14, v13, s54
    v_lshlrev_b32 v13, 4, v13
    v_lshl_add_u32 v13, v14, 4, v13
    v_add_u32 v13, s53, v13
    s_waitcnt vmcnt(36)
    ds_write_b128 v13, v[36:39]
    v_add_u32 v13, 384, v2
    v_mul_hi_u32 v14, v13, s54
    v_lshlrev_b32 v13, 4, v13
    v_lshl_add_u32 v13, v14, 4, v13
    v_add_u32 v13, s53, v13
    s_waitcnt vmcnt(35)
    ds_write_b128 v13, v[40:43]
    v_add_u32 v13, 448, v2
    v_mul_hi_u32 v14, v13, s54
    v_lshlrev_b32 v13, 4, v13
    v_lshl_add_u32 v13, v14, 4, v13
    v_add_u32 v13, s53, v13
    s_waitcnt vmcnt(34)
    ds_write_b128 v13, v[44:47]
    v_add_u32 v13, 512, v2
    v_mul_hi_u32 v14, v13, s54
    v_lshlrev_b32 v13, 4, v13
    v_lshl_add_u32 v13, v14, 4, v13
    v_add_u32 v13, s53, v13
    s_waitcnt vmcnt(33)
    ds_write_b128 v13, v[48:51]
    v_add_u32 v13, 576, v2
    v_mul_hi_u32 v14, v13, s54
    v_lshlrev_b32 v13, 4, v13
    v_lshl_add_u32 v13, v14, 4, v13
    v_add_u32 v13, s53, v13
    s_waitcnt vmcnt(32)
    ds_write_b128 v13, v[52:55]
    v_add_u32 v13, 640, v2
    v_mul_hi_u32 v14, v13, s54
    v_lshlrev_b32 v13, 4, v13
    v_lshl_add_u32 v13, v14, 4, v13
    v_add_u32 v13, s53, v13
    s_waitcnt vmcnt(31)
    ds_write_b128 v13, v[56:59]
    v_add_u32 v13, 704, v2
    v_mul_hi_u32 v14, v13, s54
    v_lshlrev_b32 v13, 4, v13
    v_lshl_add_u32 v13, v14, 4, v13
    v_add_u32 v13, s53, v13
    s_waitcnt vmcnt(30)
    ds_write_b128 v13, v[60:63]
    v_add_u32 v13, 768, v2
    v_mul_hi_u32 v14, v13, s54
    v_lshlrev_b32 v13, 4, v13
    v_lshl_add_u32 v13, v14, 4, v13
    v_add_u32 v13, s53, v13
    s_waitcnt vmcnt(29)
    ds_write_b128 v13, v[64:67]
    v_add_u32 v13, 832, v2
    v_mul_hi_u32 v14, v13, s54
    v_lshlrev_b32 v13, 4, v13
    v_lshl_add_u32 v13, v14, 4, v13
    v_add_u32 v13, s53, v13
    s_waitcnt vmcnt(28)
    ds_write_b128 v13, v[68:71]
    v_add_u32 v13, 896, v2
    v_mul_hi_u32 v14, v13, s54
    v_lshlrev_b32 v13, 4, v13
    v_lshl_add_u32 v13, v14, 4, v13
    v_add_u32 v13, s53, v13
    s_waitcnt vmcnt(27)
    ds_write_b128 v13, v[72:75]
    v_add_u32 v13, 960, v2
    v_mul_hi_u32 v14, v13, s54
    v_lshlrev_b32 v13, 4, v13
    v_lshl_add_u32 v13, v14, 4, v13
    v_add_u32 v13, s53, v13
    s_waitcnt vmcnt(26)
    ds_write_b128 v13, v[76:79]
    v_add_u32 v13, 1024, v2
    v_mul_hi_u32 v14, v13, s54
    v_lshlrev_b32 v13, 4, v13
    v_lshl_add_u32 v13, v14, 4, v13
    v_add_u32 v13, s53, v13
    s_waitcnt vmcnt(25)
    ds_write_b128 v13, v[80:83]
    v_add_u32 v13, 1088, v2
    v_mul_hi_u32 v14, v13, s54
    v_lshlrev_b32 v13, 4, v13
    v_lshl_add_u32 v13, v14, 4, v13
    v_add_u32 v13, s53, v13
    s_waitcnt vmcnt(24)
    ds_write_b128 v13, v[84:87]
    v_add_u32 v13, 1152, v2
    v_mul_hi_u32 v14, v13, s54
    v_lshlrev_b32 v13, 4, v13
    v_lshl_add_u32 v13, v14, 4, v13
    v_add_u32 v13, s53, v13
    s_waitcnt vmcnt(23)
    ds_write_b128 v13, v[88:91]
    v_add_u32 v13, 1216, v2
    v_mul_hi_u32 v14, v13, s54
    v_lshlrev_b32 v13, 4, v13
    v_lshl_add_u32 v13, v14, 4, v13
    v_add_u32 v13, s53, v13
    s_waitcnt vmcnt(22)
    ds_write_b128 v13, v[92:95]
    v_add_u32 v13, 1280, v2
    v_mul_hi_u32 v14, v13, s54
    v_lshlrev_b32 v13, 4, v13
    v_lshl_add_u32 v13, v14, 4, v13
    v_add_u32 v13, s53, v13
    s_waitcnt vmcnt(21)
    ds_write_b128 v13, v[96:99]
    v_add_u32 v13, 1344, v2
    v_mul_hi_u32 v14, v13, s54
    v_lshlrev_b32 v13, 4, v13
    v_lshl_add_u32 v13, v14, 4, v13
    v_add_u32 v13, s53, v13
    s_waitcnt vmcnt(20)
    ds_write_b128 v13, v[100:103]
    v_add_u32 v13, 1408, v2
    v_mul_hi_u32 v14, v13, s54
    v_lshlrev_b32 v13, 4, v13
    v_lshl_add_u32 v13, v14, 4, v13
    v_add_u32 v13, s53, v13
    s_waitcnt vmcnt(19)
    ds_write_b128 v13, v[104:107]
    v_add_u32 v13, 1472, v2
    v_mul_hi_u32 v14, v13, s54
    v_lshlrev_b32 v13, 4, v13
    v_lshl_add_u32 v13, v14, 4, v13
    v_add_u32 v13, s53, v13
    s_waitcnt vmcnt(18)
    ds_write_b128 v13, v[108:111]
    v_add_u32 v13, 1536, v2
    v_mul_hi_u32 v14, v13, s54
    v_lshlrev_b32 v13, 4, v13
    v_lshl_add_u32 v13, v14, 4, v13
    v_add_u32 v13, s53, v13
    s_waitcnt vmcnt(17)
    ds_write_b128 v13, v[112:115]
    v_add_u32 v13, 1600, v2
    v_mul_hi_u32 v14, v13, s54
    v_lshlrev_b32 v13, 4, v13
    v_lshl_add_u32 v13, v14, 4, v13
    v_add_u32 v13, s53, v13
    s_waitcnt vmcnt(16)
    ds_write_b128 v13, v[116:119]
    v_add_u32 v13, 1664, v2
    v_mul_hi_u32 v14, v13, s54
    v_lshlrev_b32 v13, 4, v13
    v_lshl_add_u32 v13, v14, 4, v13
    v_add_u32 v13, s53, v13
    s_waitcnt vmcnt(15)
    ds_write_b128 v13, v[120:123]
    v_add_u32 v13, 1728, v2
    v_mul_hi_u32 v14, v13, s54
    v_lshlrev_b32 v13, 4, v13
    v_lshl_add_u32 v13, v14, 4, v13
    v_add_u32 v13, s53, v13
    s_waitcnt vmcnt(14)
    ds_write_b128 v13, v[124:127]
    v_mul_u32_u24 v13, 912, v3
    v_lshl_add_u32 v13, v4, 4, v13
    v_add_u32 v13, s53, v13
    s_waitcnt lgkmcnt(0)
    ds_read_b128 v[16:19], v13 offset:0
    ds_read_b128 v[20:23], v13 offset:32
    ds_read_b128 v[24:27], v13 offset:64
    ds_read_b128 v[28:31], v13 offset:96
    ds_read_b128 v[32:35], v13 offset:128
    ds_read_b128 v[36:39], v13 offset:160
    ds_read_b128 v[40:43], v13 offset:192
    ds_read_b128 v[44:47], v13 offset:224
    ds_read_b128 v[48:51], v13 offset:256
    ds_read_b128 v[52:55], v13 offset:288
    ds_read_b128 v[56:59], v13 offset:320
    ds_read_b128 v[60:63], v13 offset:352
    ds_read_b128 v[64:67], v13 offset:384
    ds_read_b128 v[68:71], v13 offset:416
    ds_read_b128 v[72:75], v13 offset:448
    ds_read_b128 v[76:79], v13 offset:480
    ds_read_b128 v[80:83], v13 offset:512
    ds_read_b128 v[84:87], v13 offset:544
    ds_read_b128 v[88:91], v13 offset:576
    ds_read_b128 v[92:95], v13 offset:608
    ds_read_b128 v[96:99], v13 offset:640
    ds_read_b128 v[100:103], v13 offset:672
    ds_read_b128 v[104:107], v13 offset:704
    ds_read_b128 v[108:111], v13 offset:736
    ds_read_b128 v[112:115], v13 offset:768
    ds_read_b128 v[116:119], v13 offset:800
    ds_read_b128 v[120:123], v13 offset:832
    ds_read_b128 v[124:127], v13 offset:864
    s_waitcnt lgkmcnt(0)
    s_barrier
    s_waitcnt vmcnt(13)
    ds_write_b128 v11, v[128:131] offset:0
    s_waitcnt vmcnt(12)
    ds_write_b128 v11, v[132:135] offset:4096
    s_waitcnt vmcnt(11)
    ds_write_b128 v11, v[136:139] offset:8192
    s_waitcnt vmcnt(10)
    ds_write_b128 v11, v[140:143] offset:12288
    s_waitcnt vmcnt(9)
    ds_write_b128 v11, v[144:147] offset:16384
    s_waitcnt vmcnt(8)
    ds_write_b128 v11, v[148:151] offset:20480
    s_waitcnt vmcnt(7)
    ds_write_b128 v11, v[152:155] offset:24576
    s_waitcnt vmcnt(6)
    ds_write_b128 v11, v[156:159] offset:28672
    s_waitcnt vmcnt(5)
    ds_write_b128 v11, v[160:163] offset:32768
    s_waitcnt vmcnt(4)
    ds_write_b128 v11, v[164:167] offset:36864
    s_waitcnt vmcnt(3)
    ds_write_b128 v11, v[168:171] offset:40960
    s_waitcnt vmcnt(2)
    ds_write_b128 v11, v[172:175] offset:45056
    s_waitcnt vmcnt(1)
    ds_write_b128 v11, v[176:179] offset:49152
    s_waitcnt vmcnt(0)
    ds_write_b128 v11, v[180:183] offset:53248
    s_mov_b32 s12, s38
    s_and_b32 s13, s39, 0xffff
    s_mov_b32 s14, 401408
    s_mov_b32 s15, 0x00020000
    s_movk_i32 s35, 896
    v_lshrrev_b32 v13, 2, v0
    v_mul_lo_u32 v13, v13, s35
    v_and_b32 v14, 3, v0
    v_lshl_add_u32 v13, v14, 4, v13
    s_mov_b32 s35, 128
    buffer_load_dwordx4 v[128:131], v13, s[12:15], s35 offen
    s_mov_b32 s35, 57472
    buffer_load_dwordx4 v[132:135], v13, s[12:15], s35 offen
    s_mov_b32 s35, 114816
    buffer_load_dwordx4 v[136:139], v13, s[12:15], s35 offen
    s_mov_b32 s35, 172160
    buffer_load_dwordx4 v[140:143], v13, s[12:15], s35 offen
    s_mov_b32 s35, 229504
    buffer_load_dwordx4 v[144:147], v13, s[12:15], s35 offen
    s_mov_b32 s35, 286848
    buffer_load_dwordx4 v[148:151], v13, s[12:15], s35 offen
    s_mov_b32 s35, 344192
    buffer_load_dwordx4 v[152:155], v13, s[12:15], s35 offen
    s_waitcnt vmcnt(6)
    ds_write_b128 v225, v[128:131] offset:0
    s_waitcnt vmcnt(5)
    ds_write_b128 v225, v[132:135] offset:4096
    s_waitcnt vmcnt(4)
    ds_write_b128 v225, v[136:139] offset:8192
    s_waitcnt vmcnt(3)
    ds_write_b128 v225, v[140:143] offset:12288
    s_waitcnt vmcnt(2)
    ds_write_b128 v225, v[144:147] offset:16384
    s_waitcnt vmcnt(1)
    ds_write_b128 v225, v[148:151] offset:20480
    s_waitcnt vmcnt(0)
    ds_write_b128 v225, v[152:155] offset:24576
    s_mov_b32 s12, s38
    s_and_b32 s13, s39, 0xffff
    s_mov_b32 s14, 401408
    s_mov_b32 s15, 0x00020000
    s_movk_i32 s35, 896
    v_lshrrev_b32 v13, 2, v0
    v_mul_lo_u32 v13, v13, s35
    v_and_b32 v14, 3, v0
    v_lshl_add_u32 v13, v14, 4, v13
    s_mov_b32 s35, 192
    buffer_load_dwordx4 v[128:131], v13, s[12:15], s35 offen
    s_mov_b32 s35, 57536
    buffer_load_dwordx4 v[132:135], v13, s[12:15], s35 offen
    s_mov_b32 s35, 114880
    buffer_load_dwordx4 v[136:139], v13, s[12:15], s35 offen
    s_mov_b32 s35, 172224
    buffer_load_dwordx4 v[140:143], v13, s[12:15], s35 offen
    s_mov_b32 s35, 229568
    buffer_load_dwordx4 v[144:147], v13, s[12:15], s35 offen
    s_mov_b32 s35, 286912
    buffer_load_dwordx4 v[148:151], v13, s[12:15], s35 offen
    s_mov_b32 s35, 344256
    buffer_load_dwordx4 v[152:155], v13, s[12:15], s35 offen
    s_waitcnt vmcnt(6)
    ds_write_b128 v225, v[128:131] offset:28672
    s_waitcnt vmcnt(5)
    ds_write_b128 v225, v[132:135] offset:32768
    s_waitcnt vmcnt(4)
    ds_write_b128 v225, v[136:139] offset:36864
    s_waitcnt vmcnt(3)
    ds_write_b128 v225, v[140:143] offset:40960
    s_waitcnt vmcnt(2)
    ds_write_b128 v225, v[144:147] offset:45056
    s_waitcnt vmcnt(1)
    ds_write_b128 v225, v[148:151] offset:49152
    s_waitcnt vmcnt(0)
    ds_write_b128 v225, v[152:155] offset:53248
    s_waitcnt lgkmcnt(0)
    s_barrier
    ds_read_b64_tr_b16 v[192:193], v7 offset:0
    ds_read_b64_tr_b16 v[194:195], v7 offset:256
    ds_read_b64_tr_b16 v[196:197], v7 offset:28672
    ds_read_b64_tr_b16 v[198:199], v7 offset:28928
    ds_read_b64_tr_b16 v[200:201], v224 offset:0
    ds_read_b64_tr_b16 v[202:203], v224 offset:256
    ds_read_b64_tr_b16 v[204:205], v224 offset:28672
    ds_read_b64_tr_b16 v[206:207], v224 offset:28928
    ds_read_b64_tr_b16 v[208:209], v7 offset:1024
    ds_read_b64_tr_b16 v[210:211], v7 offset:1280
    ds_read_b64_tr_b16 v[212:213], v7 offset:29696
    ds_read_b64_tr_b16 v[214:215], v7 offset:29952
    ds_read_b64_tr_b16 v[216:217], v224 offset:1024
    ds_read_b64_tr_b16 v[218:219], v224 offset:1280
    ds_read_b64_tr_b16 v[220:221], v224 offset:29696
    ds_read_b64_tr_b16 v[222:223], v224 offset:29952
    s_waitcnt lgkmcnt(8)
    v_mfma_f32_32x32x16_bf16 v[128:143], v[192:195], v[16:19], 0
    v_mfma_f32_32x32x16_bf16 v[144:159], v[196:199], v[16:19], 0
    v_mfma_f32_32x32x16_bf16 v[160:175], v[200:203], v[16:19], 0
    v_mfma_f32_32x32x16_bf16 v[176:191], v[204:207], v[16:19], 0
    ds_read_b64_tr_b16 v[192:193], v7 offset:2048
    ds_read_b64_tr_b16 v[194:195], v7 offset:2304
    ds_read_b64_tr_b16 v[196:197], v7 offset:30720
    ds_read_b64_tr_b16 v[198:199], v7 offset:30976
    ds_read_b64_tr_b16 v[200:201], v224 offset:2048
    ds_read_b64_tr_b16 v[202:203], v224 offset:2304
    ds_read_b64_tr_b16 v[204:205], v224 offset:30720
    ds_read_b64_tr_b16 v[206:207], v224 offset:30976
    s_waitcnt lgkmcnt(8)
    v_mfma_f32_32x32x16_bf16 v[128:143], v[208:211], v[20:23], v[128:143]
    v_mfma_f32_32x32x16_bf16 v[144:159], v[212:215], v[20:23], v[144:159]
    v_mfma_f32_32x32x16_bf16 v[160:175], v[216:219], v[20:23], v[160:175]
    v_mfma_f32_32x32x16_bf16 v[176:191], v[220:223], v[20:23], v[176:191]
    ds_read_b64_tr_b16 v[208:209], v7 offset:3072
    ds_read_b64_tr_b16 v[210:211], v7 offset:3328
    ds_read_b64_tr_b16 v[212:213], v7 offset:31744
    ds_read_b64_tr_b16 v[214:215], v7 offset:32000
    ds_read_b64_tr_b16 v[216:217], v224 offset:3072
    ds_read_b64_tr_b16 v[218:219], v224 offset:3328
    ds_read_b64_tr_b16 v[220:221], v224 offset:31744
    ds_read_b64_tr_b16 v[222:223], v224 offset:32000
    s_waitcnt lgkmcnt(8)
    v_mfma_f32_32x32x16_bf16 v[128:143], v[192:195], v[24:27], v[128:143]
    v_mfma_f32_32x32x16_bf16 v[144:159], v[196:199], v[24:27], v[144:159]
    v_mfma_f32_32x32x16_bf16 v[160:175], v[200:203], v[24:27], v[160:175]
    v_mfma_f32_32x32x16_bf16 v[176:191], v[204:207], v[24:27], v[176:191]
    ds_read_b64_tr_b16 v[192:193], v7 offset:4096
    ds_read_b64_tr_b16 v[194:195], v7 offset:4352
    ds_read_b64_tr_b16 v[196:197], v7 offset:32768
    ds_read_b64_tr_b16 v[198:199], v7 offset:33024
    ds_read_b64_tr_b16 v[200:201], v224 offset:4096
    ds_read_b64_tr_b16 v[202:203], v224 offset:4352
    ds_read_b64_tr_b16 v[204:205], v224 offset:32768
    ds_read_b64_tr_b16 v[206:207], v224 offset:33024
    s_waitcnt lgkmcnt(8)
    v_mfma_f32_32x32x16_bf16 v[128:143], v[208:211], v[28:31], v[128:143]
    v_mfma_f32_32x32x16_bf16 v[144:159], v[212:215], v[28:31], v[144:159]
    v_mfma_f32_32x32x16_bf16 v[160:175], v[216:219], v[28:31], v[160:175]
    v_mfma_f32_32x32x16_bf16 v[176:191], v[220:223], v[28:31], v[176:191]
    ds_read_b64_tr_b16 v[208:209], v7 offset:5120
    ds_read_b64_tr_b16 v[210:211], v7 offset:5376
    ds_read_b64_tr_b16 v[212:213], v7 offset:33792
    ds_read_b64_tr_b16 v[214:215], v7 offset:34048
    ds_read_b64_tr_b16 v[216:217], v224 offset:5120
    ds_read_b64_tr_b16 v[218:219], v224 offset:5376
    ds_read_b64_tr_b16 v[220:221], v224 offset:33792
    ds_read_b64_tr_b16 v[222:223], v224 offset:34048
    s_waitcnt lgkmcnt(8)
    v_mfma_f32_32x32x16_bf16 v[128:143], v[192:195], v[32:35], v[128:143]
    v_mfma_f32_32x32x16_bf16 v[144:159], v[196:199], v[32:35], v[144:159]
    v_mfma_f32_32x32x16_bf16 v[160:175], v[200:203], v[32:35], v[160:175]
    v_mfma_f32_32x32x16_bf16 v[176:191], v[204:207], v[32:35], v[176:191]
    ds_read_b64_tr_b16 v[192:193], v7 offset:6144
    ds_read_b64_tr_b16 v[194:195], v7 offset:6400
    ds_read_b64_tr_b16 v[196:197], v7 offset:34816
    ds_read_b64_tr_b16 v[198:199], v7 offset:35072
    ds_read_b64_tr_b16 v[200:201], v224 offset:6144
    ds_read_b64_tr_b16 v[202:203], v224 offset:6400
    ds_read_b64_tr_b16 v[204:205], v224 offset:34816
    ds_read_b64_tr_b16 v[206:207], v224 offset:35072
    s_waitcnt lgkmcnt(8)
    v_mfma_f32_32x32x16_bf16 v[128:143], v[208:211], v[36:39], v[128:143]
    v_mfma_f32_32x32x16_bf16 v[144:159], v[212:215], v[36:39], v[144:159]
    v_mfma_f32_32x32x16_bf16 v[160:175], v[216:219], v[36:39], v[160:175]
    v_mfma_f32_32x32x16_bf16 v[176:191], v[220:223], v[36:39], v[176:191]
    ds_read_b64_tr_b16 v[208:209], v7 offset:7168
    ds_read_b64_tr_b16 v[210:211], v7 offset:7424
    ds_read_b64_tr_b16 v[212:213], v7 offset:35840
    ds_read_b64_tr_b16 v[214:215], v7 offset:36096
    ds_read_b64_tr_b16 v[216:217], v224 offset:7168
    ds_read_b64_tr_b16 v[218:219], v224 offset:7424
    ds_read_b64_tr_b16 v[220:221], v224 offset:35840
    ds_read_b64_tr_b16 v[222:223], v224 offset:36096
    s_waitcnt lgkmcnt(8)
    v_mfma_f32_32x32x16_bf16 v[128:143], v[192:195], v[40:43], v[128:143]
    v_mfma_f32_32x32x16_bf16 v[144:159], v[196:199], v[40:43], v[144:159]
    v_mfma_f32_32x32x16_bf16 v[160:175], v[200:203], v[40:43], v[160:175]
    v_mfma_f32_32x32x16_bf16 v[176:191], v[204:207], v[40:43], v[176:191]
    ds_read_b64_tr_b16 v[192:193], v7 offset:8192
    ds_read_b64_tr_b16 v[194:195], v7 offset:8448
    ds_read_b64_tr_b16 v[196:197], v7 offset:36864
    ds_read_b64_tr_b16 v[198:199], v7 offset:37120
    ds_read_b64_tr_b16 v[200:201], v224 offset:8192
    ds_read_b64_tr_b16 v[202:203], v224 offset:8448
    ds_read_b64_tr_b16 v[204:205], v224 offset:36864
    ds_read_b64_tr_b16 v[206:207], v224 offset:37120
    s_waitcnt lgkmcnt(8)
    v_mfma_f32_32x32x16_bf16 v[128:143], v[208:211], v[44:47], v[128:143]
    v_mfma_f32_32x32x16_bf16 v[144:159], v[212:215], v[44:47], v[144:159]
    v_mfma_f32_32x32x16_bf16 v[160:175], v[216:219], v[44:47], v[160:175]
    v_mfma_f32_32x32x16_bf16 v[176:191], v[220:223], v[44:47], v[176:191]
    ds_read_b64_tr_b16 v[208:209], v7 offset:9216
    ds_read_b64_tr_b16 v[210:211], v7 offset:9472
    ds_read_b64_tr_b16 v[212:213], v7 offset:37888
    ds_read_b64_tr_b16 v[214:215], v7 offset:38144
    ds_read_b64_tr_b16 v[216:217], v224 offset:9216
    ds_read_b64_tr_b16 v[218:219], v224 offset:9472
    ds_read_b64_tr_b16 v[220:221], v224 offset:37888
    ds_read_b64_tr_b16 v[222:223], v224 offset:38144
    s_waitcnt lgkmcnt(8)
    v_mfma_f32_32x32x16_bf16 v[128:143], v[192:195], v[48:51], v[128:143]
    v_mfma_f32_32x32x16_bf16 v[144:159], v[196:199], v[48:51], v[144:159]
    v_mfma_f32_32x32x16_bf16 v[160:175], v[200:203], v[48:51], v[160:175]
    v_mfma_f32_32x32x16_bf16 v[176:191], v[204:207], v[48:51], v[176:191]
    ds_read_b64_tr_b16 v[192:193], v7 offset:10240
    ds_read_b64_tr_b16 v[194:195], v7 offset:10496
    ds_read_b64_tr_b16 v[196:197], v7 offset:38912
    ds_read_b64_tr_b16 v[198:199], v7 offset:39168
    ds_read_b64_tr_b16 v[200:201], v224 offset:10240
    ds_read_b64_tr_b16 v[202:203], v224 offset:10496
    ds_read_b64_tr_b16 v[204:205], v224 offset:38912
    ds_read_b64_tr_b16 v[206:207], v224 offset:39168
    s_waitcnt lgkmcnt(8)
    v_mfma_f32_32x32x16_bf16 v[128:143], v[208:211], v[52:55], v[128:143]
    v_mfma_f32_32x32x16_bf16 v[144:159], v[212:215], v[52:55], v[144:159]
    v_mfma_f32_32x32x16_bf16 v[160:175], v[216:219], v[52:55], v[160:175]
    v_mfma_f32_32x32x16_bf16 v[176:191], v[220:223], v[52:55], v[176:191]
    ds_read_b64_tr_b16 v[208:209], v7 offset:11264
    ds_read_b64_tr_b16 v[210:211], v7 offset:11520
    ds_read_b64_tr_b16 v[212:213], v7 offset:39936
    ds_read_b64_tr_b16 v[214:215], v7 offset:40192
    ds_read_b64_tr_b16 v[216:217], v224 offset:11264
    ds_read_b64_tr_b16 v[218:219], v224 offset:11520
    ds_read_b64_tr_b16 v[220:221], v224 offset:39936
    ds_read_b64_tr_b16 v[222:223], v224 offset:40192
    s_waitcnt lgkmcnt(8)
    v_mfma_f32_32x32x16_bf16 v[128:143], v[192:195], v[56:59], v[128:143]
    v_mfma_f32_32x32x16_bf16 v[144:159], v[196:199], v[56:59], v[144:159]
    v_mfma_f32_32x32x16_bf16 v[160:175], v[200:203], v[56:59], v[160:175]
    v_mfma_f32_32x32x16_bf16 v[176:191], v[204:207], v[56:59], v[176:191]
    ds_read_b64_tr_b16 v[192:193], v7 offset:12288
    ds_read_b64_tr_b16 v[194:195], v7 offset:12544
    ds_read_b64_tr_b16 v[196:197], v7 offset:40960
    ds_read_b64_tr_b16 v[198:199], v7 offset:41216
    ds_read_b64_tr_b16 v[200:201], v224 offset:12288
    ds_read_b64_tr_b16 v[202:203], v224 offset:12544
    ds_read_b64_tr_b16 v[204:205], v224 offset:40960
    ds_read_b64_tr_b16 v[206:207], v224 offset:41216
    s_waitcnt lgkmcnt(8)
    v_mfma_f32_32x32x16_bf16 v[128:143], v[208:211], v[60:63], v[128:143]
    v_mfma_f32_32x32x16_bf16 v[144:159], v[212:215], v[60:63], v[144:159]
    v_mfma_f32_32x32x16_bf16 v[160:175], v[216:219], v[60:63], v[160:175]
    v_mfma_f32_32x32x16_bf16 v[176:191], v[220:223], v[60:63], v[176:191]
    ds_read_b64_tr_b16 v[208:209], v7 offset:13312
    ds_read_b64_tr_b16 v[210:211], v7 offset:13568
    ds_read_b64_tr_b16 v[212:213], v7 offset:41984
    ds_read_b64_tr_b16 v[214:215], v7 offset:42240
    ds_read_b64_tr_b16 v[216:217], v224 offset:13312
    ds_read_b64_tr_b16 v[218:219], v224 offset:13568
    ds_read_b64_tr_b16 v[220:221], v224 offset:41984
    ds_read_b64_tr_b16 v[222:223], v224 offset:42240
    s_waitcnt lgkmcnt(8)
    v_mfma_f32_32x32x16_bf16 v[128:143], v[192:195], v[64:67], v[128:143]
    v_mfma_f32_32x32x16_bf16 v[144:159], v[196:199], v[64:67], v[144:159]
    v_mfma_f32_32x32x16_bf16 v[160:175], v[200:203], v[64:67], v[160:175]
    v_mfma_f32_32x32x16_bf16 v[176:191], v[204:207], v[64:67], v[176:191]
    ds_read_b64_tr_b16 v[192:193], v7 offset:14336
    ds_read_b64_tr_b16 v[194:195], v7 offset:14592
    ds_read_b64_tr_b16 v[196:197], v7 offset:43008
    ds_read_b64_tr_b16 v[198:199], v7 offset:43264
    ds_read_b64_tr_b16 v[200:201], v224 offset:14336
    ds_read_b64_tr_b16 v[202:203], v224 offset:14592
    ds_read_b64_tr_b16 v[204:205], v224 offset:43008
    ds_read_b64_tr_b16 v[206:207], v224 offset:43264
    s_waitcnt lgkmcnt(8)
    v_mfma_f32_32x32x16_bf16 v[128:143], v[208:211], v[68:71], v[128:143]
    v_mfma_f32_32x32x16_bf16 v[144:159], v[212:215], v[68:71], v[144:159]
    v_mfma_f32_32x32x16_bf16 v[160:175], v[216:219], v[68:71], v[160:175]
    v_mfma_f32_32x32x16_bf16 v[176:191], v[220:223], v[68:71], v[176:191]
    ds_read_b64_tr_b16 v[208:209], v7 offset:15360
    ds_read_b64_tr_b16 v[210:211], v7 offset:15616
    ds_read_b64_tr_b16 v[212:213], v7 offset:44032
    ds_read_b64_tr_b16 v[214:215], v7 offset:44288
    ds_read_b64_tr_b16 v[216:217], v224 offset:15360
    ds_read_b64_tr_b16 v[218:219], v224 offset:15616
    ds_read_b64_tr_b16 v[220:221], v224 offset:44032
    ds_read_b64_tr_b16 v[222:223], v224 offset:44288
    s_waitcnt lgkmcnt(8)
    v_mfma_f32_32x32x16_bf16 v[128:143], v[192:195], v[72:75], v[128:143]
    v_mfma_f32_32x32x16_bf16 v[144:159], v[196:199], v[72:75], v[144:159]
    v_mfma_f32_32x32x16_bf16 v[160:175], v[200:203], v[72:75], v[160:175]
    v_mfma_f32_32x32x16_bf16 v[176:191], v[204:207], v[72:75], v[176:191]
    ds_read_b64_tr_b16 v[192:193], v7 offset:16384
    ds_read_b64_tr_b16 v[194:195], v7 offset:16640
    ds_read_b64_tr_b16 v[196:197], v7 offset:45056
    ds_read_b64_tr_b16 v[198:199], v7 offset:45312
    ds_read_b64_tr_b16 v[200:201], v224 offset:16384
    ds_read_b64_tr_b16 v[202:203], v224 offset:16640
    ds_read_b64_tr_b16 v[204:205], v224 offset:45056
    ds_read_b64_tr_b16 v[206:207], v224 offset:45312
    s_waitcnt lgkmcnt(8)
    v_mfma_f32_32x32x16_bf16 v[128:143], v[208:211], v[76:79], v[128:143]
    v_mfma_f32_32x32x16_bf16 v[144:159], v[212:215], v[76:79], v[144:159]
    v_mfma_f32_32x32x16_bf16 v[160:175], v[216:219], v[76:79], v[160:175]
    v_mfma_f32_32x32x16_bf16 v[176:191], v[220:223], v[76:79], v[176:191]
    ds_read_b64_tr_b16 v[208:209], v7 offset:17408
    ds_read_b64_tr_b16 v[210:211], v7 offset:17664
    ds_read_b64_tr_b16 v[212:213], v7 offset:46080
    ds_read_b64_tr_b16 v[214:215], v7 offset:46336
    ds_read_b64_tr_b16 v[216:217], v224 offset:17408
    ds_read_b64_tr_b16 v[218:219], v224 offset:17664
    ds_read_b64_tr_b16 v[220:221], v224 offset:46080
    ds_read_b64_tr_b16 v[222:223], v224 offset:46336
    s_waitcnt lgkmcnt(8)
    v_mfma_f32_32x32x16_bf16 v[128:143], v[192:195], v[80:83], v[128:143]
    v_mfma_f32_32x32x16_bf16 v[144:159], v[196:199], v[80:83], v[144:159]
    v_mfma_f32_32x32x16_bf16 v[160:175], v[200:203], v[80:83], v[160:175]
    v_mfma_f32_32x32x16_bf16 v[176:191], v[204:207], v[80:83], v[176:191]
    ds_read_b64_tr_b16 v[192:193], v7 offset:18432
    ds_read_b64_tr_b16 v[194:195], v7 offset:18688
    ds_read_b64_tr_b16 v[196:197], v7 offset:47104
    ds_read_b64_tr_b16 v[198:199], v7 offset:47360
    ds_read_b64_tr_b16 v[200:201], v224 offset:18432
    ds_read_b64_tr_b16 v[202:203], v224 offset:18688
    ds_read_b64_tr_b16 v[204:205], v224 offset:47104
    ds_read_b64_tr_b16 v[206:207], v224 offset:47360
    s_waitcnt lgkmcnt(8)
    v_mfma_f32_32x32x16_bf16 v[128:143], v[208:211], v[84:87], v[128:143]
    v_mfma_f32_32x32x16_bf16 v[144:159], v[212:215], v[84:87], v[144:159]
    v_mfma_f32_32x32x16_bf16 v[160:175], v[216:219], v[84:87], v[160:175]
    v_mfma_f32_32x32x16_bf16 v[176:191], v[220:223], v[84:87], v[176:191]
    ds_read_b64_tr_b16 v[208:209], v7 offset:19456
    ds_read_b64_tr_b16 v[210:211], v7 offset:19712
    ds_read_b64_tr_b16 v[212:213], v7 offset:48128
    ds_read_b64_tr_b16 v[214:215], v7 offset:48384
    ds_read_b64_tr_b16 v[216:217], v224 offset:19456
    ds_read_b64_tr_b16 v[218:219], v224 offset:19712
    ds_read_b64_tr_b16 v[220:221], v224 offset:48128
    ds_read_b64_tr_b16 v[222:223], v224 offset:48384
    s_waitcnt lgkmcnt(8)
    v_mfma_f32_32x32x16_bf16 v[128:143], v[192:195], v[88:91], v[128:143]
    v_mfma_f32_32x32x16_bf16 v[144:159], v[196:199], v[88:91], v[144:159]
    v_mfma_f32_32x32x16_bf16 v[160:175], v[200:203], v[88:91], v[160:175]
    v_mfma_f32_32x32x16_bf16 v[176:191], v[204:207], v[88:91], v[176:191]
    ds_read_b64_tr_b16 v[192:193], v7 offset:20480
    ds_read_b64_tr_b16 v[194:195], v7 offset:20736
    ds_read_b64_tr_b16 v[196:197], v7 offset:49152
    ds_read_b64_tr_b16 v[198:199], v7 offset:49408
    ds_read_b64_tr_b16 v[200:201], v224 offset:20480
    ds_read_b64_tr_b16 v[202:203], v224 offset:20736
    ds_read_b64_tr_b16 v[204:205], v224 offset:49152
    ds_read_b64_tr_b16 v[206:207], v224 offset:49408
    s_waitcnt lgkmcnt(8)
    v_mfma_f32_32x32x16_bf16 v[128:143], v[208:211], v[92:95], v[128:143]
    v_mfma_f32_32x32x16_bf16 v[144:159], v[212:215], v[92:95], v[144:159]
    v_mfma_f32_32x32x16_bf16 v[160:175], v[216:219], v[92:95], v[160:175]
    v_mfma_f32_32x32x16_bf16 v[176:191], v[220:223], v[92:95], v[176:191]
    ds_read_b64_tr_b16 v[208:209], v7 offset:21504
    ds_read_b64_tr_b16 v[210:211], v7 offset:21760
    ds_read_b64_tr_b16 v[212:213], v7 offset:50176
    ds_read_b64_tr_b16 v[214:215], v7 offset:50432
    ds_read_b64_tr_b16 v[216:217], v224 offset:21504
    ds_read_b64_tr_b16 v[218:219], v224 offset:21760
    ds_read_b64_tr_b16 v[220:221], v224 offset:50176
    ds_read_b64_tr_b16 v[222:223], v224 offset:50432
    s_waitcnt lgkmcnt(8)
    v_mfma_f32_32x32x16_bf16 v[128:143], v[192:195], v[96:99], v[128:143]
    v_mfma_f32_32x32x16_bf16 v[144:159], v[196:199], v[96:99], v[144:159]
    v_mfma_f32_32x32x16_bf16 v[160:175], v[200:203], v[96:99], v[160:175]
    v_mfma_f32_32x32x16_bf16 v[176:191], v[204:207], v[96:99], v[176:191]
    ds_read_b64_tr_b16 v[192:193], v7 offset:22528
    ds_read_b64_tr_b16 v[194:195], v7 offset:22784
    ds_read_b64_tr_b16 v[196:197], v7 offset:51200
    ds_read_b64_tr_b16 v[198:199], v7 offset:51456
    ds_read_b64_tr_b16 v[200:201], v224 offset:22528
    ds_read_b64_tr_b16 v[202:203], v224 offset:22784
    ds_read_b64_tr_b16 v[204:205], v224 offset:51200
    ds_read_b64_tr_b16 v[206:207], v224 offset:51456
    s_waitcnt lgkmcnt(8)
    v_mfma_f32_32x32x16_bf16 v[128:143], v[208:211], v[100:103], v[128:143]
    v_mfma_f32_32x32x16_bf16 v[144:159], v[212:215], v[100:103], v[144:159]
    v_mfma_f32_32x32x16_bf16 v[160:175], v[216:219], v[100:103], v[160:175]
    v_mfma_f32_32x32x16_bf16 v[176:191], v[220:223], v[100:103], v[176:191]
    ds_read_b64_tr_b16 v[208:209], v7 offset:23552
    ds_read_b64_tr_b16 v[210:211], v7 offset:23808
    ds_read_b64_tr_b16 v[212:213], v7 offset:52224
    ds_read_b64_tr_b16 v[214:215], v7 offset:52480
    ds_read_b64_tr_b16 v[216:217], v224 offset:23552
    ds_read_b64_tr_b16 v[218:219], v224 offset:23808
    ds_read_b64_tr_b16 v[220:221], v224 offset:52224
    ds_read_b64_tr_b16 v[222:223], v224 offset:52480
    s_waitcnt lgkmcnt(8)
    v_mfma_f32_32x32x16_bf16 v[128:143], v[192:195], v[104:107], v[128:143]
    v_mfma_f32_32x32x16_bf16 v[144:159], v[196:199], v[104:107], v[144:159]
    v_mfma_f32_32x32x16_bf16 v[160:175], v[200:203], v[104:107], v[160:175]
    v_mfma_f32_32x32x16_bf16 v[176:191], v[204:207], v[104:107], v[176:191]
    ds_read_b64_tr_b16 v[192:193], v7 offset:24576
    ds_read_b64_tr_b16 v[194:195], v7 offset:24832
    ds_read_b64_tr_b16 v[196:197], v7 offset:53248
    ds_read_b64_tr_b16 v[198:199], v7 offset:53504
    ds_read_b64_tr_b16 v[200:201], v224 offset:24576
    ds_read_b64_tr_b16 v[202:203], v224 offset:24832
    ds_read_b64_tr_b16 v[204:205], v224 offset:53248
    ds_read_b64_tr_b16 v[206:207], v224 offset:53504
    s_waitcnt lgkmcnt(8)
    v_mfma_f32_32x32x16_bf16 v[128:143], v[208:211], v[108:111], v[128:143]
    v_mfma_f32_32x32x16_bf16 v[144:159], v[212:215], v[108:111], v[144:159]
    v_mfma_f32_32x32x16_bf16 v[160:175], v[216:219], v[108:111], v[160:175]
    v_mfma_f32_32x32x16_bf16 v[176:191], v[220:223], v[108:111], v[176:191]
    ds_read_b64_tr_b16 v[208:209], v7 offset:25600
    ds_read_b64_tr_b16 v[210:211], v7 offset:25856
    ds_read_b64_tr_b16 v[212:213], v7 offset:54272
    ds_read_b64_tr_b16 v[214:215], v7 offset:54528
    ds_read_b64_tr_b16 v[216:217], v224 offset:25600
    ds_read_b64_tr_b16 v[218:219], v224 offset:25856
    ds_read_b64_tr_b16 v[220:221], v224 offset:54272
    ds_read_b64_tr_b16 v[222:223], v224 offset:54528
    s_waitcnt lgkmcnt(8)
    v_mfma_f32_32x32x16_bf16 v[128:143], v[192:195], v[112:115], v[128:143]
    v_mfma_f32_32x32x16_bf16 v[144:159], v[196:199], v[112:115], v[144:159]
    v_mfma_f32_32x32x16_bf16 v[160:175], v[200:203], v[112:115], v[160:175]
    v_mfma_f32_32x32x16_bf16 v[176:191], v[204:207], v[112:115], v[176:191]
    ds_read_b64_tr_b16 v[192:193], v7 offset:26624
    ds_read_b64_tr_b16 v[194:195], v7 offset:26880
    ds_read_b64_tr_b16 v[196:197], v7 offset:55296
    ds_read_b64_tr_b16 v[198:199], v7 offset:55552
    ds_read_b64_tr_b16 v[200:201], v224 offset:26624
    ds_read_b64_tr_b16 v[202:203], v224 offset:26880
    ds_read_b64_tr_b16 v[204:205], v224 offset:55296
    ds_read_b64_tr_b16 v[206:207], v224 offset:55552
    s_waitcnt lgkmcnt(8)
    v_mfma_f32_32x32x16_bf16 v[128:143], v[208:211], v[116:119], v[128:143]
    v_mfma_f32_32x32x16_bf16 v[144:159], v[212:215], v[116:119], v[144:159]
    v_mfma_f32_32x32x16_bf16 v[160:175], v[216:219], v[116:119], v[160:175]
    v_mfma_f32_32x32x16_bf16 v[176:191], v[220:223], v[116:119], v[176:191]
    ds_read_b64_tr_b16 v[208:209], v7 offset:27648
    ds_read_b64_tr_b16 v[210:211], v7 offset:27904
    ds_read_b64_tr_b16 v[212:213], v7 offset:56320
    ds_read_b64_tr_b16 v[214:215], v7 offset:56576
    ds_read_b64_tr_b16 v[216:217], v224 offset:27648
    ds_read_b64_tr_b16 v[218:219], v224 offset:27904
    ds_read_b64_tr_b16 v[220:221], v224 offset:56320
    ds_read_b64_tr_b16 v[222:223], v224 offset:56576
    s_waitcnt lgkmcnt(8)
    v_mfma_f32_32x32x16_bf16 v[128:143], v[192:195], v[120:123], v[128:143]
    v_mfma_f32_32x32x16_bf16 v[144:159], v[196:199], v[120:123], v[144:159]
    v_mfma_f32_32x32x16_bf16 v[160:175], v[200:203], v[120:123], v[160:175]
    v_mfma_f32_32x32x16_bf16 v[176:191], v[204:207], v[120:123], v[176:191]
    s_waitcnt lgkmcnt(0)
    v_mfma_f32_32x32x16_bf16 v[128:143], v[208:211], v[124:127], v[128:143]
    v_mfma_f32_32x32x16_bf16 v[144:159], v[212:215], v[124:127], v[144:159]
    v_mfma_f32_32x32x16_bf16 v[160:175], v[216:219], v[124:127], v[160:175]
    v_mfma_f32_32x32x16_bf16 v[176:191], v[220:223], v[124:127], v[176:191]
    s_nop 15
    s_nop 3
    v_lshrrev_b32 v13, 1, v5
    v_lshlrev_b32 v13, 11, v13
    v_and_b32 v14, 1, v5
    v_lshl_add_u32 v13, v14, 8, v13
    s_mov_b32 s35, 0x3e8b97f6
    v_mul_f32 v128, s35, v128
    v_mul_f32 v129, s35, v129
    v_mul_f32 v130, s35, v130
    v_mul_f32 v131, s35, v131
    v_mul_f32 v132, s35, v132
    v_mul_f32 v133, s35, v133
    v_mul_f32 v134, s35, v134
    v_mul_f32 v135, s35, v135
    v_mul_f32 v136, s35, v136
    v_mul_f32 v137, s35, v137
    v_mul_f32 v138, s35, v138
    v_mul_f32 v139, s35, v139
    v_mul_f32 v140, s35, v140
    v_mul_f32 v141, s35, v141
    v_mul_f32 v142, s35, v142
    v_mul_f32 v143, s35, v143
    v_cvt_pk_bf16_f32 v128, v128, v129
    v_cvt_pk_bf16_f32 v129, v130, v131
    v_mov_b32 v14, 0
    v_mov_b32 v15, 8
    v_cndmask_b32 v14, v14, v15, s[30:31]
    v_add_u32 v14, v14, v13
    buffer_store_dwordx2 v[128:129], v14, s[16:19], 0 offen
    v_cvt_pk_bf16_f32 v132, v132, v133
    v_cvt_pk_bf16_f32 v133, v134, v135
    v_mov_b32 v14, 512
    v_mov_b32 v15, 520
    v_cndmask_b32 v14, v14, v15, s[30:31]
    v_add_u32 v14, v14, v13
    buffer_store_dwordx2 v[132:133], v14, s[16:19], 0 offen
    v_cvt_pk_bf16_f32 v136, v136, v137
    v_cvt_pk_bf16_f32 v137, v138, v139
    v_mov_b32 v14, 1024
    v_mov_b32 v15, 1032
    v_cndmask_b32 v14, v14, v15, s[30:31]
    v_add_u32 v14, v14, v13
    buffer_store_dwordx2 v[136:137], v14, s[16:19], 0 offen
    v_cvt_pk_bf16_f32 v140, v140, v141
    v_cvt_pk_bf16_f32 v141, v142, v143
    v_mov_b32 v14, 1536
    v_mov_b32 v15, 16
    v_cndmask_b32 v14, v14, v15, s[30:31]
    v_add_u32 v14, v14, v13
    buffer_store_dwordx2 v[140:141], v14, s[16:19], 0 offen
    v_lshrrev_b32 v13, 1, v5
    v_lshlrev_b32 v13, 11, v13
    v_and_b32 v14, 1, v5
    v_lshl_add_u32 v13, v14, 8, v13
    s_mov_b32 s35, 0x3e8b97f6
    v_mul_f32 v144, s35, v144
    v_mul_f32 v145, s35, v145
    v_mul_f32 v146, s35, v146
    v_mul_f32 v147, s35, v147
    v_mul_f32 v148, s35, v148
    v_mul_f32 v149, s35, v149
    v_mul_f32 v150, s35, v150
    v_mul_f32 v151, s35, v151
    v_mul_f32 v152, s35, v152
    v_mul_f32 v153, s35, v153
    v_mul_f32 v154, s35, v154
    v_mul_f32 v155, s35, v155
    v_mul_f32 v156, s35, v156
    v_mul_f32 v157, s35, v157
    v_mul_f32 v158, s35, v158
    v_mul_f32 v159, s35, v159
    v_cvt_pk_bf16_f32 v144, v144, v145
    v_cvt_pk_bf16_f32 v145, v146, v147
    v_mov_b32 v14, 24
    v_mov_b32 v15, 528
    v_cndmask_b32 v14, v14, v15, s[30:31]
    v_add_u32 v14, v14, v13
    buffer_store_dwordx2 v[144:145], v14, s[16:19], 0 offen
    v_cvt_pk_bf16_f32 v148, v148, v149
    v_cvt_pk_bf16_f32 v149, v150, v151
    v_mov_b32 v14, 536
    v_mov_b32 v15, 1040
    v_cndmask_b32 v14, v14, v15, s[30:31]
    v_add_u32 v14, v14, v13
    buffer_store_dwordx2 v[148:149], v14, s[16:19], 0 offen
    v_cvt_pk_bf16_f32 v152, v152, v153
    v_cvt_pk_bf16_f32 v153, v154, v155
    v_mov_b32 v14, 1048
    v_mov_b32 v15, 1552
    v_cndmask_b32 v14, v14, v15, s[30:31]
    v_add_u32 v14, v14, v13
    buffer_store_dwordx2 v[152:153], v14, s[16:19], 0 offen
    v_cvt_pk_bf16_f32 v156, v156, v157
    v_cvt_pk_bf16_f32 v157, v158, v159
    v_mov_b32 v14, 32
    v_mov_b32 v15, 40
    v_cndmask_b32 v14, v14, v15, s[30:31]
    v_add_u32 v14, v14, v13
    buffer_store_dwordx2 v[156:157], v14, s[16:19], 0 offen
    v_lshrrev_b32 v13, 1, v5
    v_lshlrev_b32 v13, 11, v13
    v_and_b32 v14, 1, v5
    v_lshl_add_u32 v13, v14, 8, v13
    s_mov_b32 s35, 0x3e8b97f6
    v_mul_f32 v160, s35, v160
    v_mul_f32 v161, s35, v161
    v_mul_f32 v162, s35, v162
    v_mul_f32 v163, s35, v163
    v_mul_f32 v164, s35, v164
    v_mul_f32 v165, s35, v165
    v_mul_f32 v166, s35, v166
    v_mul_f32 v167, s35, v167
    v_mul_f32 v168, s35, v168
    v_mul_f32 v169, s35, v169
    v_mul_f32 v170, s35, v170
    v_mul_f32 v171, s35, v171
    v_mul_f32 v172, s35, v172
    v_mul_f32 v173, s35, v173
    v_mul_f32 v174, s35, v174
    v_mul_f32 v175, s35, v175
    v_cvt_pk_bf16_f32 v160, v160, v161
    v_cvt_pk_bf16_f32 v161, v162, v163
    v_mov_b32 v14, 544
    v_mov_b32 v15, 552
    v_cndmask_b32 v14, v14, v15, s[30:31]
    v_add_u32 v14, v14, v13
    buffer_store_dwordx2 v[160:161], v14, s[16:19], 0 offen
    v_cvt_pk_bf16_f32 v164, v164, v165
    v_cvt_pk_bf16_f32 v165, v166, v167
    v_mov_b32 v14, 1056
    v_mov_b32 v15, 1064
    v_cndmask_b32 v14, v14, v15, s[30:31]
    v_add_u32 v14, v14, v13
    buffer_store_dwordx2 v[164:165], v14, s[16:19], 0 offen
    v_cvt_pk_bf16_f32 v168, v168, v169
    v_cvt_pk_bf16_f32 v169, v170, v171
    v_mov_b32 v14, 1568
    v_mov_b32 v15, 48
    v_cndmask_b32 v14, v14, v15, s[30:31]
    v_add_u32 v14, v14, v13
    buffer_store_dwordx2 v[168:169], v14, s[16:19], 0 offen
    v_cvt_pk_bf16_f32 v172, v172, v173
    v_cvt_pk_bf16_f32 v173, v174, v175
    v_mov_b32 v14, 56
    v_mov_b32 v15, 560
    v_cndmask_b32 v14, v14, v15, s[30:31]
    v_add_u32 v14, v14, v13
    buffer_store_dwordx2 v[172:173], v14, s[16:19], 0 offen
    v_lshrrev_b32 v13, 1, v5
    v_lshlrev_b32 v13, 11, v13
    v_and_b32 v14, 1, v5
    v_lshl_add_u32 v13, v14, 8, v13
    s_mov_b32 s35, 0x3e8b97f6
    v_mul_f32 v176, s35, v176
    v_mul_f32 v177, s35, v177
    v_mul_f32 v178, s35, v178
    v_mul_f32 v179, s35, v179
    v_mul_f32 v180, s35, v180
    v_mul_f32 v181, s35, v181
    v_mul_f32 v182, s35, v182
    v_mul_f32 v183, s35, v183
    v_mul_f32 v184, s35, v184
    v_mul_f32 v185, s35, v185
    v_mul_f32 v186, s35, v186
    v_mul_f32 v187, s35, v187
    v_mul_f32 v188, s35, v188
    v_mul_f32 v189, s35, v189
    v_mul_f32 v190, s35, v190
    v_mul_f32 v191, s35, v191
    v_cvt_pk_bf16_f32 v176, v176, v177
    v_cvt_pk_bf16_f32 v177, v178, v179
    v_mov_b32 v14, 568
    v_mov_b32 v15, 1072
    v_cndmask_b32 v14, v14, v15, s[30:31]
    v_add_u32 v14, v14, v13
    buffer_store_dwordx2 v[176:177], v14, s[16:19], 0 offen
    v_cvt_pk_bf16_f32 v180, v180, v181
    v_cvt_pk_bf16_f32 v181, v182, v183
    v_mov_b32 v14, 1080
    v_mov_b32 v15, 1584
    v_cndmask_b32 v14, v14, v15, s[30:31]
    v_add_u32 v14, v14, v13
    buffer_store_dwordx2 v[180:181], v14, s[16:19], 0 offen
    v_cvt_pk_bf16_f32 v184, v184, v185
    v_cvt_pk_bf16_f32 v185, v186, v187
    v_mov_b32 v14, 64
    v_mov_b32 v15, 72
    v_cndmask_b32 v14, v14, v15, s[30:31]
    v_add_u32 v14, v14, v13
    buffer_store_dwordx2 v[184:185], v14, s[16:19], 0 offen
    v_cvt_pk_bf16_f32 v188, v188, v189
    v_cvt_pk_bf16_f32 v189, v190, v191
    v_mov_b32 v14, 576
    v_mov_b32 v15, 584
    v_cndmask_b32 v14, v14, v15, s[30:31]
    v_add_u32 v14, v14, v13
    buffer_store_dwordx2 v[188:189], v14, s[16:19], 0 offen
    s_endpgm
K1_v1:
    s_mov_b32 s12, s38
    s_and_b32 s13, s39, 0xffff
    s_mov_b32 s14, 401408
    s_mov_b32 s15, 0x00020000
    s_movk_i32 s35, 896
    v_lshrrev_b32 v227, 2, v0
    v_mul_lo_u32 v227, v227, s35
    v_and_b32 v14, 3, v0
    v_lshl_add_u32 v227, v14, 4, v227
    s_mov_b32 s35, 256
    buffer_load_dwordx4 v[128:131], v227, s[12:15], s35 offen
    s_mov_b32 s35, 57600
    buffer_load_dwordx4 v[132:135], v227, s[12:15], s35 offen
    s_mov_b32 s35, 114944
    buffer_load_dwordx4 v[136:139], v227, s[12:15], s35 offen
    s_mov_b32 s35, 172288
    buffer_load_dwordx4 v[140:143], v227, s[12:15], s35 offen
    s_mov_b32 s35, 229632
    buffer_load_dwordx4 v[144:147], v227, s[12:15], s35 offen
    s_mov_b32 s35, 286976
    buffer_load_dwordx4 v[148:151], v227, s[12:15], s35 offen
    s_mov_b32 s35, 344320
    buffer_load_dwordx4 v[152:155], v227, s[12:15], s35 offen
    s_mov_b32 s12, s38
    s_and_b32 s13, s39, 0xffff
    s_mov_b32 s14, 401408
    s_mov_b32 s15, 0x00020000
    s_movk_i32 s35, 896
    v_lshrrev_b32 v227, 2, v0
    v_mul_lo_u32 v227, v227, s35
    v_and_b32 v14, 3, v0
    v_lshl_add_u32 v227, v14, 4, v227
    s_mov_b32 s35, 320
    buffer_load_dwordx4 v[156:159], v227, s[12:15], s35 offen
    s_mov_b32 s35, 57664
    buffer_load_dwordx4 v[160:163], v227, s[12:15], s35 offen
    s_mov_b32 s35, 115008
    buffer_load_dwordx4 v[164:167], v227, s[12:15], s35 offen
    s_mov_b32 s35, 172352
    buffer_load_dwordx4 v[168:171], v227, s[12:15], s35 offen
    s_mov_b32 s35, 229696
    buffer_load_dwordx4 v[172:175], v227, s[12:15], s35 offen
    s_mov_b32 s35, 287040
    buffer_load_dwordx4 v[176:179], v227, s[12:15], s35 offen
    s_mov_b32 s35, 344384
    buffer_load_dwordx4 v[180:183], v227, s[12:15], s35 offen
    s_mov_b32 s54, 0x4924925
    v_add_u32 v13, 0, v2
    v_mul_hi_u32 v14, v13, s54
    v_lshlrev_b32 v13, 4, v13
    v_lshl_add_u32 v13, v14, 4, v13
    v_add_u32 v13, s53, v13
    s_waitcnt vmcnt(41)
    ds_write_b128 v13, v[16:19]
    v_add_u32 v13, 64, v2
    v_mul_hi_u32 v14, v13, s54
    v_lshlrev_b32 v13, 4, v13
    v_lshl_add_u32 v13, v14, 4, v13
    v_add_u32 v13, s53, v13
    s_waitcnt vmcnt(40)
    ds_write_b128 v13, v[20:23]
    v_add_u32 v13, 128, v2
    v_mul_hi_u32 v14, v13, s54
    v_lshlrev_b32 v13, 4, v13
    v_lshl_add_u32 v13, v14, 4, v13
    v_add_u32 v13, s53, v13
    s_waitcnt vmcnt(39)
    ds_write_b128 v13, v[24:27]
    v_add_u32 v13, 192, v2
    v_mul_hi_u32 v14, v13, s54
    v_lshlrev_b32 v13, 4, v13
    v_lshl_add_u32 v13, v14, 4, v13
    v_add_u32 v13, s53, v13
    s_waitcnt vmcnt(38)
    ds_write_b128 v13, v[28:31]
    v_add_u32 v13, 256, v2
    v_mul_hi_u32 v14, v13, s54
    v_lshlrev_b32 v13, 4, v13
    v_lshl_add_u32 v13, v14, 4, v13
    v_add_u32 v13, s53, v13
    s_waitcnt vmcnt(37)
    ds_write_b128 v13, v[32:35]
    v_add_u32 v13, 320, v2
    v_mul_hi_u32 v14, v13, s54
    v_lshlrev_b32 v13, 4, v13
    v_lshl_add_u32 v13, v14, 4, v13
    v_add_u32 v13, s53, v13
    s_waitcnt vmcnt(36)
    ds_write_b128 v13, v[36:39]
    v_add_u32 v13, 384, v2
    v_mul_hi_u32 v14, v13, s54
    v_lshlrev_b32 v13, 4, v13
    v_lshl_add_u32 v13, v14, 4, v13
    v_add_u32 v13, s53, v13
    s_waitcnt vmcnt(35)
    ds_write_b128 v13, v[40:43]
    v_add_u32 v13, 448, v2
    v_mul_hi_u32 v14, v13, s54
    v_lshlrev_b32 v13, 4, v13
    v_lshl_add_u32 v13, v14, 4, v13
    v_add_u32 v13, s53, v13
    s_waitcnt vmcnt(34)
    ds_write_b128 v13, v[44:47]
    v_add_u32 v13, 512, v2
    v_mul_hi_u32 v14, v13, s54
    v_lshlrev_b32 v13, 4, v13
    v_lshl_add_u32 v13, v14, 4, v13
    v_add_u32 v13, s53, v13
    s_waitcnt vmcnt(33)
    ds_write_b128 v13, v[48:51]
    v_add_u32 v13, 576, v2
    v_mul_hi_u32 v14, v13, s54
    v_lshlrev_b32 v13, 4, v13
    v_lshl_add_u32 v13, v14, 4, v13
    v_add_u32 v13, s53, v13
    s_waitcnt vmcnt(32)
    ds_write_b128 v13, v[52:55]
    v_add_u32 v13, 640, v2
    v_mul_hi_u32 v14, v13, s54
    v_lshlrev_b32 v13, 4, v13
    v_lshl_add_u32 v13, v14, 4, v13
    v_add_u32 v13, s53, v13
    s_waitcnt vmcnt(31)
    ds_write_b128 v13, v[56:59]
    v_add_u32 v13, 704, v2
    v_mul_hi_u32 v14, v13, s54
    v_lshlrev_b32 v13, 4, v13
    v_lshl_add_u32 v13, v14, 4, v13
    v_add_u32 v13, s53, v13
    s_waitcnt vmcnt(30)
    ds_write_b128 v13, v[60:63]
    v_add_u32 v13, 768, v2
    v_mul_hi_u32 v14, v13, s54
    v_lshlrev_b32 v13, 4, v13
    v_lshl_add_u32 v13, v14, 4, v13
    v_add_u32 v13, s53, v13
    s_waitcnt vmcnt(29)
    ds_write_b128 v13, v[64:67]
    v_add_u32 v13, 832, v2
    v_mul_hi_u32 v14, v13, s54
    v_lshlrev_b32 v13, 4, v13
    v_lshl_add_u32 v13, v14, 4, v13
    v_add_u32 v13, s53, v13
    s_waitcnt vmcnt(28)
    ds_write_b128 v13, v[68:71]
    v_add_u32 v13, 896, v2
    v_mul_hi_u32 v14, v13, s54
    v_lshlrev_b32 v13, 4, v13
    v_lshl_add_u32 v13, v14, 4, v13
    v_add_u32 v13, s53, v13
    s_waitcnt vmcnt(27)
    ds_write_b128 v13, v[72:75]
    v_add_u32 v13, 960, v2
    v_mul_hi_u32 v14, v13, s54
    v_lshlrev_b32 v13, 4, v13
    v_lshl_add_u32 v13, v14, 4, v13
    v_add_u32 v13, s53, v13
    s_waitcnt vmcnt(26)
    ds_write_b128 v13, v[76:79]
    v_add_u32 v13, 1024, v2
    v_mul_hi_u32 v14, v13, s54
    v_lshlrev_b32 v13, 4, v13
    v_lshl_add_u32 v13, v14, 4, v13
    v_add_u32 v13, s53, v13
    s_waitcnt vmcnt(25)
    ds_write_b128 v13, v[80:83]
    v_add_u32 v13, 1088, v2
    v_mul_hi_u32 v14, v13, s54
    v_lshlrev_b32 v13, 4, v13
    v_lshl_add_u32 v13, v14, 4, v13
    v_add_u32 v13, s53, v13
    s_waitcnt vmcnt(24)
    ds_write_b128 v13, v[84:87]
    v_add_u32 v13, 1152, v2
    v_mul_hi_u32 v14, v13, s54
    v_lshlrev_b32 v13, 4, v13
    v_lshl_add_u32 v13, v14, 4, v13
    v_add_u32 v13, s53, v13
    s_waitcnt vmcnt(23)
    ds_write_b128 v13, v[88:91]
    v_add_u32 v13, 1216, v2
    v_mul_hi_u32 v14, v13, s54
    v_lshlrev_b32 v13, 4, v13
    v_lshl_add_u32 v13, v14, 4, v13
    v_add_u32 v13, s53, v13
    s_waitcnt vmcnt(22)
    ds_write_b128 v13, v[92:95]
    v_add_u32 v13, 1280, v2
    v_mul_hi_u32 v14, v13, s54
    v_lshlrev_b32 v13, 4, v13
    v_lshl_add_u32 v13, v14, 4, v13
    v_add_u32 v13, s53, v13
    s_waitcnt vmcnt(21)
    ds_write_b128 v13, v[96:99]
    v_add_u32 v13, 1344, v2
    v_mul_hi_u32 v14, v13, s54
    v_lshlrev_b32 v13, 4, v13
    v_lshl_add_u32 v13, v14, 4, v13
    v_add_u32 v13, s53, v13
    s_waitcnt vmcnt(20)
    ds_write_b128 v13, v[100:103]
    v_add_u32 v13, 1408, v2
    v_mul_hi_u32 v14, v13, s54
    v_lshlrev_b32 v13, 4, v13
    v_lshl_add_u32 v13, v14, 4, v13
    v_add_u32 v13, s53, v13
    s_waitcnt vmcnt(19)
    ds_write_b128 v13, v[104:107]
    v_add_u32 v13, 1472, v2
    v_mul_hi_u32 v14, v13, s54
    v_lshlrev_b32 v13, 4, v13
    v_lshl_add_u32 v13, v14, 4, v13
    v_add_u32 v13, s53, v13
    s_waitcnt vmcnt(18)
    ds_write_b128 v13, v[108:111]
    v_add_u32 v13, 1536, v2
    v_mul_hi_u32 v14, v13, s54
    v_lshlrev_b32 v13, 4, v13
    v_lshl_add_u32 v13, v14, 4, v13
    v_add_u32 v13, s53, v13
    s_waitcnt vmcnt(17)
    ds_write_b128 v13, v[112:115]
    v_add_u32 v13, 1600, v2
    v_mul_hi_u32 v14, v13, s54
    v_lshlrev_b32 v13, 4, v13
    v_lshl_add_u32 v13, v14, 4, v13
    v_add_u32 v13, s53, v13
    s_waitcnt vmcnt(16)
    ds_write_b128 v13, v[116:119]
    v_add_u32 v13, 1664, v2
    v_mul_hi_u32 v14, v13, s54
    v_lshlrev_b32 v13, 4, v13
    v_lshl_add_u32 v13, v14, 4, v13
    v_add_u32 v13, s53, v13
    s_waitcnt vmcnt(15)
    ds_write_b128 v13, v[120:123]
    v_add_u32 v13, 1728, v2
    v_mul_hi_u32 v14, v13, s54
    v_lshlrev_b32 v13, 4, v13
    v_lshl_add_u32 v13, v14, 4, v13
    v_add_u32 v13, s53, v13
    s_waitcnt vmcnt(14)
    ds_write_b128 v13, v[124:127]
    v_mul_u32_u24 v13, 912, v3
    v_lshl_add_u32 v13, v4, 4, v13
    v_add_u32 v13, s53, v13
    s_waitcnt lgkmcnt(0)
    ds_read_b128 v[16:19], v13 offset:0
    ds_read_b128 v[20:23], v13 offset:32
    ds_read_b128 v[24:27], v13 offset:64
    ds_read_b128 v[28:31], v13 offset:96
    ds_read_b128 v[32:35], v13 offset:128
    ds_read_b128 v[36:39], v13 offset:160
    ds_read_b128 v[40:43], v13 offset:192
    ds_read_b128 v[44:47], v13 offset:224
    ds_read_b128 v[48:51], v13 offset:256
    ds_read_b128 v[52:55], v13 offset:288
    ds_read_b128 v[56:59], v13 offset:320
    ds_read_b128 v[60:63], v13 offset:352
    ds_read_b128 v[64:67], v13 offset:384
    ds_read_b128 v[68:71], v13 offset:416
    ds_read_b128 v[72:75], v13 offset:448
    ds_read_b128 v[76:79], v13 offset:480
    ds_read_b128 v[80:83], v13 offset:512
    ds_read_b128 v[84:87], v13 offset:544
    ds_read_b128 v[88:91], v13 offset:576
    ds_read_b128 v[92:95], v13 offset:608
    ds_read_b128 v[96:99], v13 offset:640
    ds_read_b128 v[100:103], v13 offset:672
    ds_read_b128 v[104:107], v13 offset:704
    ds_read_b128 v[108:111], v13 offset:736
    ds_read_b128 v[112:115], v13 offset:768
    ds_read_b128 v[116:119], v13 offset:800
    ds_read_b128 v[120:123], v13 offset:832
    ds_read_b128 v[124:127], v13 offset:864
    s_waitcnt lgkmcnt(0)
    s_barrier
    s_waitcnt vmcnt(13)
    ds_write_b128 v11, v[128:131] offset:0
    s_waitcnt vmcnt(12)
    ds_write_b128 v11, v[132:135] offset:4096
    s_waitcnt vmcnt(11)
    ds_write_b128 v11, v[136:139] offset:8192
    s_waitcnt vmcnt(10)
    ds_write_b128 v11, v[140:143] offset:12288
    s_waitcnt vmcnt(9)
    ds_write_b128 v11, v[144:147] offset:16384
    s_waitcnt vmcnt(8)
    ds_write_b128 v11, v[148:151] offset:20480
    s_waitcnt vmcnt(7)
    ds_write_b128 v11, v[152:155] offset:24576
    s_waitcnt vmcnt(6)
    ds_write_b128 v11, v[156:159] offset:28672
    s_waitcnt vmcnt(5)
    ds_write_b128 v11, v[160:163] offset:32768
    s_waitcnt vmcnt(4)
    ds_write_b128 v11, v[164:167] offset:36864
    s_waitcnt vmcnt(3)
    ds_write_b128 v11, v[168:171] offset:40960
    s_waitcnt vmcnt(2)
    ds_write_b128 v11, v[172:175] offset:45056
    s_waitcnt vmcnt(1)
    ds_write_b128 v11, v[176:179] offset:49152
    s_waitcnt vmcnt(0)
    ds_write_b128 v11, v[180:183] offset:53248
    s_mov_b32 s12, s38
    s_and_b32 s13, s39, 0xffff
    s_mov_b32 s14, 401408
    s_mov_b32 s15, 0x00020000
    s_movk_i32 s35, 896
    v_lshrrev_b32 v13, 2, v0
    v_mul_lo_u32 v13, v13, s35
    v_and_b32 v14, 3, v0
    v_lshl_add_u32 v13, v14, 4, v13
    s_mov_b32 s35, 384
    buffer_load_dwordx4 v[128:131], v13, s[12:15], s35 offen
    s_mov_b32 s35, 57728
    buffer_load_dwordx4 v[132:135], v13, s[12:15], s35 offen
    s_mov_b32 s35, 115072
    buffer_load_dwordx4 v[136:139], v13, s[12:15], s35 offen
    s_mov_b32 s35, 172416
    buffer_load_dwordx4 v[140:143], v13, s[12:15], s35 offen
    s_mov_b32 s35, 229760
    buffer_load_dwordx4 v[144:147], v13, s[12:15], s35 offen
    s_mov_b32 s35, 287104
    buffer_load_dwordx4 v[148:151], v13, s[12:15], s35 offen
    s_mov_b32 s35, 344448
    buffer_load_dwordx4 v[152:155], v13, s[12:15], s35 offen
    s_waitcnt vmcnt(6)
    ds_write_b128 v225, v[128:131] offset:0
    s_waitcnt vmcnt(5)
    ds_write_b128 v225, v[132:135] offset:4096
    s_waitcnt vmcnt(4)
    ds_write_b128 v225, v[136:139] offset:8192
    s_waitcnt vmcnt(3)
    ds_write_b128 v225, v[140:143] offset:12288
    s_waitcnt vmcnt(2)
    ds_write_b128 v225, v[144:147] offset:16384
    s_waitcnt vmcnt(1)
    ds_write_b128 v225, v[148:151] offset:20480
    s_waitcnt vmcnt(0)
    ds_write_b128 v225, v[152:155] offset:24576
    s_mov_b32 s12, s38
    s_and_b32 s13, s39, 0xffff
    s_mov_b32 s14, 401408
    s_mov_b32 s15, 0x00020000
    s_movk_i32 s35, 896
    v_lshrrev_b32 v13, 2, v0
    v_mul_lo_u32 v13, v13, s35
    v_and_b32 v14, 3, v0
    v_lshl_add_u32 v13, v14, 4, v13
    s_mov_b32 s35, 448
    buffer_load_dwordx4 v[128:131], v13, s[12:15], s35 offen
    s_mov_b32 s35, 57792
    buffer_load_dwordx4 v[132:135], v13, s[12:15], s35 offen
    s_mov_b32 s35, 115136
    buffer_load_dwordx4 v[136:139], v13, s[12:15], s35 offen
    s_mov_b32 s35, 172480
    buffer_load_dwordx4 v[140:143], v13, s[12:15], s35 offen
    s_mov_b32 s35, 229824
    buffer_load_dwordx4 v[144:147], v13, s[12:15], s35 offen
    s_mov_b32 s35, 287168
    buffer_load_dwordx4 v[148:151], v13, s[12:15], s35 offen
    s_mov_b32 s35, 344512
    buffer_load_dwordx4 v[152:155], v13, s[12:15], s35 offen
    s_waitcnt vmcnt(6)
    ds_write_b128 v225, v[128:131] offset:28672
    s_waitcnt vmcnt(5)
    ds_write_b128 v225, v[132:135] offset:32768
    s_waitcnt vmcnt(4)
    ds_write_b128 v225, v[136:139] offset:36864
    s_waitcnt vmcnt(3)
    ds_write_b128 v225, v[140:143] offset:40960
    s_waitcnt vmcnt(2)
    ds_write_b128 v225, v[144:147] offset:45056
    s_waitcnt vmcnt(1)
    ds_write_b128 v225, v[148:151] offset:49152
    s_waitcnt vmcnt(0)
    ds_write_b128 v225, v[152:155] offset:53248
    s_waitcnt lgkmcnt(0)
    s_barrier
    ds_read_b64_tr_b16 v[192:193], v7 offset:0
    ds_read_b64_tr_b16 v[194:195], v7 offset:256
    ds_read_b64_tr_b16 v[196:197], v7 offset:28672
    ds_read_b64_tr_b16 v[198:199], v7 offset:28928
    ds_read_b64_tr_b16 v[200:201], v224 offset:0
    ds_read_b64_tr_b16 v[202:203], v224 offset:256
    ds_read_b64_tr_b16 v[204:205], v224 offset:28672
    ds_read_b64_tr_b16 v[206:207], v224 offset:28928
    ds_read_b64_tr_b16 v[208:209], v7 offset:1024
    ds_read_b64_tr_b16 v[210:211], v7 offset:1280
    ds_read_b64_tr_b16 v[212:213], v7 offset:29696
    ds_read_b64_tr_b16 v[214:215], v7 offset:29952
    ds_read_b64_tr_b16 v[216:217], v224 offset:1024
    ds_read_b64_tr_b16 v[218:219], v224 offset:1280
    ds_read_b64_tr_b16 v[220:221], v224 offset:29696
    ds_read_b64_tr_b16 v[222:223], v224 offset:29952
    s_waitcnt lgkmcnt(8)
    v_mfma_f32_32x32x16_bf16 v[128:143], v[192:195], v[16:19], 0
    v_mfma_f32_32x32x16_bf16 v[144:159], v[196:199], v[16:19], 0
    v_mfma_f32_32x32x16_bf16 v[160:175], v[200:203], v[16:19], 0
    v_mfma_f32_32x32x16_bf16 v[176:191], v[204:207], v[16:19], 0
    ds_read_b64_tr_b16 v[192:193], v7 offset:2048
    ds_read_b64_tr_b16 v[194:195], v7 offset:2304
    ds_read_b64_tr_b16 v[196:197], v7 offset:30720
    ds_read_b64_tr_b16 v[198:199], v7 offset:30976
    ds_read_b64_tr_b16 v[200:201], v224 offset:2048
    ds_read_b64_tr_b16 v[202:203], v224 offset:2304
    ds_read_b64_tr_b16 v[204:205], v224 offset:30720
    ds_read_b64_tr_b16 v[206:207], v224 offset:30976
    s_waitcnt lgkmcnt(8)
    v_mfma_f32_32x32x16_bf16 v[128:143], v[208:211], v[20:23], v[128:143]
    v_mfma_f32_32x32x16_bf16 v[144:159], v[212:215], v[20:23], v[144:159]
    v_mfma_f32_32x32x16_bf16 v[160:175], v[216:219], v[20:23], v[160:175]
    v_mfma_f32_32x32x16_bf16 v[176:191], v[220:223], v[20:23], v[176:191]
    ds_read_b64_tr_b16 v[208:209], v7 offset:3072
    ds_read_b64_tr_b16 v[210:211], v7 offset:3328
    ds_read_b64_tr_b16 v[212:213], v7 offset:31744
    ds_read_b64_tr_b16 v[214:215], v7 offset:32000
    ds_read_b64_tr_b16 v[216:217], v224 offset:3072
    ds_read_b64_tr_b16 v[218:219], v224 offset:3328
    ds_read_b64_tr_b16 v[220:221], v224 offset:31744
    ds_read_b64_tr_b16 v[222:223], v224 offset:32000
    s_waitcnt lgkmcnt(8)
    v_mfma_f32_32x32x16_bf16 v[128:143], v[192:195], v[24:27], v[128:143]
    v_mfma_f32_32x32x16_bf16 v[144:159], v[196:199], v[24:27], v[144:159]
    v_mfma_f32_32x32x16_bf16 v[160:175], v[200:203], v[24:27], v[160:175]
    v_mfma_f32_32x32x16_bf16 v[176:191], v[204:207], v[24:27], v[176:191]
    ds_read_b64_tr_b16 v[192:193], v7 offset:4096
    ds_read_b64_tr_b16 v[194:195], v7 offset:4352
    ds_read_b64_tr_b16 v[196:197], v7 offset:32768
    ds_read_b64_tr_b16 v[198:199], v7 offset:33024
    ds_read_b64_tr_b16 v[200:201], v224 offset:4096
    ds_read_b64_tr_b16 v[202:203], v224 offset:4352
    ds_read_b64_tr_b16 v[204:205], v224 offset:32768
    ds_read_b64_tr_b16 v[206:207], v224 offset:33024
    s_waitcnt lgkmcnt(8)
    v_mfma_f32_32x32x16_bf16 v[128:143], v[208:211], v[28:31], v[128:143]
    v_mfma_f32_32x32x16_bf16 v[144:159], v[212:215], v[28:31], v[144:159]
    v_mfma_f32_32x32x16_bf16 v[160:175], v[216:219], v[28:31], v[160:175]
    v_mfma_f32_32x32x16_bf16 v[176:191], v[220:223], v[28:31], v[176:191]
    ds_read_b64_tr_b16 v[208:209], v7 offset:5120
    ds_read_b64_tr_b16 v[210:211], v7 offset:5376
    ds_read_b64_tr_b16 v[212:213], v7 offset:33792
    ds_read_b64_tr_b16 v[214:215], v7 offset:34048
    ds_read_b64_tr_b16 v[216:217], v224 offset:5120
    ds_read_b64_tr_b16 v[218:219], v224 offset:5376
    ds_read_b64_tr_b16 v[220:221], v224 offset:33792
    ds_read_b64_tr_b16 v[222:223], v224 offset:34048
    s_waitcnt lgkmcnt(8)
    v_mfma_f32_32x32x16_bf16 v[128:143], v[192:195], v[32:35], v[128:143]
    v_mfma_f32_32x32x16_bf16 v[144:159], v[196:199], v[32:35], v[144:159]
    v_mfma_f32_32x32x16_bf16 v[160:175], v[200:203], v[32:35], v[160:175]
    v_mfma_f32_32x32x16_bf16 v[176:191], v[204:207], v[32:35], v[176:191]
    ds_read_b64_tr_b16 v[192:193], v7 offset:6144
    ds_read_b64_tr_b16 v[194:195], v7 offset:6400
    ds_read_b64_tr_b16 v[196:197], v7 offset:34816
    ds_read_b64_tr_b16 v[198:199], v7 offset:35072
    ds_read_b64_tr_b16 v[200:201], v224 offset:6144
    ds_read_b64_tr_b16 v[202:203], v224 offset:6400
    ds_read_b64_tr_b16 v[204:205], v224 offset:34816
    ds_read_b64_tr_b16 v[206:207], v224 offset:35072
    s_waitcnt lgkmcnt(8)
    v_mfma_f32_32x32x16_bf16 v[128:143], v[208:211], v[36:39], v[128:143]
    v_mfma_f32_32x32x16_bf16 v[144:159], v[212:215], v[36:39], v[144:159]
    v_mfma_f32_32x32x16_bf16 v[160:175], v[216:219], v[36:39], v[160:175]
    v_mfma_f32_32x32x16_bf16 v[176:191], v[220:223], v[36:39], v[176:191]
    ds_read_b64_tr_b16 v[208:209], v7 offset:7168
    ds_read_b64_tr_b16 v[210:211], v7 offset:7424
    ds_read_b64_tr_b16 v[212:213], v7 offset:35840
    ds_read_b64_tr_b16 v[214:215], v7 offset:36096
    ds_read_b64_tr_b16 v[216:217], v224 offset:7168
    ds_read_b64_tr_b16 v[218:219], v224 offset:7424
    ds_read_b64_tr_b16 v[220:221], v224 offset:35840
    ds_read_b64_tr_b16 v[222:223], v224 offset:36096
    s_waitcnt lgkmcnt(8)
    v_mfma_f32_32x32x16_bf16 v[128:143], v[192:195], v[40:43], v[128:143]
    v_mfma_f32_32x32x16_bf16 v[144:159], v[196:199], v[40:43], v[144:159]
    v_mfma_f32_32x32x16_bf16 v[160:175], v[200:203], v[40:43], v[160:175]
    v_mfma_f32_32x32x16_bf16 v[176:191], v[204:207], v[40:43], v[176:191]
    ds_read_b64_tr_b16 v[192:193], v7 offset:8192
    ds_read_b64_tr_b16 v[194:195], v7 offset:8448
    ds_read_b64_tr_b16 v[196:197], v7 offset:36864
    ds_read_b64_tr_b16 v[198:199], v7 offset:37120
    ds_read_b64_tr_b16 v[200:201], v224 offset:8192
    ds_read_b64_tr_b16 v[202:203], v224 offset:8448
    ds_read_b64_tr_b16 v[204:205], v224 offset:36864
    ds_read_b64_tr_b16 v[206:207], v224 offset:37120
    s_waitcnt lgkmcnt(8)
    v_mfma_f32_32x32x16_bf16 v[128:143], v[208:211], v[44:47], v[128:143]
    v_mfma_f32_32x32x16_bf16 v[144:159], v[212:215], v[44:47], v[144:159]
    v_mfma_f32_32x32x16_bf16 v[160:175], v[216:219], v[44:47], v[160:175]
    v_mfma_f32_32x32x16_bf16 v[176:191], v[220:223], v[44:47], v[176:191]
    ds_read_b64_tr_b16 v[208:209], v7 offset:9216
    ds_read_b64_tr_b16 v[210:211], v7 offset:9472
    ds_read_b64_tr_b16 v[212:213], v7 offset:37888
    ds_read_b64_tr_b16 v[214:215], v7 offset:38144
    ds_read_b64_tr_b16 v[216:217], v224 offset:9216
    ds_read_b64_tr_b16 v[218:219], v224 offset:9472
    ds_read_b64_tr_b16 v[220:221], v224 offset:37888
    ds_read_b64_tr_b16 v[222:223], v224 offset:38144
    s_waitcnt lgkmcnt(8)
    v_mfma_f32_32x32x16_bf16 v[128:143], v[192:195], v[48:51], v[128:143]
    v_mfma_f32_32x32x16_bf16 v[144:159], v[196:199], v[48:51], v[144:159]
    v_mfma_f32_32x32x16_bf16 v[160:175], v[200:203], v[48:51], v[160:175]
    v_mfma_f32_32x32x16_bf16 v[176:191], v[204:207], v[48:51], v[176:191]
    ds_read_b64_tr_b16 v[192:193], v7 offset:10240
    ds_read_b64_tr_b16 v[194:195], v7 offset:10496
    ds_read_b64_tr_b16 v[196:197], v7 offset:38912
    ds_read_b64_tr_b16 v[198:199], v7 offset:39168
    ds_read_b64_tr_b16 v[200:201], v224 offset:10240
    ds_read_b64_tr_b16 v[202:203], v224 offset:10496
    ds_read_b64_tr_b16 v[204:205], v224 offset:38912
    ds_read_b64_tr_b16 v[206:207], v224 offset:39168
    s_waitcnt lgkmcnt(8)
    v_mfma_f32_32x32x16_bf16 v[128:143], v[208:211], v[52:55], v[128:143]
    v_mfma_f32_32x32x16_bf16 v[144:159], v[212:215], v[52:55], v[144:159]
    v_mfma_f32_32x32x16_bf16 v[160:175], v[216:219], v[52:55], v[160:175]
    v_mfma_f32_32x32x16_bf16 v[176:191], v[220:223], v[52:55], v[176:191]
    ds_read_b64_tr_b16 v[208:209], v7 offset:11264
    ds_read_b64_tr_b16 v[210:211], v7 offset:11520
    ds_read_b64_tr_b16 v[212:213], v7 offset:39936
    ds_read_b64_tr_b16 v[214:215], v7 offset:40192
    ds_read_b64_tr_b16 v[216:217], v224 offset:11264
    ds_read_b64_tr_b16 v[218:219], v224 offset:11520
    ds_read_b64_tr_b16 v[220:221], v224 offset:39936
    ds_read_b64_tr_b16 v[222:223], v224 offset:40192
    s_waitcnt lgkmcnt(8)
    v_mfma_f32_32x32x16_bf16 v[128:143], v[192:195], v[56:59], v[128:143]
    v_mfma_f32_32x32x16_bf16 v[144:159], v[196:199], v[56:59], v[144:159]
    v_mfma_f32_32x32x16_bf16 v[160:175], v[200:203], v[56:59], v[160:175]
    v_mfma_f32_32x32x16_bf16 v[176:191], v[204:207], v[56:59], v[176:191]
    ds_read_b64_tr_b16 v[192:193], v7 offset:12288
    ds_read_b64_tr_b16 v[194:195], v7 offset:12544
    ds_read_b64_tr_b16 v[196:197], v7 offset:40960
    ds_read_b64_tr_b16 v[198:199], v7 offset:41216
    ds_read_b64_tr_b16 v[200:201], v224 offset:12288
    ds_read_b64_tr_b16 v[202:203], v224 offset:12544
    ds_read_b64_tr_b16 v[204:205], v224 offset:40960
    ds_read_b64_tr_b16 v[206:207], v224 offset:41216
    s_waitcnt lgkmcnt(8)
    v_mfma_f32_32x32x16_bf16 v[128:143], v[208:211], v[60:63], v[128:143]
    v_mfma_f32_32x32x16_bf16 v[144:159], v[212:215], v[60:63], v[144:159]
    v_mfma_f32_32x32x16_bf16 v[160:175], v[216:219], v[60:63], v[160:175]
    v_mfma_f32_32x32x16_bf16 v[176:191], v[220:223], v[60:63], v[176:191]
    ds_read_b64_tr_b16 v[208:209], v7 offset:13312
    ds_read_b64_tr_b16 v[210:211], v7 offset:13568
    ds_read_b64_tr_b16 v[212:213], v7 offset:41984
    ds_read_b64_tr_b16 v[214:215], v7 offset:42240
    ds_read_b64_tr_b16 v[216:217], v224 offset:13312
    ds_read_b64_tr_b16 v[218:219], v224 offset:13568
    ds_read_b64_tr_b16 v[220:221], v224 offset:41984
    ds_read_b64_tr_b16 v[222:223], v224 offset:42240
    s_waitcnt lgkmcnt(8)
    v_mfma_f32_32x32x16_bf16 v[128:143], v[192:195], v[64:67], v[128:143]
    v_mfma_f32_32x32x16_bf16 v[144:159], v[196:199], v[64:67], v[144:159]
    v_mfma_f32_32x32x16_bf16 v[160:175], v[200:203], v[64:67], v[160:175]
    v_mfma_f32_32x32x16_bf16 v[176:191], v[204:207], v[64:67], v[176:191]
    ds_read_b64_tr_b16 v[192:193], v7 offset:14336
    ds_read_b64_tr_b16 v[194:195], v7 offset:14592
    ds_read_b64_tr_b16 v[196:197], v7 offset:43008
    ds_read_b64_tr_b16 v[198:199], v7 offset:43264
    ds_read_b64_tr_b16 v[200:201], v224 offset:14336
    ds_read_b64_tr_b16 v[202:203], v224 offset:14592
    ds_read_b64_tr_b16 v[204:205], v224 offset:43008
    ds_read_b64_tr_b16 v[206:207], v224 offset:43264
    s_waitcnt lgkmcnt(8)
    v_mfma_f32_32x32x16_bf16 v[128:143], v[208:211], v[68:71], v[128:143]
    v_mfma_f32_32x32x16_bf16 v[144:159], v[212:215], v[68:71], v[144:159]
    v_mfma_f32_32x32x16_bf16 v[160:175], v[216:219], v[68:71], v[160:175]
    v_mfma_f32_32x32x16_bf16 v[176:191], v[220:223], v[68:71], v[176:191]
    ds_read_b64_tr_b16 v[208:209], v7 offset:15360
    ds_read_b64_tr_b16 v[210:211], v7 offset:15616
    ds_read_b64_tr_b16 v[212:213], v7 offset:44032
    ds_read_b64_tr_b16 v[214:215], v7 offset:44288
    ds_read_b64_tr_b16 v[216:217], v224 offset:15360
    ds_read_b64_tr_b16 v[218:219], v224 offset:15616
    ds_read_b64_tr_b16 v[220:221], v224 offset:44032
    ds_read_b64_tr_b16 v[222:223], v224 offset:44288
    s_waitcnt lgkmcnt(8)
    v_mfma_f32_32x32x16_bf16 v[128:143], v[192:195], v[72:75], v[128:143]
    v_mfma_f32_32x32x16_bf16 v[144:159], v[196:199], v[72:75], v[144:159]
    v_mfma_f32_32x32x16_bf16 v[160:175], v[200:203], v[72:75], v[160:175]
    v_mfma_f32_32x32x16_bf16 v[176:191], v[204:207], v[72:75], v[176:191]
    ds_read_b64_tr_b16 v[192:193], v7 offset:16384
    ds_read_b64_tr_b16 v[194:195], v7 offset:16640
    ds_read_b64_tr_b16 v[196:197], v7 offset:45056
    ds_read_b64_tr_b16 v[198:199], v7 offset:45312
    ds_read_b64_tr_b16 v[200:201], v224 offset:16384
    ds_read_b64_tr_b16 v[202:203], v224 offset:16640
    ds_read_b64_tr_b16 v[204:205], v224 offset:45056
    ds_read_b64_tr_b16 v[206:207], v224 offset:45312
    s_waitcnt lgkmcnt(8)
    v_mfma_f32_32x32x16_bf16 v[128:143], v[208:211], v[76:79], v[128:143]
    v_mfma_f32_32x32x16_bf16 v[144:159], v[212:215], v[76:79], v[144:159]
    v_mfma_f32_32x32x16_bf16 v[160:175], v[216:219], v[76:79], v[160:175]
    v_mfma_f32_32x32x16_bf16 v[176:191], v[220:223], v[76:79], v[176:191]
    ds_read_b64_tr_b16 v[208:209], v7 offset:17408
    ds_read_b64_tr_b16 v[210:211], v7 offset:17664
    ds_read_b64_tr_b16 v[212:213], v7 offset:46080
    ds_read_b64_tr_b16 v[214:215], v7 offset:46336
    ds_read_b64_tr_b16 v[216:217], v224 offset:17408
    ds_read_b64_tr_b16 v[218:219], v224 offset:17664
    ds_read_b64_tr_b16 v[220:221], v224 offset:46080
    ds_read_b64_tr_b16 v[222:223], v224 offset:46336
    s_waitcnt lgkmcnt(8)
    v_mfma_f32_32x32x16_bf16 v[128:143], v[192:195], v[80:83], v[128:143]
    v_mfma_f32_32x32x16_bf16 v[144:159], v[196:199], v[80:83], v[144:159]
    v_mfma_f32_32x32x16_bf16 v[160:175], v[200:203], v[80:83], v[160:175]
    v_mfma_f32_32x32x16_bf16 v[176:191], v[204:207], v[80:83], v[176:191]
    ds_read_b64_tr_b16 v[192:193], v7 offset:18432
    ds_read_b64_tr_b16 v[194:195], v7 offset:18688
    ds_read_b64_tr_b16 v[196:197], v7 offset:47104
    ds_read_b64_tr_b16 v[198:199], v7 offset:47360
    ds_read_b64_tr_b16 v[200:201], v224 offset:18432
    ds_read_b64_tr_b16 v[202:203], v224 offset:18688
    ds_read_b64_tr_b16 v[204:205], v224 offset:47104
    ds_read_b64_tr_b16 v[206:207], v224 offset:47360
    s_waitcnt lgkmcnt(8)
    v_mfma_f32_32x32x16_bf16 v[128:143], v[208:211], v[84:87], v[128:143]
    v_mfma_f32_32x32x16_bf16 v[144:159], v[212:215], v[84:87], v[144:159]
    v_mfma_f32_32x32x16_bf16 v[160:175], v[216:219], v[84:87], v[160:175]
    v_mfma_f32_32x32x16_bf16 v[176:191], v[220:223], v[84:87], v[176:191]
    ds_read_b64_tr_b16 v[208:209], v7 offset:19456
    ds_read_b64_tr_b16 v[210:211], v7 offset:19712
    ds_read_b64_tr_b16 v[212:213], v7 offset:48128
    ds_read_b64_tr_b16 v[214:215], v7 offset:48384
    ds_read_b64_tr_b16 v[216:217], v224 offset:19456
    ds_read_b64_tr_b16 v[218:219], v224 offset:19712
    ds_read_b64_tr_b16 v[220:221], v224 offset:48128
    ds_read_b64_tr_b16 v[222:223], v224 offset:48384
    s_waitcnt lgkmcnt(8)
    v_mfma_f32_32x32x16_bf16 v[128:143], v[192:195], v[88:91], v[128:143]
    v_mfma_f32_32x32x16_bf16 v[144:159], v[196:199], v[88:91], v[144:159]
    v_mfma_f32_32x32x16_bf16 v[160:175], v[200:203], v[88:91], v[160:175]
    v_mfma_f32_32x32x16_bf16 v[176:191], v[204:207], v[88:91], v[176:191]
    ds_read_b64_tr_b16 v[192:193], v7 offset:20480
    ds_read_b64_tr_b16 v[194:195], v7 offset:20736
    ds_read_b64_tr_b16 v[196:197], v7 offset:49152
    ds_read_b64_tr_b16 v[198:199], v7 offset:49408
    ds_read_b64_tr_b16 v[200:201], v224 offset:20480
    ds_read_b64_tr_b16 v[202:203], v224 offset:20736
    ds_read_b64_tr_b16 v[204:205], v224 offset:49152
    ds_read_b64_tr_b16 v[206:207], v224 offset:49408
    s_waitcnt lgkmcnt(8)
    v_mfma_f32_32x32x16_bf16 v[128:143], v[208:211], v[92:95], v[128:143]
    v_mfma_f32_32x32x16_bf16 v[144:159], v[212:215], v[92:95], v[144:159]
    v_mfma_f32_32x32x16_bf16 v[160:175], v[216:219], v[92:95], v[160:175]
    v_mfma_f32_32x32x16_bf16 v[176:191], v[220:223], v[92:95], v[176:191]
    ds_read_b64_tr_b16 v[208:209], v7 offset:21504
    ds_read_b64_tr_b16 v[210:211], v7 offset:21760
    ds_read_b64_tr_b16 v[212:213], v7 offset:50176
    ds_read_b64_tr_b16 v[214:215], v7 offset:50432
    ds_read_b64_tr_b16 v[216:217], v224 offset:21504
    ds_read_b64_tr_b16 v[218:219], v224 offset:21760
    ds_read_b64_tr_b16 v[220:221], v224 offset:50176
    ds_read_b64_tr_b16 v[222:223], v224 offset:50432
    s_waitcnt lgkmcnt(8)
    v_mfma_f32_32x32x16_bf16 v[128:143], v[192:195], v[96:99], v[128:143]
    v_mfma_f32_32x32x16_bf16 v[144:159], v[196:199], v[96:99], v[144:159]
    v_mfma_f32_32x32x16_bf16 v[160:175], v[200:203], v[96:99], v[160:175]
    v_mfma_f32_32x32x16_bf16 v[176:191], v[204:207], v[96:99], v[176:191]
    ds_read_b64_tr_b16 v[192:193], v7 offset:22528
    ds_read_b64_tr_b16 v[194:195], v7 offset:22784
    ds_read_b64_tr_b16 v[196:197], v7 offset:51200
    ds_read_b64_tr_b16 v[198:199], v7 offset:51456
    ds_read_b64_tr_b16 v[200:201], v224 offset:22528
    ds_read_b64_tr_b16 v[202:203], v224 offset:22784
    ds_read_b64_tr_b16 v[204:205], v224 offset:51200
    ds_read_b64_tr_b16 v[206:207], v224 offset:51456
    s_waitcnt lgkmcnt(8)
    v_mfma_f32_32x32x16_bf16 v[128:143], v[208:211], v[100:103], v[128:143]
    v_mfma_f32_32x32x16_bf16 v[144:159], v[212:215], v[100:103], v[144:159]
    v_mfma_f32_32x32x16_bf16 v[160:175], v[216:219], v[100:103], v[160:175]
    v_mfma_f32_32x32x16_bf16 v[176:191], v[220:223], v[100:103], v[176:191]
    ds_read_b64_tr_b16 v[208:209], v7 offset:23552
    ds_read_b64_tr_b16 v[210:211], v7 offset:23808
    ds_read_b64_tr_b16 v[212:213], v7 offset:52224
    ds_read_b64_tr_b16 v[214:215], v7 offset:52480
    ds_read_b64_tr_b16 v[216:217], v224 offset:23552
    ds_read_b64_tr_b16 v[218:219], v224 offset:23808
    ds_read_b64_tr_b16 v[220:221], v224 offset:52224
    ds_read_b64_tr_b16 v[222:223], v224 offset:52480
    s_waitcnt lgkmcnt(8)
    v_mfma_f32_32x32x16_bf16 v[128:143], v[192:195], v[104:107], v[128:143]
    v_mfma_f32_32x32x16_bf16 v[144:159], v[196:199], v[104:107], v[144:159]
    v_mfma_f32_32x32x16_bf16 v[160:175], v[200:203], v[104:107], v[160:175]
    v_mfma_f32_32x32x16_bf16 v[176:191], v[204:207], v[104:107], v[176:191]
    ds_read_b64_tr_b16 v[192:193], v7 offset:24576
    ds_read_b64_tr_b16 v[194:195], v7 offset:24832
    ds_read_b64_tr_b16 v[196:197], v7 offset:53248
    ds_read_b64_tr_b16 v[198:199], v7 offset:53504
    ds_read_b64_tr_b16 v[200:201], v224 offset:24576
    ds_read_b64_tr_b16 v[202:203], v224 offset:24832
    ds_read_b64_tr_b16 v[204:205], v224 offset:53248
    ds_read_b64_tr_b16 v[206:207], v224 offset:53504
    s_waitcnt lgkmcnt(8)
    v_mfma_f32_32x32x16_bf16 v[128:143], v[208:211], v[108:111], v[128:143]
    v_mfma_f32_32x32x16_bf16 v[144:159], v[212:215], v[108:111], v[144:159]
    v_mfma_f32_32x32x16_bf16 v[160:175], v[216:219], v[108:111], v[160:175]
    v_mfma_f32_32x32x16_bf16 v[176:191], v[220:223], v[108:111], v[176:191]
    ds_read_b64_tr_b16 v[208:209], v7 offset:25600
    ds_read_b64_tr_b16 v[210:211], v7 offset:25856
    ds_read_b64_tr_b16 v[212:213], v7 offset:54272
    ds_read_b64_tr_b16 v[214:215], v7 offset:54528
    ds_read_b64_tr_b16 v[216:217], v224 offset:25600
    ds_read_b64_tr_b16 v[218:219], v224 offset:25856
    ds_read_b64_tr_b16 v[220:221], v224 offset:54272
    ds_read_b64_tr_b16 v[222:223], v224 offset:54528
    s_waitcnt lgkmcnt(8)
    v_mfma_f32_32x32x16_bf16 v[128:143], v[192:195], v[112:115], v[128:143]
    v_mfma_f32_32x32x16_bf16 v[144:159], v[196:199], v[112:115], v[144:159]
    v_mfma_f32_32x32x16_bf16 v[160:175], v[200:203], v[112:115], v[160:175]
    v_mfma_f32_32x32x16_bf16 v[176:191], v[204:207], v[112:115], v[176:191]
    ds_read_b64_tr_b16 v[192:193], v7 offset:26624
    ds_read_b64_tr_b16 v[194:195], v7 offset:26880
    ds_read_b64_tr_b16 v[196:197], v7 offset:55296
    ds_read_b64_tr_b16 v[198:199], v7 offset:55552
    ds_read_b64_tr_b16 v[200:201], v224 offset:26624
    ds_read_b64_tr_b16 v[202:203], v224 offset:26880
    ds_read_b64_tr_b16 v[204:205], v224 offset:55296
    ds_read_b64_tr_b16 v[206:207], v224 offset:55552
    s_waitcnt lgkmcnt(8)
    v_mfma_f32_32x32x16_bf16 v[128:143], v[208:211], v[116:119], v[128:143]
    v_mfma_f32_32x32x16_bf16 v[144:159], v[212:215], v[116:119], v[144:159]
    v_mfma_f32_32x32x16_bf16 v[160:175], v[216:219], v[116:119], v[160:175]
    v_mfma_f32_32x32x16_bf16 v[176:191], v[220:223], v[116:119], v[176:191]
    ds_read_b64_tr_b16 v[208:209], v7 offset:27648
    ds_read_b64_tr_b16 v[210:211], v7 offset:27904
    ds_read_b64_tr_b16 v[212:213], v7 offset:56320
    ds_read_b64_tr_b16 v[214:215], v7 offset:56576
    ds_read_b64_tr_b16 v[216:217], v224 offset:27648
    ds_read_b64_tr_b16 v[218:219], v224 offset:27904
    ds_read_b64_tr_b16 v[220:221], v224 offset:56320
    ds_read_b64_tr_b16 v[222:223], v224 offset:56576
    s_waitcnt lgkmcnt(8)
    v_mfma_f32_32x32x16_bf16 v[128:143], v[192:195], v[120:123], v[128:143]
    v_mfma_f32_32x32x16_bf16 v[144:159], v[196:199], v[120:123], v[144:159]
    v_mfma_f32_32x32x16_bf16 v[160:175], v[200:203], v[120:123], v[160:175]
    v_mfma_f32_32x32x16_bf16 v[176:191], v[204:207], v[120:123], v[176:191]
    s_waitcnt lgkmcnt(0)
    v_mfma_f32_32x32x16_bf16 v[128:143], v[208:211], v[124:127], v[128:143]
    v_mfma_f32_32x32x16_bf16 v[144:159], v[212:215], v[124:127], v[144:159]
    v_mfma_f32_32x32x16_bf16 v[160:175], v[216:219], v[124:127], v[160:175]
    v_mfma_f32_32x32x16_bf16 v[176:191], v[220:223], v[124:127], v[176:191]
    s_nop 15
    s_nop 3
    v_lshrrev_b32 v13, 1, v5
    v_lshlrev_b32 v13, 11, v13
    v_and_b32 v14, 1, v5
    v_lshl_add_u32 v13, v14, 8, v13
    s_mov_b32 s35, 0x3e8b97f6
    v_mul_f32 v128, s35, v128
    v_mul_f32 v129, s35, v129
    v_mul_f32 v130, s35, v130
    v_mul_f32 v131, s35, v131
    v_mul_f32 v132, s35, v132
    v_mul_f32 v133, s35, v133
    v_mul_f32 v134, s35, v134
    v_mul_f32 v135, s35, v135
    v_mul_f32 v136, s35, v136
    v_mul_f32 v137, s35, v137
    v_mul_f32 v138, s35, v138
    v_mul_f32 v139, s35, v139
    v_mul_f32 v140, s35, v140
    v_mul_f32 v141, s35, v141
    v_mul_f32 v142, s35, v142
    v_mul_f32 v143, s35, v143
    v_cvt_pk_bf16_f32 v128, v128, v129
    v_cvt_pk_bf16_f32 v129, v130, v131
    v_mov_b32 v14, 1088
    v_mov_b32 v15, 1096
    v_cndmask_b32 v14, v14, v15, s[30:31]
    v_add_u32 v14, v14, v13
    buffer_store_dwordx2 v[128:129], v14, s[16:19], 0 offen
    v_cvt_pk_bf16_f32 v132, v132, v133
    v_cvt_pk_bf16_f32 v133, v134, v135
    v_mov_b32 v14, 1600
    v_mov_b32 v15, 80
    v_cndmask_b32 v14, v14, v15, s[30:31]
    v_add_u32 v14, v14, v13
    buffer_store_dwordx2 v[132:133], v14, s[16:19], 0 offen
    v_cvt_pk_bf16_f32 v136, v136, v137
    v_cvt_pk_bf16_f32 v137, v138, v139
    v_mov_b32 v14, 88
    v_mov_b32 v15, 592
    v_cndmask_b32 v14, v14, v15, s[30:31]
    v_add_u32 v14, v14, v13
    buffer_store_dwordx2 v[136:137], v14, s[16:19], 0 offen
    v_cvt_pk_bf16_f32 v140, v140, v141
    v_cvt_pk_bf16_f32 v141, v142, v143
    v_mov_b32 v14, 600
    v_mov_b32 v15, 1104
    v_cndmask_b32 v14, v14, v15, s[30:31]
    v_add_u32 v14, v14, v13
    buffer_store_dwordx2 v[140:141], v14, s[16:19], 0 offen
    v_lshrrev_b32 v13, 1, v5
    v_lshlrev_b32 v13, 11, v13
    v_and_b32 v14, 1, v5
    v_lshl_add_u32 v13, v14, 8, v13
    s_mov_b32 s35, 0x3e8b97f6
    v_mul_f32 v144, s35, v144
    v_mul_f32 v145, s35, v145
    v_mul_f32 v146, s35, v146
    v_mul_f32 v147, s35, v147
    v_mul_f32 v148, s35, v148
    v_mul_f32 v149, s35, v149
    v_mul_f32 v150, s35, v150
    v_mul_f32 v151, s35, v151
    v_mul_f32 v152, s35, v152
    v_mul_f32 v153, s35, v153
    v_mul_f32 v154, s35, v154
    v_mul_f32 v155, s35, v155
    v_mul_f32 v156, s35, v156
    v_mul_f32 v157, s35, v157
    v_mul_f32 v158, s35, v158
    v_mul_f32 v159, s35, v159
    v_cvt_pk_bf16_f32 v144, v144, v145
    v_cvt_pk_bf16_f32 v145, v146, v147
    v_mov_b32 v14, 1112
    v_mov_b32 v15, 1616
    v_cndmask_b32 v14, v14, v15, s[30:31]
    v_add_u32 v14, v14, v13
    buffer_store_dwordx2 v[144:145], v14, s[16:19], 0 offen
    v_cvt_pk_bf16_f32 v148, v148, v149
    v_cvt_pk_bf16_f32 v149, v150, v151
    v_mov_b32 v14, 96
    v_mov_b32 v15, 104
    v_cndmask_b32 v14, v14, v15, s[30:31]
    v_add_u32 v14, v14, v13
    buffer_store_dwordx2 v[148:149], v14, s[16:19], 0 offen
    v_cvt_pk_bf16_f32 v152, v152, v153
    v_cvt_pk_bf16_f32 v153, v154, v155
    v_mov_b32 v14, 608
    v_mov_b32 v15, 616
    v_cndmask_b32 v14, v14, v15, s[30:31]
    v_add_u32 v14, v14, v13
    buffer_store_dwordx2 v[152:153], v14, s[16:19], 0 offen
    v_cvt_pk_bf16_f32 v156, v156, v157
    v_cvt_pk_bf16_f32 v157, v158, v159
    v_mov_b32 v14, 1120
    v_mov_b32 v15, 1128
    v_cndmask_b32 v14, v14, v15, s[30:31]
    v_add_u32 v14, v14, v13
    buffer_store_dwordx2 v[156:157], v14, s[16:19], 0 offen
    v_lshrrev_b32 v13, 1, v5
    v_lshlrev_b32 v13, 11, v13
    v_and_b32 v14, 1, v5
    v_lshl_add_u32 v13, v14, 8, v13
    s_mov_b32 s35, 0x3e8b97f6
    v_mul_f32 v160, s35, v160
    v_mul_f32 v161, s35, v161
    v_mul_f32 v162, s35, v162
    v_mul_f32 v163, s35, v163
    v_mul_f32 v164, s35, v164
    v_mul_f32 v165, s35, v165
    v_mul_f32 v166, s35, v166
    v_mul_f32 v167, s35, v167
    v_mul_f32 v168, s35, v168
    v_mul_f32 v169, s35, v169
    v_mul_f32 v170, s35, v170
    v_mul_f32 v171, s35, v171
    v_mul_f32 v172, s35, v172
    v_mul_f32 v173, s35, v173
    v_mul_f32 v174, s35, v174
    v_mul_f32 v175, s35, v175
    v_cvt_pk_bf16_f32 v160, v160, v161
    v_cvt_pk_bf16_f32 v161, v162, v163
    v_mov_b32 v14, 1632
    v_mov_b32 v15, 112
    v_cndmask_b32 v14, v14, v15, s[30:31]
    v_add_u32 v14, v14, v13
    buffer_store_dwordx2 v[160:161], v14, s[16:19], 0 offen
    v_cvt_pk_bf16_f32 v164, v164, v165
    v_cvt_pk_bf16_f32 v165, v166, v167
    v_mov_b32 v14, 120
    v_mov_b32 v15, 624
    v_cndmask_b32 v14, v14, v15, s[30:31]
    v_add_u32 v14, v14, v13
    buffer_store_dwordx2 v[164:165], v14, s[16:19], 0 offen
    v_cvt_pk_bf16_f32 v168, v168, v169
    v_cvt_pk_bf16_f32 v169, v170, v171
    v_mov_b32 v14, 632
    v_mov_b32 v15, 1136
    v_cndmask_b32 v14, v14, v15, s[30:31]
    v_add_u32 v14, v14, v13
    buffer_store_dwordx2 v[168:169], v14, s[16:19], 0 offen
    v_cvt_pk_bf16_f32 v172, v172, v173
    v_cvt_pk_bf16_f32 v173, v174, v175
    v_mov_b32 v14, 1144
    v_mov_b32 v15, 1648
    v_cndmask_b32 v14, v14, v15, s[30:31]
    v_add_u32 v14, v14, v13
    buffer_store_dwordx2 v[172:173], v14, s[16:19], 0 offen
    v_lshrrev_b32 v13, 1, v5
    v_lshlrev_b32 v13, 11, v13
    v_and_b32 v14, 1, v5
    v_lshl_add_u32 v13, v14, 8, v13
    s_mov_b32 s35, 0x3e8b97f6
    v_mul_f32 v176, s35, v176
    v_mul_f32 v177, s35, v177
    v_mul_f32 v178, s35, v178
    v_mul_f32 v179, s35, v179
    v_mul_f32 v180, s35, v180
    v_mul_f32 v181, s35, v181
    v_mul_f32 v182, s35, v182
    v_mul_f32 v183, s35, v183
    v_mul_f32 v184, s35, v184
    v_mul_f32 v185, s35, v185
    v_mul_f32 v186, s35, v186
    v_mul_f32 v187, s35, v187
    v_mul_f32 v188, s35, v188
    v_mul_f32 v189, s35, v189
    v_mul_f32 v190, s35, v190
    v_mul_f32 v191, s35, v191
    v_cvt_pk_bf16_f32 v176, v176, v177
    v_cvt_pk_bf16_f32 v177, v178, v179
    v_mov_b32 v14, 128
    v_mov_b32 v15, 136
    v_cndmask_b32 v14, v14, v15, s[30:31]
    v_add_u32 v14, v14, v13
    buffer_store_dwordx2 v[176:177], v14, s[16:19], 0 offen
    v_cvt_pk_bf16_f32 v180, v180, v181
    v_cvt_pk_bf16_f32 v181, v182, v183
    v_mov_b32 v14, 640
    v_mov_b32 v15, 648
    v_cndmask_b32 v14, v14, v15, s[30:31]
    v_add_u32 v14, v14, v13
    buffer_store_dwordx2 v[180:181], v14, s[16:19], 0 offen
    v_cvt_pk_bf16_f32 v184, v184, v185
    v_cvt_pk_bf16_f32 v185, v186, v187
    v_mov_b32 v14, 1152
    v_mov_b32 v15, 1160
    v_cndmask_b32 v14, v14, v15, s[30:31]
    v_add_u32 v14, v14, v13
    buffer_store_dwordx2 v[184:185], v14, s[16:19], 0 offen
    v_cvt_pk_bf16_f32 v188, v188, v189
    v_cvt_pk_bf16_f32 v189, v190, v191
    v_mov_b32 v14, 1664
    v_mov_b32 v15, 144
    v_cndmask_b32 v14, v14, v15, s[30:31]
    v_add_u32 v14, v14, v13
    buffer_store_dwordx2 v[188:189], v14, s[16:19], 0 offen
    s_endpgm
K1_v2:
    s_mov_b32 s12, s38
    s_and_b32 s13, s39, 0xffff
    s_mov_b32 s14, 401408
    s_mov_b32 s15, 0x00020000
    s_movk_i32 s35, 896
    v_lshrrev_b32 v227, 2, v0
    v_mul_lo_u32 v227, v227, s35
    v_and_b32 v14, 3, v0
    v_lshl_add_u32 v227, v14, 4, v227
    s_mov_b32 s35, 512
    buffer_load_dwordx4 v[128:131], v227, s[12:15], s35 offen
    s_mov_b32 s35, 57856
    buffer_load_dwordx4 v[132:135], v227, s[12:15], s35 offen
    s_mov_b32 s35, 115200
    buffer_load_dwordx4 v[136:139], v227, s[12:15], s35 offen
    s_mov_b32 s35, 172544
    buffer_load_dwordx4 v[140:143], v227, s[12:15], s35 offen
    s_mov_b32 s35, 229888
    buffer_load_dwordx4 v[144:147], v227, s[12:15], s35 offen
    s_mov_b32 s35, 287232
    buffer_load_dwordx4 v[148:151], v227, s[12:15], s35 offen
    s_mov_b32 s35, 344576
    buffer_load_dwordx4 v[152:155], v227, s[12:15], s35 offen
    s_mov_b32 s12, s38
    s_and_b32 s13, s39, 0xffff
    s_mov_b32 s14, 401408
    s_mov_b32 s15, 0x00020000
    s_movk_i32 s35, 896
    v_lshrrev_b32 v227, 2, v0
    v_mul_lo_u32 v227, v227, s35
    v_and_b32 v14, 3, v0
    v_lshl_add_u32 v227, v14, 4, v227
    s_mov_b32 s35, 576
    buffer_load_dwordx4 v[156:159], v227, s[12:15], s35 offen
    s_mov_b32 s35, 57920
    buffer_load_dwordx4 v[160:163], v227, s[12:15], s35 offen
    s_mov_b32 s35, 115264
    buffer_load_dwordx4 v[164:167], v227, s[12:15], s35 offen
    s_mov_b32 s35, 172608
    buffer_load_dwordx4 v[168:171], v227, s[12:15], s35 offen
    s_mov_b32 s35, 229952
    buffer_load_dwordx4 v[172:175], v227, s[12:15], s35 offen
    s_mov_b32 s35, 287296
    buffer_load_dwordx4 v[176:179], v227, s[12:15], s35 offen
    s_mov_b32 s35, 344640
    buffer_load_dwordx4 v[180:183], v227, s[12:15], s35 offen
    s_mov_b32 s54, 0x4924925
    v_add_u32 v13, 0, v2
    v_mul_hi_u32 v14, v13, s54
    v_lshlrev_b32 v13, 4, v13
    v_lshl_add_u32 v13, v14, 4, v13
    v_add_u32 v13, s53, v13
    s_waitcnt vmcnt(41)
    ds_write_b128 v13, v[16:19]
    v_add_u32 v13, 64, v2
    v_mul_hi_u32 v14, v13, s54
    v_lshlrev_b32 v13, 4, v13
    v_lshl_add_u32 v13, v14, 4, v13
    v_add_u32 v13, s53, v13
    s_waitcnt vmcnt(40)
    ds_write_b128 v13, v[20:23]
    v_add_u32 v13, 128, v2
    v_mul_hi_u32 v14, v13, s54
    v_lshlrev_b32 v13, 4, v13
    v_lshl_add_u32 v13, v14, 4, v13
    v_add_u32 v13, s53, v13
    s_waitcnt vmcnt(39)
    ds_write_b128 v13, v[24:27]
    v_add_u32 v13, 192, v2
    v_mul_hi_u32 v14, v13, s54
    v_lshlrev_b32 v13, 4, v13
    v_lshl_add_u32 v13, v14, 4, v13
    v_add_u32 v13, s53, v13
    s_waitcnt vmcnt(38)
    ds_write_b128 v13, v[28:31]
    v_add_u32 v13, 256, v2
    v_mul_hi_u32 v14, v13, s54
    v_lshlrev_b32 v13, 4, v13
    v_lshl_add_u32 v13, v14, 4, v13
    v_add_u32 v13, s53, v13
    s_waitcnt vmcnt(37)
    ds_write_b128 v13, v[32:35]
    v_add_u32 v13, 320, v2
    v_mul_hi_u32 v14, v13, s54
    v_lshlrev_b32 v13, 4, v13
    v_lshl_add_u32 v13, v14, 4, v13
    v_add_u32 v13, s53, v13
    s_waitcnt vmcnt(36)
    ds_write_b128 v13, v[36:39]
    v_add_u32 v13, 384, v2
    v_mul_hi_u32 v14, v13, s54
    v_lshlrev_b32 v13, 4, v13
    v_lshl_add_u32 v13, v14, 4, v13
    v_add_u32 v13, s53, v13
    s_waitcnt vmcnt(35)
    ds_write_b128 v13, v[40:43]
    v_add_u32 v13, 448, v2
    v_mul_hi_u32 v14, v13, s54
    v_lshlrev_b32 v13, 4, v13
    v_lshl_add_u32 v13, v14, 4, v13
    v_add_u32 v13, s53, v13
    s_waitcnt vmcnt(34)
    ds_write_b128 v13, v[44:47]
    v_add_u32 v13, 512, v2
    v_mul_hi_u32 v14, v13, s54
    v_lshlrev_b32 v13, 4, v13
    v_lshl_add_u32 v13, v14, 4, v13
    v_add_u32 v13, s53, v13
    s_waitcnt vmcnt(33)
    ds_write_b128 v13, v[48:51]
    v_add_u32 v13, 576, v2
    v_mul_hi_u32 v14, v13, s54
    v_lshlrev_b32 v13, 4, v13
    v_lshl_add_u32 v13, v14, 4, v13
    v_add_u32 v13, s53, v13
    s_waitcnt vmcnt(32)
    ds_write_b128 v13, v[52:55]
    v_add_u32 v13, 640, v2
    v_mul_hi_u32 v14, v13, s54
    v_lshlrev_b32 v13, 4, v13
    v_lshl_add_u32 v13, v14, 4, v13
    v_add_u32 v13, s53, v13
    s_waitcnt vmcnt(31)
    ds_write_b128 v13, v[56:59]
    v_add_u32 v13, 704, v2
    v_mul_hi_u32 v14, v13, s54
    v_lshlrev_b32 v13, 4, v13
    v_lshl_add_u32 v13, v14, 4, v13
    v_add_u32 v13, s53, v13
    s_waitcnt vmcnt(30)
    ds_write_b128 v13, v[60:63]
    v_add_u32 v13, 768, v2
    v_mul_hi_u32 v14, v13, s54
    v_lshlrev_b32 v13, 4, v13
    v_lshl_add_u32 v13, v14, 4, v13
    v_add_u32 v13, s53, v13
    s_waitcnt vmcnt(29)
    ds_write_b128 v13, v[64:67]
    v_add_u32 v13, 832, v2
    v_mul_hi_u32 v14, v13, s54
    v_lshlrev_b32 v13, 4, v13
    v_lshl_add_u32 v13, v14, 4, v13
    v_add_u32 v13, s53, v13
    s_waitcnt vmcnt(28)
    ds_write_b128 v13, v[68:71]
    v_add_u32 v13, 896, v2
    v_mul_hi_u32 v14, v13, s54
    v_lshlrev_b32 v13, 4, v13
    v_lshl_add_u32 v13, v14, 4, v13
    v_add_u32 v13, s53, v13
    s_waitcnt vmcnt(27)
    ds_write_b128 v13, v[72:75]
    v_add_u32 v13, 960, v2
    v_mul_hi_u32 v14, v13, s54
    v_lshlrev_b32 v13, 4, v13
    v_lshl_add_u32 v13, v14, 4, v13
    v_add_u32 v13, s53, v13
    s_waitcnt vmcnt(26)
    ds_write_b128 v13, v[76:79]
    v_add_u32 v13, 1024, v2
    v_mul_hi_u32 v14, v13, s54
    v_lshlrev_b32 v13, 4, v13
    v_lshl_add_u32 v13, v14, 4, v13
    v_add_u32 v13, s53, v13
    s_waitcnt vmcnt(25)
    ds_write_b128 v13, v[80:83]
    v_add_u32 v13, 1088, v2
    v_mul_hi_u32 v14, v13, s54
    v_lshlrev_b32 v13, 4, v13
    v_lshl_add_u32 v13, v14, 4, v13
    v_add_u32 v13, s53, v13
    s_waitcnt vmcnt(24)
    ds_write_b128 v13, v[84:87]
    v_add_u32 v13, 1152, v2
    v_mul_hi_u32 v14, v13, s54
    v_lshlrev_b32 v13, 4, v13
    v_lshl_add_u32 v13, v14, 4, v13
    v_add_u32 v13, s53, v13
    s_waitcnt vmcnt(23)
    ds_write_b128 v13, v[88:91]
    v_add_u32 v13, 1216, v2
    v_mul_hi_u32 v14, v13, s54
    v_lshlrev_b32 v13, 4, v13
    v_lshl_add_u32 v13, v14, 4, v13
    v_add_u32 v13, s53, v13
    s_waitcnt vmcnt(22)
    ds_write_b128 v13, v[92:95]
    v_add_u32 v13, 1280, v2
    v_mul_hi_u32 v14, v13, s54
    v_lshlrev_b32 v13, 4, v13
    v_lshl_add_u32 v13, v14, 4, v13
    v_add_u32 v13, s53, v13
    s_waitcnt vmcnt(21)
    ds_write_b128 v13, v[96:99]
    v_add_u32 v13, 1344, v2
    v_mul_hi_u32 v14, v13, s54
    v_lshlrev_b32 v13, 4, v13
    v_lshl_add_u32 v13, v14, 4, v13
    v_add_u32 v13, s53, v13
    s_waitcnt vmcnt(20)
    ds_write_b128 v13, v[100:103]
    v_add_u32 v13, 1408, v2
    v_mul_hi_u32 v14, v13, s54
    v_lshlrev_b32 v13, 4, v13
    v_lshl_add_u32 v13, v14, 4, v13
    v_add_u32 v13, s53, v13
    s_waitcnt vmcnt(19)
    ds_write_b128 v13, v[104:107]
    v_add_u32 v13, 1472, v2
    v_mul_hi_u32 v14, v13, s54
    v_lshlrev_b32 v13, 4, v13
    v_lshl_add_u32 v13, v14, 4, v13
    v_add_u32 v13, s53, v13
    s_waitcnt vmcnt(18)
    ds_write_b128 v13, v[108:111]
    v_add_u32 v13, 1536, v2
    v_mul_hi_u32 v14, v13, s54
    v_lshlrev_b32 v13, 4, v13
    v_lshl_add_u32 v13, v14, 4, v13
    v_add_u32 v13, s53, v13
    s_waitcnt vmcnt(17)
    ds_write_b128 v13, v[112:115]
    v_add_u32 v13, 1600, v2
    v_mul_hi_u32 v14, v13, s54
    v_lshlrev_b32 v13, 4, v13
    v_lshl_add_u32 v13, v14, 4, v13
    v_add_u32 v13, s53, v13
    s_waitcnt vmcnt(16)
    ds_write_b128 v13, v[116:119]
    v_add_u32 v13, 1664, v2
    v_mul_hi_u32 v14, v13, s54
    v_lshlrev_b32 v13, 4, v13
    v_lshl_add_u32 v13, v14, 4, v13
    v_add_u32 v13, s53, v13
    s_waitcnt vmcnt(15)
    ds_write_b128 v13, v[120:123]
    v_add_u32 v13, 1728, v2
    v_mul_hi_u32 v14, v13, s54
    v_lshlrev_b32 v13, 4, v13
    v_lshl_add_u32 v13, v14, 4, v13
    v_add_u32 v13, s53, v13
    s_waitcnt vmcnt(14)
    ds_write_b128 v13, v[124:127]
    v_mul_u32_u24 v13, 912, v3
    v_lshl_add_u32 v13, v4, 4, v13
    v_add_u32 v13, s53, v13
    s_waitcnt lgkmcnt(0)
    ds_read_b128 v[16:19], v13 offset:0
    ds_read_b128 v[20:23], v13 offset:32
    ds_read_b128 v[24:27], v13 offset:64
    ds_read_b128 v[28:31], v13 offset:96
    ds_read_b128 v[32:35], v13 offset:128
    ds_read_b128 v[36:39], v13 offset:160
    ds_read_b128 v[40:43], v13 offset:192
    ds_read_b128 v[44:47], v13 offset:224
    ds_read_b128 v[48:51], v13 offset:256
    ds_read_b128 v[52:55], v13 offset:288
    ds_read_b128 v[56:59], v13 offset:320
    ds_read_b128 v[60:63], v13 offset:352
    ds_read_b128 v[64:67], v13 offset:384
    ds_read_b128 v[68:71], v13 offset:416
    ds_read_b128 v[72:75], v13 offset:448
    ds_read_b128 v[76:79], v13 offset:480
    ds_read_b128 v[80:83], v13 offset:512
    ds_read_b128 v[84:87], v13 offset:544
    ds_read_b128 v[88:91], v13 offset:576
    ds_read_b128 v[92:95], v13 offset:608
    ds_read_b128 v[96:99], v13 offset:640
    ds_read_b128 v[100:103], v13 offset:672
    ds_read_b128 v[104:107], v13 offset:704
    ds_read_b128 v[108:111], v13 offset:736
    ds_read_b128 v[112:115], v13 offset:768
    ds_read_b128 v[116:119], v13 offset:800
    ds_read_b128 v[120:123], v13 offset:832
    ds_read_b128 v[124:127], v13 offset:864
    s_waitcnt lgkmcnt(0)
    s_barrier
    s_waitcnt vmcnt(13)
    ds_write_b128 v11, v[128:131] offset:0
    s_waitcnt vmcnt(12)
    ds_write_b128 v11, v[132:135] offset:4096
    s_waitcnt vmcnt(11)
    ds_write_b128 v11, v[136:139] offset:8192
    s_waitcnt vmcnt(10)
    ds_write_b128 v11, v[140:143] offset:12288
    s_waitcnt vmcnt(9)
    ds_write_b128 v11, v[144:147] offset:16384
    s_waitcnt vmcnt(8)
    ds_write_b128 v11, v[148:151] offset:20480
    s_waitcnt vmcnt(7)
    ds_write_b128 v11, v[152:155] offset:24576
    s_waitcnt vmcnt(6)
    ds_write_b128 v11, v[156:159] offset:28672
    s_waitcnt vmcnt(5)
    ds_write_b128 v11, v[160:163] offset:32768
    s_waitcnt vmcnt(4)
    ds_write_b128 v11, v[164:167] offset:36864
    s_waitcnt vmcnt(3)
    ds_write_b128 v11, v[168:171] offset:40960
    s_waitcnt vmcnt(2)
    ds_write_b128 v11, v[172:175] offset:45056
    s_waitcnt vmcnt(1)
    ds_write_b128 v11, v[176:179] offset:49152
    s_waitcnt vmcnt(0)
    ds_write_b128 v11, v[180:183] offset:53248
    s_mov_b32 s12, s38
    s_and_b32 s13, s39, 0xffff
    s_mov_b32 s14, 401408
    s_mov_b32 s15, 0x00020000
    s_movk_i32 s35, 896
    v_lshrrev_b32 v13, 2, v0
    v_mul_lo_u32 v13, v13, s35
    v_and_b32 v14, 3, v0
    v_lshl_add_u32 v13, v14, 4, v13
    s_mov_b32 s35, 640
    buffer_load_dwordx4 v[128:131], v13, s[12:15], s35 offen
    s_mov_b32 s35, 57984
    buffer_load_dwordx4 v[132:135], v13, s[12:15], s35 offen
    s_mov_b32 s35, 115328
    buffer_load_dwordx4 v[136:139], v13, s[12:15], s35 offen
    s_mov_b32 s35, 172672
    buffer_load_dwordx4 v[140:143], v13, s[12:15], s35 offen
    s_mov_b32 s35, 230016
    buffer_load_dwordx4 v[144:147], v13, s[12:15], s35 offen
    s_mov_b32 s35, 287360
    buffer_load_dwordx4 v[148:151], v13, s[12:15], s35 offen
    s_mov_b32 s35, 344704
    buffer_load_dwordx4 v[152:155], v13, s[12:15], s35 offen
    s_waitcnt vmcnt(6)
    ds_write_b128 v225, v[128:131] offset:0
    s_waitcnt vmcnt(5)
    ds_write_b128 v225, v[132:135] offset:4096
    s_waitcnt vmcnt(4)
    ds_write_b128 v225, v[136:139] offset:8192
    s_waitcnt vmcnt(3)
    ds_write_b128 v225, v[140:143] offset:12288
    s_waitcnt vmcnt(2)
    ds_write_b128 v225, v[144:147] offset:16384
    s_waitcnt vmcnt(1)
    ds_write_b128 v225, v[148:151] offset:20480
    s_waitcnt vmcnt(0)
    ds_write_b128 v225, v[152:155] offset:24576
    s_mov_b32 s12, s38
    s_and_b32 s13, s39, 0xffff
    s_mov_b32 s14, 401408
    s_mov_b32 s15, 0x00020000
    s_movk_i32 s35, 896
    v_lshrrev_b32 v13, 2, v0
    v_mul_lo_u32 v13, v13, s35
    v_and_b32 v14, 3, v0
    v_lshl_add_u32 v13, v14, 4, v13
    s_mov_b32 s35, 704
    buffer_load_dwordx4 v[128:131], v13, s[12:15], s35 offen
    s_mov_b32 s35, 58048
    buffer_load_dwordx4 v[132:135], v13, s[12:15], s35 offen
    s_mov_b32 s35, 115392
    buffer_load_dwordx4 v[136:139], v13, s[12:15], s35 offen
    s_mov_b32 s35, 172736
    buffer_load_dwordx4 v[140:143], v13, s[12:15], s35 offen
    s_mov_b32 s35, 230080
    buffer_load_dwordx4 v[144:147], v13, s[12:15], s35 offen
    s_mov_b32 s35, 287424
    buffer_load_dwordx4 v[148:151], v13, s[12:15], s35 offen
    s_mov_b32 s35, 344768
    buffer_load_dwordx4 v[152:155], v13, s[12:15], s35 offen
    s_waitcnt vmcnt(6)
    ds_write_b128 v225, v[128:131] offset:28672
    s_waitcnt vmcnt(5)
    ds_write_b128 v225, v[132:135] offset:32768
    s_waitcnt vmcnt(4)
    ds_write_b128 v225, v[136:139] offset:36864
    s_waitcnt vmcnt(3)
    ds_write_b128 v225, v[140:143] offset:40960
    s_waitcnt vmcnt(2)
    ds_write_b128 v225, v[144:147] offset:45056
    s_waitcnt vmcnt(1)
    ds_write_b128 v225, v[148:151] offset:49152
    s_waitcnt vmcnt(0)
    ds_write_b128 v225, v[152:155] offset:53248
    s_waitcnt lgkmcnt(0)
    s_barrier
    ds_read_b64_tr_b16 v[192:193], v7 offset:0
    ds_read_b64_tr_b16 v[194:195], v7 offset:256
    ds_read_b64_tr_b16 v[196:197], v7 offset:28672
    ds_read_b64_tr_b16 v[198:199], v7 offset:28928
    ds_read_b64_tr_b16 v[200:201], v224 offset:0
    ds_read_b64_tr_b16 v[202:203], v224 offset:256
    ds_read_b64_tr_b16 v[204:205], v224 offset:28672
    ds_read_b64_tr_b16 v[206:207], v224 offset:28928
    ds_read_b64_tr_b16 v[208:209], v7 offset:1024
    ds_read_b64_tr_b16 v[210:211], v7 offset:1280
    ds_read_b64_tr_b16 v[212:213], v7 offset:29696
    ds_read_b64_tr_b16 v[214:215], v7 offset:29952
    ds_read_b64_tr_b16 v[216:217], v224 offset:1024
    ds_read_b64_tr_b16 v[218:219], v224 offset:1280
    ds_read_b64_tr_b16 v[220:221], v224 offset:29696
    ds_read_b64_tr_b16 v[222:223], v224 offset:29952
    s_waitcnt lgkmcnt(8)
    v_mfma_f32_32x32x16_bf16 v[128:143], v[192:195], v[16:19], 0
    v_mfma_f32_32x32x16_bf16 v[144:159], v[196:199], v[16:19], 0
    v_mfma_f32_32x32x16_bf16 v[160:175], v[200:203], v[16:19], 0
    v_mfma_f32_32x32x16_bf16 v[176:191], v[204:207], v[16:19], 0
    ds_read_b64_tr_b16 v[192:193], v7 offset:2048
    ds_read_b64_tr_b16 v[194:195], v7 offset:2304
    ds_read_b64_tr_b16 v[196:197], v7 offset:30720
    ds_read_b64_tr_b16 v[198:199], v7 offset:30976
    ds_read_b64_tr_b16 v[200:201], v224 offset:2048
    ds_read_b64_tr_b16 v[202:203], v224 offset:2304
    ds_read_b64_tr_b16 v[204:205], v224 offset:30720
    ds_read_b64_tr_b16 v[206:207], v224 offset:30976
    s_waitcnt lgkmcnt(8)
    v_mfma_f32_32x32x16_bf16 v[128:143], v[208:211], v[20:23], v[128:143]
    v_mfma_f32_32x32x16_bf16 v[144:159], v[212:215], v[20:23], v[144:159]
    v_mfma_f32_32x32x16_bf16 v[160:175], v[216:219], v[20:23], v[160:175]
    v_mfma_f32_32x32x16_bf16 v[176:191], v[220:223], v[20:23], v[176:191]
    ds_read_b64_tr_b16 v[208:209], v7 offset:3072
    ds_read_b64_tr_b16 v[210:211], v7 offset:3328
    ds_read_b64_tr_b16 v[212:213], v7 offset:31744
    ds_read_b64_tr_b16 v[214:215], v7 offset:32000
    ds_read_b64_tr_b16 v[216:217], v224 offset:3072
    ds_read_b64_tr_b16 v[218:219], v224 offset:3328
    ds_read_b64_tr_b16 v[220:221], v224 offset:31744
    ds_read_b64_tr_b16 v[222:223], v224 offset:32000
    s_waitcnt lgkmcnt(8)
    v_mfma_f32_32x32x16_bf16 v[128:143], v[192:195], v[24:27], v[128:143]
    v_mfma_f32_32x32x16_bf16 v[144:159], v[196:199], v[24:27], v[144:159]
    v_mfma_f32_32x32x16_bf16 v[160:175], v[200:203], v[24:27], v[160:175]
    v_mfma_f32_32x32x16_bf16 v[176:191], v[204:207], v[24:27], v[176:191]
    ds_read_b64_tr_b16 v[192:193], v7 offset:4096
    ds_read_b64_tr_b16 v[194:195], v7 offset:4352
    ds_read_b64_tr_b16 v[196:197], v7 offset:32768
    ds_read_b64_tr_b16 v[198:199], v7 offset:33024
    ds_read_b64_tr_b16 v[200:201], v224 offset:4096
    ds_read_b64_tr_b16 v[202:203], v224 offset:4352
    ds_read_b64_tr_b16 v[204:205], v224 offset:32768
    ds_read_b64_tr_b16 v[206:207], v224 offset:33024
    s_waitcnt lgkmcnt(8)
    v_mfma_f32_32x32x16_bf16 v[128:143], v[208:211], v[28:31], v[128:143]
    v_mfma_f32_32x32x16_bf16 v[144:159], v[212:215], v[28:31], v[144:159]
    v_mfma_f32_32x32x16_bf16 v[160:175], v[216:219], v[28:31], v[160:175]
    v_mfma_f32_32x32x16_bf16 v[176:191], v[220:223], v[28:31], v[176:191]
    ds_read_b64_tr_b16 v[208:209], v7 offset:5120
    ds_read_b64_tr_b16 v[210:211], v7 offset:5376
    ds_read_b64_tr_b16 v[212:213], v7 offset:33792
    ds_read_b64_tr_b16 v[214:215], v7 offset:34048
    ds_read_b64_tr_b16 v[216:217], v224 offset:5120
    ds_read_b64_tr_b16 v[218:219], v224 offset:5376
    ds_read_b64_tr_b16 v[220:221], v224 offset:33792
    ds_read_b64_tr_b16 v[222:223], v224 offset:34048
    s_waitcnt lgkmcnt(8)
    v_mfma_f32_32x32x16_bf16 v[128:143], v[192:195], v[32:35], v[128:143]
    v_mfma_f32_32x32x16_bf16 v[144:159], v[196:199], v[32:35], v[144:159]
    v_mfma_f32_32x32x16_bf16 v[160:175], v[200:203], v[32:35], v[160:175]
    v_mfma_f32_32x32x16_bf16 v[176:191], v[204:207], v[32:35], v[176:191]
    ds_read_b64_tr_b16 v[192:193], v7 offset:6144
    ds_read_b64_tr_b16 v[194:195], v7 offset:6400
    ds_read_b64_tr_b16 v[196:197], v7 offset:34816
    ds_read_b64_tr_b16 v[198:199], v7 offset:35072
    ds_read_b64_tr_b16 v[200:201], v224 offset:6144
    ds_read_b64_tr_b16 v[202:203], v224 offset:6400
    ds_read_b64_tr_b16 v[204:205], v224 offset:34816
    ds_read_b64_tr_b16 v[206:207], v224 offset:35072
    s_waitcnt lgkmcnt(8)
    v_mfma_f32_32x32x16_bf16 v[128:143], v[208:211], v[36:39], v[128:143]
    v_mfma_f32_32x32x16_bf16 v[144:159], v[212:215], v[36:39], v[144:159]
    v_mfma_f32_32x32x16_bf16 v[160:175], v[216:219], v[36:39], v[160:175]
    v_mfma_f32_32x32x16_bf16 v[176:191], v[220:223], v[36:39], v[176:191]
    ds_read_b64_tr_b16 v[208:209], v7 offset:7168
    ds_read_b64_tr_b16 v[210:211], v7 offset:7424
    ds_read_b64_tr_b16 v[212:213], v7 offset:35840
    ds_read_b64_tr_b16 v[214:215], v7 offset:36096
    ds_read_b64_tr_b16 v[216:217], v224 offset:7168
    ds_read_b64_tr_b16 v[218:219], v224 offset:7424
    ds_read_b64_tr_b16 v[220:221], v224 offset:35840
    ds_read_b64_tr_b16 v[222:223], v224 offset:36096
    s_waitcnt lgkmcnt(8)
    v_mfma_f32_32x32x16_bf16 v[128:143], v[192:195], v[40:43], v[128:143]
    v_mfma_f32_32x32x16_bf16 v[144:159], v[196:199], v[40:43], v[144:159]
    v_mfma_f32_32x32x16_bf16 v[160:175], v[200:203], v[40:43], v[160:175]
    v_mfma_f32_32x32x16_bf16 v[176:191], v[204:207], v[40:43], v[176:191]
    ds_read_b64_tr_b16 v[192:193], v7 offset:8192
    ds_read_b64_tr_b16 v[194:195], v7 offset:8448
    ds_read_b64_tr_b16 v[196:197], v7 offset:36864
    ds_read_b64_tr_b16 v[198:199], v7 offset:37120
    ds_read_b64_tr_b16 v[200:201], v224 offset:8192
    ds_read_b64_tr_b16 v[202:203], v224 offset:8448
    ds_read_b64_tr_b16 v[204:205], v224 offset:36864
    ds_read_b64_tr_b16 v[206:207], v224 offset:37120
    s_waitcnt lgkmcnt(8)
    v_mfma_f32_32x32x16_bf16 v[128:143], v[208:211], v[44:47], v[128:143]
    v_mfma_f32_32x32x16_bf16 v[144:159], v[212:215], v[44:47], v[144:159]
    v_mfma_f32_32x32x16_bf16 v[160:175], v[216:219], v[44:47], v[160:175]
    v_mfma_f32_32x32x16_bf16 v[176:191], v[220:223], v[44:47], v[176:191]
    ds_read_b64_tr_b16 v[208:209], v7 offset:9216
    ds_read_b64_tr_b16 v[210:211], v7 offset:9472
    ds_read_b64_tr_b16 v[212:213], v7 offset:37888
    ds_read_b64_tr_b16 v[214:215], v7 offset:38144
    ds_read_b64_tr_b16 v[216:217], v224 offset:9216
    ds_read_b64_tr_b16 v[218:219], v224 offset:9472
    ds_read_b64_tr_b16 v[220:221], v224 offset:37888
    ds_read_b64_tr_b16 v[222:223], v224 offset:38144
    s_waitcnt lgkmcnt(8)
    v_mfma_f32_32x32x16_bf16 v[128:143], v[192:195], v[48:51], v[128:143]
    v_mfma_f32_32x32x16_bf16 v[144:159], v[196:199], v[48:51], v[144:159]
    v_mfma_f32_32x32x16_bf16 v[160:175], v[200:203], v[48:51], v[160:175]
    v_mfma_f32_32x32x16_bf16 v[176:191], v[204:207], v[48:51], v[176:191]
    ds_read_b64_tr_b16 v[192:193], v7 offset:10240
    ds_read_b64_tr_b16 v[194:195], v7 offset:10496
    ds_read_b64_tr_b16 v[196:197], v7 offset:38912
    ds_read_b64_tr_b16 v[198:199], v7 offset:39168
    ds_read_b64_tr_b16 v[200:201], v224 offset:10240
    ds_read_b64_tr_b16 v[202:203], v224 offset:10496
    ds_read_b64_tr_b16 v[204:205], v224 offset:38912
    ds_read_b64_tr_b16 v[206:207], v224 offset:39168
    s_waitcnt lgkmcnt(8)
    v_mfma_f32_32x32x16_bf16 v[128:143], v[208:211], v[52:55], v[128:143]
    v_mfma_f32_32x32x16_bf16 v[144:159], v[212:215], v[52:55], v[144:159]
    v_mfma_f32_32x32x16_bf16 v[160:175], v[216:219], v[52:55], v[160:175]
    v_mfma_f32_32x32x16_bf16 v[176:191], v[220:223], v[52:55], v[176:191]
    ds_read_b64_tr_b16 v[208:209], v7 offset:11264
    ds_read_b64_tr_b16 v[210:211], v7 offset:11520
    ds_read_b64_tr_b16 v[212:213], v7 offset:39936
    ds_read_b64_tr_b16 v[214:215], v7 offset:40192
    ds_read_b64_tr_b16 v[216:217], v224 offset:11264
    ds_read_b64_tr_b16 v[218:219], v224 offset:11520
    ds_read_b64_tr_b16 v[220:221], v224 offset:39936
    ds_read_b64_tr_b16 v[222:223], v224 offset:40192
    s_waitcnt lgkmcnt(8)
    v_mfma_f32_32x32x16_bf16 v[128:143], v[192:195], v[56:59], v[128:143]
    v_mfma_f32_32x32x16_bf16 v[144:159], v[196:199], v[56:59], v[144:159]
    v_mfma_f32_32x32x16_bf16 v[160:175], v[200:203], v[56:59], v[160:175]
    v_mfma_f32_32x32x16_bf16 v[176:191], v[204:207], v[56:59], v[176:191]
    ds_read_b64_tr_b16 v[192:193], v7 offset:12288
    ds_read_b64_tr_b16 v[194:195], v7 offset:12544
    ds_read_b64_tr_b16 v[196:197], v7 offset:40960
    ds_read_b64_tr_b16 v[198:199], v7 offset:41216
    ds_read_b64_tr_b16 v[200:201], v224 offset:12288
    ds_read_b64_tr_b16 v[202:203], v224 offset:12544
    ds_read_b64_tr_b16 v[204:205], v224 offset:40960
    ds_read_b64_tr_b16 v[206:207], v224 offset:41216
    s_waitcnt lgkmcnt(8)
    v_mfma_f32_32x32x16_bf16 v[128:143], v[208:211], v[60:63], v[128:143]
    v_mfma_f32_32x32x16_bf16 v[144:159], v[212:215], v[60:63], v[144:159]
    v_mfma_f32_32x32x16_bf16 v[160:175], v[216:219], v[60:63], v[160:175]
    v_mfma_f32_32x32x16_bf16 v[176:191], v[220:223], v[60:63], v[176:191]
    ds_read_b64_tr_b16 v[208:209], v7 offset:13312
    ds_read_b64_tr_b16 v[210:211], v7 offset:13568
    ds_read_b64_tr_b16 v[212:213], v7 offset:41984
    ds_read_b64_tr_b16 v[214:215], v7 offset:42240
    ds_read_b64_tr_b16 v[216:217], v224 offset:13312
    ds_read_b64_tr_b16 v[218:219], v224 offset:13568
    ds_read_b64_tr_b16 v[220:221], v224 offset:41984
    ds_read_b64_tr_b16 v[222:223], v224 offset:42240
    s_waitcnt lgkmcnt(8)
    v_mfma_f32_32x32x16_bf16 v[128:143], v[192:195], v[64:67], v[128:143]
    v_mfma_f32_32x32x16_bf16 v[144:159], v[196:199], v[64:67], v[144:159]
    v_mfma_f32_32x32x16_bf16 v[160:175], v[200:203], v[64:67], v[160:175]
    v_mfma_f32_32x32x16_bf16 v[176:191], v[204:207], v[64:67], v[176:191]
    ds_read_b64_tr_b16 v[192:193], v7 offset:14336
    ds_read_b64_tr_b16 v[194:195], v7 offset:14592
    ds_read_b64_tr_b16 v[196:197], v7 offset:43008
    ds_read_b64_tr_b16 v[198:199], v7 offset:43264
    ds_read_b64_tr_b16 v[200:201], v224 offset:14336
    ds_read_b64_tr_b16 v[202:203], v224 offset:14592
    ds_read_b64_tr_b16 v[204:205], v224 offset:43008
    ds_read_b64_tr_b16 v[206:207], v224 offset:43264
    s_waitcnt lgkmcnt(8)
    v_mfma_f32_32x32x16_bf16 v[128:143], v[208:211], v[68:71], v[128:143]
    v_mfma_f32_32x32x16_bf16 v[144:159], v[212:215], v[68:71], v[144:159]
    v_mfma_f32_32x32x16_bf16 v[160:175], v[216:219], v[68:71], v[160:175]
    v_mfma_f32_32x32x16_bf16 v[176:191], v[220:223], v[68:71], v[176:191]
    ds_read_b64_tr_b16 v[208:209], v7 offset:15360
    ds_read_b64_tr_b16 v[210:211], v7 offset:15616
    ds_read_b64_tr_b16 v[212:213], v7 offset:44032
    ds_read_b64_tr_b16 v[214:215], v7 offset:44288
    ds_read_b64_tr_b16 v[216:217], v224 offset:15360
    ds_read_b64_tr_b16 v[218:219], v224 offset:15616
    ds_read_b64_tr_b16 v[220:221], v224 offset:44032
    ds_read_b64_tr_b16 v[222:223], v224 offset:44288
    s_waitcnt lgkmcnt(8)
    v_mfma_f32_32x32x16_bf16 v[128:143], v[192:195], v[72:75], v[128:143]
    v_mfma_f32_32x32x16_bf16 v[144:159], v[196:199], v[72:75], v[144:159]
    v_mfma_f32_32x32x16_bf16 v[160:175], v[200:203], v[72:75], v[160:175]
    v_mfma_f32_32x32x16_bf16 v[176:191], v[204:207], v[72:75], v[176:191]
    ds_read_b64_tr_b16 v[192:193], v7 offset:16384
    ds_read_b64_tr_b16 v[194:195], v7 offset:16640
    ds_read_b64_tr_b16 v[196:197], v7 offset:45056
    ds_read_b64_tr_b16 v[198:199], v7 offset:45312
    ds_read_b64_tr_b16 v[200:201], v224 offset:16384
    ds_read_b64_tr_b16 v[202:203], v224 offset:16640
    ds_read_b64_tr_b16 v[204:205], v224 offset:45056
    ds_read_b64_tr_b16 v[206:207], v224 offset:45312
    s_waitcnt lgkmcnt(8)
    v_mfma_f32_32x32x16_bf16 v[128:143], v[208:211], v[76:79], v[128:143]
    v_mfma_f32_32x32x16_bf16 v[144:159], v[212:215], v[76:79], v[144:159]
    v_mfma_f32_32x32x16_bf16 v[160:175], v[216:219], v[76:79], v[160:175]
    v_mfma_f32_32x32x16_bf16 v[176:191], v[220:223], v[76:79], v[176:191]
    ds_read_b64_tr_b16 v[208:209], v7 offset:17408
    ds_read_b64_tr_b16 v[210:211], v7 offset:17664
    ds_read_b64_tr_b16 v[212:213], v7 offset:46080
    ds_read_b64_tr_b16 v[214:215], v7 offset:46336
    ds_read_b64_tr_b16 v[216:217], v224 offset:17408
    ds_read_b64_tr_b16 v[218:219], v224 offset:17664
    ds_read_b64_tr_b16 v[220:221], v224 offset:46080
    ds_read_b64_tr_b16 v[222:223], v224 offset:46336
    s_waitcnt lgkmcnt(8)
    v_mfma_f32_32x32x16_bf16 v[128:143], v[192:195], v[80:83], v[128:143]
    v_mfma_f32_32x32x16_bf16 v[144:159], v[196:199], v[80:83], v[144:159]
    v_mfma_f32_32x32x16_bf16 v[160:175], v[200:203], v[80:83], v[160:175]
    v_mfma_f32_32x32x16_bf16 v[176:191], v[204:207], v[80:83], v[176:191]
    ds_read_b64_tr_b16 v[192:193], v7 offset:18432
    ds_read_b64_tr_b16 v[194:195], v7 offset:18688
    ds_read_b64_tr_b16 v[196:197], v7 offset:47104
    ds_read_b64_tr_b16 v[198:199], v7 offset:47360
    ds_read_b64_tr_b16 v[200:201], v224 offset:18432
    ds_read_b64_tr_b16 v[202:203], v224 offset:18688
    ds_read_b64_tr_b16 v[204:205], v224 offset:47104
    ds_read_b64_tr_b16 v[206:207], v224 offset:47360
    s_waitcnt lgkmcnt(8)
    v_mfma_f32_32x32x16_bf16 v[128:143], v[208:211], v[84:87], v[128:143]
    v_mfma_f32_32x32x16_bf16 v[144:159], v[212:215], v[84:87], v[144:159]
    v_mfma_f32_32x32x16_bf16 v[160:175], v[216:219], v[84:87], v[160:175]
    v_mfma_f32_32x32x16_bf16 v[176:191], v[220:223], v[84:87], v[176:191]
    ds_read_b64_tr_b16 v[208:209], v7 offset:19456
    ds_read_b64_tr_b16 v[210:211], v7 offset:19712
    ds_read_b64_tr_b16 v[212:213], v7 offset:48128
    ds_read_b64_tr_b16 v[214:215], v7 offset:48384
    ds_read_b64_tr_b16 v[216:217], v224 offset:19456
    ds_read_b64_tr_b16 v[218:219], v224 offset:19712
    ds_read_b64_tr_b16 v[220:221], v224 offset:48128
    ds_read_b64_tr_b16 v[222:223], v224 offset:48384
    s_waitcnt lgkmcnt(8)
    v_mfma_f32_32x32x16_bf16 v[128:143], v[192:195], v[88:91], v[128:143]
    v_mfma_f32_32x32x16_bf16 v[144:159], v[196:199], v[88:91], v[144:159]
    v_mfma_f32_32x32x16_bf16 v[160:175], v[200:203], v[88:91], v[160:175]
    v_mfma_f32_32x32x16_bf16 v[176:191], v[204:207], v[88:91], v[176:191]
    ds_read_b64_tr_b16 v[192:193], v7 offset:20480
    ds_read_b64_tr_b16 v[194:195], v7 offset:20736
    ds_read_b64_tr_b16 v[196:197], v7 offset:49152
    ds_read_b64_tr_b16 v[198:199], v7 offset:49408
    ds_read_b64_tr_b16 v[200:201], v224 offset:20480
    ds_read_b64_tr_b16 v[202:203], v224 offset:20736
    ds_read_b64_tr_b16 v[204:205], v224 offset:49152
    ds_read_b64_tr_b16 v[206:207], v224 offset:49408
    s_waitcnt lgkmcnt(8)
    v_mfma_f32_32x32x16_bf16 v[128:143], v[208:211], v[92:95], v[128:143]
    v_mfma_f32_32x32x16_bf16 v[144:159], v[212:215], v[92:95], v[144:159]
    v_mfma_f32_32x32x16_bf16 v[160:175], v[216:219], v[92:95], v[160:175]
    v_mfma_f32_32x32x16_bf16 v[176:191], v[220:223], v[92:95], v[176:191]
    ds_read_b64_tr_b16 v[208:209], v7 offset:21504
    ds_read_b64_tr_b16 v[210:211], v7 offset:21760
    ds_read_b64_tr_b16 v[212:213], v7 offset:50176
    ds_read_b64_tr_b16 v[214:215], v7 offset:50432
    ds_read_b64_tr_b16 v[216:217], v224 offset:21504
    ds_read_b64_tr_b16 v[218:219], v224 offset:21760
    ds_read_b64_tr_b16 v[220:221], v224 offset:50176
    ds_read_b64_tr_b16 v[222:223], v224 offset:50432
    s_waitcnt lgkmcnt(8)
    v_mfma_f32_32x32x16_bf16 v[128:143], v[192:195], v[96:99], v[128:143]
    v_mfma_f32_32x32x16_bf16 v[144:159], v[196:199], v[96:99], v[144:159]
    v_mfma_f32_32x32x16_bf16 v[160:175], v[200:203], v[96:99], v[160:175]
    v_mfma_f32_32x32x16_bf16 v[176:191], v[204:207], v[96:99], v[176:191]
    ds_read_b64_tr_b16 v[192:193], v7 offset:22528
    ds_read_b64_tr_b16 v[194:195], v7 offset:22784
    ds_read_b64_tr_b16 v[196:197], v7 offset:51200
    ds_read_b64_tr_b16 v[198:199], v7 offset:51456
    ds_read_b64_tr_b16 v[200:201], v224 offset:22528
    ds_read_b64_tr_b16 v[202:203], v224 offset:22784
    ds_read_b64_tr_b16 v[204:205], v224 offset:51200
    ds_read_b64_tr_b16 v[206:207], v224 offset:51456
    s_waitcnt lgkmcnt(8)
    v_mfma_f32_32x32x16_bf16 v[128:143], v[208:211], v[100:103], v[128:143]
    v_mfma_f32_32x32x16_bf16 v[144:159], v[212:215], v[100:103], v[144:159]
    v_mfma_f32_32x32x16_bf16 v[160:175], v[216:219], v[100:103], v[160:175]
    v_mfma_f32_32x32x16_bf16 v[176:191], v[220:223], v[100:103], v[176:191]
    ds_read_b64_tr_b16 v[208:209], v7 offset:23552
    ds_read_b64_tr_b16 v[210:211], v7 offset:23808
    ds_read_b64_tr_b16 v[212:213], v7 offset:52224
    ds_read_b64_tr_b16 v[214:215], v7 offset:52480
    ds_read_b64_tr_b16 v[216:217], v224 offset:23552
    ds_read_b64_tr_b16 v[218:219], v224 offset:23808
    ds_read_b64_tr_b16 v[220:221], v224 offset:52224
    ds_read_b64_tr_b16 v[222:223], v224 offset:52480
    s_waitcnt lgkmcnt(8)
    v_mfma_f32_32x32x16_bf16 v[128:143], v[192:195], v[104:107], v[128:143]
    v_mfma_f32_32x32x16_bf16 v[144:159], v[196:199], v[104:107], v[144:159]
    v_mfma_f32_32x32x16_bf16 v[160:175], v[200:203], v[104:107], v[160:175]
    v_mfma_f32_32x32x16_bf16 v[176:191], v[204:207], v[104:107], v[176:191]
    ds_read_b64_tr_b16 v[192:193], v7 offset:24576
    ds_read_b64_tr_b16 v[194:195], v7 offset:24832
    ds_read_b64_tr_b16 v[196:197], v7 offset:53248
    ds_read_b64_tr_b16 v[198:199], v7 offset:53504
    ds_read_b64_tr_b16 v[200:201], v224 offset:24576
    ds_read_b64_tr_b16 v[202:203], v224 offset:24832
    ds_read_b64_tr_b16 v[204:205], v224 offset:53248
    ds_read_b64_tr_b16 v[206:207], v224 offset:53504
    s_waitcnt lgkmcnt(8)
    v_mfma_f32_32x32x16_bf16 v[128:143], v[208:211], v[108:111], v[128:143]
    v_mfma_f32_32x32x16_bf16 v[144:159], v[212:215], v[108:111], v[144:159]
    v_mfma_f32_32x32x16_bf16 v[160:175], v[216:219], v[108:111], v[160:175]
    v_mfma_f32_32x32x16_bf16 v[176:191], v[220:223], v[108:111], v[176:191]
    ds_read_b64_tr_b16 v[208:209], v7 offset:25600
    ds_read_b64_tr_b16 v[210:211], v7 offset:25856
    ds_read_b64_tr_b16 v[212:213], v7 offset:54272
    ds_read_b64_tr_b16 v[214:215], v7 offset:54528
    ds_read_b64_tr_b16 v[216:217], v224 offset:25600
    ds_read_b64_tr_b16 v[218:219], v224 offset:25856
    ds_read_b64_tr_b16 v[220:221], v224 offset:54272
    ds_read_b64_tr_b16 v[222:223], v224 offset:54528
    s_waitcnt lgkmcnt(8)
    v_mfma_f32_32x32x16_bf16 v[128:143], v[192:195], v[112:115], v[128:143]
    v_mfma_f32_32x32x16_bf16 v[144:159], v[196:199], v[112:115], v[144:159]
    v_mfma_f32_32x32x16_bf16 v[160:175], v[200:203], v[112:115], v[160:175]
    v_mfma_f32_32x32x16_bf16 v[176:191], v[204:207], v[112:115], v[176:191]
    ds_read_b64_tr_b16 v[192:193], v7 offset:26624
    ds_read_b64_tr_b16 v[194:195], v7 offset:26880
    ds_read_b64_tr_b16 v[196:197], v7 offset:55296
    ds_read_b64_tr_b16 v[198:199], v7 offset:55552
    ds_read_b64_tr_b16 v[200:201], v224 offset:26624
    ds_read_b64_tr_b16 v[202:203], v224 offset:26880
    ds_read_b64_tr_b16 v[204:205], v224 offset:55296
    ds_read_b64_tr_b16 v[206:207], v224 offset:55552
    s_waitcnt lgkmcnt(8)
    v_mfma_f32_32x32x16_bf16 v[128:143], v[208:211], v[116:119], v[128:143]
    v_mfma_f32_32x32x16_bf16 v[144:159], v[212:215], v[116:119], v[144:159]
    v_mfma_f32_32x32x16_bf16 v[160:175], v[216:219], v[116:119], v[160:175]
    v_mfma_f32_32x32x16_bf16 v[176:191], v[220:223], v[116:119], v[176:191]
    ds_read_b64_tr_b16 v[208:209], v7 offset:27648
    ds_read_b64_tr_b16 v[210:211], v7 offset:27904
    ds_read_b64_tr_b16 v[212:213], v7 offset:56320
    ds_read_b64_tr_b16 v[214:215], v7 offset:56576
    ds_read_b64_tr_b16 v[216:217], v224 offset:27648
    ds_read_b64_tr_b16 v[218:219], v224 offset:27904
    ds_read_b64_tr_b16 v[220:221], v224 offset:56320
    ds_read_b64_tr_b16 v[222:223], v224 offset:56576
    s_waitcnt lgkmcnt(8)
    v_mfma_f32_32x32x16_bf16 v[128:143], v[192:195], v[120:123], v[128:143]
    v_mfma_f32_32x32x16_bf16 v[144:159], v[196:199], v[120:123], v[144:159]
    v_mfma_f32_32x32x16_bf16 v[160:175], v[200:203], v[120:123], v[160:175]
    v_mfma_f32_32x32x16_bf16 v[176:191], v[204:207], v[120:123], v[176:191]
    s_waitcnt lgkmcnt(0)
    v_mfma_f32_32x32x16_bf16 v[128:143], v[208:211], v[124:127], v[128:143]
    v_mfma_f32_32x32x16_bf16 v[144:159], v[212:215], v[124:127], v[144:159]
    v_mfma_f32_32x32x16_bf16 v[160:175], v[216:219], v[124:127], v[160:175]
    v_mfma_f32_32x32x16_bf16 v[176:191], v[220:223], v[124:127], v[176:191]
    s_nop 15
    s_nop 3
    v_lshrrev_b32 v13, 1, v5
    v_lshlrev_b32 v13, 11, v13
    v_and_b32 v14, 1, v5
    v_lshl_add_u32 v13, v14, 8, v13
    s_mov_b32 s35, 0x3e8b97f6
    v_mul_f32 v128, s35, v128
    v_mul_f32 v129, s35, v129
    v_mul_f32 v130, s35, v130
    v_mul_f32 v131, s35, v131
    v_mul_f32 v132, s35, v132
    v_mul_f32 v133, s35, v133
    v_mul_f32 v134, s35, v134
    v_mul_f32 v135, s35, v135
    v_mul_f32 v136, s35, v136
    v_mul_f32 v137, s35, v137
    v_mul_f32 v138, s35, v138
    v_mul_f32 v139, s35, v139
    v_mul_f32 v140, s35, v140
    v_mul_f32 v141, s35, v141
    v_mul_f32 v142, s35, v142
    v_mul_f32 v143, s35, v143
    v_cvt_pk_bf16_f32 v128, v128, v129
    v_cvt_pk_bf16_f32 v129, v130, v131
    v_mov_b32 v14, 152
    v_mov_b32 v15, 656
    v_cndmask_b32 v14, v14, v15, s[30:31]
    v_add_u32 v14, v14, v13
    buffer_store_dwordx2 v[128:129], v14, s[16:19], 0 offen
    v_cvt_pk_bf16_f32 v132, v132, v133
    v_cvt_pk_bf16_f32 v133, v134, v135
    v_mov_b32 v14, 664
    v_mov_b32 v15, 1168
    v_cndmask_b32 v14, v14, v15, s[30:31]
    v_add_u32 v14, v14, v13
    buffer_store_dwordx2 v[132:133], v14, s[16:19], 0 offen
    v_cvt_pk_bf16_f32 v136, v136, v137
    v_cvt_pk_bf16_f32 v137, v138, v139
    v_mov_b32 v14, 1176
    v_mov_b32 v15, 1680
    v_cndmask_b32 v14, v14, v15, s[30:31]
    v_add_u32 v14, v14, v13
    buffer_store_dwordx2 v[136:137], v14, s[16:19], 0 offen
    v_cvt_pk_bf16_f32 v140, v140, v141
    v_cvt_pk_bf16_f32 v141, v142, v143
    v_mov_b32 v14, 160
    v_mov_b32 v15, 168
    v_cndmask_b32 v14, v14, v15, s[30:31]
    v_add_u32 v14, v14, v13
    buffer_store_dwordx2 v[140:141], v14, s[16:19], 0 offen
    v_lshrrev_b32 v13, 1, v5
    v_lshlrev_b32 v13, 11, v13
    v_and_b32 v14, 1, v5
    v_lshl_add_u32 v13, v14, 8, v13
    s_mov_b32 s35, 0x3e8b97f6
    v_mul_f32 v144, s35, v144
    v_mul_f32 v145, s35, v145
    v_mul_f32 v146, s35, v146
    v_mul_f32 v147, s35, v147
    v_mul_f32 v148, s35, v148
    v_mul_f32 v149, s35, v149
    v_mul_f32 v150, s35, v150
    v_mul_f32 v151, s35, v151
    v_mul_f32 v152, s35, v152
    v_mul_f32 v153, s35, v153
    v_mul_f32 v154, s35, v154
    v_mul_f32 v155, s35, v155
    v_mul_f32 v156, s35, v156
    v_mul_f32 v157, s35, v157
    v_mul_f32 v158, s35, v158
    v_mul_f32 v159, s35, v159
    v_cvt_pk_bf16_f32 v144, v144, v145
    v_cvt_pk_bf16_f32 v145, v146, v147
    v_mov_b32 v14, 672
    v_mov_b32 v15, 680
    v_cndmask_b32 v14, v14, v15, s[30:31]
    v_add_u32 v14, v14, v13
    buffer_store_dwordx2 v[144:145], v14, s[16:19], 0 offen
    v_cvt_pk_bf16_f32 v148, v148, v149
    v_cvt_pk_bf16_f32 v149, v150, v151
    v_mov_b32 v14, 1184
    v_mov_b32 v15, 1192
    v_cndmask_b32 v14, v14, v15, s[30:31]
    v_add_u32 v14, v14, v13
    buffer_store_dwordx2 v[148:149], v14, s[16:19], 0 offen
    v_cvt_pk_bf16_f32 v152, v152, v153
    v_cvt_pk_bf16_f32 v153, v154, v155
    v_mov_b32 v14, 1696
    v_mov_b32 v15, 176
    v_cndmask_b32 v14, v14, v15, s[30:31]
    v_add_u32 v14, v14, v13
    buffer_store_dwordx2 v[152:153], v14, s[16:19], 0 offen
    v_cvt_pk_bf16_f32 v156, v156, v157
    v_cvt_pk_bf16_f32 v157, v158, v159
    v_mov_b32 v14, 184
    v_mov_b32 v15, 688
    v_cndmask_b32 v14, v14, v15, s[30:31]
    v_add_u32 v14, v14, v13
    buffer_store_dwordx2 v[156:157], v14, s[16:19], 0 offen
    v_lshrrev_b32 v13, 1, v5
    v_lshlrev_b32 v13, 11, v13
    v_and_b32 v14, 1, v5
    v_lshl_add_u32 v13, v14, 8, v13
    s_mov_b32 s35, 0x3e8b97f6
    v_mul_f32 v160, s35, v160
    v_mul_f32 v161, s35, v161
    v_mul_f32 v162, s35, v162
    v_mul_f32 v163, s35, v163
    v_mul_f32 v164, s35, v164
    v_mul_f32 v165, s35, v165
    v_mul_f32 v166, s35, v166
    v_mul_f32 v167, s35, v167
    v_mul_f32 v168, s35, v168
    v_mul_f32 v169, s35, v169
    v_mul_f32 v170, s35, v170
    v_mul_f32 v171, s35, v171
    v_mul_f32 v172, s35, v172
    v_mul_f32 v173, s35, v173
    v_mul_f32 v174, s35, v174
    v_mul_f32 v175, s35, v175
    v_cvt_pk_bf16_f32 v160, v160, v161
    v_cvt_pk_bf16_f32 v161, v162, v163
    v_mov_b32 v14, 696
    v_mov_b32 v15, 1200
    v_cndmask_b32 v14, v14, v15, s[30:31]
    v_add_u32 v14, v14, v13
    buffer_store_dwordx2 v[160:161], v14, s[16:19], 0 offen
    v_cvt_pk_bf16_f32 v164, v164, v165
    v_cvt_pk_bf16_f32 v165, v166, v167
    v_mov_b32 v14, 1208
    v_mov_b32 v15, 1712
    v_cndmask_b32 v14, v14, v15, s[30:31]
    v_add_u32 v14, v14, v13
    buffer_store_dwordx2 v[164:165], v14, s[16:19], 0 offen
    v_cvt_pk_bf16_f32 v168, v168, v169
    v_cvt_pk_bf16_f32 v169, v170, v171
    v_mov_b32 v14, 192
    v_mov_b32 v15, 200
    v_cndmask_b32 v14, v14, v15, s[30:31]
    v_add_u32 v14, v14, v13
    buffer_store_dwordx2 v[168:169], v14, s[16:19], 0 offen
    v_cvt_pk_bf16_f32 v172, v172, v173
    v_cvt_pk_bf16_f32 v173, v174, v175
    v_mov_b32 v14, 704
    v_mov_b32 v15, 712
    v_cndmask_b32 v14, v14, v15, s[30:31]
    v_add_u32 v14, v14, v13
    buffer_store_dwordx2 v[172:173], v14, s[16:19], 0 offen
    v_lshrrev_b32 v13, 1, v5
    v_lshlrev_b32 v13, 11, v13
    v_and_b32 v14, 1, v5
    v_lshl_add_u32 v13, v14, 8, v13
    s_mov_b32 s35, 0x3e8b97f6
    v_mul_f32 v176, s35, v176
    v_mul_f32 v177, s35, v177
    v_mul_f32 v178, s35, v178
    v_mul_f32 v179, s35, v179
    v_mul_f32 v180, s35, v180
    v_mul_f32 v181, s35, v181
    v_mul_f32 v182, s35, v182
    v_mul_f32 v183, s35, v183
    v_mul_f32 v184, s35, v184
    v_mul_f32 v185, s35, v185
    v_mul_f32 v186, s35, v186
    v_mul_f32 v187, s35, v187
    v_mul_f32 v188, s35, v188
    v_mul_f32 v189, s35, v189
    v_mul_f32 v190, s35, v190
    v_mul_f32 v191, s35, v191
    v_cvt_pk_bf16_f32 v176, v176, v177
    v_cvt_pk_bf16_f32 v177, v178, v179
    v_mov_b32 v14, 1216
    v_mov_b32 v15, 1224
    v_cndmask_b32 v14, v14, v15, s[30:31]
    v_add_u32 v14, v14, v13
    buffer_store_dwordx2 v[176:177], v14, s[16:19], 0 offen
    v_cvt_pk_bf16_f32 v180, v180, v181
    v_cvt_pk_bf16_f32 v181, v182, v183
    v_mov_b32 v14, 1728
    v_mov_b32 v15, 208
    v_cndmask_b32 v14, v14, v15, s[30:31]
    v_add_u32 v14, v14, v13
    buffer_store_dwordx2 v[180:181], v14, s[16:19], 0 offen
    v_cvt_pk_bf16_f32 v184, v184, v185
    v_cvt_pk_bf16_f32 v185, v186, v187
    v_mov_b32 v14, 216
    v_mov_b32 v15, 720
    v_cndmask_b32 v14, v14, v15, s[30:31]
    v_add_u32 v14, v14, v13
    buffer_store_dwordx2 v[184:185], v14, s[16:19], 0 offen
    v_cvt_pk_bf16_f32 v188, v188, v189
    v_cvt_pk_bf16_f32 v189, v190, v191
    v_mov_b32 v14, 728
    v_mov_b32 v15, 1232
    v_cndmask_b32 v14, v14, v15, s[30:31]
    v_add_u32 v14, v14, v13
    buffer_store_dwordx2 v[188:189], v14, s[16:19], 0 offen
    s_endpgm
K1_v3:
    s_mov_b32 s12, s38
    s_and_b32 s13, s39, 0xffff
    s_mov_b32 s14, 401408
    s_mov_b32 s15, 0x00020000
    s_movk_i32 s35, 896
    v_lshrrev_b32 v227, 2, v0
    v_mul_lo_u32 v227, v227, s35
    v_and_b32 v14, 3, v0
    v_lshl_add_u32 v227, v14, 4, v227
    s_mov_b32 s35, 768
    buffer_load_dwordx4 v[128:131], v227, s[12:15], s35 offen
    s_mov_b32 s35, 58112
    buffer_load_dwordx4 v[132:135], v227, s[12:15], s35 offen
    s_mov_b32 s35, 115456
    buffer_load_dwordx4 v[136:139], v227, s[12:15], s35 offen
    s_mov_b32 s35, 172800
    buffer_load_dwordx4 v[140:143], v227, s[12:15], s35 offen
    s_mov_b32 s35, 230144
    buffer_load_dwordx4 v[144:147], v227, s[12:15], s35 offen
    s_mov_b32 s35, 287488
    buffer_load_dwordx4 v[148:151], v227, s[12:15], s35 offen
    s_mov_b32 s35, 344832
    buffer_load_dwordx4 v[152:155], v227, s[12:15], s35 offen
    s_mov_b32 s12, s38
    s_and_b32 s13, s39, 0xffff
    s_mov_b32 s14, 401408
    s_mov_b32 s15, 0x00020000
    s_movk_i32 s35, 896
    v_lshrrev_b32 v227, 2, v0
    v_mul_lo_u32 v227, v227, s35
    v_and_b32 v14, 3, v0
    v_lshl_add_u32 v227, v14, 4, v227
    s_mov_b32 s35, 832
    buffer_load_dwordx4 v[156:159], v227, s[12:15], s35 offen
    s_mov_b32 s35, 58176
    buffer_load_dwordx4 v[160:163], v227, s[12:15], s35 offen
    s_mov_b32 s35, 115520
    buffer_load_dwordx4 v[164:167], v227, s[12:15], s35 offen
    s_mov_b32 s35, 172864
    buffer_load_dwordx4 v[168:171], v227, s[12:15], s35 offen
    s_mov_b32 s35, 230208
    buffer_load_dwordx4 v[172:175], v227, s[12:15], s35 offen
    s_mov_b32 s35, 287552
    buffer_load_dwordx4 v[176:179], v227, s[12:15], s35 offen
    s_mov_b32 s35, 344896
    buffer_load_dwordx4 v[180:183], v227, s[12:15], s35 offen
    s_mov_b32 s54, 0x4924925
    v_add_u32 v13, 0, v2
    v_mul_hi_u32 v14, v13, s54
    v_lshlrev_b32 v13, 4, v13
    v_lshl_add_u32 v13, v14, 4, v13
    v_add_u32 v13, s53, v13
    s_waitcnt vmcnt(41)
    ds_write_b128 v13, v[16:19]
    v_add_u32 v13, 64, v2
    v_mul_hi_u32 v14, v13, s54
    v_lshlrev_b32 v13, 4, v13
    v_lshl_add_u32 v13, v14, 4, v13
    v_add_u32 v13, s53, v13
    s_waitcnt vmcnt(40)
    ds_write_b128 v13, v[20:23]
    v_add_u32 v13, 128, v2
    v_mul_hi_u32 v14, v13, s54
    v_lshlrev_b32 v13, 4, v13
    v_lshl_add_u32 v13, v14, 4, v13
    v_add_u32 v13, s53, v13
    s_waitcnt vmcnt(39)
    ds_write_b128 v13, v[24:27]
    v_add_u32 v13, 192, v2
    v_mul_hi_u32 v14, v13, s54
    v_lshlrev_b32 v13, 4, v13
    v_lshl_add_u32 v13, v14, 4, v13
    v_add_u32 v13, s53, v13
    s_waitcnt vmcnt(38)
    ds_write_b128 v13, v[28:31]
    v_add_u32 v13, 256, v2
    v_mul_hi_u32 v14, v13, s54
    v_lshlrev_b32 v13, 4, v13
    v_lshl_add_u32 v13, v14, 4, v13
    v_add_u32 v13, s53, v13
    s_waitcnt vmcnt(37)
    ds_write_b128 v13, v[32:35]
    v_add_u32 v13, 320, v2
    v_mul_hi_u32 v14, v13, s54
    v_lshlrev_b32 v13, 4, v13
    v_lshl_add_u32 v13, v14, 4, v13
    v_add_u32 v13, s53, v13
    s_waitcnt vmcnt(36)
    ds_write_b128 v13, v[36:39]
    v_add_u32 v13, 384, v2
    v_mul_hi_u32 v14, v13, s54
    v_lshlrev_b32 v13, 4, v13
    v_lshl_add_u32 v13, v14, 4, v13
    v_add_u32 v13, s53, v13
    s_waitcnt vmcnt(35)
    ds_write_b128 v13, v[40:43]
    v_add_u32 v13, 448, v2
    v_mul_hi_u32 v14, v13, s54
    v_lshlrev_b32 v13, 4, v13
    v_lshl_add_u32 v13, v14, 4, v13
    v_add_u32 v13, s53, v13
    s_waitcnt vmcnt(34)
    ds_write_b128 v13, v[44:47]
    v_add_u32 v13, 512, v2
    v_mul_hi_u32 v14, v13, s54
    v_lshlrev_b32 v13, 4, v13
    v_lshl_add_u32 v13, v14, 4, v13
    v_add_u32 v13, s53, v13
    s_waitcnt vmcnt(33)
    ds_write_b128 v13, v[48:51]
    v_add_u32 v13, 576, v2
    v_mul_hi_u32 v14, v13, s54
    v_lshlrev_b32 v13, 4, v13
    v_lshl_add_u32 v13, v14, 4, v13
    v_add_u32 v13, s53, v13
    s_waitcnt vmcnt(32)
    ds_write_b128 v13, v[52:55]
    v_add_u32 v13, 640, v2
    v_mul_hi_u32 v14, v13, s54
    v_lshlrev_b32 v13, 4, v13
    v_lshl_add_u32 v13, v14, 4, v13
    v_add_u32 v13, s53, v13
    s_waitcnt vmcnt(31)
    ds_write_b128 v13, v[56:59]
    v_add_u32 v13, 704, v2
    v_mul_hi_u32 v14, v13, s54
    v_lshlrev_b32 v13, 4, v13
    v_lshl_add_u32 v13, v14, 4, v13
    v_add_u32 v13, s53, v13
    s_waitcnt vmcnt(30)
    ds_write_b128 v13, v[60:63]
    v_add_u32 v13, 768, v2
    v_mul_hi_u32 v14, v13, s54
    v_lshlrev_b32 v13, 4, v13
    v_lshl_add_u32 v13, v14, 4, v13
    v_add_u32 v13, s53, v13
    s_waitcnt vmcnt(29)
    ds_write_b128 v13, v[64:67]
    v_add_u32 v13, 832, v2
    v_mul_hi_u32 v14, v13, s54
    v_lshlrev_b32 v13, 4, v13
    v_lshl_add_u32 v13, v14, 4, v13
    v_add_u32 v13, s53, v13
    s_waitcnt vmcnt(28)
    ds_write_b128 v13, v[68:71]
    v_add_u32 v13, 896, v2
    v_mul_hi_u32 v14, v13, s54
    v_lshlrev_b32 v13, 4, v13
    v_lshl_add_u32 v13, v14, 4, v13
    v_add_u32 v13, s53, v13
    s_waitcnt vmcnt(27)
    ds_write_b128 v13, v[72:75]
    v_add_u32 v13, 960, v2
    v_mul_hi_u32 v14, v13, s54
    v_lshlrev_b32 v13, 4, v13
    v_lshl_add_u32 v13, v14, 4, v13
    v_add_u32 v13, s53, v13
    s_waitcnt vmcnt(26)
    ds_write_b128 v13, v[76:79]
    v_add_u32 v13, 1024, v2
    v_mul_hi_u32 v14, v13, s54
    v_lshlrev_b32 v13, 4, v13
    v_lshl_add_u32 v13, v14, 4, v13
    v_add_u32 v13, s53, v13
    s_waitcnt vmcnt(25)
    ds_write_b128 v13, v[80:83]
    v_add_u32 v13, 1088, v2
    v_mul_hi_u32 v14, v13, s54
    v_lshlrev_b32 v13, 4, v13
    v_lshl_add_u32 v13, v14, 4, v13
    v_add_u32 v13, s53, v13
    s_waitcnt vmcnt(24)
    ds_write_b128 v13, v[84:87]
    v_add_u32 v13, 1152, v2
    v_mul_hi_u32 v14, v13, s54
    v_lshlrev_b32 v13, 4, v13
    v_lshl_add_u32 v13, v14, 4, v13
    v_add_u32 v13, s53, v13
    s_waitcnt vmcnt(23)
    ds_write_b128 v13, v[88:91]
    v_add_u32 v13, 1216, v2
    v_mul_hi_u32 v14, v13, s54
    v_lshlrev_b32 v13, 4, v13
    v_lshl_add_u32 v13, v14, 4, v13
    v_add_u32 v13, s53, v13
    s_waitcnt vmcnt(22)
    ds_write_b128 v13, v[92:95]
    v_add_u32 v13, 1280, v2
    v_mul_hi_u32 v14, v13, s54
    v_lshlrev_b32 v13, 4, v13
    v_lshl_add_u32 v13, v14, 4, v13
    v_add_u32 v13, s53, v13
    s_waitcnt vmcnt(21)
    ds_write_b128 v13, v[96:99]
    v_add_u32 v13, 1344, v2
    v_mul_hi_u32 v14, v13, s54
    v_lshlrev_b32 v13, 4, v13
    v_lshl_add_u32 v13, v14, 4, v13
    v_add_u32 v13, s53, v13
    s_waitcnt vmcnt(20)
    ds_write_b128 v13, v[100:103]
    v_add_u32 v13, 1408, v2
    v_mul_hi_u32 v14, v13, s54
    v_lshlrev_b32 v13, 4, v13
    v_lshl_add_u32 v13, v14, 4, v13
    v_add_u32 v13, s53, v13
    s_waitcnt vmcnt(19)
    ds_write_b128 v13, v[104:107]
    v_add_u32 v13, 1472, v2
    v_mul_hi_u32 v14, v13, s54
    v_lshlrev_b32 v13, 4, v13
    v_lshl_add_u32 v13, v14, 4, v13
    v_add_u32 v13, s53, v13
    s_waitcnt vmcnt(18)
    ds_write_b128 v13, v[108:111]
    v_add_u32 v13, 1536, v2
    v_mul_hi_u32 v14, v13, s54
    v_lshlrev_b32 v13, 4, v13
    v_lshl_add_u32 v13, v14, 4, v13
    v_add_u32 v13, s53, v13
    s_waitcnt vmcnt(17)
    ds_write_b128 v13, v[112:115]
    v_add_u32 v13, 1600, v2
    v_mul_hi_u32 v14, v13, s54
    v_lshlrev_b32 v13, 4, v13
    v_lshl_add_u32 v13, v14, 4, v13
    v_add_u32 v13, s53, v13
    s_waitcnt vmcnt(16)
    ds_write_b128 v13, v[116:119]
    v_add_u32 v13, 1664, v2
    v_mul_hi_u32 v14, v13, s54
    v_lshlrev_b32 v13, 4, v13
    v_lshl_add_u32 v13, v14, 4, v13
    v_add_u32 v13, s53, v13
    s_waitcnt vmcnt(15)
    ds_write_b128 v13, v[120:123]
    v_add_u32 v13, 1728, v2
    v_mul_hi_u32 v14, v13, s54
    v_lshlrev_b32 v13, 4, v13
    v_lshl_add_u32 v13, v14, 4, v13
    v_add_u32 v13, s53, v13
    s_waitcnt vmcnt(14)
    ds_write_b128 v13, v[124:127]
    v_mul_u32_u24 v13, 912, v3
    v_lshl_add_u32 v13, v4, 4, v13
    v_add_u32 v13, s53, v13
    s_waitcnt lgkmcnt(0)
    ds_read_b128 v[16:19], v13 offset:0
    ds_read_b128 v[20:23], v13 offset:32
    ds_read_b128 v[24:27], v13 offset:64
    ds_read_b128 v[28:31], v13 offset:96
    ds_read_b128 v[32:35], v13 offset:128
    ds_read_b128 v[36:39], v13 offset:160
    ds_read_b128 v[40:43], v13 offset:192
    ds_read_b128 v[44:47], v13 offset:224
    ds_read_b128 v[48:51], v13 offset:256
    ds_read_b128 v[52:55], v13 offset:288
    ds_read_b128 v[56:59], v13 offset:320
    ds_read_b128 v[60:63], v13 offset:352
    ds_read_b128 v[64:67], v13 offset:384
    ds_read_b128 v[68:71], v13 offset:416
    ds_read_b128 v[72:75], v13 offset:448
    ds_read_b128 v[76:79], v13 offset:480
    ds_read_b128 v[80:83], v13 offset:512
    ds_read_b128 v[84:87], v13 offset:544
    ds_read_b128 v[88:91], v13 offset:576
    ds_read_b128 v[92:95], v13 offset:608
    ds_read_b128 v[96:99], v13 offset:640
    ds_read_b128 v[100:103], v13 offset:672
    ds_read_b128 v[104:107], v13 offset:704
    ds_read_b128 v[108:111], v13 offset:736
    ds_read_b128 v[112:115], v13 offset:768
    ds_read_b128 v[116:119], v13 offset:800
    ds_read_b128 v[120:123], v13 offset:832
    ds_read_b128 v[124:127], v13 offset:864
    s_waitcnt lgkmcnt(0)
    s_barrier
    s_waitcnt vmcnt(13)
    ds_write_b128 v11, v[128:131] offset:0
    s_waitcnt vmcnt(12)
    ds_write_b128 v11, v[132:135] offset:4096
    s_waitcnt vmcnt(11)
    ds_write_b128 v11, v[136:139] offset:8192
    s_waitcnt vmcnt(10)
    ds_write_b128 v11, v[140:143] offset:12288
    s_waitcnt vmcnt(9)
    ds_write_b128 v11, v[144:147] offset:16384
    s_waitcnt vmcnt(8)
    ds_write_b128 v11, v[148:151] offset:20480
    s_waitcnt vmcnt(7)
    ds_write_b128 v11, v[152:155] offset:24576
    s_waitcnt vmcnt(6)
    ds_write_b128 v11, v[156:159] offset:28672
    s_waitcnt vmcnt(5)
    ds_write_b128 v11, v[160:163] offset:32768
    s_waitcnt vmcnt(4)
    ds_write_b128 v11, v[164:167] offset:36864
    s_waitcnt vmcnt(3)
    ds_write_b128 v11, v[168:171] offset:40960
    s_waitcnt vmcnt(2)
    ds_write_b128 v11, v[172:175] offset:45056
    s_waitcnt vmcnt(1)
    ds_write_b128 v11, v[176:179] offset:49152
    s_waitcnt vmcnt(0)
    ds_write_b128 v11, v[180:183] offset:53248
    s_mov_b32 s12, s40
    s_and_b32 s13, s41, 0xffff
    s_mov_b32 s14, 25088
    s_mov_b32 s15, 0x00020000
    v_lshrrev_b32 v13, 3, v0
    v_mul_u32_u24 v13, 56, v13
    v_and_b32 v14, 7, v0
    v_lshl_add_u32 v13, v14, 3, v13
    v_mov_b32 v15, 0x7fffff00
    v_cmp_eq_u32 vcc, 7, v14
    s_nop 1
    v_cndmask_b32 v13, v13, v15, vcc
    s_movk_i32 s35, 0
    buffer_load_dwordx2 v[128:129], v13, s[12:15], s35 offen
    s_movk_i32 s35, 1792
    buffer_load_dwordx2 v[130:131], v13, s[12:15], s35 offen
    s_movk_i32 s35, 3584
    buffer_load_dwordx2 v[132:133], v13, s[12:15], s35 offen
    s_movk_i32 s35, 5376
    buffer_load_dwordx2 v[134:135], v13, s[12:15], s35 offen
    s_movk_i32 s35, 7168
    buffer_load_dwordx2 v[136:137], v13, s[12:15], s35 offen
    s_movk_i32 s35, 8960
    buffer_load_dwordx2 v[138:139], v13, s[12:15], s35 offen
    s_movk_i32 s35, 10752
    buffer_load_dwordx2 v[140:141], v13, s[12:15], s35 offen
    s_movk_i32 s35, 12544
    buffer_load_dwordx2 v[142:143], v13, s[12:15], s35 offen
    s_movk_i32 s35, 14336
    buffer_load_dwordx2 v[144:145], v13, s[12:15], s35 offen
    s_movk_i32 s35, 16128
    buffer_load_dwordx2 v[146:147], v13, s[12:15], s35 offen
    s_movk_i32 s35, 17920
    buffer_load_dwordx2 v[148:149], v13, s[12:15], s35 offen
    s_movk_i32 s35, 19712
    buffer_load_dwordx2 v[150:151], v13, s[12:15], s35 offen
    s_movk_i32 s35, 21504
    buffer_load_dwordx2 v[152:153], v13, s[12:15], s35 offen
    s_movk_i32 s35, 23296
    buffer_load_dwordx2 v[154:155], v13, s[12:15], s35 offen
    s_load_dwordx2 s[48:49], s[0:1], 64
    s_waitcnt lgkmcnt(0)
    s_mov_b32 s20, s48
    s_and_b32 s21, s49, 0xffff
    s_mov_b32 s22, 896
    s_mov_b32 s23, 0x00020000
    v_lshrrev_b32 v15, 3, v0
    v_lshlrev_b32 v15, 1, v15
    s_and_saveexec_b64 s[50:51], vcc
    buffer_load_ushort v128, v15, s[20:23], 0 offen offset:0
    buffer_load_ushort v130, v15, s[20:23], 0 offen offset:64
    buffer_load_ushort v132, v15, s[20:23], 0 offen offset:128
    buffer_load_ushort v134, v15, s[20:23], 0 offen offset:192
    buffer_load_ushort v136, v15, s[20:23], 0 offen offset:256
    buffer_load_ushort v138, v15, s[20:23], 0 offen offset:320
    buffer_load_ushort v140, v15, s[20:23], 0 offen offset:384
    buffer_load_ushort v142, v15, s[20:23], 0 offen offset:448
    buffer_load_ushort v144, v15, s[20:23], 0 offen offset:512
    buffer_load_ushort v146, v15, s[20:23], 0 offen offset:576
    buffer_load_ushort v148, v15, s[20:23], 0 offen offset:640
    buffer_load_ushort v150, v15, s[20:23], 0 offen offset:704
    buffer_load_ushort v152, v15, s[20:23], 0 offen offset:768
    buffer_load_ushort v154, v15, s[20:23], 0 offen offset:832
    s_mov_b64 exec, s[50:51]
    s_waitcnt vmcnt(0)
    s_waitcnt vmcnt(13)
    ds_write_b64 v226, v[128:129] offset:0
    s_waitcnt vmcnt(12)
    ds_write_b64 v226, v[130:131] offset:2048
    s_waitcnt vmcnt(11)
    ds_write_b64 v226, v[132:133] offset:4096
    s_waitcnt vmcnt(10)
    ds_write_b64 v226, v[134:135] offset:6144
    s_waitcnt vmcnt(9)
    ds_write_b64 v226, v[136:137] offset:8192
    s_waitcnt vmcnt(8)
    ds_write_b64 v226, v[138:139] offset:10240
    s_waitcnt vmcnt(7)
    ds_write_b64 v226, v[140:141] offset:12288
    s_waitcnt vmcnt(6)
    ds_write_b64 v226, v[142:143] offset:14336
    s_waitcnt vmcnt(5)
    ds_write_b64 v226, v[144:145] offset:16384
    s_waitcnt vmcnt(4)
    ds_write_b64 v226, v[146:147] offset:18432
    s_waitcnt vmcnt(3)
    ds_write_b64 v226, v[148:149] offset:20480
    s_waitcnt vmcnt(2)
    ds_write_b64 v226, v[150:151] offset:22528
    s_waitcnt vmcnt(1)
    ds_write_b64 v226, v[152:153] offset:24576
    s_waitcnt vmcnt(0)
    ds_write_b64 v226, v[154:155] offset:26624
    s_mov_b32 s12, s42
    s_and_b32 s13, s43, 0xffff
    s_mov_b32 s14, 25088
    s_mov_b32 s15, 0x00020000
    v_lshrrev_b32 v13, 3, v0
    v_mul_u32_u24 v13, 56, v13
    v_and_b32 v14, 7, v0
    v_lshl_add_u32 v13, v14, 3, v13
    v_mov_b32 v15, 0x7fffff00
    v_cmp_eq_u32 vcc, 7, v14
    s_nop 1
    v_cndmask_b32 v13, v13, v15, vcc
    s_movk_i32 s35, 0
    buffer_load_dwordx2 v[128:129], v13, s[12:15], s35 offen
    s_movk_i32 s35, 1792
    buffer_load_dwordx2 v[130:131], v13, s[12:15], s35 offen
    s_movk_i32 s35, 3584
    buffer_load_dwordx2 v[132:133], v13, s[12:15], s35 offen
    s_movk_i32 s35, 5376
    buffer_load_dwordx2 v[134:135], v13, s[12:15], s35 offen
    s_movk_i32 s35, 7168
    buffer_load_dwordx2 v[136:137], v13, s[12:15], s35 offen
    s_movk_i32 s35, 8960
    buffer_load_dwordx2 v[138:139], v13, s[12:15], s35 offen
    s_movk_i32 s35, 10752
    buffer_load_dwordx2 v[140:141], v13, s[12:15], s35 offen
    s_movk_i32 s35, 12544
    buffer_load_dwordx2 v[142:143], v13, s[12:15], s35 offen
    s_movk_i32 s35, 14336
    buffer_load_dwordx2 v[144:145], v13, s[12:15], s35 offen
    s_movk_i32 s35, 16128
    buffer_load_dwordx2 v[146:147], v13, s[12:15], s35 offen
    s_movk_i32 s35, 17920
    buffer_load_dwordx2 v[148:149], v13, s[12:15], s35 offen
    s_movk_i32 s35, 19712
    buffer_load_dwordx2 v[150:151], v13, s[12:15], s35 offen
    s_movk_i32 s35, 21504
    buffer_load_dwordx2 v[152:153], v13, s[12:15], s35 offen
    s_movk_i32 s35, 23296
    buffer_load_dwordx2 v[154:155], v13, s[12:15], s35 offen
    s_waitcnt vmcnt(13)
    ds_write_b64 v226, v[128:129] offset:28672
    s_waitcnt vmcnt(12)
    ds_write_b64 v226, v[130:131] offset:30720
    s_waitcnt vmcnt(11)
    ds_write_b64 v226, v[132:133] offset:32768
    s_waitcnt vmcnt(10)
    ds_write_b64 v226, v[134:135] offset:34816
    s_waitcnt vmcnt(9)
    ds_write_b64 v226, v[136:137] offset:36864
    s_waitcnt vmcnt(8)
    ds_write_b64 v226, v[138:139] offset:38912
    s_waitcnt vmcnt(7)
    ds_write_b64 v226, v[140:141] offset:40960
    s_waitcnt vmcnt(6)
    ds_write_b64 v226, v[142:143] offset:43008
    s_waitcnt vmcnt(5)
    ds_write_b64 v226, v[144:145] offset:45056
    s_waitcnt vmcnt(4)
    ds_write_b64 v226, v[146:147] offset:47104
    s_waitcnt vmcnt(3)
    ds_write_b64 v226, v[148:149] offset:49152
    s_waitcnt vmcnt(2)
    ds_write_b64 v226, v[150:151] offset:51200
    s_waitcnt vmcnt(1)
    ds_write_b64 v226, v[152:153] offset:53248
    s_waitcnt vmcnt(0)
    ds_write_b64 v226, v[154:155] offset:55296
    s_waitcnt lgkmcnt(0)
    s_barrier
    ds_read_b64_tr_b16 v[192:193], v7 offset:0
    ds_read_b64_tr_b16 v[194:195], v7 offset:256
    ds_read_b64_tr_b16 v[196:197], v7 offset:28672
    ds_read_b64_tr_b16 v[198:199], v7 offset:28928
    ds_read_b64_tr_b16 v[200:201], v224 offset:0
    ds_read_b64_tr_b16 v[202:203], v224 offset:256
    ds_read_b64_tr_b16 v[204:205], v224 offset:28672
    ds_read_b64_tr_b16 v[206:207], v224 offset:28928
    ds_read_b64_tr_b16 v[208:209], v7 offset:1024
    ds_read_b64_tr_b16 v[210:211], v7 offset:1280
    ds_read_b64_tr_b16 v[212:213], v7 offset:29696
    ds_read_b64_tr_b16 v[214:215], v7 offset:29952
    ds_read_b64_tr_b16 v[216:217], v224 offset:1024
    ds_read_b64_tr_b16 v[218:219], v224 offset:1280
    ds_read_b64_tr_b16 v[220:221], v224 offset:29696
    ds_read_b64_tr_b16 v[222:223], v224 offset:29952
    s_waitcnt lgkmcnt(8)
    v_mfma_f32_32x32x16_bf16 v[128:143], v[192:195], v[16:19], 0
    v_mfma_f32_32x32x16_bf16 v[144:159], v[196:199], v[16:19], 0
    v_mfma_f32_32x32x16_bf16 v[160:175], v[200:203], v[16:19], 0
    v_mfma_f32_32x32x16_bf16 v[176:191], v[16:19], v[204:207], 0
    ds_read_b64_tr_b16 v[192:193], v7 offset:2048
    ds_read_b64_tr_b16 v[194:195], v7 offset:2304
    ds_read_b64_tr_b16 v[196:197], v7 offset:30720
    ds_read_b64_tr_b16 v[198:199], v7 offset:30976
    ds_read_b64_tr_b16 v[200:201], v224 offset:2048
    ds_read_b64_tr_b16 v[202:203], v224 offset:2304
    ds_read_b64_tr_b16 v[204:205], v224 offset:30720
    ds_read_b64_tr_b16 v[206:207], v224 offset:30976
    s_waitcnt lgkmcnt(8)
    v_mfma_f32_32x32x16_bf16 v[128:143], v[208:211], v[20:23], v[128:143]
    v_mfma_f32_32x32x16_bf16 v[144:159], v[212:215], v[20:23], v[144:159]
    v_mfma_f32_32x32x16_bf16 v[160:175], v[216:219], v[20:23], v[160:175]
    v_mfma_f32_32x32x16_bf16 v[176:191], v[20:23], v[220:223], v[176:191]
    ds_read_b64_tr_b16 v[208:209], v7 offset:3072
    ds_read_b64_tr_b16 v[210:211], v7 offset:3328
    ds_read_b64_tr_b16 v[212:213], v7 offset:31744
    ds_read_b64_tr_b16 v[214:215], v7 offset:32000
    ds_read_b64_tr_b16 v[216:217], v224 offset:3072
    ds_read_b64_tr_b16 v[218:219], v224 offset:3328
    ds_read_b64_tr_b16 v[220:221], v224 offset:31744
    ds_read_b64_tr_b16 v[222:223], v224 offset:32000
    s_waitcnt lgkmcnt(8)
    v_mfma_f32_32x32x16_bf16 v[128:143], v[192:195], v[24:27], v[128:143]
    v_mfma_f32_32x32x16_bf16 v[144:159], v[196:199], v[24:27], v[144:159]
    v_mfma_f32_32x32x16_bf16 v[160:175], v[200:203], v[24:27], v[160:175]
    v_mfma_f32_32x32x16_bf16 v[176:191], v[24:27], v[204:207], v[176:191]
    ds_read_b64_tr_b16 v[192:193], v7 offset:4096
    ds_read_b64_tr_b16 v[194:195], v7 offset:4352
    ds_read_b64_tr_b16 v[196:197], v7 offset:32768
    ds_read_b64_tr_b16 v[198:199], v7 offset:33024
    ds_read_b64_tr_b16 v[200:201], v224 offset:4096
    ds_read_b64_tr_b16 v[202:203], v224 offset:4352
    ds_read_b64_tr_b16 v[204:205], v224 offset:32768
    ds_read_b64_tr_b16 v[206:207], v224 offset:33024
    s_waitcnt lgkmcnt(8)
    v_mfma_f32_32x32x16_bf16 v[128:143], v[208:211], v[28:31], v[128:143]
    v_mfma_f32_32x32x16_bf16 v[144:159], v[212:215], v[28:31], v[144:159]
    v_mfma_f32_32x32x16_bf16 v[160:175], v[216:219], v[28:31], v[160:175]
    v_mfma_f32_32x32x16_bf16 v[176:191], v[28:31], v[220:223], v[176:191]
    ds_read_b64_tr_b16 v[208:209], v7 offset:5120
    ds_read_b64_tr_b16 v[210:211], v7 offset:5376
    ds_read_b64_tr_b16 v[212:213], v7 offset:33792
    ds_read_b64_tr_b16 v[214:215], v7 offset:34048
    ds_read_b64_tr_b16 v[216:217], v224 offset:5120
    ds_read_b64_tr_b16 v[218:219], v224 offset:5376
    ds_read_b64_tr_b16 v[220:221], v224 offset:33792
    ds_read_b64_tr_b16 v[222:223], v224 offset:34048
    s_waitcnt lgkmcnt(8)
    v_mfma_f32_32x32x16_bf16 v[128:143], v[192:195], v[32:35], v[128:143]
    v_mfma_f32_32x32x16_bf16 v[144:159], v[196:199], v[32:35], v[144:159]
    v_mfma_f32_32x32x16_bf16 v[160:175], v[200:203], v[32:35], v[160:175]
    v_mfma_f32_32x32x16_bf16 v[176:191], v[32:35], v[204:207], v[176:191]
    ds_read_b64_tr_b16 v[192:193], v7 offset:6144
    ds_read_b64_tr_b16 v[194:195], v7 offset:6400
    ds_read_b64_tr_b16 v[196:197], v7 offset:34816
    ds_read_b64_tr_b16 v[198:199], v7 offset:35072
    ds_read_b64_tr_b16 v[200:201], v224 offset:6144
    ds_read_b64_tr_b16 v[202:203], v224 offset:6400
    ds_read_b64_tr_b16 v[204:205], v224 offset:34816
    ds_read_b64_tr_b16 v[206:207], v224 offset:35072
    s_waitcnt lgkmcnt(8)
    v_mfma_f32_32x32x16_bf16 v[128:143], v[208:211], v[36:39], v[128:143]
    v_mfma_f32_32x32x16_bf16 v[144:159], v[212:215], v[36:39], v[144:159]
    v_mfma_f32_32x32x16_bf16 v[160:175], v[216:219], v[36:39], v[160:175]
    v_mfma_f32_32x32x16_bf16 v[176:191], v[36:39], v[220:223], v[176:191]
    ds_read_b64_tr_b16 v[208:209], v7 offset:7168
    ds_read_b64_tr_b16 v[210:211], v7 offset:7424
    ds_read_b64_tr_b16 v[212:213], v7 offset:35840
    ds_read_b64_tr_b16 v[214:215], v7 offset:36096
    ds_read_b64_tr_b16 v[216:217], v224 offset:7168
    ds_read_b64_tr_b16 v[218:219], v224 offset:7424
    ds_read_b64_tr_b16 v[220:221], v224 offset:35840
    ds_read_b64_tr_b16 v[222:223], v224 offset:36096
    s_waitcnt lgkmcnt(8)
    v_mfma_f32_32x32x16_bf16 v[128:143], v[192:195], v[40:43], v[128:143]
    v_mfma_f32_32x32x16_bf16 v[144:159], v[196:199], v[40:43], v[144:159]
    v_mfma_f32_32x32x16_bf16 v[160:175], v[200:203], v[40:43], v[160:175]
    v_mfma_f32_32x32x16_bf16 v[176:191], v[40:43], v[204:207], v[176:191]
    ds_read_b64_tr_b16 v[192:193], v7 offset:8192
    ds_read_b64_tr_b16 v[194:195], v7 offset:8448
    ds_read_b64_tr_b16 v[196:197], v7 offset:36864
    ds_read_b64_tr_b16 v[198:199], v7 offset:37120
    ds_read_b64_tr_b16 v[200:201], v224 offset:8192
    ds_read_b64_tr_b16 v[202:203], v224 offset:8448
    ds_read_b64_tr_b16 v[204:205], v224 offset:36864
    ds_read_b64_tr_b16 v[206:207], v224 offset:37120
    s_waitcnt lgkmcnt(8)
    v_mfma_f32_32x32x16_bf16 v[128:143], v[208:211], v[44:47], v[128:143]
    v_mfma_f32_32x32x16_bf16 v[144:159], v[212:215], v[44:47], v[144:159]
    v_mfma_f32_32x32x16_bf16 v[160:175], v[216:219], v[44:47], v[160:175]
    v_mfma_f32_32x32x16_bf16 v[176:191], v[44:47], v[220:223], v[176:191]
    ds_read_b64_tr_b16 v[208:209], v7 offset:9216
    ds_read_b64_tr_b16 v[210:211], v7 offset:9472
    ds_read_b64_tr_b16 v[212:213], v7 offset:37888
    ds_read_b64_tr_b16 v[214:215], v7 offset:38144
    ds_read_b64_tr_b16 v[216:217], v224 offset:9216
    ds_read_b64_tr_b16 v[218:219], v224 offset:9472
    ds_read_b64_tr_b16 v[220:221], v224 offset:37888
    ds_read_b64_tr_b16 v[222:223], v224 offset:38144
    s_waitcnt lgkmcnt(8)
    v_mfma_f32_32x32x16_bf16 v[128:143], v[192:195], v[48:51], v[128:143]
    v_mfma_f32_32x32x16_bf16 v[144:159], v[196:199], v[48:51], v[144:159]
    v_mfma_f32_32x32x16_bf16 v[160:175], v[200:203], v[48:51], v[160:175]
    v_mfma_f32_32x32x16_bf16 v[176:191], v[48:51], v[204:207], v[176:191]
    ds_read_b64_tr_b16 v[192:193], v7 offset:10240
    ds_read_b64_tr_b16 v[194:195], v7 offset:10496
    ds_read_b64_tr_b16 v[196:197], v7 offset:38912
    ds_read_b64_tr_b16 v[198:199], v7 offset:39168
    ds_read_b64_tr_b16 v[200:201], v224 offset:10240
    ds_read_b64_tr_b16 v[202:203], v224 offset:10496
    ds_read_b64_tr_b16 v[204:205], v224 offset:38912
    ds_read_b64_tr_b16 v[206:207], v224 offset:39168
    s_waitcnt lgkmcnt(8)
    v_mfma_f32_32x32x16_bf16 v[128:143], v[208:211], v[52:55], v[128:143]
    v_mfma_f32_32x32x16_bf16 v[144:159], v[212:215], v[52:55], v[144:159]
    v_mfma_f32_32x32x16_bf16 v[160:175], v[216:219], v[52:55], v[160:175]
    v_mfma_f32_32x32x16_bf16 v[176:191], v[52:55], v[220:223], v[176:191]
    ds_read_b64_tr_b16 v[208:209], v7 offset:11264
    ds_read_b64_tr_b16 v[210:211], v7 offset:11520
    ds_read_b64_tr_b16 v[212:213], v7 offset:39936
    ds_read_b64_tr_b16 v[214:215], v7 offset:40192
    ds_read_b64_tr_b16 v[216:217], v224 offset:11264
    ds_read_b64_tr_b16 v[218:219], v224 offset:11520
    ds_read_b64_tr_b16 v[220:221], v224 offset:39936
    ds_read_b64_tr_b16 v[222:223], v224 offset:40192
    s_waitcnt lgkmcnt(8)
    v_mfma_f32_32x32x16_bf16 v[128:143], v[192:195], v[56:59], v[128:143]
    v_mfma_f32_32x32x16_bf16 v[144:159], v[196:199], v[56:59], v[144:159]
    v_mfma_f32_32x32x16_bf16 v[160:175], v[200:203], v[56:59], v[160:175]
    v_mfma_f32_32x32x16_bf16 v[176:191], v[56:59], v[204:207], v[176:191]
    ds_read_b64_tr_b16 v[192:193], v7 offset:12288
    ds_read_b64_tr_b16 v[194:195], v7 offset:12544
    ds_read_b64_tr_b16 v[196:197], v7 offset:40960
    ds_read_b64_tr_b16 v[198:199], v7 offset:41216
    ds_read_b64_tr_b16 v[200:201], v224 offset:12288
    ds_read_b64_tr_b16 v[202:203], v224 offset:12544
    ds_read_b64_tr_b16 v[204:205], v224 offset:40960
    ds_read_b64_tr_b16 v[206:207], v224 offset:41216
    s_waitcnt lgkmcnt(8)
    v_mfma_f32_32x32x16_bf16 v[128:143], v[208:211], v[60:63], v[128:143]
    v_mfma_f32_32x32x16_bf16 v[144:159], v[212:215], v[60:63], v[144:159]
    v_mfma_f32_32x32x16_bf16 v[160:175], v[216:219], v[60:63], v[160:175]
    v_mfma_f32_32x32x16_bf16 v[176:191], v[60:63], v[220:223], v[176:191]
    ds_read_b64_tr_b16 v[208:209], v7 offset:13312
    ds_read_b64_tr_b16 v[210:211], v7 offset:13568
    ds_read_b64_tr_b16 v[212:213], v7 offset:41984
    ds_read_b64_tr_b16 v[214:215], v7 offset:42240
    ds_read_b64_tr_b16 v[216:217], v224 offset:13312
    ds_read_b64_tr_b16 v[218:219], v224 offset:13568
    ds_read_b64_tr_b16 v[220:221], v224 offset:41984
    ds_read_b64_tr_b16 v[222:223], v224 offset:42240
    s_waitcnt lgkmcnt(8)
    v_mfma_f32_32x32x16_bf16 v[128:143], v[192:195], v[64:67], v[128:143]
    v_mfma_f32_32x32x16_bf16 v[144:159], v[196:199], v[64:67], v[144:159]
    v_mfma_f32_32x32x16_bf16 v[160:175], v[200:203], v[64:67], v[160:175]
    v_mfma_f32_32x32x16_bf16 v[176:191], v[64:67], v[204:207], v[176:191]
    ds_read_b64_tr_b16 v[192:193], v7 offset:14336
    ds_read_b64_tr_b16 v[194:195], v7 offset:14592
    ds_read_b64_tr_b16 v[196:197], v7 offset:43008
    ds_read_b64_tr_b16 v[198:199], v7 offset:43264
    ds_read_b64_tr_b16 v[200:201], v224 offset:14336
    ds_read_b64_tr_b16 v[202:203], v224 offset:14592
    ds_read_b64_tr_b16 v[204:205], v224 offset:43008
    ds_read_b64_tr_b16 v[206:207], v224 offset:43264
    s_waitcnt lgkmcnt(8)
    v_mfma_f32_32x32x16_bf16 v[128:143], v[208:211], v[68:71], v[128:143]
    v_mfma_f32_32x32x16_bf16 v[144:159], v[212:215], v[68:71], v[144:159]
    v_mfma_f32_32x32x16_bf16 v[160:175], v[216:219], v[68:71], v[160:175]
    v_mfma_f32_32x32x16_bf16 v[176:191], v[68:71], v[220:223], v[176:191]
    ds_read_b64_tr_b16 v[208:209], v7 offset:15360
    ds_read_b64_tr_b16 v[210:211], v7 offset:15616
    ds_read_b64_tr_b16 v[212:213], v7 offset:44032
    ds_read_b64_tr_b16 v[214:215], v7 offset:44288
    ds_read_b64_tr_b16 v[216:217], v224 offset:15360
    ds_read_b64_tr_b16 v[218:219], v224 offset:15616
    ds_read_b64_tr_b16 v[220:221], v224 offset:44032
    ds_read_b64_tr_b16 v[222:223], v224 offset:44288
    s_waitcnt lgkmcnt(8)
    v_mfma_f32_32x32x16_bf16 v[128:143], v[192:195], v[72:75], v[128:143]
    v_mfma_f32_32x32x16_bf16 v[144:159], v[196:199], v[72:75], v[144:159]
    v_mfma_f32_32x32x16_bf16 v[160:175], v[200:203], v[72:75], v[160:175]
    v_mfma_f32_32x32x16_bf16 v[176:191], v[72:75], v[204:207], v[176:191]
    ds_read_b64_tr_b16 v[192:193], v7 offset:16384
    ds_read_b64_tr_b16 v[194:195], v7 offset:16640
    ds_read_b64_tr_b16 v[196:197], v7 offset:45056
    ds_read_b64_tr_b16 v[198:199], v7 offset:45312
    ds_read_b64_tr_b16 v[200:201], v224 offset:16384
    ds_read_b64_tr_b16 v[202:203], v224 offset:16640
    ds_read_b64_tr_b16 v[204:205], v224 offset:45056
    ds_read_b64_tr_b16 v[206:207], v224 offset:45312
    s_waitcnt lgkmcnt(8)
    v_mfma_f32_32x32x16_bf16 v[128:143], v[208:211], v[76:79], v[128:143]
    v_mfma_f32_32x32x16_bf16 v[144:159], v[212:215], v[76:79], v[144:159]
    v_mfma_f32_32x32x16_bf16 v[160:175], v[216:219], v[76:79], v[160:175]
    v_mfma_f32_32x32x16_bf16 v[176:191], v[76:79], v[220:223], v[176:191]
    ds_read_b64_tr_b16 v[208:209], v7 offset:17408
    ds_read_b64_tr_b16 v[210:211], v7 offset:17664
    ds_read_b64_tr_b16 v[212:213], v7 offset:46080
    ds_read_b64_tr_b16 v[214:215], v7 offset:46336
    ds_read_b64_tr_b16 v[216:217], v224 offset:17408
    ds_read_b64_tr_b16 v[218:219], v224 offset:17664
    ds_read_b64_tr_b16 v[220:221], v224 offset:46080
    ds_read_b64_tr_b16 v[222:223], v224 offset:46336
    s_waitcnt lgkmcnt(8)
    v_mfma_f32_32x32x16_bf16 v[128:143], v[192:195], v[80:83], v[128:143]
    v_mfma_f32_32x32x16_bf16 v[144:159], v[196:199], v[80:83], v[144:159]
    v_mfma_f32_32x32x16_bf16 v[160:175], v[200:203], v[80:83], v[160:175]
    v_mfma_f32_32x32x16_bf16 v[176:191], v[80:83], v[204:207], v[176:191]
    ds_read_b64_tr_b16 v[192:193], v7 offset:18432
    ds_read_b64_tr_b16 v[194:195], v7 offset:18688
    ds_read_b64_tr_b16 v[196:197], v7 offset:47104
    ds_read_b64_tr_b16 v[198:199], v7 offset:47360
    ds_read_b64_tr_b16 v[200:201], v224 offset:18432
    ds_read_b64_tr_b16 v[202:203], v224 offset:18688
    ds_read_b64_tr_b16 v[204:205], v224 offset:47104
    ds_read_b64_tr_b16 v[206:207], v224 offset:47360
    s_waitcnt lgkmcnt(8)
    v_mfma_f32_32x32x16_bf16 v[128:143], v[208:211], v[84:87], v[128:143]
    v_mfma_f32_32x32x16_bf16 v[144:159], v[212:215], v[84:87], v[144:159]
    v_mfma_f32_32x32x16_bf16 v[160:175], v[216:219], v[84:87], v[160:175]
    v_mfma_f32_32x32x16_bf16 v[176:191], v[84:87], v[220:223], v[176:191]
    ds_read_b64_tr_b16 v[208:209], v7 offset:19456
    ds_read_b64_tr_b16 v[210:211], v7 offset:19712
    ds_read_b64_tr_b16 v[212:213], v7 offset:48128
    ds_read_b64_tr_b16 v[214:215], v7 offset:48384
    ds_read_b64_tr_b16 v[216:217], v224 offset:19456
    ds_read_b64_tr_b16 v[218:219], v224 offset:19712
    ds_read_b64_tr_b16 v[220:221], v224 offset:48128
    ds_read_b64_tr_b16 v[222:223], v224 offset:48384
    s_waitcnt lgkmcnt(8)
    v_mfma_f32_32x32x16_bf16 v[128:143], v[192:195], v[88:91], v[128:143]
    v_mfma_f32_32x32x16_bf16 v[144:159], v[196:199], v[88:91], v[144:159]
    v_mfma_f32_32x32x16_bf16 v[160:175], v[200:203], v[88:91], v[160:175]
    v_mfma_f32_32x32x16_bf16 v[176:191], v[88:91], v[204:207], v[176:191]
    ds_read_b64_tr_b16 v[192:193], v7 offset:20480
    ds_read_b64_tr_b16 v[194:195], v7 offset:20736
    ds_read_b64_tr_b16 v[196:197], v7 offset:49152
    ds_read_b64_tr_b16 v[198:199], v7 offset:49408
    ds_read_b64_tr_b16 v[200:201], v224 offset:20480
    ds_read_b64_tr_b16 v[202:203], v224 offset:20736
    ds_read_b64_tr_b16 v[204:205], v224 offset:49152
    ds_read_b64_tr_b16 v[206:207], v224 offset:49408
    s_waitcnt lgkmcnt(8)
    v_mfma_f32_32x32x16_bf16 v[128:143], v[208:211], v[92:95], v[128:143]
    v_mfma_f32_32x32x16_bf16 v[144:159], v[212:215], v[92:95], v[144:159]
    v_mfma_f32_32x32x16_bf16 v[160:175], v[216:219], v[92:95], v[160:175]
    v_mfma_f32_32x32x16_bf16 v[176:191], v[92:95], v[220:223], v[176:191]
    ds_read_b64_tr_b16 v[208:209], v7 offset:21504
    ds_read_b64_tr_b16 v[210:211], v7 offset:21760
    ds_read_b64_tr_b16 v[212:213], v7 offset:50176
    ds_read_b64_tr_b16 v[214:215], v7 offset:50432
    ds_read_b64_tr_b16 v[216:217], v224 offset:21504
    ds_read_b64_tr_b16 v[218:219], v224 offset:21760
    ds_read_b64_tr_b16 v[220:221], v224 offset:50176
    ds_read_b64_tr_b16 v[222:223], v224 offset:50432
    s_waitcnt lgkmcnt(8)
    v_mfma_f32_32x32x16_bf16 v[128:143], v[192:195], v[96:99], v[128:143]
    v_mfma_f32_32x32x16_bf16 v[144:159], v[196:199], v[96:99], v[144:159]
    v_mfma_f32_32x32x16_bf16 v[160:175], v[200:203], v[96:99], v[160:175]
    v_mfma_f32_32x32x16_bf16 v[176:191], v[96:99], v[204:207], v[176:191]
    ds_read_b64_tr_b16 v[192:193], v7 offset:22528
    ds_read_b64_tr_b16 v[194:195], v7 offset:22784
    ds_read_b64_tr_b16 v[196:197], v7 offset:51200
    ds_read_b64_tr_b16 v[198:199], v7 offset:51456
    ds_read_b64_tr_b16 v[200:201], v224 offset:22528
    ds_read_b64_tr_b16 v[202:203], v224 offset:22784
    ds_read_b64_tr_b16 v[204:205], v224 offset:51200
    ds_read_b64_tr_b16 v[206:207], v224 offset:51456
    s_waitcnt lgkmcnt(8)
    v_mfma_f32_32x32x16_bf16 v[128:143], v[208:211], v[100:103], v[128:143]
    v_mfma_f32_32x32x16_bf16 v[144:159], v[212:215], v[100:103], v[144:159]
    v_mfma_f32_32x32x16_bf16 v[160:175], v[216:219], v[100:103], v[160:175]
    v_mfma_f32_32x32x16_bf16 v[176:191], v[100:103], v[220:223], v[176:191]
    ds_read_b64_tr_b16 v[208:209], v7 offset:23552
    ds_read_b64_tr_b16 v[210:211], v7 offset:23808
    ds_read_b64_tr_b16 v[212:213], v7 offset:52224
    ds_read_b64_tr_b16 v[214:215], v7 offset:52480
    ds_read_b64_tr_b16 v[216:217], v224 offset:23552
    ds_read_b64_tr_b16 v[218:219], v224 offset:23808
    ds_read_b64_tr_b16 v[220:221], v224 offset:52224
    ds_read_b64_tr_b16 v[222:223], v224 offset:52480
    s_waitcnt lgkmcnt(8)
    v_mfma_f32_32x32x16_bf16 v[128:143], v[192:195], v[104:107], v[128:143]
    v_mfma_f32_32x32x16_bf16 v[144:159], v[196:199], v[104:107], v[144:159]
    v_mfma_f32_32x32x16_bf16 v[160:175], v[200:203], v[104:107], v[160:175]
    v_mfma_f32_32x32x16_bf16 v[176:191], v[104:107], v[204:207], v[176:191]
    ds_read_b64_tr_b16 v[192:193], v7 offset:24576
    ds_read_b64_tr_b16 v[194:195], v7 offset:24832
    ds_read_b64_tr_b16 v[196:197], v7 offset:53248
    ds_read_b64_tr_b16 v[198:199], v7 offset:53504
    ds_read_b64_tr_b16 v[200:201], v224 offset:24576
    ds_read_b64_tr_b16 v[202:203], v224 offset:24832
    ds_read_b64_tr_b16 v[204:205], v224 offset:53248
    ds_read_b64_tr_b16 v[206:207], v224 offset:53504
    s_waitcnt lgkmcnt(8)
    v_mfma_f32_32x32x16_bf16 v[128:143], v[208:211], v[108:111], v[128:143]
    v_mfma_f32_32x32x16_bf16 v[144:159], v[212:215], v[108:111], v[144:159]
    v_mfma_f32_32x32x16_bf16 v[160:175], v[216:219], v[108:111], v[160:175]
    v_mfma_f32_32x32x16_bf16 v[176:191], v[108:111], v[220:223], v[176:191]
    ds_read_b64_tr_b16 v[208:209], v7 offset:25600
    ds_read_b64_tr_b16 v[210:211], v7 offset:25856
    ds_read_b64_tr_b16 v[212:213], v7 offset:54272
    ds_read_b64_tr_b16 v[214:215], v7 offset:54528
    ds_read_b64_tr_b16 v[216:217], v224 offset:25600
    ds_read_b64_tr_b16 v[218:219], v224 offset:25856
    ds_read_b64_tr_b16 v[220:221], v224 offset:54272
    ds_read_b64_tr_b16 v[222:223], v224 offset:54528
    s_waitcnt lgkmcnt(8)
    v_mfma_f32_32x32x16_bf16 v[128:143], v[192:195], v[112:115], v[128:143]
    v_mfma_f32_32x32x16_bf16 v[144:159], v[196:199], v[112:115], v[144:159]
    v_mfma_f32_32x32x16_bf16 v[160:175], v[200:203], v[112:115], v[160:175]
    v_mfma_f32_32x32x16_bf16 v[176:191], v[112:115], v[204:207], v[176:191]
    ds_read_b64_tr_b16 v[192:193], v7 offset:26624
    ds_read_b64_tr_b16 v[194:195], v7 offset:26880
    ds_read_b64_tr_b16 v[196:197], v7 offset:55296
    ds_read_b64_tr_b16 v[198:199], v7 offset:55552
    ds_read_b64_tr_b16 v[200:201], v224 offset:26624
    ds_read_b64_tr_b16 v[202:203], v224 offset:26880
    ds_read_b64_tr_b16 v[204:205], v224 offset:55296
    ds_read_b64_tr_b16 v[206:207], v224 offset:55552
    s_waitcnt lgkmcnt(8)
    v_mfma_f32_32x32x16_bf16 v[128:143], v[208:211], v[116:119], v[128:143]
    v_mfma_f32_32x32x16_bf16 v[144:159], v[212:215], v[116:119], v[144:159]
    v_mfma_f32_32x32x16_bf16 v[160:175], v[216:219], v[116:119], v[160:175]
    v_mfma_f32_32x32x16_bf16 v[176:191], v[116:119], v[220:223], v[176:191]
    ds_read_b64_tr_b16 v[208:209], v7 offset:27648
    ds_read_b64_tr_b16 v[210:211], v7 offset:27904
    ds_read_b64_tr_b16 v[212:213], v7 offset:56320
    ds_read_b64_tr_b16 v[214:215], v7 offset:56576
    ds_read_b64_tr_b16 v[216:217], v224 offset:27648
    ds_read_b64_tr_b16 v[218:219], v224 offset:27904
    ds_read_b64_tr_b16 v[220:221], v224 offset:56320
    ds_read_b64_tr_b16 v[222:223], v224 offset:56576
    s_waitcnt lgkmcnt(8)
    v_mfma_f32_32x32x16_bf16 v[128:143], v[192:195], v[120:123], v[128:143]
    v_mfma_f32_32x32x16_bf16 v[144:159], v[196:199], v[120:123], v[144:159]
    v_mfma_f32_32x32x16_bf16 v[160:175], v[200:203], v[120:123], v[160:175]
    v_mfma_f32_32x32x16_bf16 v[176:191], v[120:123], v[204:207], v[176:191]
    s_waitcnt lgkmcnt(0)
    v_mfma_f32_32x32x16_bf16 v[128:143], v[208:211], v[124:127], v[128:143]
    v_mfma_f32_32x32x16_bf16 v[144:159], v[212:215], v[124:127], v[144:159]
    v_mfma_f32_32x32x16_bf16 v[160:175], v[216:219], v[124:127], v[160:175]
    v_mfma_f32_32x32x16_bf16 v[176:191], v[124:127], v[220:223], v[176:191]
    s_nop 15
    s_nop 3
    v_lshrrev_b32 v13, 1, v5
    v_lshlrev_b32 v13, 11, v13
    v_and_b32 v14, 1, v5
    v_lshl_add_u32 v13, v14, 8, v13
    s_mov_b32 s35, 0x3e8b97f6
    v_mul_f32 v128, s35, v128
    v_mul_f32 v129, s35, v129
    v_mul_f32 v130, s35, v130
    v_mul_f32 v131, s35, v131
    v_mul_f32 v132, s35, v132
    v_mul_f32 v133, s35, v133
    v_mul_f32 v134, s35, v134
    v_mul_f32 v135, s35, v135
    v_mul_f32 v136, s35, v136
    v_mul_f32 v137, s35, v137
    v_mul_f32 v138, s35, v138
    v_mul_f32 v139, s35, v139
    v_mul_f32 v140, s35, v140
    v_mul_f32 v141, s35, v141
    v_mul_f32 v142, s35, v142
    v_mul_f32 v143, s35, v143
    v_cvt_pk_bf16_f32 v128, v128, v129
    v_cvt_pk_bf16_f32 v129, v130, v131
    v_mov_b32 v14, 1240
    v_mov_b32 v15, 1744
    v_cndmask_b32 v14, v14, v15, s[30:31]
    v_add_u32 v14, v14, v13
    buffer_store_dwordx2 v[128:129], v14, s[16:19], 0 offen
    v_cvt_pk_bf16_f32 v132, v132, v133
    v_cvt_pk_bf16_f32 v133, v134, v135
    v_mov_b32 v14, 224
    v_mov_b32 v15, 232
    v_cndmask_b32 v14, v14, v15, s[30:31]
    v_add_u32 v14, v14, v13
    buffer_store_dwordx2 v[132:133], v14, s[16:19], 0 offen
    v_cvt_pk_bf16_f32 v136, v136, v137
    v_cvt_pk_bf16_f32 v137, v138, v139
    v_mov_b32 v14, 736
    v_mov_b32 v15, 744
    v_cndmask_b32 v14, v14, v15, s[30:31]
    v_add_u32 v14, v14, v13
    buffer_store_dwordx2 v[136:137], v14, s[16:19], 0 offen
    v_cvt_pk_bf16_f32 v140, v140, v141
    v_cvt_pk_bf16_f32 v141, v142, v143
    v_mov_b32 v14, 1248
    v_mov_b32 v15, 1256
    v_cndmask_b32 v14, v14, v15, s[30:31]
    v_add_u32 v14, v14, v13
    buffer_store_dwordx2 v[140:141], v14, s[16:19], 0 offen
    v_lshrrev_b32 v13, 1, v5
    v_lshlrev_b32 v13, 11, v13
    v_and_b32 v14, 1, v5
    v_lshl_add_u32 v13, v14, 8, v13
    s_mov_b32 s35, 0x3e8b97f6
    v_mul_f32 v144, s35, v144
    v_mul_f32 v145, s35, v145
    v_mul_f32 v146, s35, v146
    v_mul_f32 v147, s35, v147
    v_mul_f32 v148, s35, v148
    v_mul_f32 v149, s35, v149
    v_mul_f32 v150, s35, v150
    v_mul_f32 v151, s35, v151
    v_mul_f32 v152, s35, v152
    v_mul_f32 v153, s35, v153
    v_mul_f32 v154, s35, v154
    v_mul_f32 v155, s35, v155
    v_mul_f32 v156, s35, v156
    v_mul_f32 v157, s35, v157
    v_mul_f32 v158, s35, v158
    v_mul_f32 v159, s35, v159
    v_cvt_pk_bf16_f32 v144, v144, v145
    v_cvt_pk_bf16_f32 v145, v146, v147
    v_mov_b32 v14, 1760
    v_mov_b32 v15, 240
    v_cndmask_b32 v14, v14, v15, s[30:31]
    v_add_u32 v14, v14, v13
    buffer_store_dwordx2 v[144:145], v14, s[16:19], 0 offen
    v_cvt_pk_bf16_f32 v148, v148, v149
    v_cvt_pk_bf16_f32 v149, v150, v151
    v_mov_b32 v14, 248
    v_mov_b32 v15, 752
    v_cndmask_b32 v14, v14, v15, s[30:31]
    v_add_u32 v14, v14, v13
    buffer_store_dwordx2 v[148:149], v14, s[16:19], 0 offen
    v_cvt_pk_bf16_f32 v152, v152, v153
    v_cvt_pk_bf16_f32 v153, v154, v155
    v_mov_b32 v14, 760
    v_mov_b32 v15, 1264
    v_cndmask_b32 v14, v14, v15, s[30:31]
    v_add_u32 v14, v14, v13
    buffer_store_dwordx2 v[152:153], v14, s[16:19], 0 offen
    v_cvt_pk_bf16_f32 v156, v156, v157
    v_cvt_pk_bf16_f32 v157, v158, v159
    v_mov_b32 v14, 1272
    v_mov_b32 v15, 1776
    v_cndmask_b32 v14, v14, v15, s[30:31]
    v_add_u32 v14, v14, v13
    buffer_store_dwordx2 v[156:157], v14, s[16:19], 0 offen
    v_lshrrev_b32 v13, 5, v5
    v_lshlrev_b32 v13, 11, v13
    v_lshl_add_u32 v13, v3, 4, v13
    v_lshl_add_u32 v13, v4, 3, v13
    v_add_u32 v13, 2097152, v13
    v_lshlrev_b32 v14, 2, v5
    v_add_u32 v14, 11534336, v14
    s_mov_b64 s[50:51], exec
    s_mov_b64 exec, s[30:31]
    buffer_store_dword v172, v14, s[16:19], 0 offen
    v_mov_b32 v172, 0
    s_mov_b64 exec, s[50:51]
    v_cvt_pk_bf16_f32 v160, v160, v161
    v_cvt_pk_bf16_f32 v161, v162, v163
    buffer_store_dwordx2 v[160:161], v13, s[16:19], 0 offen offset:0
    v_cvt_pk_bf16_f32 v164, v164, v165
    v_cvt_pk_bf16_f32 v165, v166, v167
    buffer_store_dwordx2 v[164:165], v13, s[16:19], 0 offen offset:512
    v_cvt_pk_bf16_f32 v168, v168, v169
    v_cvt_pk_bf16_f32 v169, v170, v171
    buffer_store_dwordx2 v[168:169], v13, s[16:19], 0 offen offset:1024
    v_cvt_pk_bf16_f32 v172, v172, v173
    v_cvt_pk_bf16_f32 v173, v174, v175
    buffer_store_dwordx2 v[172:173], v13, s[16:19], 0 offen offset:1536
    v_lshrrev_b32 v13, 5, v5
    v_lshlrev_b32 v13, 11, v13
    v_lshl_add_u32 v13, v2, 4, v13
    v_add_u32 v13, 2228224, v13
    v_cmp_eq_u32 vcc, 28, v3
    s_nop 1
    v_cndmask_b32 v176, v176, 1.0, vcc
    v_cndmask_b32 v177, v177, 1.0, vcc
    v_cndmask_b32 v178, v178, 1.0, vcc
    v_cndmask_b32 v179, v179, 1.0, vcc
    v_cndmask_b32 v180, v180, 1.0, vcc
    v_cndmask_b32 v181, v181, 1.0, vcc
    v_cndmask_b32 v182, v182, 1.0, vcc
    v_cndmask_b32 v183, v183, 1.0, vcc
    v_cndmask_b32 v184, v184, 1.0, vcc
    v_cndmask_b32 v185, v185, 1.0, vcc
    v_cndmask_b32 v186, v186, 1.0, vcc
    v_cndmask_b32 v187, v187, 1.0, vcc
    v_cndmask_b32 v188, v188, 1.0, vcc
    v_cndmask_b32 v189, v189, 1.0, vcc
    v_cndmask_b32 v190, v190, 1.0, vcc
    v_cndmask_b32 v191, v191, 1.0, vcc
    v_cvt_pk_bf16_f32 v176, v176, v177
    v_cvt_pk_bf16_f32 v177, v178, v179
    buffer_store_dwordx2 v[176:177], v13, s[16:19], 0 offen offset:0
    v_cvt_pk_bf16_f32 v180, v180, v181
    v_cvt_pk_bf16_f32 v181, v182, v183
    buffer_store_dwordx2 v[180:181], v13, s[16:19], 0 offen offset:8
    v_cvt_pk_bf16_f32 v184, v184, v185
    v_cvt_pk_bf16_f32 v185, v186, v187
    buffer_store_dwordx2 v[184:185], v13, s[16:19], 0 offen offset:1024
    v_cvt_pk_bf16_f32 v188, v188, v189
    v_cvt_pk_bf16_f32 v189, v190, v191
    buffer_store_dwordx2 v[188:189], v13, s[16:19], 0 offen offset:1032
    s_endpgm
K1_v4:
    s_mov_b32 s12, s44
    s_and_b32 s13, s45, 0xffff
    s_mov_b32 s14, 1204224
    s_mov_b32 s15, 0x00020000
    s_movk_i32 s35, 2688
    v_lshrrev_b32 v227, 2, v0
    v_mul_lo_u32 v227, v227, s35
    v_and_b32 v14, 3, v0
    v_lshl_add_u32 v227, v14, 4, v227
    s_mov_b32 s35, 0
    buffer_load_dwordx4 v[128:131], v227, s[12:15], s35 offen
    s_mov_b32 s35, 172032
    buffer_load_dwordx4 v[132:135], v227, s[12:15], s35 offen
    s_mov_b32 s35, 344064
    buffer_load_dwordx4 v[136:139], v227, s[12:15], s35 offen
    s_mov_b32 s35, 516096
    buffer_load_dwordx4 v[140:143], v227, s[12:15], s35 offen
    s_mov_b32 s35, 688128
    buffer_load_dwordx4 v[144:147], v227, s[12:15], s35 offen
    s_mov_b32 s35, 860160
    buffer_load_dwordx4 v[148:151], v227, s[12:15], s35 offen
    s_mov_b32 s35, 1032192
    buffer_load_dwordx4 v[152:155], v227, s[12:15], s35 offen
    s_mov_b32 s12, s44
    s_and_b32 s13, s45, 0xffff
    s_mov_b32 s14, 1204224
    s_mov_b32 s15, 0x00020000
    s_movk_i32 s35, 2688
    v_lshrrev_b32 v227, 2, v0
    v_mul_lo_u32 v227, v227, s35
    v_and_b32 v14, 3, v0
    v_lshl_add_u32 v227, v14, 4, v227
    s_mov_b32 s35, 64
    buffer_load_dwordx4 v[156:159], v227, s[12:15], s35 offen
    s_mov_b32 s35, 172096
    buffer_load_dwordx4 v[160:163], v227, s[12:15], s35 offen
    s_mov_b32 s35, 344128
    buffer_load_dwordx4 v[164:167], v227, s[12:15], s35 offen
    s_mov_b32 s35, 516160
    buffer_load_dwordx4 v[168:171], v227, s[12:15], s35 offen
    s_mov_b32 s35, 688192
    buffer_load_dwordx4 v[172:175], v227, s[12:15], s35 offen
    s_mov_b32 s35, 860224
    buffer_load_dwordx4 v[176:179], v227, s[12:15], s35 offen
    s_mov_b32 s35, 1032256
    buffer_load_dwordx4 v[180:183], v227, s[12:15], s35 offen
    s_mov_b32 s54, 0x4924925
    v_add_u32 v13, 0, v2
    v_mul_hi_u32 v14, v13, s54
    v_lshlrev_b32 v13, 4, v13
    v_lshl_add_u32 v13, v14, 4, v13
    v_add_u32 v13, s53, v13
    s_waitcnt vmcnt(41)
    ds_write_b128 v13, v[16:19]
    v_add_u32 v13, 64, v2
    v_mul_hi_u32 v14, v13, s54
    v_lshlrev_b32 v13, 4, v13
    v_lshl_add_u32 v13, v14, 4, v13
    v_add_u32 v13, s53, v13
    s_waitcnt vmcnt(40)
    ds_write_b128 v13, v[20:23]
    v_add_u32 v13, 128, v2
    v_mul_hi_u32 v14, v13, s54
    v_lshlrev_b32 v13, 4, v13
    v_lshl_add_u32 v13, v14, 4, v13
    v_add_u32 v13, s53, v13
    s_waitcnt vmcnt(39)
    ds_write_b128 v13, v[24:27]
    v_add_u32 v13, 192, v2
    v_mul_hi_u32 v14, v13, s54
    v_lshlrev_b32 v13, 4, v13
    v_lshl_add_u32 v13, v14, 4, v13
    v_add_u32 v13, s53, v13
    s_waitcnt vmcnt(38)
    ds_write_b128 v13, v[28:31]
    v_add_u32 v13, 256, v2
    v_mul_hi_u32 v14, v13, s54
    v_lshlrev_b32 v13, 4, v13
    v_lshl_add_u32 v13, v14, 4, v13
    v_add_u32 v13, s53, v13
    s_waitcnt vmcnt(37)
    ds_write_b128 v13, v[32:35]
    v_add_u32 v13, 320, v2
    v_mul_hi_u32 v14, v13, s54
    v_lshlrev_b32 v13, 4, v13
    v_lshl_add_u32 v13, v14, 4, v13
    v_add_u32 v13, s53, v13
    s_waitcnt vmcnt(36)
    ds_write_b128 v13, v[36:39]
    v_add_u32 v13, 384, v2
    v_mul_hi_u32 v14, v13, s54
    v_lshlrev_b32 v13, 4, v13
    v_lshl_add_u32 v13, v14, 4, v13
    v_add_u32 v13, s53, v13
    s_waitcnt vmcnt(35)
    ds_write_b128 v13, v[40:43]
    v_add_u32 v13, 448, v2
    v_mul_hi_u32 v14, v13, s54
    v_lshlrev_b32 v13, 4, v13
    v_lshl_add_u32 v13, v14, 4, v13
    v_add_u32 v13, s53, v13
    s_waitcnt vmcnt(34)
    ds_write_b128 v13, v[44:47]
    v_add_u32 v13, 512, v2
    v_mul_hi_u32 v14, v13, s54
    v_lshlrev_b32 v13, 4, v13
    v_lshl_add_u32 v13, v14, 4, v13
    v_add_u32 v13, s53, v13
    s_waitcnt vmcnt(33)
    ds_write_b128 v13, v[48:51]
    v_add_u32 v13, 576, v2
    v_mul_hi_u32 v14, v13, s54
    v_lshlrev_b32 v13, 4, v13
    v_lshl_add_u32 v13, v14, 4, v13
    v_add_u32 v13, s53, v13
    s_waitcnt vmcnt(32)
    ds_write_b128 v13, v[52:55]
    v_add_u32 v13, 640, v2
    v_mul_hi_u32 v14, v13, s54
    v_lshlrev_b32 v13, 4, v13
    v_lshl_add_u32 v13, v14, 4, v13
    v_add_u32 v13, s53, v13
    s_waitcnt vmcnt(31)
    ds_write_b128 v13, v[56:59]
    v_add_u32 v13, 704, v2
    v_mul_hi_u32 v14, v13, s54
    v_lshlrev_b32 v13, 4, v13
    v_lshl_add_u32 v13, v14, 4, v13
    v_add_u32 v13, s53, v13
    s_waitcnt vmcnt(30)
    ds_write_b128 v13, v[60:63]
    v_add_u32 v13, 768, v2
    v_mul_hi_u32 v14, v13, s54
    v_lshlrev_b32 v13, 4, v13
    v_lshl_add_u32 v13, v14, 4, v13
    v_add_u32 v13, s53, v13
    s_waitcnt vmcnt(29)
    ds_write_b128 v13, v[64:67]
    v_add_u32 v13, 832, v2
    v_mul_hi_u32 v14, v13, s54
    v_lshlrev_b32 v13, 4, v13
    v_lshl_add_u32 v13, v14, 4, v13
    v_add_u32 v13, s53, v13
    s_waitcnt vmcnt(28)
    ds_write_b128 v13, v[68:71]
    v_add_u32 v13, 896, v2
    v_mul_hi_u32 v14, v13, s54
    v_lshlrev_b32 v13, 4, v13
    v_lshl_add_u32 v13, v14, 4, v13
    v_add_u32 v13, s53, v13
    s_waitcnt vmcnt(27)
    ds_write_b128 v13, v[72:75]
    v_add_u32 v13, 960, v2
    v_mul_hi_u32 v14, v13, s54
    v_lshlrev_b32 v13, 4, v13
    v_lshl_add_u32 v13, v14, 4, v13
    v_add_u32 v13, s53, v13
    s_waitcnt vmcnt(26)
    ds_write_b128 v13, v[76:79]
    v_add_u32 v13, 1024, v2
    v_mul_hi_u32 v14, v13, s54
    v_lshlrev_b32 v13, 4, v13
    v_lshl_add_u32 v13, v14, 4, v13
    v_add_u32 v13, s53, v13
    s_waitcnt vmcnt(25)
    ds_write_b128 v13, v[80:83]
    v_add_u32 v13, 1088, v2
    v_mul_hi_u32 v14, v13, s54
    v_lshlrev_b32 v13, 4, v13
    v_lshl_add_u32 v13, v14, 4, v13
    v_add_u32 v13, s53, v13
    s_waitcnt vmcnt(24)
    ds_write_b128 v13, v[84:87]
    v_add_u32 v13, 1152, v2
    v_mul_hi_u32 v14, v13, s54
    v_lshlrev_b32 v13, 4, v13
    v_lshl_add_u32 v13, v14, 4, v13
    v_add_u32 v13, s53, v13
    s_waitcnt vmcnt(23)
    ds_write_b128 v13, v[88:91]
    v_add_u32 v13, 1216, v2
    v_mul_hi_u32 v14, v13, s54
    v_lshlrev_b32 v13, 4, v13
    v_lshl_add_u32 v13, v14, 4, v13
    v_add_u32 v13, s53, v13
    s_waitcnt vmcnt(22)
    ds_write_b128 v13, v[92:95]
    v_add_u32 v13, 1280, v2
    v_mul_hi_u32 v14, v13, s54
    v_lshlrev_b32 v13, 4, v13
    v_lshl_add_u32 v13, v14, 4, v13
    v_add_u32 v13, s53, v13
    s_waitcnt vmcnt(21)
    ds_write_b128 v13, v[96:99]
    v_add_u32 v13, 1344, v2
    v_mul_hi_u32 v14, v13, s54
    v_lshlrev_b32 v13, 4, v13
    v_lshl_add_u32 v13, v14, 4, v13
    v_add_u32 v13, s53, v13
    s_waitcnt vmcnt(20)
    ds_write_b128 v13, v[100:103]
    v_add_u32 v13, 1408, v2
    v_mul_hi_u32 v14, v13, s54
    v_lshlrev_b32 v13, 4, v13
    v_lshl_add_u32 v13, v14, 4, v13
    v_add_u32 v13, s53, v13
    s_waitcnt vmcnt(19)
    ds_write_b128 v13, v[104:107]
    v_add_u32 v13, 1472, v2
    v_mul_hi_u32 v14, v13, s54
    v_lshlrev_b32 v13, 4, v13
    v_lshl_add_u32 v13, v14, 4, v13
    v_add_u32 v13, s53, v13
    s_waitcnt vmcnt(18)
    ds_write_b128 v13, v[108:111]
    v_add_u32 v13, 1536, v2
    v_mul_hi_u32 v14, v13, s54
    v_lshlrev_b32 v13, 4, v13
    v_lshl_add_u32 v13, v14, 4, v13
    v_add_u32 v13, s53, v13
    s_waitcnt vmcnt(17)
    ds_write_b128 v13, v[112:115]
    v_add_u32 v13, 1600, v2
    v_mul_hi_u32 v14, v13, s54
    v_lshlrev_b32 v13, 4, v13
    v_lshl_add_u32 v13, v14, 4, v13
    v_add_u32 v13, s53, v13
    s_waitcnt vmcnt(16)
    ds_write_b128 v13, v[116:119]
    v_add_u32 v13, 1664, v2
    v_mul_hi_u32 v14, v13, s54
    v_lshlrev_b32 v13, 4, v13
    v_lshl_add_u32 v13, v14, 4, v13
    v_add_u32 v13, s53, v13
    s_waitcnt vmcnt(15)
    ds_write_b128 v13, v[120:123]
    v_add_u32 v13, 1728, v2
    v_mul_hi_u32 v14, v13, s54
    v_lshlrev_b32 v13, 4, v13
    v_lshl_add_u32 v13, v14, 4, v13
    v_add_u32 v13, s53, v13
    s_waitcnt vmcnt(14)
    ds_write_b128 v13, v[124:127]
    v_mul_u32_u24 v13, 912, v3
    v_lshl_add_u32 v13, v4, 4, v13
    v_add_u32 v13, s53, v13
    s_waitcnt lgkmcnt(0)
    ds_read_b128 v[16:19], v13 offset:0
    ds_read_b128 v[20:23], v13 offset:32
    ds_read_b128 v[24:27], v13 offset:64
    ds_read_b128 v[28:31], v13 offset:96
    ds_read_b128 v[32:35], v13 offset:128
    ds_read_b128 v[36:39], v13 offset:160
    ds_read_b128 v[40:43], v13 offset:192
    ds_read_b128 v[44:47], v13 offset:224
    ds_read_b128 v[48:51], v13 offset:256
    ds_read_b128 v[52:55], v13 offset:288
    ds_read_b128 v[56:59], v13 offset:320
    ds_read_b128 v[60:63], v13 offset:352
    ds_read_b128 v[64:67], v13 offset:384
    ds_read_b128 v[68:71], v13 offset:416
    ds_read_b128 v[72:75], v13 offset:448
    ds_read_b128 v[76:79], v13 offset:480
    ds_read_b128 v[80:83], v13 offset:512
    ds_read_b128 v[84:87], v13 offset:544
    ds_read_b128 v[88:91], v13 offset:576
    ds_read_b128 v[92:95], v13 offset:608
    ds_read_b128 v[96:99], v13 offset:640
    ds_read_b128 v[100:103], v13 offset:672
    ds_read_b128 v[104:107], v13 offset:704
    ds_read_b128 v[108:111], v13 offset:736
    ds_read_b128 v[112:115], v13 offset:768
    ds_read_b128 v[116:119], v13 offset:800
    ds_read_b128 v[120:123], v13 offset:832
    ds_read_b128 v[124:127], v13 offset:864
    s_waitcnt lgkmcnt(0)
    s_barrier
    s_waitcnt vmcnt(13)
    ds_write_b128 v11, v[128:131] offset:0
    s_waitcnt vmcnt(12)
    ds_write_b128 v11, v[132:135] offset:4096
    s_waitcnt vmcnt(11)
    ds_write_b128 v11, v[136:139] offset:8192
    s_waitcnt vmcnt(10)
    ds_write_b128 v11, v[140:143] offset:12288
    s_waitcnt vmcnt(9)
    ds_write_b128 v11, v[144:147] offset:16384
    s_waitcnt vmcnt(8)
    ds_write_b128 v11, v[148:151] offset:20480
    s_waitcnt vmcnt(7)
    ds_write_b128 v11, v[152:155] offset:24576
    s_waitcnt vmcnt(6)
    ds_write_b128 v11, v[156:159] offset:28672
    s_waitcnt vmcnt(5)
    ds_write_b128 v11, v[160:163] offset:32768
    s_waitcnt vmcnt(4)
    ds_write_b128 v11, v[164:167] offset:36864
    s_waitcnt vmcnt(3)
    ds_write_b128 v11, v[168:171] offset:40960
    s_waitcnt vmcnt(2)
    ds_write_b128 v11, v[172:175] offset:45056
    s_waitcnt vmcnt(1)
    ds_write_b128 v11, v[176:179] offset:49152
    s_waitcnt vmcnt(0)
    ds_write_b128 v11, v[180:183] offset:53248
    s_mov_b32 s12, s44
    s_and_b32 s13, s45, 0xffff
    s_mov_b32 s14, 1204224
    s_mov_b32 s15, 0x00020000
    s_movk_i32 s35, 2688
    v_lshrrev_b32 v13, 2, v0
    v_mul_lo_u32 v13, v13, s35
    v_and_b32 v14, 3, v0
    v_lshl_add_u32 v13, v14, 4, v13
    s_mov_b32 s35, 128
    buffer_load_dwordx4 v[128:131], v13, s[12:15], s35 offen
    s_mov_b32 s35, 172160
    buffer_load_dwordx4 v[132:135], v13, s[12:15], s35 offen
    s_mov_b32 s35, 344192
    buffer_load_dwordx4 v[136:139], v13, s[12:15], s35 offen
    s_mov_b32 s35, 516224
    buffer_load_dwordx4 v[140:143], v13, s[12:15], s35 offen
    s_mov_b32 s35, 688256
    buffer_load_dwordx4 v[144:147], v13, s[12:15], s35 offen
    s_mov_b32 s35, 860288
    buffer_load_dwordx4 v[148:151], v13, s[12:15], s35 offen
    s_mov_b32 s35, 1032320
    buffer_load_dwordx4 v[152:155], v13, s[12:15], s35 offen
    s_waitcnt vmcnt(6)
    ds_write_b128 v225, v[128:131] offset:0
    s_waitcnt vmcnt(5)
    ds_write_b128 v225, v[132:135] offset:4096
    s_waitcnt vmcnt(4)
    ds_write_b128 v225, v[136:139] offset:8192
    s_waitcnt vmcnt(3)
    ds_write_b128 v225, v[140:143] offset:12288
    s_waitcnt vmcnt(2)
    ds_write_b128 v225, v[144:147] offset:16384
    s_waitcnt vmcnt(1)
    ds_write_b128 v225, v[148:151] offset:20480
    s_waitcnt vmcnt(0)
    ds_write_b128 v225, v[152:155] offset:24576
    s_mov_b32 s12, s44
    s_and_b32 s13, s45, 0xffff
    s_mov_b32 s14, 1204224
    s_mov_b32 s15, 0x00020000
    s_movk_i32 s35, 2688
    v_lshrrev_b32 v13, 2, v0
    v_mul_lo_u32 v13, v13, s35
    v_and_b32 v14, 3, v0
    v_lshl_add_u32 v13, v14, 4, v13
    s_mov_b32 s35, 192
    buffer_load_dwordx4 v[128:131], v13, s[12:15], s35 offen
    s_mov_b32 s35, 172224
    buffer_load_dwordx4 v[132:135], v13, s[12:15], s35 offen
    s_mov_b32 s35, 344256
    buffer_load_dwordx4 v[136:139], v13, s[12:15], s35 offen
    s_mov_b32 s35, 516288
    buffer_load_dwordx4 v[140:143], v13, s[12:15], s35 offen
    s_mov_b32 s35, 688320
    buffer_load_dwordx4 v[144:147], v13, s[12:15], s35 offen
    s_mov_b32 s35, 860352
    buffer_load_dwordx4 v[148:151], v13, s[12:15], s35 offen
    s_mov_b32 s35, 1032384
    buffer_load_dwordx4 v[152:155], v13, s[12:15], s35 offen
    s_waitcnt vmcnt(6)
    ds_write_b128 v225, v[128:131] offset:28672
    s_waitcnt vmcnt(5)
    ds_write_b128 v225, v[132:135] offset:32768
    s_waitcnt vmcnt(4)
    ds_write_b128 v225, v[136:139] offset:36864
    s_waitcnt vmcnt(3)
    ds_write_b128 v225, v[140:143] offset:40960
    s_waitcnt vmcnt(2)
    ds_write_b128 v225, v[144:147] offset:45056
    s_waitcnt vmcnt(1)
    ds_write_b128 v225, v[148:151] offset:49152
    s_waitcnt vmcnt(0)
    ds_write_b128 v225, v[152:155] offset:53248
    s_waitcnt lgkmcnt(0)
    s_barrier
    ds_read_b64_tr_b16 v[192:193], v7 offset:0
    ds_read_b64_tr_b16 v[194:195], v7 offset:256
    ds_read_b64_tr_b16 v[196:197], v7 offset:28672
    ds_read_b64_tr_b16 v[198:199], v7 offset:28928
    ds_read_b64_tr_b16 v[200:201], v224 offset:0
    ds_read_b64_tr_b16 v[202:203], v224 offset:256
    ds_read_b64_tr_b16 v[204:205], v224 offset:28672
    ds_read_b64_tr_b16 v[206:207], v224 offset:28928
    ds_read_b64_tr_b16 v[208:209], v7 offset:1024
    ds_read_b64_tr_b16 v[210:211], v7 offset:1280
    ds_read_b64_tr_b16 v[212:213], v7 offset:29696
    ds_read_b64_tr_b16 v[214:215], v7 offset:29952
    ds_read_b64_tr_b16 v[216:217], v224 offset:1024
    ds_read_b64_tr_b16 v[218:219], v224 offset:1280
    ds_read_b64_tr_b16 v[220:221], v224 offset:29696
    ds_read_b64_tr_b16 v[222:223], v224 offset:29952
    s_waitcnt lgkmcnt(8)
    v_mfma_f32_32x32x16_bf16 v[128:143], v[192:195], v[16:19], 0
    v_mfma_f32_32x32x16_bf16 v[144:159], v[196:199], v[16:19], 0
    v_mfma_f32_32x32x16_bf16 v[160:175], v[200:203], v[16:19], 0
    v_mfma_f32_32x32x16_bf16 v[176:191], v[204:207], v[16:19], 0
    ds_read_b64_tr_b16 v[192:193], v7 offset:2048
    ds_read_b64_tr_b16 v[194:195], v7 offset:2304
    ds_read_b64_tr_b16 v[196:197], v7 offset:30720
    ds_read_b64_tr_b16 v[198:199], v7 offset:30976
    ds_read_b64_tr_b16 v[200:201], v224 offset:2048
    ds_read_b64_tr_b16 v[202:203], v224 offset:2304
    ds_read_b64_tr_b16 v[204:205], v224 offset:30720
    ds_read_b64_tr_b16 v[206:207], v224 offset:30976
    s_waitcnt lgkmcnt(8)
    v_mfma_f32_32x32x16_bf16 v[128:143], v[208:211], v[20:23], v[128:143]
    v_mfma_f32_32x32x16_bf16 v[144:159], v[212:215], v[20:23], v[144:159]
    v_mfma_f32_32x32x16_bf16 v[160:175], v[216:219], v[20:23], v[160:175]
    v_mfma_f32_32x32x16_bf16 v[176:191], v[220:223], v[20:23], v[176:191]
    ds_read_b64_tr_b16 v[208:209], v7 offset:3072
    ds_read_b64_tr_b16 v[210:211], v7 offset:3328
    ds_read_b64_tr_b16 v[212:213], v7 offset:31744
    ds_read_b64_tr_b16 v[214:215], v7 offset:32000
    ds_read_b64_tr_b16 v[216:217], v224 offset:3072
    ds_read_b64_tr_b16 v[218:219], v224 offset:3328
    ds_read_b64_tr_b16 v[220:221], v224 offset:31744
    ds_read_b64_tr_b16 v[222:223], v224 offset:32000
    s_waitcnt lgkmcnt(8)
    v_mfma_f32_32x32x16_bf16 v[128:143], v[192:195], v[24:27], v[128:143]
    v_mfma_f32_32x32x16_bf16 v[144:159], v[196:199], v[24:27], v[144:159]
    v_mfma_f32_32x32x16_bf16 v[160:175], v[200:203], v[24:27], v[160:175]
    v_mfma_f32_32x32x16_bf16 v[176:191], v[204:207], v[24:27], v[176:191]
    ds_read_b64_tr_b16 v[192:193], v7 offset:4096
    ds_read_b64_tr_b16 v[194:195], v7 offset:4352
    ds_read_b64_tr_b16 v[196:197], v7 offset:32768
    ds_read_b64_tr_b16 v[198:199], v7 offset:33024
    ds_read_b64_tr_b16 v[200:201], v224 offset:4096
    ds_read_b64_tr_b16 v[202:203], v224 offset:4352
    ds_read_b64_tr_b16 v[204:205], v224 offset:32768
    ds_read_b64_tr_b16 v[206:207], v224 offset:33024
    s_waitcnt lgkmcnt(8)
    v_mfma_f32_32x32x16_bf16 v[128:143], v[208:211], v[28:31], v[128:143]
    v_mfma_f32_32x32x16_bf16 v[144:159], v[212:215], v[28:31], v[144:159]
    v_mfma_f32_32x32x16_bf16 v[160:175], v[216:219], v[28:31], v[160:175]
    v_mfma_f32_32x32x16_bf16 v[176:191], v[220:223], v[28:31], v[176:191]
    ds_read_b64_tr_b16 v[208:209], v7 offset:5120
    ds_read_b64_tr_b16 v[210:211], v7 offset:5376
    ds_read_b64_tr_b16 v[212:213], v7 offset:33792
    ds_read_b64_tr_b16 v[214:215], v7 offset:34048
    ds_read_b64_tr_b16 v[216:217], v224 offset:5120
    ds_read_b64_tr_b16 v[218:219], v224 offset:5376
    ds_read_b64_tr_b16 v[220:221], v224 offset:33792
    ds_read_b64_tr_b16 v[222:223], v224 offset:34048
    s_waitcnt lgkmcnt(8)
    v_mfma_f32_32x32x16_bf16 v[128:143], v[192:195], v[32:35], v[128:143]
    v_mfma_f32_32x32x16_bf16 v[144:159], v[196:199], v[32:35], v[144:159]
    v_mfma_f32_32x32x16_bf16 v[160:175], v[200:203], v[32:35], v[160:175]
    v_mfma_f32_32x32x16_bf16 v[176:191], v[204:207], v[32:35], v[176:191]
    ds_read_b64_tr_b16 v[192:193], v7 offset:6144
    ds_read_b64_tr_b16 v[194:195], v7 offset:6400
    ds_read_b64_tr_b16 v[196:197], v7 offset:34816
    ds_read_b64_tr_b16 v[198:199], v7 offset:35072
    ds_read_b64_tr_b16 v[200:201], v224 offset:6144
    ds_read_b64_tr_b16 v[202:203], v224 offset:6400
    ds_read_b64_tr_b16 v[204:205], v224 offset:34816
    ds_read_b64_tr_b16 v[206:207], v224 offset:35072
    s_waitcnt lgkmcnt(8)
    v_mfma_f32_32x32x16_bf16 v[128:143], v[208:211], v[36:39], v[128:143]
    v_mfma_f32_32x32x16_bf16 v[144:159], v[212:215], v[36:39], v[144:159]
    v_mfma_f32_32x32x16_bf16 v[160:175], v[216:219], v[36:39], v[160:175]
    v_mfma_f32_32x32x16_bf16 v[176:191], v[220:223], v[36:39], v[176:191]
    ds_read_b64_tr_b16 v[208:209], v7 offset:7168
    ds_read_b64_tr_b16 v[210:211], v7 offset:7424
    ds_read_b64_tr_b16 v[212:213], v7 offset:35840
    ds_read_b64_tr_b16 v[214:215], v7 offset:36096
    ds_read_b64_tr_b16 v[216:217], v224 offset:7168
    ds_read_b64_tr_b16 v[218:219], v224 offset:7424
    ds_read_b64_tr_b16 v[220:221], v224 offset:35840
    ds_read_b64_tr_b16 v[222:223], v224 offset:36096
    s_waitcnt lgkmcnt(8)
    v_mfma_f32_32x32x16_bf16 v[128:143], v[192:195], v[40:43], v[128:143]
    v_mfma_f32_32x32x16_bf16 v[144:159], v[196:199], v[40:43], v[144:159]
    v_mfma_f32_32x32x16_bf16 v[160:175], v[200:203], v[40:43], v[160:175]
    v_mfma_f32_32x32x16_bf16 v[176:191], v[204:207], v[40:43], v[176:191]
    ds_read_b64_tr_b16 v[192:193], v7 offset:8192
    ds_read_b64_tr_b16 v[194:195], v7 offset:8448
    ds_read_b64_tr_b16 v[196:197], v7 offset:36864
    ds_read_b64_tr_b16 v[198:199], v7 offset:37120
    ds_read_b64_tr_b16 v[200:201], v224 offset:8192
    ds_read_b64_tr_b16 v[202:203], v224 offset:8448
    ds_read_b64_tr_b16 v[204:205], v224 offset:36864
    ds_read_b64_tr_b16 v[206:207], v224 offset:37120
    s_waitcnt lgkmcnt(8)
    v_mfma_f32_32x32x16_bf16 v[128:143], v[208:211], v[44:47], v[128:143]
    v_mfma_f32_32x32x16_bf16 v[144:159], v[212:215], v[44:47], v[144:159]
    v_mfma_f32_32x32x16_bf16 v[160:175], v[216:219], v[44:47], v[160:175]
    v_mfma_f32_32x32x16_bf16 v[176:191], v[220:223], v[44:47], v[176:191]
    ds_read_b64_tr_b16 v[208:209], v7 offset:9216
    ds_read_b64_tr_b16 v[210:211], v7 offset:9472
    ds_read_b64_tr_b16 v[212:213], v7 offset:37888
    ds_read_b64_tr_b16 v[214:215], v7 offset:38144
    ds_read_b64_tr_b16 v[216:217], v224 offset:9216
    ds_read_b64_tr_b16 v[218:219], v224 offset:9472
    ds_read_b64_tr_b16 v[220:221], v224 offset:37888
    ds_read_b64_tr_b16 v[222:223], v224 offset:38144
    s_waitcnt lgkmcnt(8)
    v_mfma_f32_32x32x16_bf16 v[128:143], v[192:195], v[48:51], v[128:143]
    v_mfma_f32_32x32x16_bf16 v[144:159], v[196:199], v[48:51], v[144:159]
    v_mfma_f32_32x32x16_bf16 v[160:175], v[200:203], v[48:51], v[160:175]
    v_mfma_f32_32x32x16_bf16 v[176:191], v[204:207], v[48:51], v[176:191]
    ds_read_b64_tr_b16 v[192:193], v7 offset:10240
    ds_read_b64_tr_b16 v[194:195], v7 offset:10496
    ds_read_b64_tr_b16 v[196:197], v7 offset:38912
    ds_read_b64_tr_b16 v[198:199], v7 offset:39168
    ds_read_b64_tr_b16 v[200:201], v224 offset:10240
    ds_read_b64_tr_b16 v[202:203], v224 offset:10496
    ds_read_b64_tr_b16 v[204:205], v224 offset:38912
    ds_read_b64_tr_b16 v[206:207], v224 offset:39168
    s_waitcnt lgkmcnt(8)
    v_mfma_f32_32x32x16_bf16 v[128:143], v[208:211], v[52:55], v[128:143]
    v_mfma_f32_32x32x16_bf16 v[144:159], v[212:215], v[52:55], v[144:159]
    v_mfma_f32_32x32x16_bf16 v[160:175], v[216:219], v[52:55], v[160:175]
    v_mfma_f32_32x32x16_bf16 v[176:191], v[220:223], v[52:55], v[176:191]
    ds_read_b64_tr_b16 v[208:209], v7 offset:11264
    ds_read_b64_tr_b16 v[210:211], v7 offset:11520
    ds_read_b64_tr_b16 v[212:213], v7 offset:39936
    ds_read_b64_tr_b16 v[214:215], v7 offset:40192
    ds_read_b64_tr_b16 v[216:217], v224 offset:11264
    ds_read_b64_tr_b16 v[218:219], v224 offset:11520
    ds_read_b64_tr_b16 v[220:221], v224 offset:39936
    ds_read_b64_tr_b16 v[222:223], v224 offset:40192
    s_waitcnt lgkmcnt(8)
    v_mfma_f32_32x32x16_bf16 v[128:143], v[192:195], v[56:59], v[128:143]
    v_mfma_f32_32x32x16_bf16 v[144:159], v[196:199], v[56:59], v[144:159]
    v_mfma_f32_32x32x16_bf16 v[160:175], v[200:203], v[56:59], v[160:175]
    v_mfma_f32_32x32x16_bf16 v[176:191], v[204:207], v[56:59], v[176:191]
    ds_read_b64_tr_b16 v[192:193], v7 offset:12288
    ds_read_b64_tr_b16 v[194:195], v7 offset:12544
    ds_read_b64_tr_b16 v[196:197], v7 offset:40960
    ds_read_b64_tr_b16 v[198:199], v7 offset:41216
    ds_read_b64_tr_b16 v[200:201], v224 offset:12288
    ds_read_b64_tr_b16 v[202:203], v224 offset:12544
    ds_read_b64_tr_b16 v[204:205], v224 offset:40960
    ds_read_b64_tr_b16 v[206:207], v224 offset:41216
    s_waitcnt lgkmcnt(8)
    v_mfma_f32_32x32x16_bf16 v[128:143], v[208:211], v[60:63], v[128:143]
    v_mfma_f32_32x32x16_bf16 v[144:159], v[212:215], v[60:63], v[144:159]
    v_mfma_f32_32x32x16_bf16 v[160:175], v[216:219], v[60:63], v[160:175]
    v_mfma_f32_32x32x16_bf16 v[176:191], v[220:223], v[60:63], v[176:191]
    ds_read_b64_tr_b16 v[208:209], v7 offset:13312
    ds_read_b64_tr_b16 v[210:211], v7 offset:13568
    ds_read_b64_tr_b16 v[212:213], v7 offset:41984
    ds_read_b64_tr_b16 v[214:215], v7 offset:42240
    ds_read_b64_tr_b16 v[216:217], v224 offset:13312
    ds_read_b64_tr_b16 v[218:219], v224 offset:13568
    ds_read_b64_tr_b16 v[220:221], v224 offset:41984
    ds_read_b64_tr_b16 v[222:223], v224 offset:42240
    s_waitcnt lgkmcnt(8)
    v_mfma_f32_32x32x16_bf16 v[128:143], v[192:195], v[64:67], v[128:143]
    v_mfma_f32_32x32x16_bf16 v[144:159], v[196:199], v[64:67], v[144:159]
    v_mfma_f32_32x32x16_bf16 v[160:175], v[200:203], v[64:67], v[160:175]
    v_mfma_f32_32x32x16_bf16 v[176:191], v[204:207], v[64:67], v[176:191]
    ds_read_b64_tr_b16 v[192:193], v7 offset:14336
    ds_read_b64_tr_b16 v[194:195], v7 offset:14592
    ds_read_b64_tr_b16 v[196:197], v7 offset:43008
    ds_read_b64_tr_b16 v[198:199], v7 offset:43264
    ds_read_b64_tr_b16 v[200:201], v224 offset:14336
    ds_read_b64_tr_b16 v[202:203], v224 offset:14592
    ds_read_b64_tr_b16 v[204:205], v224 offset:43008
    ds_read_b64_tr_b16 v[206:207], v224 offset:43264
    s_waitcnt lgkmcnt(8)
    v_mfma_f32_32x32x16_bf16 v[128:143], v[208:211], v[68:71], v[128:143]
    v_mfma_f32_32x32x16_bf16 v[144:159], v[212:215], v[68:71], v[144:159]
    v_mfma_f32_32x32x16_bf16 v[160:175], v[216:219], v[68:71], v[160:175]
    v_mfma_f32_32x32x16_bf16 v[176:191], v[220:223], v[68:71], v[176:191]
    ds_read_b64_tr_b16 v[208:209], v7 offset:15360
    ds_read_b64_tr_b16 v[210:211], v7 offset:15616
    ds_read_b64_tr_b16 v[212:213], v7 offset:44032
    ds_read_b64_tr_b16 v[214:215], v7 offset:44288
    ds_read_b64_tr_b16 v[216:217], v224 offset:15360
    ds_read_b64_tr_b16 v[218:219], v224 offset:15616
    ds_read_b64_tr_b16 v[220:221], v224 offset:44032
    ds_read_b64_tr_b16 v[222:223], v224 offset:44288
    s_waitcnt lgkmcnt(8)
    v_mfma_f32_32x32x16_bf16 v[128:143], v[192:195], v[72:75], v[128:143]
    v_mfma_f32_32x32x16_bf16 v[144:159], v[196:199], v[72:75], v[144:159]
    v_mfma_f32_32x32x16_bf16 v[160:175], v[200:203], v[72:75], v[160:175]
    v_mfma_f32_32x32x16_bf16 v[176:191], v[204:207], v[72:75], v[176:191]
    ds_read_b64_tr_b16 v[192:193], v7 offset:16384
    ds_read_b64_tr_b16 v[194:195], v7 offset:16640
    ds_read_b64_tr_b16 v[196:197], v7 offset:45056
    ds_read_b64_tr_b16 v[198:199], v7 offset:45312
    ds_read_b64_tr_b16 v[200:201], v224 offset:16384
    ds_read_b64_tr_b16 v[202:203], v224 offset:16640
    ds_read_b64_tr_b16 v[204:205], v224 offset:45056
    ds_read_b64_tr_b16 v[206:207], v224 offset:45312
    s_waitcnt lgkmcnt(8)
    v_mfma_f32_32x32x16_bf16 v[128:143], v[208:211], v[76:79], v[128:143]
    v_mfma_f32_32x32x16_bf16 v[144:159], v[212:215], v[76:79], v[144:159]
    v_mfma_f32_32x32x16_bf16 v[160:175], v[216:219], v[76:79], v[160:175]
    v_mfma_f32_32x32x16_bf16 v[176:191], v[220:223], v[76:79], v[176:191]
    ds_read_b64_tr_b16 v[208:209], v7 offset:17408
    ds_read_b64_tr_b16 v[210:211], v7 offset:17664
    ds_read_b64_tr_b16 v[212:213], v7 offset:46080
    ds_read_b64_tr_b16 v[214:215], v7 offset:46336
    ds_read_b64_tr_b16 v[216:217], v224 offset:17408
    ds_read_b64_tr_b16 v[218:219], v224 offset:17664
    ds_read_b64_tr_b16 v[220:221], v224 offset:46080
    ds_read_b64_tr_b16 v[222:223], v224 offset:46336
    s_waitcnt lgkmcnt(8)
    v_mfma_f32_32x32x16_bf16 v[128:143], v[192:195], v[80:83], v[128:143]
    v_mfma_f32_32x32x16_bf16 v[144:159], v[196:199], v[80:83], v[144:159]
    v_mfma_f32_32x32x16_bf16 v[160:175], v[200:203], v[80:83], v[160:175]
    v_mfma_f32_32x32x16_bf16 v[176:191], v[204:207], v[80:83], v[176:191]
    ds_read_b64_tr_b16 v[192:193], v7 offset:18432
    ds_read_b64_tr_b16 v[194:195], v7 offset:18688
    ds_read_b64_tr_b16 v[196:197], v7 offset:47104
    ds_read_b64_tr_b16 v[198:199], v7 offset:47360
    ds_read_b64_tr_b16 v[200:201], v224 offset:18432
    ds_read_b64_tr_b16 v[202:203], v224 offset:18688
    ds_read_b64_tr_b16 v[204:205], v224 offset:47104
    ds_read_b64_tr_b16 v[206:207], v224 offset:47360
    s_waitcnt lgkmcnt(8)
    v_mfma_f32_32x32x16_bf16 v[128:143], v[208:211], v[84:87], v[128:143]
    v_mfma_f32_32x32x16_bf16 v[144:159], v[212:215], v[84:87], v[144:159]
    v_mfma_f32_32x32x16_bf16 v[160:175], v[216:219], v[84:87], v[160:175]
    v_mfma_f32_32x32x16_bf16 v[176:191], v[220:223], v[84:87], v[176:191]
    ds_read_b64_tr_b16 v[208:209], v7 offset:19456
    ds_read_b64_tr_b16 v[210:211], v7 offset:19712
    ds_read_b64_tr_b16 v[212:213], v7 offset:48128
    ds_read_b64_tr_b16 v[214:215], v7 offset:48384
    ds_read_b64_tr_b16 v[216:217], v224 offset:19456
    ds_read_b64_tr_b16 v[218:219], v224 offset:19712
    ds_read_b64_tr_b16 v[220:221], v224 offset:48128
    ds_read_b64_tr_b16 v[222:223], v224 offset:48384
    s_waitcnt lgkmcnt(8)
    v_mfma_f32_32x32x16_bf16 v[128:143], v[192:195], v[88:91], v[128:143]
    v_mfma_f32_32x32x16_bf16 v[144:159], v[196:199], v[88:91], v[144:159]
    v_mfma_f32_32x32x16_bf16 v[160:175], v[200:203], v[88:91], v[160:175]
    v_mfma_f32_32x32x16_bf16 v[176:191], v[204:207], v[88:91], v[176:191]
    ds_read_b64_tr_b16 v[192:193], v7 offset:20480
    ds_read_b64_tr_b16 v[194:195], v7 offset:20736
    ds_read_b64_tr_b16 v[196:197], v7 offset:49152
    ds_read_b64_tr_b16 v[198:199], v7 offset:49408
    ds_read_b64_tr_b16 v[200:201], v224 offset:20480
    ds_read_b64_tr_b16 v[202:203], v224 offset:20736
    ds_read_b64_tr_b16 v[204:205], v224 offset:49152
    ds_read_b64_tr_b16 v[206:207], v224 offset:49408
    s_waitcnt lgkmcnt(8)
    v_mfma_f32_32x32x16_bf16 v[128:143], v[208:211], v[92:95], v[128:143]
    v_mfma_f32_32x32x16_bf16 v[144:159], v[212:215], v[92:95], v[144:159]
    v_mfma_f32_32x32x16_bf16 v[160:175], v[216:219], v[92:95], v[160:175]
    v_mfma_f32_32x32x16_bf16 v[176:191], v[220:223], v[92:95], v[176:191]
    ds_read_b64_tr_b16 v[208:209], v7 offset:21504
    ds_read_b64_tr_b16 v[210:211], v7 offset:21760
    ds_read_b64_tr_b16 v[212:213], v7 offset:50176
    ds_read_b64_tr_b16 v[214:215], v7 offset:50432
    ds_read_b64_tr_b16 v[216:217], v224 offset:21504
    ds_read_b64_tr_b16 v[218:219], v224 offset:21760
    ds_read_b64_tr_b16 v[220:221], v224 offset:50176
    ds_read_b64_tr_b16 v[222:223], v224 offset:50432
    s_waitcnt lgkmcnt(8)
    v_mfma_f32_32x32x16_bf16 v[128:143], v[192:195], v[96:99], v[128:143]
    v_mfma_f32_32x32x16_bf16 v[144:159], v[196:199], v[96:99], v[144:159]
    v_mfma_f32_32x32x16_bf16 v[160:175], v[200:203], v[96:99], v[160:175]
    v_mfma_f32_32x32x16_bf16 v[176:191], v[204:207], v[96:99], v[176:191]
    ds_read_b64_tr_b16 v[192:193], v7 offset:22528
    ds_read_b64_tr_b16 v[194:195], v7 offset:22784
    ds_read_b64_tr_b16 v[196:197], v7 offset:51200
    ds_read_b64_tr_b16 v[198:199], v7 offset:51456
    ds_read_b64_tr_b16 v[200:201], v224 offset:22528
    ds_read_b64_tr_b16 v[202:203], v224 offset:22784
    ds_read_b64_tr_b16 v[204:205], v224 offset:51200
    ds_read_b64_tr_b16 v[206:207], v224 offset:51456
    s_waitcnt lgkmcnt(8)
    v_mfma_f32_32x32x16_bf16 v[128:143], v[208:211], v[100:103], v[128:143]
    v_mfma_f32_32x32x16_bf16 v[144:159], v[212:215], v[100:103], v[144:159]
    v_mfma_f32_32x32x16_bf16 v[160:175], v[216:219], v[100:103], v[160:175]
    v_mfma_f32_32x32x16_bf16 v[176:191], v[220:223], v[100:103], v[176:191]
    ds_read_b64_tr_b16 v[208:209], v7 offset:23552
    ds_read_b64_tr_b16 v[210:211], v7 offset:23808
    ds_read_b64_tr_b16 v[212:213], v7 offset:52224
    ds_read_b64_tr_b16 v[214:215], v7 offset:52480
    ds_read_b64_tr_b16 v[216:217], v224 offset:23552
    ds_read_b64_tr_b16 v[218:219], v224 offset:23808
    ds_read_b64_tr_b16 v[220:221], v224 offset:52224
    ds_read_b64_tr_b16 v[222:223], v224 offset:52480
    s_waitcnt lgkmcnt(8)
    v_mfma_f32_32x32x16_bf16 v[128:143], v[192:195], v[104:107], v[128:143]
    v_mfma_f32_32x32x16_bf16 v[144:159], v[196:199], v[104:107], v[144:159]
    v_mfma_f32_32x32x16_bf16 v[160:175], v[200:203], v[104:107], v[160:175]
    v_mfma_f32_32x32x16_bf16 v[176:191], v[204:207], v[104:107], v[176:191]
    ds_read_b64_tr_b16 v[192:193], v7 offset:24576
    ds_read_b64_tr_b16 v[194:195], v7 offset:24832
    ds_read_b64_tr_b16 v[196:197], v7 offset:53248
    ds_read_b64_tr_b16 v[198:199], v7 offset:53504
    ds_read_b64_tr_b16 v[200:201], v224 offset:24576
    ds_read_b64_tr_b16 v[202:203], v224 offset:24832
    ds_read_b64_tr_b16 v[204:205], v224 offset:53248
    ds_read_b64_tr_b16 v[206:207], v224 offset:53504
    s_waitcnt lgkmcnt(8)
    v_mfma_f32_32x32x16_bf16 v[128:143], v[208:211], v[108:111], v[128:143]
    v_mfma_f32_32x32x16_bf16 v[144:159], v[212:215], v[108:111], v[144:159]
    v_mfma_f32_32x32x16_bf16 v[160:175], v[216:219], v[108:111], v[160:175]
    v_mfma_f32_32x32x16_bf16 v[176:191], v[220:223], v[108:111], v[176:191]
    ds_read_b64_tr_b16 v[208:209], v7 offset:25600
    ds_read_b64_tr_b16 v[210:211], v7 offset:25856
    ds_read_b64_tr_b16 v[212:213], v7 offset:54272
    ds_read_b64_tr_b16 v[214:215], v7 offset:54528
    ds_read_b64_tr_b16 v[216:217], v224 offset:25600
    ds_read_b64_tr_b16 v[218:219], v224 offset:25856
    ds_read_b64_tr_b16 v[220:221], v224 offset:54272
    ds_read_b64_tr_b16 v[222:223], v224 offset:54528
    s_waitcnt lgkmcnt(8)
    v_mfma_f32_32x32x16_bf16 v[128:143], v[192:195], v[112:115], v[128:143]
    v_mfma_f32_32x32x16_bf16 v[144:159], v[196:199], v[112:115], v[144:159]
    v_mfma_f32_32x32x16_bf16 v[160:175], v[200:203], v[112:115], v[160:175]
    v_mfma_f32_32x32x16_bf16 v[176:191], v[204:207], v[112:115], v[176:191]
    ds_read_b64_tr_b16 v[192:193], v7 offset:26624
    ds_read_b64_tr_b16 v[194:195], v7 offset:26880
    ds_read_b64_tr_b16 v[196:197], v7 offset:55296
    ds_read_b64_tr_b16 v[198:199], v7 offset:55552
    ds_read_b64_tr_b16 v[200:201], v224 offset:26624
    ds_read_b64_tr_b16 v[202:203], v224 offset:26880
    ds_read_b64_tr_b16 v[204:205], v224 offset:55296
    ds_read_b64_tr_b16 v[206:207], v224 offset:55552
    s_waitcnt lgkmcnt(8)
    v_mfma_f32_32x32x16_bf16 v[128:143], v[208:211], v[116:119], v[128:143]
    v_mfma_f32_32x32x16_bf16 v[144:159], v[212:215], v[116:119], v[144:159]
    v_mfma_f32_32x32x16_bf16 v[160:175], v[216:219], v[116:119], v[160:175]
    v_mfma_f32_32x32x16_bf16 v[176:191], v[220:223], v[116:119], v[176:191]
    ds_read_b64_tr_b16 v[208:209], v7 offset:27648
    ds_read_b64_tr_b16 v[210:211], v7 offset:27904
    ds_read_b64_tr_b16 v[212:213], v7 offset:56320
    ds_read_b64_tr_b16 v[214:215], v7 offset:56576
    ds_read_b64_tr_b16 v[216:217], v224 offset:27648
    ds_read_b64_tr_b16 v[218:219], v224 offset:27904
    ds_read_b64_tr_b16 v[220:221], v224 offset:56320
    ds_read_b64_tr_b16 v[222:223], v224 offset:56576
    s_waitcnt lgkmcnt(8)
    v_mfma_f32_32x32x16_bf16 v[128:143], v[192:195], v[120:123], v[128:143]
    v_mfma_f32_32x32x16_bf16 v[144:159], v[196:199], v[120:123], v[144:159]
    v_mfma_f32_32x32x16_bf16 v[160:175], v[200:203], v[120:123], v[160:175]
    v_mfma_f32_32x32x16_bf16 v[176:191], v[204:207], v[120:123], v[176:191]
    s_waitcnt lgkmcnt(0)
    v_mfma_f32_32x32x16_bf16 v[128:143], v[208:211], v[124:127], v[128:143]
    v_mfma_f32_32x32x16_bf16 v[144:159], v[212:215], v[124:127], v[144:159]
    v_mfma_f32_32x32x16_bf16 v[160:175], v[216:219], v[124:127], v[160:175]
    v_mfma_f32_32x32x16_bf16 v[176:191], v[220:223], v[124:127], v[176:191]
    s_nop 15
    s_nop 3
    s_movk_i32 s35, 1792
    v_mul_lo_u32 v13, v5, s35
    v_lshl_add_u32 v13, v4, 3, v13
    v_add_u32 v13, 2359296, v13
    v_cvt_pk_bf16_f32 v128, v128, v129
    v_cvt_pk_bf16_f32 v129, v130, v131
    buffer_store_dwordx2 v[128:129], v13, s[16:19], 0 offen offset:0
    v_cvt_pk_bf16_f32 v132, v132, v133
    v_cvt_pk_bf16_f32 v133, v134, v135
    buffer_store_dwordx2 v[132:133], v13, s[16:19], 0 offen offset:16
    v_cvt_pk_bf16_f32 v136, v136, v137
    v_cvt_pk_bf16_f32 v137, v138, v139
    buffer_store_dwordx2 v[136:137], v13, s[16:19], 0 offen offset:32
    v_cvt_pk_bf16_f32 v140, v140, v141
    v_cvt_pk_bf16_f32 v141, v142, v143
    buffer_store_dwordx2 v[140:141], v13, s[16:19], 0 offen offset:48
    s_movk_i32 s35, 1792
    v_mul_lo_u32 v13, v5, s35
    v_lshl_add_u32 v13, v4, 3, v13
    v_add_u32 v13, 2359360, v13
    v_cvt_pk_bf16_f32 v144, v144, v145
    v_cvt_pk_bf16_f32 v145, v146, v147
    buffer_store_dwordx2 v[144:145], v13, s[16:19], 0 offen offset:0
    v_cvt_pk_bf16_f32 v148, v148, v149
    v_cvt_pk_bf16_f32 v149, v150, v151
    buffer_store_dwordx2 v[148:149], v13, s[16:19], 0 offen offset:16
    v_cvt_pk_bf16_f32 v152, v152, v153
    v_cvt_pk_bf16_f32 v153, v154, v155
    buffer_store_dwordx2 v[152:153], v13, s[16:19], 0 offen offset:32
    v_cvt_pk_bf16_f32 v156, v156, v157
    v_cvt_pk_bf16_f32 v157, v158, v159
    buffer_store_dwordx2 v[156:157], v13, s[16:19], 0 offen offset:48
    s_movk_i32 s35, 1792
    v_mul_lo_u32 v13, v5, s35
    v_lshl_add_u32 v13, v4, 3, v13
    v_add_u32 v13, 2359424, v13
    v_cvt_pk_bf16_f32 v160, v160, v161
    v_cvt_pk_bf16_f32 v161, v162, v163
    buffer_store_dwordx2 v[160:161], v13, s[16:19], 0 offen offset:0
    v_cvt_pk_bf16_f32 v164, v164, v165
    v_cvt_pk_bf16_f32 v165, v166, v167
    buffer_store_dwordx2 v[164:165], v13, s[16:19], 0 offen offset:16
    v_cvt_pk_bf16_f32 v168, v168, v169
    v_cvt_pk_bf16_f32 v169, v170, v171
    buffer_store_dwordx2 v[168:169], v13, s[16:19], 0 offen offset:32
    v_cvt_pk_bf16_f32 v172, v172, v173
    v_cvt_pk_bf16_f32 v173, v174, v175
    buffer_store_dwordx2 v[172:173], v13, s[16:19], 0 offen offset:48
    s_movk_i32 s35, 1792
    v_mul_lo_u32 v13, v5, s35
    v_lshl_add_u32 v13, v4, 3, v13
    v_add_u32 v13, 2359488, v13
    v_cvt_pk_bf16_f32 v176, v176, v177
    v_cvt_pk_bf16_f32 v177, v178, v179
    buffer_store_dwordx2 v[176:177], v13, s[16:19], 0 offen offset:0
    v_cvt_pk_bf16_f32 v180, v180, v181
    v_cvt_pk_bf16_f32 v181, v182, v183
    buffer_store_dwordx2 v[180:181], v13, s[16:19], 0 offen offset:16
    v_cvt_pk_bf16_f32 v184, v184, v185
    v_cvt_pk_bf16_f32 v185, v186, v187
    buffer_store_dwordx2 v[184:185], v13, s[16:19], 0 offen offset:32
    v_cvt_pk_bf16_f32 v188, v188, v189
    v_cvt_pk_bf16_f32 v189, v190, v191
    buffer_store_dwordx2 v[188:189], v13, s[16:19], 0 offen offset:48
    s_endpgm
K1_v5:
    s_mov_b32 s12, s44
    s_and_b32 s13, s45, 0xffff
    s_mov_b32 s14, 1204224
    s_mov_b32 s15, 0x00020000
    s_movk_i32 s35, 2688
    v_lshrrev_b32 v227, 2, v0
    v_mul_lo_u32 v227, v227, s35
    v_and_b32 v14, 3, v0
    v_lshl_add_u32 v227, v14, 4, v227
    s_mov_b32 s35, 256
    buffer_load_dwordx4 v[128:131], v227, s[12:15], s35 offen
    s_mov_b32 s35, 172288
    buffer_load_dwordx4 v[132:135], v227, s[12:15], s35 offen
    s_mov_b32 s35, 344320
    buffer_load_dwordx4 v[136:139], v227, s[12:15], s35 offen
    s_mov_b32 s35, 516352
    buffer_load_dwordx4 v[140:143], v227, s[12:15], s35 offen
    s_mov_b32 s35, 688384
    buffer_load_dwordx4 v[144:147], v227, s[12:15], s35 offen
    s_mov_b32 s35, 860416
    buffer_load_dwordx4 v[148:151], v227, s[12:15], s35 offen
    s_mov_b32 s35, 1032448
    buffer_load_dwordx4 v[152:155], v227, s[12:15], s35 offen
    s_mov_b32 s12, s44
    s_and_b32 s13, s45, 0xffff
    s_mov_b32 s14, 1204224
    s_mov_b32 s15, 0x00020000
    s_movk_i32 s35, 2688
    v_lshrrev_b32 v227, 2, v0
    v_mul_lo_u32 v227, v227, s35
    v_and_b32 v14, 3, v0
    v_lshl_add_u32 v227, v14, 4, v227
    s_mov_b32 s35, 320
    buffer_load_dwordx4 v[156:159], v227, s[12:15], s35 offen
    s_mov_b32 s35, 172352
    buffer_load_dwordx4 v[160:163], v227, s[12:15], s35 offen
    s_mov_b32 s35, 344384
    buffer_load_dwordx4 v[164:167], v227, s[12:15], s35 offen
    s_mov_b32 s35, 516416
    buffer_load_dwordx4 v[168:171], v227, s[12:15], s35 offen
    s_mov_b32 s35, 688448
    buffer_load_dwordx4 v[172:175], v227, s[12:15], s35 offen
    s_mov_b32 s35, 860480
    buffer_load_dwordx4 v[176:179], v227, s[12:15], s35 offen
    s_mov_b32 s35, 1032512
    buffer_load_dwordx4 v[180:183], v227, s[12:15], s35 offen
    s_mov_b32 s54, 0x4924925
    v_add_u32 v13, 0, v2
    v_mul_hi_u32 v14, v13, s54
    v_lshlrev_b32 v13, 4, v13
    v_lshl_add_u32 v13, v14, 4, v13
    v_add_u32 v13, s53, v13
    s_waitcnt vmcnt(41)
    ds_write_b128 v13, v[16:19]
    v_add_u32 v13, 64, v2
    v_mul_hi_u32 v14, v13, s54
    v_lshlrev_b32 v13, 4, v13
    v_lshl_add_u32 v13, v14, 4, v13
    v_add_u32 v13, s53, v13
    s_waitcnt vmcnt(40)
    ds_write_b128 v13, v[20:23]
    v_add_u32 v13, 128, v2
    v_mul_hi_u32 v14, v13, s54
    v_lshlrev_b32 v13, 4, v13
    v_lshl_add_u32 v13, v14, 4, v13
    v_add_u32 v13, s53, v13
    s_waitcnt vmcnt(39)
    ds_write_b128 v13, v[24:27]
    v_add_u32 v13, 192, v2
    v_mul_hi_u32 v14, v13, s54
    v_lshlrev_b32 v13, 4, v13
    v_lshl_add_u32 v13, v14, 4, v13
    v_add_u32 v13, s53, v13
    s_waitcnt vmcnt(38)
    ds_write_b128 v13, v[28:31]
    v_add_u32 v13, 256, v2
    v_mul_hi_u32 v14, v13, s54
    v_lshlrev_b32 v13, 4, v13
    v_lshl_add_u32 v13, v14, 4, v13
    v_add_u32 v13, s53, v13
    s_waitcnt vmcnt(37)
    ds_write_b128 v13, v[32:35]
    v_add_u32 v13, 320, v2
    v_mul_hi_u32 v14, v13, s54
    v_lshlrev_b32 v13, 4, v13
    v_lshl_add_u32 v13, v14, 4, v13
    v_add_u32 v13, s53, v13
    s_waitcnt vmcnt(36)
    ds_write_b128 v13, v[36:39]
    v_add_u32 v13, 384, v2
    v_mul_hi_u32 v14, v13, s54
    v_lshlrev_b32 v13, 4, v13
    v_lshl_add_u32 v13, v14, 4, v13
    v_add_u32 v13, s53, v13
    s_waitcnt vmcnt(35)
    ds_write_b128 v13, v[40:43]
    v_add_u32 v13, 448, v2
    v_mul_hi_u32 v14, v13, s54
    v_lshlrev_b32 v13, 4, v13
    v_lshl_add_u32 v13, v14, 4, v13
    v_add_u32 v13, s53, v13
    s_waitcnt vmcnt(34)
    ds_write_b128 v13, v[44:47]
    v_add_u32 v13, 512, v2
    v_mul_hi_u32 v14, v13, s54
    v_lshlrev_b32 v13, 4, v13
    v_lshl_add_u32 v13, v14, 4, v13
    v_add_u32 v13, s53, v13
    s_waitcnt vmcnt(33)
    ds_write_b128 v13, v[48:51]
    v_add_u32 v13, 576, v2
    v_mul_hi_u32 v14, v13, s54
    v_lshlrev_b32 v13, 4, v13
    v_lshl_add_u32 v13, v14, 4, v13
    v_add_u32 v13, s53, v13
    s_waitcnt vmcnt(32)
    ds_write_b128 v13, v[52:55]
    v_add_u32 v13, 640, v2
    v_mul_hi_u32 v14, v13, s54
    v_lshlrev_b32 v13, 4, v13
    v_lshl_add_u32 v13, v14, 4, v13
    v_add_u32 v13, s53, v13
    s_waitcnt vmcnt(31)
    ds_write_b128 v13, v[56:59]
    v_add_u32 v13, 704, v2
    v_mul_hi_u32 v14, v13, s54
    v_lshlrev_b32 v13, 4, v13
    v_lshl_add_u32 v13, v14, 4, v13
    v_add_u32 v13, s53, v13
    s_waitcnt vmcnt(30)
    ds_write_b128 v13, v[60:63]
    v_add_u32 v13, 768, v2
    v_mul_hi_u32 v14, v13, s54
    v_lshlrev_b32 v13, 4, v13
    v_lshl_add_u32 v13, v14, 4, v13
    v_add_u32 v13, s53, v13
    s_waitcnt vmcnt(29)
    ds_write_b128 v13, v[64:67]
    v_add_u32 v13, 832, v2
    v_mul_hi_u32 v14, v13, s54
    v_lshlrev_b32 v13, 4, v13
    v_lshl_add_u32 v13, v14, 4, v13
    v_add_u32 v13, s53, v13
    s_waitcnt vmcnt(28)
    ds_write_b128 v13, v[68:71]
    v_add_u32 v13, 896, v2
    v_mul_hi_u32 v14, v13, s54
    v_lshlrev_b32 v13, 4, v13
    v_lshl_add_u32 v13, v14, 4, v13
    v_add_u32 v13, s53, v13
    s_waitcnt vmcnt(27)
    ds_write_b128 v13, v[72:75]
    v_add_u32 v13, 960, v2
    v_mul_hi_u32 v14, v13, s54
    v_lshlrev_b32 v13, 4, v13
    v_lshl_add_u32 v13, v14, 4, v13
    v_add_u32 v13, s53, v13
    s_waitcnt vmcnt(26)
    ds_write_b128 v13, v[76:79]
    v_add_u32 v13, 1024, v2
    v_mul_hi_u32 v14, v13, s54
    v_lshlrev_b32 v13, 4, v13
    v_lshl_add_u32 v13, v14, 4, v13
    v_add_u32 v13, s53, v13
    s_waitcnt vmcnt(25)
    ds_write_b128 v13, v[80:83]
    v_add_u32 v13, 1088, v2
    v_mul_hi_u32 v14, v13, s54
    v_lshlrev_b32 v13, 4, v13
    v_lshl_add_u32 v13, v14, 4, v13
    v_add_u32 v13, s53, v13
    s_waitcnt vmcnt(24)
    ds_write_b128 v13, v[84:87]
    v_add_u32 v13, 1152, v2
    v_mul_hi_u32 v14, v13, s54
    v_lshlrev_b32 v13, 4, v13
    v_lshl_add_u32 v13, v14, 4, v13
    v_add_u32 v13, s53, v13
    s_waitcnt vmcnt(23)
    ds_write_b128 v13, v[88:91]
    v_add_u32 v13, 1216, v2
    v_mul_hi_u32 v14, v13, s54
    v_lshlrev_b32 v13, 4, v13
    v_lshl_add_u32 v13, v14, 4, v13
    v_add_u32 v13, s53, v13
    s_waitcnt vmcnt(22)
    ds_write_b128 v13, v[92:95]
    v_add_u32 v13, 1280, v2
    v_mul_hi_u32 v14, v13, s54
    v_lshlrev_b32 v13, 4, v13
    v_lshl_add_u32 v13, v14, 4, v13
    v_add_u32 v13, s53, v13
    s_waitcnt vmcnt(21)
    ds_write_b128 v13, v[96:99]
    v_add_u32 v13, 1344, v2
    v_mul_hi_u32 v14, v13, s54
    v_lshlrev_b32 v13, 4, v13
    v_lshl_add_u32 v13, v14, 4, v13
    v_add_u32 v13, s53, v13
    s_waitcnt vmcnt(20)
    ds_write_b128 v13, v[100:103]
    v_add_u32 v13, 1408, v2
    v_mul_hi_u32 v14, v13, s54
    v_lshlrev_b32 v13, 4, v13
    v_lshl_add_u32 v13, v14, 4, v13
    v_add_u32 v13, s53, v13
    s_waitcnt vmcnt(19)
    ds_write_b128 v13, v[104:107]
    v_add_u32 v13, 1472, v2
    v_mul_hi_u32 v14, v13, s54
    v_lshlrev_b32 v13, 4, v13
    v_lshl_add_u32 v13, v14, 4, v13
    v_add_u32 v13, s53, v13
    s_waitcnt vmcnt(18)
    ds_write_b128 v13, v[108:111]
    v_add_u32 v13, 1536, v2
    v_mul_hi_u32 v14, v13, s54
    v_lshlrev_b32 v13, 4, v13
    v_lshl_add_u32 v13, v14, 4, v13
    v_add_u32 v13, s53, v13
    s_waitcnt vmcnt(17)
    ds_write_b128 v13, v[112:115]
    v_add_u32 v13, 1600, v2
    v_mul_hi_u32 v14, v13, s54
    v_lshlrev_b32 v13, 4, v13
    v_lshl_add_u32 v13, v14, 4, v13
    v_add_u32 v13, s53, v13
    s_waitcnt vmcnt(16)
    ds_write_b128 v13, v[116:119]
    v_add_u32 v13, 1664, v2
    v_mul_hi_u32 v14, v13, s54
    v_lshlrev_b32 v13, 4, v13
    v_lshl_add_u32 v13, v14, 4, v13
    v_add_u32 v13, s53, v13
    s_waitcnt vmcnt(15)
    ds_write_b128 v13, v[120:123]
    v_add_u32 v13, 1728, v2
    v_mul_hi_u32 v14, v13, s54
    v_lshlrev_b32 v13, 4, v13
    v_lshl_add_u32 v13, v14, 4, v13
    v_add_u32 v13, s53, v13
    s_waitcnt vmcnt(14)
    ds_write_b128 v13, v[124:127]
    v_mul_u32_u24 v13, 912, v3
    v_lshl_add_u32 v13, v4, 4, v13
    v_add_u32 v13, s53, v13
    s_waitcnt lgkmcnt(0)
    ds_read_b128 v[16:19], v13 offset:0
    ds_read_b128 v[20:23], v13 offset:32
    ds_read_b128 v[24:27], v13 offset:64
    ds_read_b128 v[28:31], v13 offset:96
    ds_read_b128 v[32:35], v13 offset:128
    ds_read_b128 v[36:39], v13 offset:160
    ds_read_b128 v[40:43], v13 offset:192
    ds_read_b128 v[44:47], v13 offset:224
    ds_read_b128 v[48:51], v13 offset:256
    ds_read_b128 v[52:55], v13 offset:288
    ds_read_b128 v[56:59], v13 offset:320
    ds_read_b128 v[60:63], v13 offset:352
    ds_read_b128 v[64:67], v13 offset:384
    ds_read_b128 v[68:71], v13 offset:416
    ds_read_b128 v[72:75], v13 offset:448
    ds_read_b128 v[76:79], v13 offset:480
    ds_read_b128 v[80:83], v13 offset:512
    ds_read_b128 v[84:87], v13 offset:544
    ds_read_b128 v[88:91], v13 offset:576
    ds_read_b128 v[92:95], v13 offset:608
    ds_read_b128 v[96:99], v13 offset:640
    ds_read_b128 v[100:103], v13 offset:672
    ds_read_b128 v[104:107], v13 offset:704
    ds_read_b128 v[108:111], v13 offset:736
    ds_read_b128 v[112:115], v13 offset:768
    ds_read_b128 v[116:119], v13 offset:800
    ds_read_b128 v[120:123], v13 offset:832
    ds_read_b128 v[124:127], v13 offset:864
    s_waitcnt lgkmcnt(0)
    s_barrier
    s_waitcnt vmcnt(13)
    ds_write_b128 v11, v[128:131] offset:0
    s_waitcnt vmcnt(12)
    ds_write_b128 v11, v[132:135] offset:4096
    s_waitcnt vmcnt(11)
    ds_write_b128 v11, v[136:139] offset:8192
    s_waitcnt vmcnt(10)
    ds_write_b128 v11, v[140:143] offset:12288
    s_waitcnt vmcnt(9)
    ds_write_b128 v11, v[144:147] offset:16384
    s_waitcnt vmcnt(8)
    ds_write_b128 v11, v[148:151] offset:20480
    s_waitcnt vmcnt(7)
    ds_write_b128 v11, v[152:155] offset:24576
    s_waitcnt vmcnt(6)
    ds_write_b128 v11, v[156:159] offset:28672
    s_waitcnt vmcnt(5)
    ds_write_b128 v11, v[160:163] offset:32768
    s_waitcnt vmcnt(4)
    ds_write_b128 v11, v[164:167] offset:36864
    s_waitcnt vmcnt(3)
    ds_write_b128 v11, v[168:171] offset:40960
    s_waitcnt vmcnt(2)
    ds_write_b128 v11, v[172:175] offset:45056
    s_waitcnt vmcnt(1)
    ds_write_b128 v11, v[176:179] offset:49152
    s_waitcnt vmcnt(0)
    ds_write_b128 v11, v[180:183] offset:53248
    s_mov_b32 s12, s44
    s_and_b32 s13, s45, 0xffff
    s_mov_b32 s14, 1204224
    s_mov_b32 s15, 0x00020000
    s_movk_i32 s35, 2688
    v_lshrrev_b32 v13, 2, v0
    v_mul_lo_u32 v13, v13, s35
    v_and_b32 v14, 3, v0
    v_lshl_add_u32 v13, v14, 4, v13
    s_mov_b32 s35, 384
    buffer_load_dwordx4 v[128:131], v13, s[12:15], s35 offen
    s_mov_b32 s35, 172416
    buffer_load_dwordx4 v[132:135], v13, s[12:15], s35 offen
    s_mov_b32 s35, 344448
    buffer_load_dwordx4 v[136:139], v13, s[12:15], s35 offen
    s_mov_b32 s35, 516480
    buffer_load_dwordx4 v[140:143], v13, s[12:15], s35 offen
    s_mov_b32 s35, 688512
    buffer_load_dwordx4 v[144:147], v13, s[12:15], s35 offen
    s_mov_b32 s35, 860544
    buffer_load_dwordx4 v[148:151], v13, s[12:15], s35 offen
    s_mov_b32 s35, 1032576
    buffer_load_dwordx4 v[152:155], v13, s[12:15], s35 offen
    s_waitcnt vmcnt(6)
    ds_write_b128 v225, v[128:131] offset:0
    s_waitcnt vmcnt(5)
    ds_write_b128 v225, v[132:135] offset:4096
    s_waitcnt vmcnt(4)
    ds_write_b128 v225, v[136:139] offset:8192
    s_waitcnt vmcnt(3)
    ds_write_b128 v225, v[140:143] offset:12288
    s_waitcnt vmcnt(2)
    ds_write_b128 v225, v[144:147] offset:16384
    s_waitcnt vmcnt(1)
    ds_write_b128 v225, v[148:151] offset:20480
    s_waitcnt vmcnt(0)
    ds_write_b128 v225, v[152:155] offset:24576
    s_mov_b32 s12, s44
    s_and_b32 s13, s45, 0xffff
    s_mov_b32 s14, 1204224
    s_mov_b32 s15, 0x00020000
    s_movk_i32 s35, 2688
    v_lshrrev_b32 v13, 2, v0
    v_mul_lo_u32 v13, v13, s35
    v_and_b32 v14, 3, v0
    v_lshl_add_u32 v13, v14, 4, v13
    s_mov_b32 s35, 448
    buffer_load_dwordx4 v[128:131], v13, s[12:15], s35 offen
    s_mov_b32 s35, 172480
    buffer_load_dwordx4 v[132:135], v13, s[12:15], s35 offen
    s_mov_b32 s35, 344512
    buffer_load_dwordx4 v[136:139], v13, s[12:15], s35 offen
    s_mov_b32 s35, 516544
    buffer_load_dwordx4 v[140:143], v13, s[12:15], s35 offen
    s_mov_b32 s35, 688576
    buffer_load_dwordx4 v[144:147], v13, s[12:15], s35 offen
    s_mov_b32 s35, 860608
    buffer_load_dwordx4 v[148:151], v13, s[12:15], s35 offen
    s_mov_b32 s35, 1032640
    buffer_load_dwordx4 v[152:155], v13, s[12:15], s35 offen
    s_waitcnt vmcnt(6)
    ds_write_b128 v225, v[128:131] offset:28672
    s_waitcnt vmcnt(5)
    ds_write_b128 v225, v[132:135] offset:32768
    s_waitcnt vmcnt(4)
    ds_write_b128 v225, v[136:139] offset:36864
    s_waitcnt vmcnt(3)
    ds_write_b128 v225, v[140:143] offset:40960
    s_waitcnt vmcnt(2)
    ds_write_b128 v225, v[144:147] offset:45056
    s_waitcnt vmcnt(1)
    ds_write_b128 v225, v[148:151] offset:49152
    s_waitcnt vmcnt(0)
    ds_write_b128 v225, v[152:155] offset:53248
    s_waitcnt lgkmcnt(0)
    s_barrier
    ds_read_b64_tr_b16 v[192:193], v7 offset:0
    ds_read_b64_tr_b16 v[194:195], v7 offset:256
    ds_read_b64_tr_b16 v[196:197], v7 offset:28672
    ds_read_b64_tr_b16 v[198:199], v7 offset:28928
    ds_read_b64_tr_b16 v[200:201], v224 offset:0
    ds_read_b64_tr_b16 v[202:203], v224 offset:256
    ds_read_b64_tr_b16 v[204:205], v224 offset:28672
    ds_read_b64_tr_b16 v[206:207], v224 offset:28928
    ds_read_b64_tr_b16 v[208:209], v7 offset:1024
    ds_read_b64_tr_b16 v[210:211], v7 offset:1280
    ds_read_b64_tr_b16 v[212:213], v7 offset:29696
    ds_read_b64_tr_b16 v[214:215], v7 offset:29952
    ds_read_b64_tr_b16 v[216:217], v224 offset:1024
    ds_read_b64_tr_b16 v[218:219], v224 offset:1280
    ds_read_b64_tr_b16 v[220:221], v224 offset:29696
    ds_read_b64_tr_b16 v[222:223], v224 offset:29952
    s_waitcnt lgkmcnt(8)
    v_mfma_f32_32x32x16_bf16 v[128:143], v[192:195], v[16:19], 0
    v_mfma_f32_32x32x16_bf16 v[144:159], v[196:199], v[16:19], 0
    v_mfma_f32_32x32x16_bf16 v[160:175], v[200:203], v[16:19], 0
    v_mfma_f32_32x32x16_bf16 v[176:191], v[204:207], v[16:19], 0
    ds_read_b64_tr_b16 v[192:193], v7 offset:2048
    ds_read_b64_tr_b16 v[194:195], v7 offset:2304
    ds_read_b64_tr_b16 v[196:197], v7 offset:30720
    ds_read_b64_tr_b16 v[198:199], v7 offset:30976
    ds_read_b64_tr_b16 v[200:201], v224 offset:2048
    ds_read_b64_tr_b16 v[202:203], v224 offset:2304
    ds_read_b64_tr_b16 v[204:205], v224 offset:30720
    ds_read_b64_tr_b16 v[206:207], v224 offset:30976
    s_waitcnt lgkmcnt(8)
    v_mfma_f32_32x32x16_bf16 v[128:143], v[208:211], v[20:23], v[128:143]
    v_mfma_f32_32x32x16_bf16 v[144:159], v[212:215], v[20:23], v[144:159]
    v_mfma_f32_32x32x16_bf16 v[160:175], v[216:219], v[20:23], v[160:175]
    v_mfma_f32_32x32x16_bf16 v[176:191], v[220:223], v[20:23], v[176:191]
    ds_read_b64_tr_b16 v[208:209], v7 offset:3072
    ds_read_b64_tr_b16 v[210:211], v7 offset:3328
    ds_read_b64_tr_b16 v[212:213], v7 offset:31744
    ds_read_b64_tr_b16 v[214:215], v7 offset:32000
    ds_read_b64_tr_b16 v[216:217], v224 offset:3072
    ds_read_b64_tr_b16 v[218:219], v224 offset:3328
    ds_read_b64_tr_b16 v[220:221], v224 offset:31744
    ds_read_b64_tr_b16 v[222:223], v224 offset:32000
    s_waitcnt lgkmcnt(8)
    v_mfma_f32_32x32x16_bf16 v[128:143], v[192:195], v[24:27], v[128:143]
    v_mfma_f32_32x32x16_bf16 v[144:159], v[196:199], v[24:27], v[144:159]
    v_mfma_f32_32x32x16_bf16 v[160:175], v[200:203], v[24:27], v[160:175]
    v_mfma_f32_32x32x16_bf16 v[176:191], v[204:207], v[24:27], v[176:191]
    ds_read_b64_tr_b16 v[192:193], v7 offset:4096
    ds_read_b64_tr_b16 v[194:195], v7 offset:4352
    ds_read_b64_tr_b16 v[196:197], v7 offset:32768
    ds_read_b64_tr_b16 v[198:199], v7 offset:33024
    ds_read_b64_tr_b16 v[200:201], v224 offset:4096
    ds_read_b64_tr_b16 v[202:203], v224 offset:4352
    ds_read_b64_tr_b16 v[204:205], v224 offset:32768
    ds_read_b64_tr_b16 v[206:207], v224 offset:33024
    s_waitcnt lgkmcnt(8)
    v_mfma_f32_32x32x16_bf16 v[128:143], v[208:211], v[28:31], v[128:143]
    v_mfma_f32_32x32x16_bf16 v[144:159], v[212:215], v[28:31], v[144:159]
    v_mfma_f32_32x32x16_bf16 v[160:175], v[216:219], v[28:31], v[160:175]
    v_mfma_f32_32x32x16_bf16 v[176:191], v[220:223], v[28:31], v[176:191]
    ds_read_b64_tr_b16 v[208:209], v7 offset:5120
    ds_read_b64_tr_b16 v[210:211], v7 offset:5376
    ds_read_b64_tr_b16 v[212:213], v7 offset:33792
    ds_read_b64_tr_b16 v[214:215], v7 offset:34048
    ds_read_b64_tr_b16 v[216:217], v224 offset:5120
    ds_read_b64_tr_b16 v[218:219], v224 offset:5376
    ds_read_b64_tr_b16 v[220:221], v224 offset:33792
    ds_read_b64_tr_b16 v[222:223], v224 offset:34048
    s_waitcnt lgkmcnt(8)
    v_mfma_f32_32x32x16_bf16 v[128:143], v[192:195], v[32:35], v[128:143]
    v_mfma_f32_32x32x16_bf16 v[144:159], v[196:199], v[32:35], v[144:159]
    v_mfma_f32_32x32x16_bf16 v[160:175], v[200:203], v[32:35], v[160:175]
    v_mfma_f32_32x32x16_bf16 v[176:191], v[204:207], v[32:35], v[176:191]
    ds_read_b64_tr_b16 v[192:193], v7 offset:6144
    ds_read_b64_tr_b16 v[194:195], v7 offset:6400
    ds_read_b64_tr_b16 v[196:197], v7 offset:34816
    ds_read_b64_tr_b16 v[198:199], v7 offset:35072
    ds_read_b64_tr_b16 v[200:201], v224 offset:6144
    ds_read_b64_tr_b16 v[202:203], v224 offset:6400
    ds_read_b64_tr_b16 v[204:205], v224 offset:34816
    ds_read_b64_tr_b16 v[206:207], v224 offset:35072
    s_waitcnt lgkmcnt(8)
    v_mfma_f32_32x32x16_bf16 v[128:143], v[208:211], v[36:39], v[128:143]
    v_mfma_f32_32x32x16_bf16 v[144:159], v[212:215], v[36:39], v[144:159]
    v_mfma_f32_32x32x16_bf16 v[160:175], v[216:219], v[36:39], v[160:175]
    v_mfma_f32_32x32x16_bf16 v[176:191], v[220:223], v[36:39], v[176:191]
    ds_read_b64_tr_b16 v[208:209], v7 offset:7168
    ds_read_b64_tr_b16 v[210:211], v7 offset:7424
    ds_read_b64_tr_b16 v[212:213], v7 offset:35840
    ds_read_b64_tr_b16 v[214:215], v7 offset:36096
    ds_read_b64_tr_b16 v[216:217], v224 offset:7168
    ds_read_b64_tr_b16 v[218:219], v224 offset:7424
    ds_read_b64_tr_b16 v[220:221], v224 offset:35840
    ds_read_b64_tr_b16 v[222:223], v224 offset:36096
    s_waitcnt lgkmcnt(8)
    v_mfma_f32_32x32x16_bf16 v[128:143], v[192:195], v[40:43], v[128:143]
    v_mfma_f32_32x32x16_bf16 v[144:159], v[196:199], v[40:43], v[144:159]
    v_mfma_f32_32x32x16_bf16 v[160:175], v[200:203], v[40:43], v[160:175]
    v_mfma_f32_32x32x16_bf16 v[176:191], v[204:207], v[40:43], v[176:191]
    ds_read_b64_tr_b16 v[192:193], v7 offset:8192
    ds_read_b64_tr_b16 v[194:195], v7 offset:8448
    ds_read_b64_tr_b16 v[196:197], v7 offset:36864
    ds_read_b64_tr_b16 v[198:199], v7 offset:37120
    ds_read_b64_tr_b16 v[200:201], v224 offset:8192
    ds_read_b64_tr_b16 v[202:203], v224 offset:8448
    ds_read_b64_tr_b16 v[204:205], v224 offset:36864
    ds_read_b64_tr_b16 v[206:207], v224 offset:37120
    s_waitcnt lgkmcnt(8)
    v_mfma_f32_32x32x16_bf16 v[128:143], v[208:211], v[44:47], v[128:143]
    v_mfma_f32_32x32x16_bf16 v[144:159], v[212:215], v[44:47], v[144:159]
    v_mfma_f32_32x32x16_bf16 v[160:175], v[216:219], v[44:47], v[160:175]
    v_mfma_f32_32x32x16_bf16 v[176:191], v[220:223], v[44:47], v[176:191]
    ds_read_b64_tr_b16 v[208:209], v7 offset:9216
    ds_read_b64_tr_b16 v[210:211], v7 offset:9472
    ds_read_b64_tr_b16 v[212:213], v7 offset:37888
    ds_read_b64_tr_b16 v[214:215], v7 offset:38144
    ds_read_b64_tr_b16 v[216:217], v224 offset:9216
    ds_read_b64_tr_b16 v[218:219], v224 offset:9472
    ds_read_b64_tr_b16 v[220:221], v224 offset:37888
    ds_read_b64_tr_b16 v[222:223], v224 offset:38144
    s_waitcnt lgkmcnt(8)
    v_mfma_f32_32x32x16_bf16 v[128:143], v[192:195], v[48:51], v[128:143]
    v_mfma_f32_32x32x16_bf16 v[144:159], v[196:199], v[48:51], v[144:159]
    v_mfma_f32_32x32x16_bf16 v[160:175], v[200:203], v[48:51], v[160:175]
    v_mfma_f32_32x32x16_bf16 v[176:191], v[204:207], v[48:51], v[176:191]
    ds_read_b64_tr_b16 v[192:193], v7 offset:10240
    ds_read_b64_tr_b16 v[194:195], v7 offset:10496
    ds_read_b64_tr_b16 v[196:197], v7 offset:38912
    ds_read_b64_tr_b16 v[198:199], v7 offset:39168
    ds_read_b64_tr_b16 v[200:201], v224 offset:10240
    ds_read_b64_tr_b16 v[202:203], v224 offset:10496
    ds_read_b64_tr_b16 v[204:205], v224 offset:38912
    ds_read_b64_tr_b16 v[206:207], v224 offset:39168
    s_waitcnt lgkmcnt(8)
    v_mfma_f32_32x32x16_bf16 v[128:143], v[208:211], v[52:55], v[128:143]
    v_mfma_f32_32x32x16_bf16 v[144:159], v[212:215], v[52:55], v[144:159]
    v_mfma_f32_32x32x16_bf16 v[160:175], v[216:219], v[52:55], v[160:175]
    v_mfma_f32_32x32x16_bf16 v[176:191], v[220:223], v[52:55], v[176:191]
    ds_read_b64_tr_b16 v[208:209], v7 offset:11264
    ds_read_b64_tr_b16 v[210:211], v7 offset:11520
    ds_read_b64_tr_b16 v[212:213], v7 offset:39936
    ds_read_b64_tr_b16 v[214:215], v7 offset:40192
    ds_read_b64_tr_b16 v[216:217], v224 offset:11264
    ds_read_b64_tr_b16 v[218:219], v224 offset:11520
    ds_read_b64_tr_b16 v[220:221], v224 offset:39936
    ds_read_b64_tr_b16 v[222:223], v224 offset:40192
    s_waitcnt lgkmcnt(8)
    v_mfma_f32_32x32x16_bf16 v[128:143], v[192:195], v[56:59], v[128:143]
    v_mfma_f32_32x32x16_bf16 v[144:159], v[196:199], v[56:59], v[144:159]
    v_mfma_f32_32x32x16_bf16 v[160:175], v[200:203], v[56:59], v[160:175]
    v_mfma_f32_32x32x16_bf16 v[176:191], v[204:207], v[56:59], v[176:191]
    ds_read_b64_tr_b16 v[192:193], v7 offset:12288
    ds_read_b64_tr_b16 v[194:195], v7 offset:12544
    ds_read_b64_tr_b16 v[196:197], v7 offset:40960
    ds_read_b64_tr_b16 v[198:199], v7 offset:41216
    ds_read_b64_tr_b16 v[200:201], v224 offset:12288
    ds_read_b64_tr_b16 v[202:203], v224 offset:12544
    ds_read_b64_tr_b16 v[204:205], v224 offset:40960
    ds_read_b64_tr_b16 v[206:207], v224 offset:41216
    s_waitcnt lgkmcnt(8)
    v_mfma_f32_32x32x16_bf16 v[128:143], v[208:211], v[60:63], v[128:143]
    v_mfma_f32_32x32x16_bf16 v[144:159], v[212:215], v[60:63], v[144:159]
    v_mfma_f32_32x32x16_bf16 v[160:175], v[216:219], v[60:63], v[160:175]
    v_mfma_f32_32x32x16_bf16 v[176:191], v[220:223], v[60:63], v[176:191]
    ds_read_b64_tr_b16 v[208:209], v7 offset:13312
    ds_read_b64_tr_b16 v[210:211], v7 offset:13568
    ds_read_b64_tr_b16 v[212:213], v7 offset:41984
    ds_read_b64_tr_b16 v[214:215], v7 offset:42240
    ds_read_b64_tr_b16 v[216:217], v224 offset:13312
    ds_read_b64_tr_b16 v[218:219], v224 offset:13568
    ds_read_b64_tr_b16 v[220:221], v224 offset:41984
    ds_read_b64_tr_b16 v[222:223], v224 offset:42240
    s_waitcnt lgkmcnt(8)
    v_mfma_f32_32x32x16_bf16 v[128:143], v[192:195], v[64:67], v[128:143]
    v_mfma_f32_32x32x16_bf16 v[144:159], v[196:199], v[64:67], v[144:159]
    v_mfma_f32_32x32x16_bf16 v[160:175], v[200:203], v[64:67], v[160:175]
    v_mfma_f32_32x32x16_bf16 v[176:191], v[204:207], v[64:67], v[176:191]
    ds_read_b64_tr_b16 v[192:193], v7 offset:14336
    ds_read_b64_tr_b16 v[194:195], v7 offset:14592
    ds_read_b64_tr_b16 v[196:197], v7 offset:43008
    ds_read_b64_tr_b16 v[198:199], v7 offset:43264
    ds_read_b64_tr_b16 v[200:201], v224 offset:14336
    ds_read_b64_tr_b16 v[202:203], v224 offset:14592
    ds_read_b64_tr_b16 v[204:205], v224 offset:43008
    ds_read_b64_tr_b16 v[206:207], v224 offset:43264
    s_waitcnt lgkmcnt(8)
    v_mfma_f32_32x32x16_bf16 v[128:143], v[208:211], v[68:71], v[128:143]
    v_mfma_f32_32x32x16_bf16 v[144:159], v[212:215], v[68:71], v[144:159]
    v_mfma_f32_32x32x16_bf16 v[160:175], v[216:219], v[68:71], v[160:175]
    v_mfma_f32_32x32x16_bf16 v[176:191], v[220:223], v[68:71], v[176:191]
    ds_read_b64_tr_b16 v[208:209], v7 offset:15360
    ds_read_b64_tr_b16 v[210:211], v7 offset:15616
    ds_read_b64_tr_b16 v[212:213], v7 offset:44032
    ds_read_b64_tr_b16 v[214:215], v7 offset:44288
    ds_read_b64_tr_b16 v[216:217], v224 offset:15360
    ds_read_b64_tr_b16 v[218:219], v224 offset:15616
    ds_read_b64_tr_b16 v[220:221], v224 offset:44032
    ds_read_b64_tr_b16 v[222:223], v224 offset:44288
    s_waitcnt lgkmcnt(8)
    v_mfma_f32_32x32x16_bf16 v[128:143], v[192:195], v[72:75], v[128:143]
    v_mfma_f32_32x32x16_bf16 v[144:159], v[196:199], v[72:75], v[144:159]
    v_mfma_f32_32x32x16_bf16 v[160:175], v[200:203], v[72:75], v[160:175]
    v_mfma_f32_32x32x16_bf16 v[176:191], v[204:207], v[72:75], v[176:191]
    ds_read_b64_tr_b16 v[192:193], v7 offset:16384
    ds_read_b64_tr_b16 v[194:195], v7 offset:16640
    ds_read_b64_tr_b16 v[196:197], v7 offset:45056
    ds_read_b64_tr_b16 v[198:199], v7 offset:45312
    ds_read_b64_tr_b16 v[200:201], v224 offset:16384
    ds_read_b64_tr_b16 v[202:203], v224 offset:16640
    ds_read_b64_tr_b16 v[204:205], v224 offset:45056
    ds_read_b64_tr_b16 v[206:207], v224 offset:45312
    s_waitcnt lgkmcnt(8)
    v_mfma_f32_32x32x16_bf16 v[128:143], v[208:211], v[76:79], v[128:143]
    v_mfma_f32_32x32x16_bf16 v[144:159], v[212:215], v[76:79], v[144:159]
    v_mfma_f32_32x32x16_bf16 v[160:175], v[216:219], v[76:79], v[160:175]
    v_mfma_f32_32x32x16_bf16 v[176:191], v[220:223], v[76:79], v[176:191]
    ds_read_b64_tr_b16 v[208:209], v7 offset:17408
    ds_read_b64_tr_b16 v[210:211], v7 offset:17664
    ds_read_b64_tr_b16 v[212:213], v7 offset:46080
    ds_read_b64_tr_b16 v[214:215], v7 offset:46336
    ds_read_b64_tr_b16 v[216:217], v224 offset:17408
    ds_read_b64_tr_b16 v[218:219], v224 offset:17664
    ds_read_b64_tr_b16 v[220:221], v224 offset:46080
    ds_read_b64_tr_b16 v[222:223], v224 offset:46336
    s_waitcnt lgkmcnt(8)
    v_mfma_f32_32x32x16_bf16 v[128:143], v[192:195], v[80:83], v[128:143]
    v_mfma_f32_32x32x16_bf16 v[144:159], v[196:199], v[80:83], v[144:159]
    v_mfma_f32_32x32x16_bf16 v[160:175], v[200:203], v[80:83], v[160:175]
    v_mfma_f32_32x32x16_bf16 v[176:191], v[204:207], v[80:83], v[176:191]
    ds_read_b64_tr_b16 v[192:193], v7 offset:18432
    ds_read_b64_tr_b16 v[194:195], v7 offset:18688
    ds_read_b64_tr_b16 v[196:197], v7 offset:47104
    ds_read_b64_tr_b16 v[198:199], v7 offset:47360
    ds_read_b64_tr_b16 v[200:201], v224 offset:18432
    ds_read_b64_tr_b16 v[202:203], v224 offset:18688
    ds_read_b64_tr_b16 v[204:205], v224 offset:47104
    ds_read_b64_tr_b16 v[206:207], v224 offset:47360
    s_waitcnt lgkmcnt(8)
    v_mfma_f32_32x32x16_bf16 v[128:143], v[208:211], v[84:87], v[128:143]
    v_mfma_f32_32x32x16_bf16 v[144:159], v[212:215], v[84:87], v[144:159]
    v_mfma_f32_32x32x16_bf16 v[160:175], v[216:219], v[84:87], v[160:175]
    v_mfma_f32_32x32x16_bf16 v[176:191], v[220:223], v[84:87], v[176:191]
    ds_read_b64_tr_b16 v[208:209], v7 offset:19456
    ds_read_b64_tr_b16 v[210:211], v7 offset:19712
    ds_read_b64_tr_b16 v[212:213], v7 offset:48128
    ds_read_b64_tr_b16 v[214:215], v7 offset:48384
    ds_read_b64_tr_b16 v[216:217], v224 offset:19456
    ds_read_b64_tr_b16 v[218:219], v224 offset:19712
    ds_read_b64_tr_b16 v[220:221], v224 offset:48128
    ds_read_b64_tr_b16 v[222:223], v224 offset:48384
    s_waitcnt lgkmcnt(8)
    v_mfma_f32_32x32x16_bf16 v[128:143], v[192:195], v[88:91], v[128:143]
    v_mfma_f32_32x32x16_bf16 v[144:159], v[196:199], v[88:91], v[144:159]
    v_mfma_f32_32x32x16_bf16 v[160:175], v[200:203], v[88:91], v[160:175]
    v_mfma_f32_32x32x16_bf16 v[176:191], v[204:207], v[88:91], v[176:191]
    ds_read_b64_tr_b16 v[192:193], v7 offset:20480
    ds_read_b64_tr_b16 v[194:195], v7 offset:20736
    ds_read_b64_tr_b16 v[196:197], v7 offset:49152
    ds_read_b64_tr_b16 v[198:199], v7 offset:49408
    ds_read_b64_tr_b16 v[200:201], v224 offset:20480
    ds_read_b64_tr_b16 v[202:203], v224 offset:20736
    ds_read_b64_tr_b16 v[204:205], v224 offset:49152
    ds_read_b64_tr_b16 v[206:207], v224 offset:49408
    s_waitcnt lgkmcnt(8)
    v_mfma_f32_32x32x16_bf16 v[128:143], v[208:211], v[92:95], v[128:143]
    v_mfma_f32_32x32x16_bf16 v[144:159], v[212:215], v[92:95], v[144:159]
    v_mfma_f32_32x32x16_bf16 v[160:175], v[216:219], v[92:95], v[160:175]
    v_mfma_f32_32x32x16_bf16 v[176:191], v[220:223], v[92:95], v[176:191]
    ds_read_b64_tr_b16 v[208:209], v7 offset:21504
    ds_read_b64_tr_b16 v[210:211], v7 offset:21760
    ds_read_b64_tr_b16 v[212:213], v7 offset:50176
    ds_read_b64_tr_b16 v[214:215], v7 offset:50432
    ds_read_b64_tr_b16 v[216:217], v224 offset:21504
    ds_read_b64_tr_b16 v[218:219], v224 offset:21760
    ds_read_b64_tr_b16 v[220:221], v224 offset:50176
    ds_read_b64_tr_b16 v[222:223], v224 offset:50432
    s_waitcnt lgkmcnt(8)
    v_mfma_f32_32x32x16_bf16 v[128:143], v[192:195], v[96:99], v[128:143]
    v_mfma_f32_32x32x16_bf16 v[144:159], v[196:199], v[96:99], v[144:159]
    v_mfma_f32_32x32x16_bf16 v[160:175], v[200:203], v[96:99], v[160:175]
    v_mfma_f32_32x32x16_bf16 v[176:191], v[204:207], v[96:99], v[176:191]
    ds_read_b64_tr_b16 v[192:193], v7 offset:22528
    ds_read_b64_tr_b16 v[194:195], v7 offset:22784
    ds_read_b64_tr_b16 v[196:197], v7 offset:51200
    ds_read_b64_tr_b16 v[198:199], v7 offset:51456
    ds_read_b64_tr_b16 v[200:201], v224 offset:22528
    ds_read_b64_tr_b16 v[202:203], v224 offset:22784
    ds_read_b64_tr_b16 v[204:205], v224 offset:51200
    ds_read_b64_tr_b16 v[206:207], v224 offset:51456
    s_waitcnt lgkmcnt(8)
    v_mfma_f32_32x32x16_bf16 v[128:143], v[208:211], v[100:103], v[128:143]
    v_mfma_f32_32x32x16_bf16 v[144:159], v[212:215], v[100:103], v[144:159]
    v_mfma_f32_32x32x16_bf16 v[160:175], v[216:219], v[100:103], v[160:175]
    v_mfma_f32_32x32x16_bf16 v[176:191], v[220:223], v[100:103], v[176:191]
    ds_read_b64_tr_b16 v[208:209], v7 offset:23552
    ds_read_b64_tr_b16 v[210:211], v7 offset:23808
    ds_read_b64_tr_b16 v[212:213], v7 offset:52224
    ds_read_b64_tr_b16 v[214:215], v7 offset:52480
    ds_read_b64_tr_b16 v[216:217], v224 offset:23552
    ds_read_b64_tr_b16 v[218:219], v224 offset:23808
    ds_read_b64_tr_b16 v[220:221], v224 offset:52224
    ds_read_b64_tr_b16 v[222:223], v224 offset:52480
    s_waitcnt lgkmcnt(8)
    v_mfma_f32_32x32x16_bf16 v[128:143], v[192:195], v[104:107], v[128:143]
    v_mfma_f32_32x32x16_bf16 v[144:159], v[196:199], v[104:107], v[144:159]
    v_mfma_f32_32x32x16_bf16 v[160:175], v[200:203], v[104:107], v[160:175]
    v_mfma_f32_32x32x16_bf16 v[176:191], v[204:207], v[104:107], v[176:191]
    ds_read_b64_tr_b16 v[192:193], v7 offset:24576
    ds_read_b64_tr_b16 v[194:195], v7 offset:24832
    ds_read_b64_tr_b16 v[196:197], v7 offset:53248
    ds_read_b64_tr_b16 v[198:199], v7 offset:53504
    ds_read_b64_tr_b16 v[200:201], v224 offset:24576
    ds_read_b64_tr_b16 v[202:203], v224 offset:24832
    ds_read_b64_tr_b16 v[204:205], v224 offset:53248
    ds_read_b64_tr_b16 v[206:207], v224 offset:53504
    s_waitcnt lgkmcnt(8)
    v_mfma_f32_32x32x16_bf16 v[128:143], v[208:211], v[108:111], v[128:143]
    v_mfma_f32_32x32x16_bf16 v[144:159], v[212:215], v[108:111], v[144:159]
    v_mfma_f32_32x32x16_bf16 v[160:175], v[216:219], v[108:111], v[160:175]
    v_mfma_f32_32x32x16_bf16 v[176:191], v[220:223], v[108:111], v[176:191]
    ds_read_b64_tr_b16 v[208:209], v7 offset:25600
    ds_read_b64_tr_b16 v[210:211], v7 offset:25856
    ds_read_b64_tr_b16 v[212:213], v7 offset:54272
    ds_read_b64_tr_b16 v[214:215], v7 offset:54528
    ds_read_b64_tr_b16 v[216:217], v224 offset:25600
    ds_read_b64_tr_b16 v[218:219], v224 offset:25856
    ds_read_b64_tr_b16 v[220:221], v224 offset:54272
    ds_read_b64_tr_b16 v[222:223], v224 offset:54528
    s_waitcnt lgkmcnt(8)
    v_mfma_f32_32x32x16_bf16 v[128:143], v[192:195], v[112:115], v[128:143]
    v_mfma_f32_32x32x16_bf16 v[144:159], v[196:199], v[112:115], v[144:159]
    v_mfma_f32_32x32x16_bf16 v[160:175], v[200:203], v[112:115], v[160:175]
    v_mfma_f32_32x32x16_bf16 v[176:191], v[204:207], v[112:115], v[176:191]
    ds_read_b64_tr_b16 v[192:193], v7 offset:26624
    ds_read_b64_tr_b16 v[194:195], v7 offset:26880
    ds_read_b64_tr_b16 v[196:197], v7 offset:55296
    ds_read_b64_tr_b16 v[198:199], v7 offset:55552
    ds_read_b64_tr_b16 v[200:201], v224 offset:26624
    ds_read_b64_tr_b16 v[202:203], v224 offset:26880
    ds_read_b64_tr_b16 v[204:205], v224 offset:55296
    ds_read_b64_tr_b16 v[206:207], v224 offset:55552
    s_waitcnt lgkmcnt(8)
    v_mfma_f32_32x32x16_bf16 v[128:143], v[208:211], v[116:119], v[128:143]
    v_mfma_f32_32x32x16_bf16 v[144:159], v[212:215], v[116:119], v[144:159]
    v_mfma_f32_32x32x16_bf16 v[160:175], v[216:219], v[116:119], v[160:175]
    v_mfma_f32_32x32x16_bf16 v[176:191], v[220:223], v[116:119], v[176:191]
    ds_read_b64_tr_b16 v[208:209], v7 offset:27648
    ds_read_b64_tr_b16 v[210:211], v7 offset:27904
    ds_read_b64_tr_b16 v[212:213], v7 offset:56320
    ds_read_b64_tr_b16 v[214:215], v7 offset:56576
    ds_read_b64_tr_b16 v[216:217], v224 offset:27648
    ds_read_b64_tr_b16 v[218:219], v224 offset:27904
    ds_read_b64_tr_b16 v[220:221], v224 offset:56320
    ds_read_b64_tr_b16 v[222:223], v224 offset:56576
    s_waitcnt lgkmcnt(8)
    v_mfma_f32_32x32x16_bf16 v[128:143], v[192:195], v[120:123], v[128:143]
    v_mfma_f32_32x32x16_bf16 v[144:159], v[196:199], v[120:123], v[144:159]
    v_mfma_f32_32x32x16_bf16 v[160:175], v[200:203], v[120:123], v[160:175]
    v_mfma_f32_32x32x16_bf16 v[176:191], v[204:207], v[120:123], v[176:191]
    s_waitcnt lgkmcnt(0)
    v_mfma_f32_32x32x16_bf16 v[128:143], v[208:211], v[124:127], v[128:143]
    v_mfma_f32_32x32x16_bf16 v[144:159], v[212:215], v[124:127], v[144:159]
    v_mfma_f32_32x32x16_bf16 v[160:175], v[216:219], v[124:127], v[160:175]
    v_mfma_f32_32x32x16_bf16 v[176:191], v[220:223], v[124:127], v[176:191]
    s_nop 15
    s_nop 3
    s_movk_i32 s35, 1792
    v_mul_lo_u32 v13, v5, s35
    v_lshl_add_u32 v13, v4, 3, v13
    v_add_u32 v13, 2359552, v13
    v_cvt_pk_bf16_f32 v128, v128, v129
    v_cvt_pk_bf16_f32 v129, v130, v131
    buffer_store_dwordx2 v[128:129], v13, s[16:19], 0 offen offset:0
    v_cvt_pk_bf16_f32 v132, v132, v133
    v_cvt_pk_bf16_f32 v133, v134, v135
    buffer_store_dwordx2 v[132:133], v13, s[16:19], 0 offen offset:16
    v_cvt_pk_bf16_f32 v136, v136, v137
    v_cvt_pk_bf16_f32 v137, v138, v139
    buffer_store_dwordx2 v[136:137], v13, s[16:19], 0 offen offset:32
    v_cvt_pk_bf16_f32 v140, v140, v141
    v_cvt_pk_bf16_f32 v141, v142, v143
    buffer_store_dwordx2 v[140:141], v13, s[16:19], 0 offen offset:48
    s_movk_i32 s35, 1792
    v_mul_lo_u32 v13, v5, s35
    v_lshl_add_u32 v13, v4, 3, v13
    v_add_u32 v13, 2359616, v13
    v_cvt_pk_bf16_f32 v144, v144, v145
    v_cvt_pk_bf16_f32 v145, v146, v147
    buffer_store_dwordx2 v[144:145], v13, s[16:19], 0 offen offset:0
    v_cvt_pk_bf16_f32 v148, v148, v149
    v_cvt_pk_bf16_f32 v149, v150, v151
    buffer_store_dwordx2 v[148:149], v13, s[16:19], 0 offen offset:16
    v_cvt_pk_bf16_f32 v152, v152, v153
    v_cvt_pk_bf16_f32 v153, v154, v155
    buffer_store_dwordx2 v[152:153], v13, s[16:19], 0 offen offset:32
    v_cvt_pk_bf16_f32 v156, v156, v157
    v_cvt_pk_bf16_f32 v157, v158, v159
    buffer_store_dwordx2 v[156:157], v13, s[16:19], 0 offen offset:48
    s_movk_i32 s35, 1792
    v_mul_lo_u32 v13, v5, s35
    v_lshl_add_u32 v13, v4, 3, v13
    v_add_u32 v13, 2359680, v13
    v_cvt_pk_bf16_f32 v160, v160, v161
    v_cvt_pk_bf16_f32 v161, v162, v163
    buffer_store_dwordx2 v[160:161], v13, s[16:19], 0 offen offset:0
    v_cvt_pk_bf16_f32 v164, v164, v165
    v_cvt_pk_bf16_f32 v165, v166, v167
    buffer_store_dwordx2 v[164:165], v13, s[16:19], 0 offen offset:16
    v_cvt_pk_bf16_f32 v168, v168, v169
    v_cvt_pk_bf16_f32 v169, v170, v171
    buffer_store_dwordx2 v[168:169], v13, s[16:19], 0 offen offset:32
    v_cvt_pk_bf16_f32 v172, v172, v173
    v_cvt_pk_bf16_f32 v173, v174, v175
    buffer_store_dwordx2 v[172:173], v13, s[16:19], 0 offen offset:48
    s_movk_i32 s35, 1792
    v_mul_lo_u32 v13, v5, s35
    v_lshl_add_u32 v13, v4, 3, v13
    v_add_u32 v13, 2359744, v13
    v_cvt_pk_bf16_f32 v176, v176, v177
    v_cvt_pk_bf16_f32 v177, v178, v179
    buffer_store_dwordx2 v[176:177], v13, s[16:19], 0 offen offset:0
    v_cvt_pk_bf16_f32 v180, v180, v181
    v_cvt_pk_bf16_f32 v181, v182, v183
    buffer_store_dwordx2 v[180:181], v13, s[16:19], 0 offen offset:16
    v_cvt_pk_bf16_f32 v184, v184, v185
    v_cvt_pk_bf16_f32 v185, v186, v187
    buffer_store_dwordx2 v[184:185], v13, s[16:19], 0 offen offset:32
    v_cvt_pk_bf16_f32 v188, v188, v189
    v_cvt_pk_bf16_f32 v189, v190, v191
    buffer_store_dwordx2 v[188:189], v13, s[16:19], 0 offen offset:48
    s_endpgm
K1_v6:
    s_mov_b32 s12, s44
    s_and_b32 s13, s45, 0xffff
    s_mov_b32 s14, 1204224
    s_mov_b32 s15, 0x00020000
    s_movk_i32 s35, 2688
    v_lshrrev_b32 v227, 2, v0
    v_mul_lo_u32 v227, v227, s35
    v_and_b32 v14, 3, v0
    v_lshl_add_u32 v227, v14, 4, v227
    s_mov_b32 s35, 512
    buffer_load_dwordx4 v[128:131], v227, s[12:15], s35 offen
    s_mov_b32 s35, 172544
    buffer_load_dwordx4 v[132:135], v227, s[12:15], s35 offen
    s_mov_b32 s35, 344576
    buffer_load_dwordx4 v[136:139], v227, s[12:15], s35 offen
    s_mov_b32 s35, 516608
    buffer_load_dwordx4 v[140:143], v227, s[12:15], s35 offen
    s_mov_b32 s35, 688640
    buffer_load_dwordx4 v[144:147], v227, s[12:15], s35 offen
    s_mov_b32 s35, 860672
    buffer_load_dwordx4 v[148:151], v227, s[12:15], s35 offen
    s_mov_b32 s35, 1032704
    buffer_load_dwordx4 v[152:155], v227, s[12:15], s35 offen
    s_mov_b32 s12, s44
    s_and_b32 s13, s45, 0xffff
    s_mov_b32 s14, 1204224
    s_mov_b32 s15, 0x00020000
    s_movk_i32 s35, 2688
    v_lshrrev_b32 v227, 2, v0
    v_mul_lo_u32 v227, v227, s35
    v_and_b32 v14, 3, v0
    v_lshl_add_u32 v227, v14, 4, v227
    s_mov_b32 s35, 576
    buffer_load_dwordx4 v[156:159], v227, s[12:15], s35 offen
    s_mov_b32 s35, 172608
    buffer_load_dwordx4 v[160:163], v227, s[12:15], s35 offen
    s_mov_b32 s35, 344640
    buffer_load_dwordx4 v[164:167], v227, s[12:15], s35 offen
    s_mov_b32 s35, 516672
    buffer_load_dwordx4 v[168:171], v227, s[12:15], s35 offen
    s_mov_b32 s35, 688704
    buffer_load_dwordx4 v[172:175], v227, s[12:15], s35 offen
    s_mov_b32 s35, 860736
    buffer_load_dwordx4 v[176:179], v227, s[12:15], s35 offen
    s_mov_b32 s35, 1032768
    buffer_load_dwordx4 v[180:183], v227, s[12:15], s35 offen
    s_mov_b32 s54, 0x4924925
    v_add_u32 v13, 0, v2
    v_mul_hi_u32 v14, v13, s54
    v_lshlrev_b32 v13, 4, v13
    v_lshl_add_u32 v13, v14, 4, v13
    v_add_u32 v13, s53, v13
    s_waitcnt vmcnt(41)
    ds_write_b128 v13, v[16:19]
    v_add_u32 v13, 64, v2
    v_mul_hi_u32 v14, v13, s54
    v_lshlrev_b32 v13, 4, v13
    v_lshl_add_u32 v13, v14, 4, v13
    v_add_u32 v13, s53, v13
    s_waitcnt vmcnt(40)
    ds_write_b128 v13, v[20:23]
    v_add_u32 v13, 128, v2
    v_mul_hi_u32 v14, v13, s54
    v_lshlrev_b32 v13, 4, v13
    v_lshl_add_u32 v13, v14, 4, v13
    v_add_u32 v13, s53, v13
    s_waitcnt vmcnt(39)
    ds_write_b128 v13, v[24:27]
    v_add_u32 v13, 192, v2
    v_mul_hi_u32 v14, v13, s54
    v_lshlrev_b32 v13, 4, v13
    v_lshl_add_u32 v13, v14, 4, v13
    v_add_u32 v13, s53, v13
    s_waitcnt vmcnt(38)
    ds_write_b128 v13, v[28:31]
    v_add_u32 v13, 256, v2
    v_mul_hi_u32 v14, v13, s54
    v_lshlrev_b32 v13, 4, v13
    v_lshl_add_u32 v13, v14, 4, v13
    v_add_u32 v13, s53, v13
    s_waitcnt vmcnt(37)
    ds_write_b128 v13, v[32:35]
    v_add_u32 v13, 320, v2
    v_mul_hi_u32 v14, v13, s54
    v_lshlrev_b32 v13, 4, v13
    v_lshl_add_u32 v13, v14, 4, v13
    v_add_u32 v13, s53, v13
    s_waitcnt vmcnt(36)
    ds_write_b128 v13, v[36:39]
    v_add_u32 v13, 384, v2
    v_mul_hi_u32 v14, v13, s54
    v_lshlrev_b32 v13, 4, v13
    v_lshl_add_u32 v13, v14, 4, v13
    v_add_u32 v13, s53, v13
    s_waitcnt vmcnt(35)
    ds_write_b128 v13, v[40:43]
    v_add_u32 v13, 448, v2
    v_mul_hi_u32 v14, v13, s54
    v_lshlrev_b32 v13, 4, v13
    v_lshl_add_u32 v13, v14, 4, v13
    v_add_u32 v13, s53, v13
    s_waitcnt vmcnt(34)
    ds_write_b128 v13, v[44:47]
    v_add_u32 v13, 512, v2
    v_mul_hi_u32 v14, v13, s54
    v_lshlrev_b32 v13, 4, v13
    v_lshl_add_u32 v13, v14, 4, v13
    v_add_u32 v13, s53, v13
    s_waitcnt vmcnt(33)
    ds_write_b128 v13, v[48:51]
    v_add_u32 v13, 576, v2
    v_mul_hi_u32 v14, v13, s54
    v_lshlrev_b32 v13, 4, v13
    v_lshl_add_u32 v13, v14, 4, v13
    v_add_u32 v13, s53, v13
    s_waitcnt vmcnt(32)
    ds_write_b128 v13, v[52:55]
    v_add_u32 v13, 640, v2
    v_mul_hi_u32 v14, v13, s54
    v_lshlrev_b32 v13, 4, v13
    v_lshl_add_u32 v13, v14, 4, v13
    v_add_u32 v13, s53, v13
    s_waitcnt vmcnt(31)
    ds_write_b128 v13, v[56:59]
    v_add_u32 v13, 704, v2
    v_mul_hi_u32 v14, v13, s54
    v_lshlrev_b32 v13, 4, v13
    v_lshl_add_u32 v13, v14, 4, v13
    v_add_u32 v13, s53, v13
    s_waitcnt vmcnt(30)
    ds_write_b128 v13, v[60:63]
    v_add_u32 v13, 768, v2
    v_mul_hi_u32 v14, v13, s54
    v_lshlrev_b32 v13, 4, v13
    v_lshl_add_u32 v13, v14, 4, v13
    v_add_u32 v13, s53, v13
    s_waitcnt vmcnt(29)
    ds_write_b128 v13, v[64:67]
    v_add_u32 v13, 832, v2
    v_mul_hi_u32 v14, v13, s54
    v_lshlrev_b32 v13, 4, v13
    v_lshl_add_u32 v13, v14, 4, v13
    v_add_u32 v13, s53, v13
    s_waitcnt vmcnt(28)
    ds_write_b128 v13, v[68:71]
    v_add_u32 v13, 896, v2
    v_mul_hi_u32 v14, v13, s54
    v_lshlrev_b32 v13, 4, v13
    v_lshl_add_u32 v13, v14, 4, v13
    v_add_u32 v13, s53, v13
    s_waitcnt vmcnt(27)
    ds_write_b128 v13, v[72:75]
    v_add_u32 v13, 960, v2
    v_mul_hi_u32 v14, v13, s54
    v_lshlrev_b32 v13, 4, v13
    v_lshl_add_u32 v13, v14, 4, v13
    v_add_u32 v13, s53, v13
    s_waitcnt vmcnt(26)
    ds_write_b128 v13, v[76:79]
    v_add_u32 v13, 1024, v2
    v_mul_hi_u32 v14, v13, s54
    v_lshlrev_b32 v13, 4, v13
    v_lshl_add_u32 v13, v14, 4, v13
    v_add_u32 v13, s53, v13
    s_waitcnt vmcnt(25)
    ds_write_b128 v13, v[80:83]
    v_add_u32 v13, 1088, v2
    v_mul_hi_u32 v14, v13, s54
    v_lshlrev_b32 v13, 4, v13
    v_lshl_add_u32 v13, v14, 4, v13
    v_add_u32 v13, s53, v13
    s_waitcnt vmcnt(24)
    ds_write_b128 v13, v[84:87]
    v_add_u32 v13, 1152, v2
    v_mul_hi_u32 v14, v13, s54
    v_lshlrev_b32 v13, 4, v13
    v_lshl_add_u32 v13, v14, 4, v13
    v_add_u32 v13, s53, v13
    s_waitcnt vmcnt(23)
    ds_write_b128 v13, v[88:91]
    v_add_u32 v13, 1216, v2
    v_mul_hi_u32 v14, v13, s54
    v_lshlrev_b32 v13, 4, v13
    v_lshl_add_u32 v13, v14, 4, v13
    v_add_u32 v13, s53, v13
    s_waitcnt vmcnt(22)
    ds_write_b128 v13, v[92:95]
    v_add_u32 v13, 1280, v2
    v_mul_hi_u32 v14, v13, s54
    v_lshlrev_b32 v13, 4, v13
    v_lshl_add_u32 v13, v14, 4, v13
    v_add_u32 v13, s53, v13
    s_waitcnt vmcnt(21)
    ds_write_b128 v13, v[96:99]
    v_add_u32 v13, 1344, v2
    v_mul_hi_u32 v14, v13, s54
    v_lshlrev_b32 v13, 4, v13
    v_lshl_add_u32 v13, v14, 4, v13
    v_add_u32 v13, s53, v13
    s_waitcnt vmcnt(20)
    ds_write_b128 v13, v[100:103]
    v_add_u32 v13, 1408, v2
    v_mul_hi_u32 v14, v13, s54
    v_lshlrev_b32 v13, 4, v13
    v_lshl_add_u32 v13, v14, 4, v13
    v_add_u32 v13, s53, v13
    s_waitcnt vmcnt(19)
    ds_write_b128 v13, v[104:107]
    v_add_u32 v13, 1472, v2
    v_mul_hi_u32 v14, v13, s54
    v_lshlrev_b32 v13, 4, v13
    v_lshl_add_u32 v13, v14, 4, v13
    v_add_u32 v13, s53, v13
    s_waitcnt vmcnt(18)
    ds_write_b128 v13, v[108:111]
    v_add_u32 v13, 1536, v2
    v_mul_hi_u32 v14, v13, s54
    v_lshlrev_b32 v13, 4, v13
    v_lshl_add_u32 v13, v14, 4, v13
    v_add_u32 v13, s53, v13
    s_waitcnt vmcnt(17)
    ds_write_b128 v13, v[112:115]
    v_add_u32 v13, 1600, v2
    v_mul_hi_u32 v14, v13, s54
    v_lshlrev_b32 v13, 4, v13
    v_lshl_add_u32 v13, v14, 4, v13
    v_add_u32 v13, s53, v13
    s_waitcnt vmcnt(16)
    ds_write_b128 v13, v[116:119]
    v_add_u32 v13, 1664, v2
    v_mul_hi_u32 v14, v13, s54
    v_lshlrev_b32 v13, 4, v13
    v_lshl_add_u32 v13, v14, 4, v13
    v_add_u32 v13, s53, v13
    s_waitcnt vmcnt(15)
    ds_write_b128 v13, v[120:123]
    v_add_u32 v13, 1728, v2
    v_mul_hi_u32 v14, v13, s54
    v_lshlrev_b32 v13, 4, v13
    v_lshl_add_u32 v13, v14, 4, v13
    v_add_u32 v13, s53, v13
    s_waitcnt vmcnt(14)
    ds_write_b128 v13, v[124:127]
    v_mul_u32_u24 v13, 912, v3
    v_lshl_add_u32 v13, v4, 4, v13
    v_add_u32 v13, s53, v13
    s_waitcnt lgkmcnt(0)
    ds_read_b128 v[16:19], v13 offset:0
    ds_read_b128 v[20:23], v13 offset:32
    ds_read_b128 v[24:27], v13 offset:64
    ds_read_b128 v[28:31], v13 offset:96
    ds_read_b128 v[32:35], v13 offset:128
    ds_read_b128 v[36:39], v13 offset:160
    ds_read_b128 v[40:43], v13 offset:192
    ds_read_b128 v[44:47], v13 offset:224
    ds_read_b128 v[48:51], v13 offset:256
    ds_read_b128 v[52:55], v13 offset:288
    ds_read_b128 v[56:59], v13 offset:320
    ds_read_b128 v[60:63], v13 offset:352
    ds_read_b128 v[64:67], v13 offset:384
    ds_read_b128 v[68:71], v13 offset:416
    ds_read_b128 v[72:75], v13 offset:448
    ds_read_b128 v[76:79], v13 offset:480
    ds_read_b128 v[80:83], v13 offset:512
    ds_read_b128 v[84:87], v13 offset:544
    ds_read_b128 v[88:91], v13 offset:576
    ds_read_b128 v[92:95], v13 offset:608
    ds_read_b128 v[96:99], v13 offset:640
    ds_read_b128 v[100:103], v13 offset:672
    ds_read_b128 v[104:107], v13 offset:704
    ds_read_b128 v[108:111], v13 offset:736
    ds_read_b128 v[112:115], v13 offset:768
    ds_read_b128 v[116:119], v13 offset:800
    ds_read_b128 v[120:123], v13 offset:832
    ds_read_b128 v[124:127], v13 offset:864
    s_waitcnt lgkmcnt(0)
    s_barrier
    s_waitcnt vmcnt(13)
    ds_write_b128 v11, v[128:131] offset:0
    s_waitcnt vmcnt(12)
    ds_write_b128 v11, v[132:135] offset:4096
    s_waitcnt vmcnt(11)
    ds_write_b128 v11, v[136:139] offset:8192
    s_waitcnt vmcnt(10)
    ds_write_b128 v11, v[140:143] offset:12288
    s_waitcnt vmcnt(9)
    ds_write_b128 v11, v[144:147] offset:16384
    s_waitcnt vmcnt(8)
    ds_write_b128 v11, v[148:151] offset:20480
    s_waitcnt vmcnt(7)
    ds_write_b128 v11, v[152:155] offset:24576
    s_waitcnt vmcnt(6)
    ds_write_b128 v11, v[156:159] offset:28672
    s_waitcnt vmcnt(5)
    ds_write_b128 v11, v[160:163] offset:32768
    s_waitcnt vmcnt(4)
    ds_write_b128 v11, v[164:167] offset:36864
    s_waitcnt vmcnt(3)
    ds_write_b128 v11, v[168:171] offset:40960
    s_waitcnt vmcnt(2)
    ds_write_b128 v11, v[172:175] offset:45056
    s_waitcnt vmcnt(1)
    ds_write_b128 v11, v[176:179] offset:49152
    s_waitcnt vmcnt(0)
    ds_write_b128 v11, v[180:183] offset:53248
    s_mov_b32 s12, s44
    s_and_b32 s13, s45, 0xffff
    s_mov_b32 s14, 1204224
    s_mov_b32 s15, 0x00020000
    s_movk_i32 s35, 2688
    v_lshrrev_b32 v13, 2, v0
    v_mul_lo_u32 v13, v13, s35
    v_and_b32 v14, 3, v0
    v_lshl_add_u32 v13, v14, 4, v13
    s_mov_b32 s35, 640
    buffer_load_dwordx4 v[128:131], v13, s[12:15], s35 offen
    s_mov_b32 s35, 172672
    buffer_load_dwordx4 v[132:135], v13, s[12:15], s35 offen
    s_mov_b32 s35, 344704
    buffer_load_dwordx4 v[136:139], v13, s[12:15], s35 offen
    s_mov_b32 s35, 516736
    buffer_load_dwordx4 v[140:143], v13, s[12:15], s35 offen
    s_mov_b32 s35, 688768
    buffer_load_dwordx4 v[144:147], v13, s[12:15], s35 offen
    s_mov_b32 s35, 860800
    buffer_load_dwordx4 v[148:151], v13, s[12:15], s35 offen
    s_mov_b32 s35, 1032832
    buffer_load_dwordx4 v[152:155], v13, s[12:15], s35 offen
    s_waitcnt vmcnt(6)
    ds_write_b128 v225, v[128:131] offset:0
    s_waitcnt vmcnt(5)
    ds_write_b128 v225, v[132:135] offset:4096
    s_waitcnt vmcnt(4)
    ds_write_b128 v225, v[136:139] offset:8192
    s_waitcnt vmcnt(3)
    ds_write_b128 v225, v[140:143] offset:12288
    s_waitcnt vmcnt(2)
    ds_write_b128 v225, v[144:147] offset:16384
    s_waitcnt vmcnt(1)
    ds_write_b128 v225, v[148:151] offset:20480
    s_waitcnt vmcnt(0)
    ds_write_b128 v225, v[152:155] offset:24576
    s_mov_b32 s12, s44
    s_and_b32 s13, s45, 0xffff
    s_mov_b32 s14, 1204224
    s_mov_b32 s15, 0x00020000
    s_movk_i32 s35, 2688
    v_lshrrev_b32 v13, 2, v0
    v_mul_lo_u32 v13, v13, s35
    v_and_b32 v14, 3, v0
    v_lshl_add_u32 v13, v14, 4, v13
    s_mov_b32 s35, 704
    buffer_load_dwordx4 v[128:131], v13, s[12:15], s35 offen
    s_mov_b32 s35, 172736
    buffer_load_dwordx4 v[132:135], v13, s[12:15], s35 offen
    s_mov_b32 s35, 344768
    buffer_load_dwordx4 v[136:139], v13, s[12:15], s35 offen
    s_mov_b32 s35, 516800
    buffer_load_dwordx4 v[140:143], v13, s[12:15], s35 offen
    s_mov_b32 s35, 688832
    buffer_load_dwordx4 v[144:147], v13, s[12:15], s35 offen
    s_mov_b32 s35, 860864
    buffer_load_dwordx4 v[148:151], v13, s[12:15], s35 offen
    s_mov_b32 s35, 1032896
    buffer_load_dwordx4 v[152:155], v13, s[12:15], s35 offen
    s_waitcnt vmcnt(6)
    ds_write_b128 v225, v[128:131] offset:28672
    s_waitcnt vmcnt(5)
    ds_write_b128 v225, v[132:135] offset:32768
    s_waitcnt vmcnt(4)
    ds_write_b128 v225, v[136:139] offset:36864
    s_waitcnt vmcnt(3)
    ds_write_b128 v225, v[140:143] offset:40960
    s_waitcnt vmcnt(2)
    ds_write_b128 v225, v[144:147] offset:45056
    s_waitcnt vmcnt(1)
    ds_write_b128 v225, v[148:151] offset:49152
    s_waitcnt vmcnt(0)
    ds_write_b128 v225, v[152:155] offset:53248
    s_waitcnt lgkmcnt(0)
    s_barrier
    ds_read_b64_tr_b16 v[192:193], v7 offset:0
    ds_read_b64_tr_b16 v[194:195], v7 offset:256
    ds_read_b64_tr_b16 v[196:197], v7 offset:28672
    ds_read_b64_tr_b16 v[198:199], v7 offset:28928
    ds_read_b64_tr_b16 v[200:201], v224 offset:0
    ds_read_b64_tr_b16 v[202:203], v224 offset:256
    ds_read_b64_tr_b16 v[204:205], v224 offset:28672
    ds_read_b64_tr_b16 v[206:207], v224 offset:28928
    ds_read_b64_tr_b16 v[208:209], v7 offset:1024
    ds_read_b64_tr_b16 v[210:211], v7 offset:1280
    ds_read_b64_tr_b16 v[212:213], v7 offset:29696
    ds_read_b64_tr_b16 v[214:215], v7 offset:29952
    ds_read_b64_tr_b16 v[216:217], v224 offset:1024
    ds_read_b64_tr_b16 v[218:219], v224 offset:1280
    ds_read_b64_tr_b16 v[220:221], v224 offset:29696
    ds_read_b64_tr_b16 v[222:223], v224 offset:29952
    s_waitcnt lgkmcnt(8)
    v_mfma_f32_32x32x16_bf16 v[128:143], v[192:195], v[16:19], 0
    v_mfma_f32_32x32x16_bf16 v[144:159], v[196:199], v[16:19], 0
    v_mfma_f32_32x32x16_bf16 v[160:175], v[200:203], v[16:19], 0
    v_mfma_f32_32x32x16_bf16 v[176:191], v[204:207], v[16:19], 0
    ds_read_b64_tr_b16 v[192:193], v7 offset:2048
    ds_read_b64_tr_b16 v[194:195], v7 offset:2304
    ds_read_b64_tr_b16 v[196:197], v7 offset:30720
    ds_read_b64_tr_b16 v[198:199], v7 offset:30976
    ds_read_b64_tr_b16 v[200:201], v224 offset:2048
    ds_read_b64_tr_b16 v[202:203], v224 offset:2304
    ds_read_b64_tr_b16 v[204:205], v224 offset:30720
    ds_read_b64_tr_b16 v[206:207], v224 offset:30976
    s_waitcnt lgkmcnt(8)
    v_mfma_f32_32x32x16_bf16 v[128:143], v[208:211], v[20:23], v[128:143]
    v_mfma_f32_32x32x16_bf16 v[144:159], v[212:215], v[20:23], v[144:159]
    v_mfma_f32_32x32x16_bf16 v[160:175], v[216:219], v[20:23], v[160:175]
    v_mfma_f32_32x32x16_bf16 v[176:191], v[220:223], v[20:23], v[176:191]
    ds_read_b64_tr_b16 v[208:209], v7 offset:3072
    ds_read_b64_tr_b16 v[210:211], v7 offset:3328
    ds_read_b64_tr_b16 v[212:213], v7 offset:31744
    ds_read_b64_tr_b16 v[214:215], v7 offset:32000
    ds_read_b64_tr_b16 v[216:217], v224 offset:3072
    ds_read_b64_tr_b16 v[218:219], v224 offset:3328
    ds_read_b64_tr_b16 v[220:221], v224 offset:31744
    ds_read_b64_tr_b16 v[222:223], v224 offset:32000
    s_waitcnt lgkmcnt(8)
    v_mfma_f32_32x32x16_bf16 v[128:143], v[192:195], v[24:27], v[128:143]
    v_mfma_f32_32x32x16_bf16 v[144:159], v[196:199], v[24:27], v[144:159]
    v_mfma_f32_32x32x16_bf16 v[160:175], v[200:203], v[24:27], v[160:175]
    v_mfma_f32_32x32x16_bf16 v[176:191], v[204:207], v[24:27], v[176:191]
    ds_read_b64_tr_b16 v[192:193], v7 offset:4096
    ds_read_b64_tr_b16 v[194:195], v7 offset:4352
    ds_read_b64_tr_b16 v[196:197], v7 offset:32768
    ds_read_b64_tr_b16 v[198:199], v7 offset:33024
    ds_read_b64_tr_b16 v[200:201], v224 offset:4096
    ds_read_b64_tr_b16 v[202:203], v224 offset:4352
    ds_read_b64_tr_b16 v[204:205], v224 offset:32768
    ds_read_b64_tr_b16 v[206:207], v224 offset:33024
    s_waitcnt lgkmcnt(8)
    v_mfma_f32_32x32x16_bf16 v[128:143], v[208:211], v[28:31], v[128:143]
    v_mfma_f32_32x32x16_bf16 v[144:159], v[212:215], v[28:31], v[144:159]
    v_mfma_f32_32x32x16_bf16 v[160:175], v[216:219], v[28:31], v[160:175]
    v_mfma_f32_32x32x16_bf16 v[176:191], v[220:223], v[28:31], v[176:191]
    ds_read_b64_tr_b16 v[208:209], v7 offset:5120
    ds_read_b64_tr_b16 v[210:211], v7 offset:5376
    ds_read_b64_tr_b16 v[212:213], v7 offset:33792
    ds_read_b64_tr_b16 v[214:215], v7 offset:34048
    ds_read_b64_tr_b16 v[216:217], v224 offset:5120
    ds_read_b64_tr_b16 v[218:219], v224 offset:5376
    ds_read_b64_tr_b16 v[220:221], v224 offset:33792
    ds_read_b64_tr_b16 v[222:223], v224 offset:34048
    s_waitcnt lgkmcnt(8)
    v_mfma_f32_32x32x16_bf16 v[128:143], v[192:195], v[32:35], v[128:143]
    v_mfma_f32_32x32x16_bf16 v[144:159], v[196:199], v[32:35], v[144:159]
    v_mfma_f32_32x32x16_bf16 v[160:175], v[200:203], v[32:35], v[160:175]
    v_mfma_f32_32x32x16_bf16 v[176:191], v[204:207], v[32:35], v[176:191]
    ds_read_b64_tr_b16 v[192:193], v7 offset:6144
    ds_read_b64_tr_b16 v[194:195], v7 offset:6400
    ds_read_b64_tr_b16 v[196:197], v7 offset:34816
    ds_read_b64_tr_b16 v[198:199], v7 offset:35072
    ds_read_b64_tr_b16 v[200:201], v224 offset:6144
    ds_read_b64_tr_b16 v[202:203], v224 offset:6400
    ds_read_b64_tr_b16 v[204:205], v224 offset:34816
    ds_read_b64_tr_b16 v[206:207], v224 offset:35072
    s_waitcnt lgkmcnt(8)
    v_mfma_f32_32x32x16_bf16 v[128:143], v[208:211], v[36:39], v[128:143]
    v_mfma_f32_32x32x16_bf16 v[144:159], v[212:215], v[36:39], v[144:159]
    v_mfma_f32_32x32x16_bf16 v[160:175], v[216:219], v[36:39], v[160:175]
    v_mfma_f32_32x32x16_bf16 v[176:191], v[220:223], v[36:39], v[176:191]
    ds_read_b64_tr_b16 v[208:209], v7 offset:7168
    ds_read_b64_tr_b16 v[210:211], v7 offset:7424
    ds_read_b64_tr_b16 v[212:213], v7 offset:35840
    ds_read_b64_tr_b16 v[214:215], v7 offset:36096
    ds_read_b64_tr_b16 v[216:217], v224 offset:7168
    ds_read_b64_tr_b16 v[218:219], v224 offset:7424
    ds_read_b64_tr_b16 v[220:221], v224 offset:35840
    ds_read_b64_tr_b16 v[222:223], v224 offset:36096
    s_waitcnt lgkmcnt(8)
    v_mfma_f32_32x32x16_bf16 v[128:143], v[192:195], v[40:43], v[128:143]
    v_mfma_f32_32x32x16_bf16 v[144:159], v[196:199], v[40:43], v[144:159]
    v_mfma_f32_32x32x16_bf16 v[160:175], v[200:203], v[40:43], v[160:175]
    v_mfma_f32_32x32x16_bf16 v[176:191], v[204:207], v[40:43], v[176:191]
    ds_read_b64_tr_b16 v[192:193], v7 offset:8192
    ds_read_b64_tr_b16 v[194:195], v7 offset:8448
    ds_read_b64_tr_b16 v[196:197], v7 offset:36864
    ds_read_b64_tr_b16 v[198:199], v7 offset:37120
    ds_read_b64_tr_b16 v[200:201], v224 offset:8192
    ds_read_b64_tr_b16 v[202:203], v224 offset:8448
    ds_read_b64_tr_b16 v[204:205], v224 offset:36864
    ds_read_b64_tr_b16 v[206:207], v224 offset:37120
    s_waitcnt lgkmcnt(8)
    v_mfma_f32_32x32x16_bf16 v[128:143], v[208:211], v[44:47], v[128:143]
    v_mfma_f32_32x32x16_bf16 v[144:159], v[212:215], v[44:47], v[144:159]
    v_mfma_f32_32x32x16_bf16 v[160:175], v[216:219], v[44:47], v[160:175]
    v_mfma_f32_32x32x16_bf16 v[176:191], v[220:223], v[44:47], v[176:191]
    ds_read_b64_tr_b16 v[208:209], v7 offset:9216
    ds_read_b64_tr_b16 v[210:211], v7 offset:9472
    ds_read_b64_tr_b16 v[212:213], v7 offset:37888
    ds_read_b64_tr_b16 v[214:215], v7 offset:38144
    ds_read_b64_tr_b16 v[216:217], v224 offset:9216
    ds_read_b64_tr_b16 v[218:219], v224 offset:9472
    ds_read_b64_tr_b16 v[220:221], v224 offset:37888
    ds_read_b64_tr_b16 v[222:223], v224 offset:38144
    s_waitcnt lgkmcnt(8)
    v_mfma_f32_32x32x16_bf16 v[128:143], v[192:195], v[48:51], v[128:143]
    v_mfma_f32_32x32x16_bf16 v[144:159], v[196:199], v[48:51], v[144:159]
    v_mfma_f32_32x32x16_bf16 v[160:175], v[200:203], v[48:51], v[160:175]
    v_mfma_f32_32x32x16_bf16 v[176:191], v[204:207], v[48:51], v[176:191]
    ds_read_b64_tr_b16 v[192:193], v7 offset:10240
    ds_read_b64_tr_b16 v[194:195], v7 offset:10496
    ds_read_b64_tr_b16 v[196:197], v7 offset:38912
    ds_read_b64_tr_b16 v[198:199], v7 offset:39168
    ds_read_b64_tr_b16 v[200:201], v224 offset:10240
    ds_read_b64_tr_b16 v[202:203], v224 offset:10496
    ds_read_b64_tr_b16 v[204:205], v224 offset:38912
    ds_read_b64_tr_b16 v[206:207], v224 offset:39168
    s_waitcnt lgkmcnt(8)
    v_mfma_f32_32x32x16_bf16 v[128:143], v[208:211], v[52:55], v[128:143]
    v_mfma_f32_32x32x16_bf16 v[144:159], v[212:215], v[52:55], v[144:159]
    v_mfma_f32_32x32x16_bf16 v[160:175], v[216:219], v[52:55], v[160:175]
    v_mfma_f32_32x32x16_bf16 v[176:191], v[220:223], v[52:55], v[176:191]
    ds_read_b64_tr_b16 v[208:209], v7 offset:11264
    ds_read_b64_tr_b16 v[210:211], v7 offset:11520
    ds_read_b64_tr_b16 v[212:213], v7 offset:39936
    ds_read_b64_tr_b16 v[214:215], v7 offset:40192
    ds_read_b64_tr_b16 v[216:217], v224 offset:11264
    ds_read_b64_tr_b16 v[218:219], v224 offset:11520
    ds_read_b64_tr_b16 v[220:221], v224 offset:39936
    ds_read_b64_tr_b16 v[222:223], v224 offset:40192
    s_waitcnt lgkmcnt(8)
    v_mfma_f32_32x32x16_bf16 v[128:143], v[192:195], v[56:59], v[128:143]
    v_mfma_f32_32x32x16_bf16 v[144:159], v[196:199], v[56:59], v[144:159]
    v_mfma_f32_32x32x16_bf16 v[160:175], v[200:203], v[56:59], v[160:175]
    v_mfma_f32_32x32x16_bf16 v[176:191], v[204:207], v[56:59], v[176:191]
    ds_read_b64_tr_b16 v[192:193], v7 offset:12288
    ds_read_b64_tr_b16 v[194:195], v7 offset:12544
    ds_read_b64_tr_b16 v[196:197], v7 offset:40960
    ds_read_b64_tr_b16 v[198:199], v7 offset:41216
    ds_read_b64_tr_b16 v[200:201], v224 offset:12288
    ds_read_b64_tr_b16 v[202:203], v224 offset:12544
    ds_read_b64_tr_b16 v[204:205], v224 offset:40960
    ds_read_b64_tr_b16 v[206:207], v224 offset:41216
    s_waitcnt lgkmcnt(8)
    v_mfma_f32_32x32x16_bf16 v[128:143], v[208:211], v[60:63], v[128:143]
    v_mfma_f32_32x32x16_bf16 v[144:159], v[212:215], v[60:63], v[144:159]
    v_mfma_f32_32x32x16_bf16 v[160:175], v[216:219], v[60:63], v[160:175]
    v_mfma_f32_32x32x16_bf16 v[176:191], v[220:223], v[60:63], v[176:191]
    ds_read_b64_tr_b16 v[208:209], v7 offset:13312
    ds_read_b64_tr_b16 v[210:211], v7 offset:13568
    ds_read_b64_tr_b16 v[212:213], v7 offset:41984
    ds_read_b64_tr_b16 v[214:215], v7 offset:42240
    ds_read_b64_tr_b16 v[216:217], v224 offset:13312
    ds_read_b64_tr_b16 v[218:219], v224 offset:13568
    ds_read_b64_tr_b16 v[220:221], v224 offset:41984
    ds_read_b64_tr_b16 v[222:223], v224 offset:42240
    s_waitcnt lgkmcnt(8)
    v_mfma_f32_32x32x16_bf16 v[128:143], v[192:195], v[64:67], v[128:143]
    v_mfma_f32_32x32x16_bf16 v[144:159], v[196:199], v[64:67], v[144:159]
    v_mfma_f32_32x32x16_bf16 v[160:175], v[200:203], v[64:67], v[160:175]
    v_mfma_f32_32x32x16_bf16 v[176:191], v[204:207], v[64:67], v[176:191]
    ds_read_b64_tr_b16 v[192:193], v7 offset:14336
    ds_read_b64_tr_b16 v[194:195], v7 offset:14592
    ds_read_b64_tr_b16 v[196:197], v7 offset:43008
    ds_read_b64_tr_b16 v[198:199], v7 offset:43264
    ds_read_b64_tr_b16 v[200:201], v224 offset:14336
    ds_read_b64_tr_b16 v[202:203], v224 offset:14592
    ds_read_b64_tr_b16 v[204:205], v224 offset:43008
    ds_read_b64_tr_b16 v[206:207], v224 offset:43264
    s_waitcnt lgkmcnt(8)
    v_mfma_f32_32x32x16_bf16 v[128:143], v[208:211], v[68:71], v[128:143]
    v_mfma_f32_32x32x16_bf16 v[144:159], v[212:215], v[68:71], v[144:159]
    v_mfma_f32_32x32x16_bf16 v[160:175], v[216:219], v[68:71], v[160:175]
    v_mfma_f32_32x32x16_bf16 v[176:191], v[220:223], v[68:71], v[176:191]
    ds_read_b64_tr_b16 v[208:209], v7 offset:15360
    ds_read_b64_tr_b16 v[210:211], v7 offset:15616
    ds_read_b64_tr_b16 v[212:213], v7 offset:44032
    ds_read_b64_tr_b16 v[214:215], v7 offset:44288
    ds_read_b64_tr_b16 v[216:217], v224 offset:15360
    ds_read_b64_tr_b16 v[218:219], v224 offset:15616
    ds_read_b64_tr_b16 v[220:221], v224 offset:44032
    ds_read_b64_tr_b16 v[222:223], v224 offset:44288
    s_waitcnt lgkmcnt(8)
    v_mfma_f32_32x32x16_bf16 v[128:143], v[192:195], v[72:75], v[128:143]
    v_mfma_f32_32x32x16_bf16 v[144:159], v[196:199], v[72:75], v[144:159]
    v_mfma_f32_32x32x16_bf16 v[160:175], v[200:203], v[72:75], v[160:175]
    v_mfma_f32_32x32x16_bf16 v[176:191], v[204:207], v[72:75], v[176:191]
    ds_read_b64_tr_b16 v[192:193], v7 offset:16384
    ds_read_b64_tr_b16 v[194:195], v7 offset:16640
    ds_read_b64_tr_b16 v[196:197], v7 offset:45056
    ds_read_b64_tr_b16 v[198:199], v7 offset:45312
    ds_read_b64_tr_b16 v[200:201], v224 offset:16384
    ds_read_b64_tr_b16 v[202:203], v224 offset:16640
    ds_read_b64_tr_b16 v[204:205], v224 offset:45056
    ds_read_b64_tr_b16 v[206:207], v224 offset:45312
    s_waitcnt lgkmcnt(8)
    v_mfma_f32_32x32x16_bf16 v[128:143], v[208:211], v[76:79], v[128:143]
    v_mfma_f32_32x32x16_bf16 v[144:159], v[212:215], v[76:79], v[144:159]
    v_mfma_f32_32x32x16_bf16 v[160:175], v[216:219], v[76:79], v[160:175]
    v_mfma_f32_32x32x16_bf16 v[176:191], v[220:223], v[76:79], v[176:191]
    ds_read_b64_tr_b16 v[208:209], v7 offset:17408
    ds_read_b64_tr_b16 v[210:211], v7 offset:17664
    ds_read_b64_tr_b16 v[212:213], v7 offset:46080
    ds_read_b64_tr_b16 v[214:215], v7 offset:46336
    ds_read_b64_tr_b16 v[216:217], v224 offset:17408
    ds_read_b64_tr_b16 v[218:219], v224 offset:17664
    ds_read_b64_tr_b16 v[220:221], v224 offset:46080
    ds_read_b64_tr_b16 v[222:223], v224 offset:46336
    s_waitcnt lgkmcnt(8)
    v_mfma_f32_32x32x16_bf16 v[128:143], v[192:195], v[80:83], v[128:143]
    v_mfma_f32_32x32x16_bf16 v[144:159], v[196:199], v[80:83], v[144:159]
    v_mfma_f32_32x32x16_bf16 v[160:175], v[200:203], v[80:83], v[160:175]
    v_mfma_f32_32x32x16_bf16 v[176:191], v[204:207], v[80:83], v[176:191]
    ds_read_b64_tr_b16 v[192:193], v7 offset:18432
    ds_read_b64_tr_b16 v[194:195], v7 offset:18688
    ds_read_b64_tr_b16 v[196:197], v7 offset:47104
    ds_read_b64_tr_b16 v[198:199], v7 offset:47360
    ds_read_b64_tr_b16 v[200:201], v224 offset:18432
    ds_read_b64_tr_b16 v[202:203], v224 offset:18688
    ds_read_b64_tr_b16 v[204:205], v224 offset:47104
    ds_read_b64_tr_b16 v[206:207], v224 offset:47360
    s_waitcnt lgkmcnt(8)
    v_mfma_f32_32x32x16_bf16 v[128:143], v[208:211], v[84:87], v[128:143]
    v_mfma_f32_32x32x16_bf16 v[144:159], v[212:215], v[84:87], v[144:159]
    v_mfma_f32_32x32x16_bf16 v[160:175], v[216:219], v[84:87], v[160:175]
    v_mfma_f32_32x32x16_bf16 v[176:191], v[220:223], v[84:87], v[176:191]
    ds_read_b64_tr_b16 v[208:209], v7 offset:19456
    ds_read_b64_tr_b16 v[210:211], v7 offset:19712
    ds_read_b64_tr_b16 v[212:213], v7 offset:48128
    ds_read_b64_tr_b16 v[214:215], v7 offset:48384
    ds_read_b64_tr_b16 v[216:217], v224 offset:19456
    ds_read_b64_tr_b16 v[218:219], v224 offset:19712
    ds_read_b64_tr_b16 v[220:221], v224 offset:48128
    ds_read_b64_tr_b16 v[222:223], v224 offset:48384
    s_waitcnt lgkmcnt(8)
    v_mfma_f32_32x32x16_bf16 v[128:143], v[192:195], v[88:91], v[128:143]
    v_mfma_f32_32x32x16_bf16 v[144:159], v[196:199], v[88:91], v[144:159]
    v_mfma_f32_32x32x16_bf16 v[160:175], v[200:203], v[88:91], v[160:175]
    v_mfma_f32_32x32x16_bf16 v[176:191], v[204:207], v[88:91], v[176:191]
    ds_read_b64_tr_b16 v[192:193], v7 offset:20480
    ds_read_b64_tr_b16 v[194:195], v7 offset:20736
    ds_read_b64_tr_b16 v[196:197], v7 offset:49152
    ds_read_b64_tr_b16 v[198:199], v7 offset:49408
    ds_read_b64_tr_b16 v[200:201], v224 offset:20480
    ds_read_b64_tr_b16 v[202:203], v224 offset:20736
    ds_read_b64_tr_b16 v[204:205], v224 offset:49152
    ds_read_b64_tr_b16 v[206:207], v224 offset:49408
    s_waitcnt lgkmcnt(8)
    v_mfma_f32_32x32x16_bf16 v[128:143], v[208:211], v[92:95], v[128:143]
    v_mfma_f32_32x32x16_bf16 v[144:159], v[212:215], v[92:95], v[144:159]
    v_mfma_f32_32x32x16_bf16 v[160:175], v[216:219], v[92:95], v[160:175]
    v_mfma_f32_32x32x16_bf16 v[176:191], v[220:223], v[92:95], v[176:191]
    ds_read_b64_tr_b16 v[208:209], v7 offset:21504
    ds_read_b64_tr_b16 v[210:211], v7 offset:21760
    ds_read_b64_tr_b16 v[212:213], v7 offset:50176
    ds_read_b64_tr_b16 v[214:215], v7 offset:50432
    ds_read_b64_tr_b16 v[216:217], v224 offset:21504
    ds_read_b64_tr_b16 v[218:219], v224 offset:21760
    ds_read_b64_tr_b16 v[220:221], v224 offset:50176
    ds_read_b64_tr_b16 v[222:223], v224 offset:50432
    s_waitcnt lgkmcnt(8)
    v_mfma_f32_32x32x16_bf16 v[128:143], v[192:195], v[96:99], v[128:143]
    v_mfma_f32_32x32x16_bf16 v[144:159], v[196:199], v[96:99], v[144:159]
    v_mfma_f32_32x32x16_bf16 v[160:175], v[200:203], v[96:99], v[160:175]
    v_mfma_f32_32x32x16_bf16 v[176:191], v[204:207], v[96:99], v[176:191]
    ds_read_b64_tr_b16 v[192:193], v7 offset:22528
    ds_read_b64_tr_b16 v[194:195], v7 offset:22784
    ds_read_b64_tr_b16 v[196:197], v7 offset:51200
    ds_read_b64_tr_b16 v[198:199], v7 offset:51456
    ds_read_b64_tr_b16 v[200:201], v224 offset:22528
    ds_read_b64_tr_b16 v[202:203], v224 offset:22784
    ds_read_b64_tr_b16 v[204:205], v224 offset:51200
    ds_read_b64_tr_b16 v[206:207], v224 offset:51456
    s_waitcnt lgkmcnt(8)
    v_mfma_f32_32x32x16_bf16 v[128:143], v[208:211], v[100:103], v[128:143]
    v_mfma_f32_32x32x16_bf16 v[144:159], v[212:215], v[100:103], v[144:159]
    v_mfma_f32_32x32x16_bf16 v[160:175], v[216:219], v[100:103], v[160:175]
    v_mfma_f32_32x32x16_bf16 v[176:191], v[220:223], v[100:103], v[176:191]
    ds_read_b64_tr_b16 v[208:209], v7 offset:23552
    ds_read_b64_tr_b16 v[210:211], v7 offset:23808
    ds_read_b64_tr_b16 v[212:213], v7 offset:52224
    ds_read_b64_tr_b16 v[214:215], v7 offset:52480
    ds_read_b64_tr_b16 v[216:217], v224 offset:23552
    ds_read_b64_tr_b16 v[218:219], v224 offset:23808
    ds_read_b64_tr_b16 v[220:221], v224 offset:52224
    ds_read_b64_tr_b16 v[222:223], v224 offset:52480
    s_waitcnt lgkmcnt(8)
    v_mfma_f32_32x32x16_bf16 v[128:143], v[192:195], v[104:107], v[128:143]
    v_mfma_f32_32x32x16_bf16 v[144:159], v[196:199], v[104:107], v[144:159]
    v_mfma_f32_32x32x16_bf16 v[160:175], v[200:203], v[104:107], v[160:175]
    v_mfma_f32_32x32x16_bf16 v[176:191], v[204:207], v[104:107], v[176:191]
    ds_read_b64_tr_b16 v[192:193], v7 offset:24576
    ds_read_b64_tr_b16 v[194:195], v7 offset:24832
    ds_read_b64_tr_b16 v[196:197], v7 offset:53248
    ds_read_b64_tr_b16 v[198:199], v7 offset:53504
    ds_read_b64_tr_b16 v[200:201], v224 offset:24576
    ds_read_b64_tr_b16 v[202:203], v224 offset:24832
    ds_read_b64_tr_b16 v[204:205], v224 offset:53248
    ds_read_b64_tr_b16 v[206:207], v224 offset:53504
    s_waitcnt lgkmcnt(8)
    v_mfma_f32_32x32x16_bf16 v[128:143], v[208:211], v[108:111], v[128:143]
    v_mfma_f32_32x32x16_bf16 v[144:159], v[212:215], v[108:111], v[144:159]
    v_mfma_f32_32x32x16_bf16 v[160:175], v[216:219], v[108:111], v[160:175]
    v_mfma_f32_32x32x16_bf16 v[176:191], v[220:223], v[108:111], v[176:191]
    ds_read_b64_tr_b16 v[208:209], v7 offset:25600
    ds_read_b64_tr_b16 v[210:211], v7 offset:25856
    ds_read_b64_tr_b16 v[212:213], v7 offset:54272
    ds_read_b64_tr_b16 v[214:215], v7 offset:54528
    ds_read_b64_tr_b16 v[216:217], v224 offset:25600
    ds_read_b64_tr_b16 v[218:219], v224 offset:25856
    ds_read_b64_tr_b16 v[220:221], v224 offset:54272
    ds_read_b64_tr_b16 v[222:223], v224 offset:54528
    s_waitcnt lgkmcnt(8)
    v_mfma_f32_32x32x16_bf16 v[128:143], v[192:195], v[112:115], v[128:143]
    v_mfma_f32_32x32x16_bf16 v[144:159], v[196:199], v[112:115], v[144:159]
    v_mfma_f32_32x32x16_bf16 v[160:175], v[200:203], v[112:115], v[160:175]
    v_mfma_f32_32x32x16_bf16 v[176:191], v[204:207], v[112:115], v[176:191]
    ds_read_b64_tr_b16 v[192:193], v7 offset:26624
    ds_read_b64_tr_b16 v[194:195], v7 offset:26880
    ds_read_b64_tr_b16 v[196:197], v7 offset:55296
    ds_read_b64_tr_b16 v[198:199], v7 offset:55552
    ds_read_b64_tr_b16 v[200:201], v224 offset:26624
    ds_read_b64_tr_b16 v[202:203], v224 offset:26880
    ds_read_b64_tr_b16 v[204:205], v224 offset:55296
    ds_read_b64_tr_b16 v[206:207], v224 offset:55552
    s_waitcnt lgkmcnt(8)
    v_mfma_f32_32x32x16_bf16 v[128:143], v[208:211], v[116:119], v[128:143]
    v_mfma_f32_32x32x16_bf16 v[144:159], v[212:215], v[116:119], v[144:159]
    v_mfma_f32_32x32x16_bf16 v[160:175], v[216:219], v[116:119], v[160:175]
    v_mfma_f32_32x32x16_bf16 v[176:191], v[220:223], v[116:119], v[176:191]
    ds_read_b64_tr_b16 v[208:209], v7 offset:27648
    ds_read_b64_tr_b16 v[210:211], v7 offset:27904
    ds_read_b64_tr_b16 v[212:213], v7 offset:56320
    ds_read_b64_tr_b16 v[214:215], v7 offset:56576
    ds_read_b64_tr_b16 v[216:217], v224 offset:27648
    ds_read_b64_tr_b16 v[218:219], v224 offset:27904
    ds_read_b64_tr_b16 v[220:221], v224 offset:56320
    ds_read_b64_tr_b16 v[222:223], v224 offset:56576
    s_waitcnt lgkmcnt(8)
    v_mfma_f32_32x32x16_bf16 v[128:143], v[192:195], v[120:123], v[128:143]
    v_mfma_f32_32x32x16_bf16 v[144:159], v[196:199], v[120:123], v[144:159]
    v_mfma_f32_32x32x16_bf16 v[160:175], v[200:203], v[120:123], v[160:175]
    v_mfma_f32_32x32x16_bf16 v[176:191], v[204:207], v[120:123], v[176:191]
    s_waitcnt lgkmcnt(0)
    v_mfma_f32_32x32x16_bf16 v[128:143], v[208:211], v[124:127], v[128:143]
    v_mfma_f32_32x32x16_bf16 v[144:159], v[212:215], v[124:127], v[144:159]
    v_mfma_f32_32x32x16_bf16 v[160:175], v[216:219], v[124:127], v[160:175]
    v_mfma_f32_32x32x16_bf16 v[176:191], v[220:223], v[124:127], v[176:191]
    s_nop 15
    s_nop 3
    s_movk_i32 s35, 1792
    v_mul_lo_u32 v13, v5, s35
    v_lshl_add_u32 v13, v4, 3, v13
    v_add_u32 v13, 2359808, v13
    v_cvt_pk_bf16_f32 v128, v128, v129
    v_cvt_pk_bf16_f32 v129, v130, v131
    buffer_store_dwordx2 v[128:129], v13, s[16:19], 0 offen offset:0
    v_cvt_pk_bf16_f32 v132, v132, v133
    v_cvt_pk_bf16_f32 v133, v134, v135
    buffer_store_dwordx2 v[132:133], v13, s[16:19], 0 offen offset:16
    v_cvt_pk_bf16_f32 v136, v136, v137
    v_cvt_pk_bf16_f32 v137, v138, v139
    buffer_store_dwordx2 v[136:137], v13, s[16:19], 0 offen offset:32
    v_cvt_pk_bf16_f32 v140, v140, v141
    v_cvt_pk_bf16_f32 v141, v142, v143
    buffer_store_dwordx2 v[140:141], v13, s[16:19], 0 offen offset:48
    s_movk_i32 s35, 1792
    v_mul_lo_u32 v13, v5, s35
    v_lshl_add_u32 v13, v4, 3, v13
    v_add_u32 v13, 2359872, v13
    v_cvt_pk_bf16_f32 v144, v144, v145
    v_cvt_pk_bf16_f32 v145, v146, v147
    buffer_store_dwordx2 v[144:145], v13, s[16:19], 0 offen offset:0
    v_cvt_pk_bf16_f32 v148, v148, v149
    v_cvt_pk_bf16_f32 v149, v150, v151
    buffer_store_dwordx2 v[148:149], v13, s[16:19], 0 offen offset:16
    v_cvt_pk_bf16_f32 v152, v152, v153
    v_cvt_pk_bf16_f32 v153, v154, v155
    buffer_store_dwordx2 v[152:153], v13, s[16:19], 0 offen offset:32
    v_cvt_pk_bf16_f32 v156, v156, v157
    v_cvt_pk_bf16_f32 v157, v158, v159
    buffer_store_dwordx2 v[156:157], v13, s[16:19], 0 offen offset:48
    s_movk_i32 s35, 1792
    v_mul_lo_u32 v13, v5, s35
    v_lshl_add_u32 v13, v4, 3, v13
    v_add_u32 v13, 2359936, v13
    v_cvt_pk_bf16_f32 v160, v160, v161
    v_cvt_pk_bf16_f32 v161, v162, v163
    buffer_store_dwordx2 v[160:161], v13, s[16:19], 0 offen offset:0
    v_cvt_pk_bf16_f32 v164, v164, v165
    v_cvt_pk_bf16_f32 v165, v166, v167
    buffer_store_dwordx2 v[164:165], v13, s[16:19], 0 offen offset:16
    v_cvt_pk_bf16_f32 v168, v168, v169
    v_cvt_pk_bf16_f32 v169, v170, v171
    buffer_store_dwordx2 v[168:169], v13, s[16:19], 0 offen offset:32
    v_cvt_pk_bf16_f32 v172, v172, v173
    v_cvt_pk_bf16_f32 v173, v174, v175
    buffer_store_dwordx2 v[172:173], v13, s[16:19], 0 offen offset:48
    s_movk_i32 s35, 1792
    v_mul_lo_u32 v13, v5, s35
    v_lshl_add_u32 v13, v4, 3, v13
    v_add_u32 v13, 2360000, v13
    v_cvt_pk_bf16_f32 v176, v176, v177
    v_cvt_pk_bf16_f32 v177, v178, v179
    buffer_store_dwordx2 v[176:177], v13, s[16:19], 0 offen offset:0
    v_cvt_pk_bf16_f32 v180, v180, v181
    v_cvt_pk_bf16_f32 v181, v182, v183
    buffer_store_dwordx2 v[180:181], v13, s[16:19], 0 offen offset:16
    v_cvt_pk_bf16_f32 v184, v184, v185
    v_cvt_pk_bf16_f32 v185, v186, v187
    buffer_store_dwordx2 v[184:185], v13, s[16:19], 0 offen offset:32
    v_cvt_pk_bf16_f32 v188, v188, v189
    v_cvt_pk_bf16_f32 v189, v190, v191
    buffer_store_dwordx2 v[188:189], v13, s[16:19], 0 offen offset:48
    s_endpgm
K1_v7:
    s_mov_b32 s12, s44
    s_and_b32 s13, s45, 0xffff
    s_mov_b32 s14, 1204224
    s_mov_b32 s15, 0x00020000
    s_movk_i32 s35, 2688
    v_lshrrev_b32 v227, 2, v0
    v_mul_lo_u32 v227, v227, s35
    v_and_b32 v14, 3, v0
    v_lshl_add_u32 v227, v14, 4, v227
    s_mov_b32 s35, 768
    buffer_load_dwordx4 v[128:131], v227, s[12:15], s35 offen
    s_mov_b32 s35, 172800
    buffer_load_dwordx4 v[132:135], v227, s[12:15], s35 offen
    s_mov_b32 s35, 344832
    buffer_load_dwordx4 v[136:139], v227, s[12:15], s35 offen
    s_mov_b32 s35, 516864
    buffer_load_dwordx4 v[140:143], v227, s[12:15], s35 offen
    s_mov_b32 s35, 688896
    buffer_load_dwordx4 v[144:147], v227, s[12:15], s35 offen
    s_mov_b32 s35, 860928
    buffer_load_dwordx4 v[148:151], v227, s[12:15], s35 offen
    s_mov_b32 s35, 1032960
    buffer_load_dwordx4 v[152:155], v227, s[12:15], s35 offen
    s_mov_b32 s12, s44
    s_and_b32 s13, s45, 0xffff
    s_mov_b32 s14, 1204224
    s_mov_b32 s15, 0x00020000
    s_movk_i32 s35, 2688
    v_lshrrev_b32 v227, 2, v0
    v_mul_lo_u32 v227, v227, s35
    v_and_b32 v14, 3, v0
    v_lshl_add_u32 v227, v14, 4, v227
    s_mov_b32 s35, 832
    buffer_load_dwordx4 v[156:159], v227, s[12:15], s35 offen
    s_mov_b32 s35, 172864
    buffer_load_dwordx4 v[160:163], v227, s[12:15], s35 offen
    s_mov_b32 s35, 344896
    buffer_load_dwordx4 v[164:167], v227, s[12:15], s35 offen
    s_mov_b32 s35, 516928
    buffer_load_dwordx4 v[168:171], v227, s[12:15], s35 offen
    s_mov_b32 s35, 688960
    buffer_load_dwordx4 v[172:175], v227, s[12:15], s35 offen
    s_mov_b32 s35, 860992
    buffer_load_dwordx4 v[176:179], v227, s[12:15], s35 offen
    s_mov_b32 s35, 1033024
    buffer_load_dwordx4 v[180:183], v227, s[12:15], s35 offen
    s_mov_b32 s54, 0x4924925
    v_add_u32 v13, 0, v2
    v_mul_hi_u32 v14, v13, s54
    v_lshlrev_b32 v13, 4, v13
    v_lshl_add_u32 v13, v14, 4, v13
    v_add_u32 v13, s53, v13
    s_waitcnt vmcnt(41)
    ds_write_b128 v13, v[16:19]
    v_add_u32 v13, 64, v2
    v_mul_hi_u32 v14, v13, s54
    v_lshlrev_b32 v13, 4, v13
    v_lshl_add_u32 v13, v14, 4, v13
    v_add_u32 v13, s53, v13
    s_waitcnt vmcnt(40)
    ds_write_b128 v13, v[20:23]
    v_add_u32 v13, 128, v2
    v_mul_hi_u32 v14, v13, s54
    v_lshlrev_b32 v13, 4, v13
    v_lshl_add_u32 v13, v14, 4, v13
    v_add_u32 v13, s53, v13
    s_waitcnt vmcnt(39)
    ds_write_b128 v13, v[24:27]
    v_add_u32 v13, 192, v2
    v_mul_hi_u32 v14, v13, s54
    v_lshlrev_b32 v13, 4, v13
    v_lshl_add_u32 v13, v14, 4, v13
    v_add_u32 v13, s53, v13
    s_waitcnt vmcnt(38)
    ds_write_b128 v13, v[28:31]
    v_add_u32 v13, 256, v2
    v_mul_hi_u32 v14, v13, s54
    v_lshlrev_b32 v13, 4, v13
    v_lshl_add_u32 v13, v14, 4, v13
    v_add_u32 v13, s53, v13
    s_waitcnt vmcnt(37)
    ds_write_b128 v13, v[32:35]
    v_add_u32 v13, 320, v2
    v_mul_hi_u32 v14, v13, s54
    v_lshlrev_b32 v13, 4, v13
    v_lshl_add_u32 v13, v14, 4, v13
    v_add_u32 v13, s53, v13
    s_waitcnt vmcnt(36)
    ds_write_b128 v13, v[36:39]
    v_add_u32 v13, 384, v2
    v_mul_hi_u32 v14, v13, s54
    v_lshlrev_b32 v13, 4, v13
    v_lshl_add_u32 v13, v14, 4, v13
    v_add_u32 v13, s53, v13
    s_waitcnt vmcnt(35)
    ds_write_b128 v13, v[40:43]
    v_add_u32 v13, 448, v2
    v_mul_hi_u32 v14, v13, s54
    v_lshlrev_b32 v13, 4, v13
    v_lshl_add_u32 v13, v14, 4, v13
    v_add_u32 v13, s53, v13
    s_waitcnt vmcnt(34)
    ds_write_b128 v13, v[44:47]
    v_add_u32 v13, 512, v2
    v_mul_hi_u32 v14, v13, s54
    v_lshlrev_b32 v13, 4, v13
    v_lshl_add_u32 v13, v14, 4, v13
    v_add_u32 v13, s53, v13
    s_waitcnt vmcnt(33)
    ds_write_b128 v13, v[48:51]
    v_add_u32 v13, 576, v2
    v_mul_hi_u32 v14, v13, s54
    v_lshlrev_b32 v13, 4, v13
    v_lshl_add_u32 v13, v14, 4, v13
    v_add_u32 v13, s53, v13
    s_waitcnt vmcnt(32)
    ds_write_b128 v13, v[52:55]
    v_add_u32 v13, 640, v2
    v_mul_hi_u32 v14, v13, s54
    v_lshlrev_b32 v13, 4, v13
    v_lshl_add_u32 v13, v14, 4, v13
    v_add_u32 v13, s53, v13
    s_waitcnt vmcnt(31)
    ds_write_b128 v13, v[56:59]
    v_add_u32 v13, 704, v2
    v_mul_hi_u32 v14, v13, s54
    v_lshlrev_b32 v13, 4, v13
    v_lshl_add_u32 v13, v14, 4, v13
    v_add_u32 v13, s53, v13
    s_waitcnt vmcnt(30)
    ds_write_b128 v13, v[60:63]
    v_add_u32 v13, 768, v2
    v_mul_hi_u32 v14, v13, s54
    v_lshlrev_b32 v13, 4, v13
    v_lshl_add_u32 v13, v14, 4, v13
    v_add_u32 v13, s53, v13
    s_waitcnt vmcnt(29)
    ds_write_b128 v13, v[64:67]
    v_add_u32 v13, 832, v2
    v_mul_hi_u32 v14, v13, s54
    v_lshlrev_b32 v13, 4, v13
    v_lshl_add_u32 v13, v14, 4, v13
    v_add_u32 v13, s53, v13
    s_waitcnt vmcnt(28)
    ds_write_b128 v13, v[68:71]
    v_add_u32 v13, 896, v2
    v_mul_hi_u32 v14, v13, s54
    v_lshlrev_b32 v13, 4, v13
    v_lshl_add_u32 v13, v14, 4, v13
    v_add_u32 v13, s53, v13
    s_waitcnt vmcnt(27)
    ds_write_b128 v13, v[72:75]
    v_add_u32 v13, 960, v2
    v_mul_hi_u32 v14, v13, s54
    v_lshlrev_b32 v13, 4, v13
    v_lshl_add_u32 v13, v14, 4, v13
    v_add_u32 v13, s53, v13
    s_waitcnt vmcnt(26)
    ds_write_b128 v13, v[76:79]
    v_add_u32 v13, 1024, v2
    v_mul_hi_u32 v14, v13, s54
    v_lshlrev_b32 v13, 4, v13
    v_lshl_add_u32 v13, v14, 4, v13
    v_add_u32 v13, s53, v13
    s_waitcnt vmcnt(25)
    ds_write_b128 v13, v[80:83]
    v_add_u32 v13, 1088, v2
    v_mul_hi_u32 v14, v13, s54
    v_lshlrev_b32 v13, 4, v13
    v_lshl_add_u32 v13, v14, 4, v13
    v_add_u32 v13, s53, v13
    s_waitcnt vmcnt(24)
    ds_write_b128 v13, v[84:87]
    v_add_u32 v13, 1152, v2
    v_mul_hi_u32 v14, v13, s54
    v_lshlrev_b32 v13, 4, v13
    v_lshl_add_u32 v13, v14, 4, v13
    v_add_u32 v13, s53, v13
    s_waitcnt vmcnt(23)
    ds_write_b128 v13, v[88:91]
    v_add_u32 v13, 1216, v2
    v_mul_hi_u32 v14, v13, s54
    v_lshlrev_b32 v13, 4, v13
    v_lshl_add_u32 v13, v14, 4, v13
    v_add_u32 v13, s53, v13
    s_waitcnt vmcnt(22)
    ds_write_b128 v13, v[92:95]
    v_add_u32 v13, 1280, v2
    v_mul_hi_u32 v14, v13, s54
    v_lshlrev_b32 v13, 4, v13
    v_lshl_add_u32 v13, v14, 4, v13
    v_add_u32 v13, s53, v13
    s_waitcnt vmcnt(21)
    ds_write_b128 v13, v[96:99]
    v_add_u32 v13, 1344, v2
    v_mul_hi_u32 v14, v13, s54
    v_lshlrev_b32 v13, 4, v13
    v_lshl_add_u32 v13, v14, 4, v13
    v_add_u32 v13, s53, v13
    s_waitcnt vmcnt(20)
    ds_write_b128 v13, v[100:103]
    v_add_u32 v13, 1408, v2
    v_mul_hi_u32 v14, v13, s54
    v_lshlrev_b32 v13, 4, v13
    v_lshl_add_u32 v13, v14, 4, v13
    v_add_u32 v13, s53, v13
    s_waitcnt vmcnt(19)
    ds_write_b128 v13, v[104:107]
    v_add_u32 v13, 1472, v2
    v_mul_hi_u32 v14, v13, s54
    v_lshlrev_b32 v13, 4, v13
    v_lshl_add_u32 v13, v14, 4, v13
    v_add_u32 v13, s53, v13
    s_waitcnt vmcnt(18)
    ds_write_b128 v13, v[108:111]
    v_add_u32 v13, 1536, v2
    v_mul_hi_u32 v14, v13, s54
    v_lshlrev_b32 v13, 4, v13
    v_lshl_add_u32 v13, v14, 4, v13
    v_add_u32 v13, s53, v13
    s_waitcnt vmcnt(17)
    ds_write_b128 v13, v[112:115]
    v_add_u32 v13, 1600, v2
    v_mul_hi_u32 v14, v13, s54
    v_lshlrev_b32 v13, 4, v13
    v_lshl_add_u32 v13, v14, 4, v13
    v_add_u32 v13, s53, v13
    s_waitcnt vmcnt(16)
    ds_write_b128 v13, v[116:119]
    v_add_u32 v13, 1664, v2
    v_mul_hi_u32 v14, v13, s54
    v_lshlrev_b32 v13, 4, v13
    v_lshl_add_u32 v13, v14, 4, v13
    v_add_u32 v13, s53, v13
    s_waitcnt vmcnt(15)
    ds_write_b128 v13, v[120:123]
    v_add_u32 v13, 1728, v2
    v_mul_hi_u32 v14, v13, s54
    v_lshlrev_b32 v13, 4, v13
    v_lshl_add_u32 v13, v14, 4, v13
    v_add_u32 v13, s53, v13
    s_waitcnt vmcnt(14)
    ds_write_b128 v13, v[124:127]
    v_mul_u32_u24 v13, 912, v3
    v_lshl_add_u32 v13, v4, 4, v13
    v_add_u32 v13, s53, v13
    s_waitcnt lgkmcnt(0)
    ds_read_b128 v[16:19], v13 offset:0
    ds_read_b128 v[20:23], v13 offset:32
    ds_read_b128 v[24:27], v13 offset:64
    ds_read_b128 v[28:31], v13 offset:96
    ds_read_b128 v[32:35], v13 offset:128
    ds_read_b128 v[36:39], v13 offset:160
    ds_read_b128 v[40:43], v13 offset:192
    ds_read_b128 v[44:47], v13 offset:224
    ds_read_b128 v[48:51], v13 offset:256
    ds_read_b128 v[52:55], v13 offset:288
    ds_read_b128 v[56:59], v13 offset:320
    ds_read_b128 v[60:63], v13 offset:352
    ds_read_b128 v[64:67], v13 offset:384
    ds_read_b128 v[68:71], v13 offset:416
    ds_read_b128 v[72:75], v13 offset:448
    ds_read_b128 v[76:79], v13 offset:480
    ds_read_b128 v[80:83], v13 offset:512
    ds_read_b128 v[84:87], v13 offset:544
    ds_read_b128 v[88:91], v13 offset:576
    ds_read_b128 v[92:95], v13 offset:608
    ds_read_b128 v[96:99], v13 offset:640
    ds_read_b128 v[100:103], v13 offset:672
    ds_read_b128 v[104:107], v13 offset:704
    ds_read_b128 v[108:111], v13 offset:736
    ds_read_b128 v[112:115], v13 offset:768
    ds_read_b128 v[116:119], v13 offset:800
    ds_read_b128 v[120:123], v13 offset:832
    ds_read_b128 v[124:127], v13 offset:864
    s_waitcnt lgkmcnt(0)
    s_barrier
    s_waitcnt vmcnt(13)
    ds_write_b128 v11, v[128:131] offset:0
    s_waitcnt vmcnt(12)
    ds_write_b128 v11, v[132:135] offset:4096
    s_waitcnt vmcnt(11)
    ds_write_b128 v11, v[136:139] offset:8192
    s_waitcnt vmcnt(10)
    ds_write_b128 v11, v[140:143] offset:12288
    s_waitcnt vmcnt(9)
    ds_write_b128 v11, v[144:147] offset:16384
    s_waitcnt vmcnt(8)
    ds_write_b128 v11, v[148:151] offset:20480
    s_waitcnt vmcnt(7)
    ds_write_b128 v11, v[152:155] offset:24576
    s_waitcnt vmcnt(6)
    ds_write_b128 v11, v[156:159] offset:28672
    s_waitcnt vmcnt(5)
    ds_write_b128 v11, v[160:163] offset:32768
    s_waitcnt vmcnt(4)
    ds_write_b128 v11, v[164:167] offset:36864
    s_waitcnt vmcnt(3)
    ds_write_b128 v11, v[168:171] offset:40960
    s_waitcnt vmcnt(2)
    ds_write_b128 v11, v[172:175] offset:45056
    s_waitcnt vmcnt(1)
    ds_write_b128 v11, v[176:179] offset:49152
    s_waitcnt vmcnt(0)
    ds_write_b128 v11, v[180:183] offset:53248
    s_mov_b32 s12, s44
    s_and_b32 s13, s45, 0xffff
    s_mov_b32 s14, 1204224
    s_mov_b32 s15, 0x00020000
    s_movk_i32 s35, 2688
    v_lshrrev_b32 v13, 2, v0
    v_mul_lo_u32 v13, v13, s35
    v_and_b32 v14, 3, v0
    v_lshl_add_u32 v13, v14, 4, v13
    s_mov_b32 s35, 896
    buffer_load_dwordx4 v[128:131], v13, s[12:15], s35 offen
    s_mov_b32 s35, 172928
    buffer_load_dwordx4 v[132:135], v13, s[12:15], s35 offen
    s_mov_b32 s35, 344960
    buffer_load_dwordx4 v[136:139], v13, s[12:15], s35 offen
    s_mov_b32 s35, 516992
    buffer_load_dwordx4 v[140:143], v13, s[12:15], s35 offen
    s_mov_b32 s35, 689024
    buffer_load_dwordx4 v[144:147], v13, s[12:15], s35 offen
    s_mov_b32 s35, 861056
    buffer_load_dwordx4 v[148:151], v13, s[12:15], s35 offen
    s_mov_b32 s35, 1033088
    buffer_load_dwordx4 v[152:155], v13, s[12:15], s35 offen
    s_waitcnt vmcnt(6)
    ds_write_b128 v225, v[128:131] offset:0
    s_waitcnt vmcnt(5)
    ds_write_b128 v225, v[132:135] offset:4096
    s_waitcnt vmcnt(4)
    ds_write_b128 v225, v[136:139] offset:8192
    s_waitcnt vmcnt(3)
    ds_write_b128 v225, v[140:143] offset:12288
    s_waitcnt vmcnt(2)
    ds_write_b128 v225, v[144:147] offset:16384
    s_waitcnt vmcnt(1)
    ds_write_b128 v225, v[148:151] offset:20480
    s_waitcnt vmcnt(0)
    ds_write_b128 v225, v[152:155] offset:24576
    s_mov_b32 s12, s44
    s_and_b32 s13, s45, 0xffff
    s_mov_b32 s14, 1204224
    s_mov_b32 s15, 0x00020000
    s_movk_i32 s35, 2688
    v_lshrrev_b32 v13, 2, v0
    v_mul_lo_u32 v13, v13, s35
    v_and_b32 v14, 3, v0
    v_lshl_add_u32 v13, v14, 4, v13
    s_mov_b32 s35, 960
    buffer_load_dwordx4 v[128:131], v13, s[12:15], s35 offen
    s_mov_b32 s35, 172992
    buffer_load_dwordx4 v[132:135], v13, s[12:15], s35 offen
    s_mov_b32 s35, 345024
    buffer_load_dwordx4 v[136:139], v13, s[12:15], s35 offen
    s_mov_b32 s35, 517056
    buffer_load_dwordx4 v[140:143], v13, s[12:15], s35 offen
    s_mov_b32 s35, 689088
    buffer_load_dwordx4 v[144:147], v13, s[12:15], s35 offen
    s_mov_b32 s35, 861120
    buffer_load_dwordx4 v[148:151], v13, s[12:15], s35 offen
    s_mov_b32 s35, 1033152
    buffer_load_dwordx4 v[152:155], v13, s[12:15], s35 offen
    s_waitcnt vmcnt(6)
    ds_write_b128 v225, v[128:131] offset:28672
    s_waitcnt vmcnt(5)
    ds_write_b128 v225, v[132:135] offset:32768
    s_waitcnt vmcnt(4)
    ds_write_b128 v225, v[136:139] offset:36864
    s_waitcnt vmcnt(3)
    ds_write_b128 v225, v[140:143] offset:40960
    s_waitcnt vmcnt(2)
    ds_write_b128 v225, v[144:147] offset:45056
    s_waitcnt vmcnt(1)
    ds_write_b128 v225, v[148:151] offset:49152
    s_waitcnt vmcnt(0)
    ds_write_b128 v225, v[152:155] offset:53248
    s_waitcnt lgkmcnt(0)
    s_barrier
    ds_read_b64_tr_b16 v[192:193], v7 offset:0
    ds_read_b64_tr_b16 v[194:195], v7 offset:256
    ds_read_b64_tr_b16 v[196:197], v7 offset:28672
    ds_read_b64_tr_b16 v[198:199], v7 offset:28928
    ds_read_b64_tr_b16 v[200:201], v224 offset:0
    ds_read_b64_tr_b16 v[202:203], v224 offset:256
    ds_read_b64_tr_b16 v[204:205], v224 offset:28672
    ds_read_b64_tr_b16 v[206:207], v224 offset:28928
    ds_read_b64_tr_b16 v[208:209], v7 offset:1024
    ds_read_b64_tr_b16 v[210:211], v7 offset:1280
    ds_read_b64_tr_b16 v[212:213], v7 offset:29696
    ds_read_b64_tr_b16 v[214:215], v7 offset:29952
    ds_read_b64_tr_b16 v[216:217], v224 offset:1024
    ds_read_b64_tr_b16 v[218:219], v224 offset:1280
    ds_read_b64_tr_b16 v[220:221], v224 offset:29696
    ds_read_b64_tr_b16 v[222:223], v224 offset:29952
    s_waitcnt lgkmcnt(8)
    v_mfma_f32_32x32x16_bf16 v[128:143], v[192:195], v[16:19], 0
    v_mfma_f32_32x32x16_bf16 v[144:159], v[196:199], v[16:19], 0
    v_mfma_f32_32x32x16_bf16 v[160:175], v[200:203], v[16:19], 0
    v_mfma_f32_32x32x16_bf16 v[176:191], v[204:207], v[16:19], 0
    ds_read_b64_tr_b16 v[192:193], v7 offset:2048
    ds_read_b64_tr_b16 v[194:195], v7 offset:2304
    ds_read_b64_tr_b16 v[196:197], v7 offset:30720
    ds_read_b64_tr_b16 v[198:199], v7 offset:30976
    ds_read_b64_tr_b16 v[200:201], v224 offset:2048
    ds_read_b64_tr_b16 v[202:203], v224 offset:2304
    ds_read_b64_tr_b16 v[204:205], v224 offset:30720
    ds_read_b64_tr_b16 v[206:207], v224 offset:30976
    s_waitcnt lgkmcnt(8)
    v_mfma_f32_32x32x16_bf16 v[128:143], v[208:211], v[20:23], v[128:143]
    v_mfma_f32_32x32x16_bf16 v[144:159], v[212:215], v[20:23], v[144:159]
    v_mfma_f32_32x32x16_bf16 v[160:175], v[216:219], v[20:23], v[160:175]
    v_mfma_f32_32x32x16_bf16 v[176:191], v[220:223], v[20:23], v[176:191]
    ds_read_b64_tr_b16 v[208:209], v7 offset:3072
    ds_read_b64_tr_b16 v[210:211], v7 offset:3328
    ds_read_b64_tr_b16 v[212:213], v7 offset:31744
    ds_read_b64_tr_b16 v[214:215], v7 offset:32000
    ds_read_b64_tr_b16 v[216:217], v224 offset:3072
    ds_read_b64_tr_b16 v[218:219], v224 offset:3328
    ds_read_b64_tr_b16 v[220:221], v224 offset:31744
    ds_read_b64_tr_b16 v[222:223], v224 offset:32000
    s_waitcnt lgkmcnt(8)
    v_mfma_f32_32x32x16_bf16 v[128:143], v[192:195], v[24:27], v[128:143]
    v_mfma_f32_32x32x16_bf16 v[144:159], v[196:199], v[24:27], v[144:159]
    v_mfma_f32_32x32x16_bf16 v[160:175], v[200:203], v[24:27], v[160:175]
    v_mfma_f32_32x32x16_bf16 v[176:191], v[204:207], v[24:27], v[176:191]
    ds_read_b64_tr_b16 v[192:193], v7 offset:4096
    ds_read_b64_tr_b16 v[194:195], v7 offset:4352
    ds_read_b64_tr_b16 v[196:197], v7 offset:32768
    ds_read_b64_tr_b16 v[198:199], v7 offset:33024
    ds_read_b64_tr_b16 v[200:201], v224 offset:4096
    ds_read_b64_tr_b16 v[202:203], v224 offset:4352
    ds_read_b64_tr_b16 v[204:205], v224 offset:32768
    ds_read_b64_tr_b16 v[206:207], v224 offset:33024
    s_waitcnt lgkmcnt(8)
    v_mfma_f32_32x32x16_bf16 v[128:143], v[208:211], v[28:31], v[128:143]
    v_mfma_f32_32x32x16_bf16 v[144:159], v[212:215], v[28:31], v[144:159]
    v_mfma_f32_32x32x16_bf16 v[160:175], v[216:219], v[28:31], v[160:175]
    v_mfma_f32_32x32x16_bf16 v[176:191], v[220:223], v[28:31], v[176:191]
    ds_read_b64_tr_b16 v[208:209], v7 offset:5120
    ds_read_b64_tr_b16 v[210:211], v7 offset:5376
    ds_read_b64_tr_b16 v[212:213], v7 offset:33792
    ds_read_b64_tr_b16 v[214:215], v7 offset:34048
    ds_read_b64_tr_b16 v[216:217], v224 offset:5120
    ds_read_b64_tr_b16 v[218:219], v224 offset:5376
    ds_read_b64_tr_b16 v[220:221], v224 offset:33792
    ds_read_b64_tr_b16 v[222:223], v224 offset:34048
    s_waitcnt lgkmcnt(8)
    v_mfma_f32_32x32x16_bf16 v[128:143], v[192:195], v[32:35], v[128:143]
    v_mfma_f32_32x32x16_bf16 v[144:159], v[196:199], v[32:35], v[144:159]
    v_mfma_f32_32x32x16_bf16 v[160:175], v[200:203], v[32:35], v[160:175]
    v_mfma_f32_32x32x16_bf16 v[176:191], v[204:207], v[32:35], v[176:191]
    ds_read_b64_tr_b16 v[192:193], v7 offset:6144
    ds_read_b64_tr_b16 v[194:195], v7 offset:6400
    ds_read_b64_tr_b16 v[196:197], v7 offset:34816
    ds_read_b64_tr_b16 v[198:199], v7 offset:35072
    ds_read_b64_tr_b16 v[200:201], v224 offset:6144
    ds_read_b64_tr_b16 v[202:203], v224 offset:6400
    ds_read_b64_tr_b16 v[204:205], v224 offset:34816
    ds_read_b64_tr_b16 v[206:207], v224 offset:35072
    s_waitcnt lgkmcnt(8)
    v_mfma_f32_32x32x16_bf16 v[128:143], v[208:211], v[36:39], v[128:143]
    v_mfma_f32_32x32x16_bf16 v[144:159], v[212:215], v[36:39], v[144:159]
    v_mfma_f32_32x32x16_bf16 v[160:175], v[216:219], v[36:39], v[160:175]
    v_mfma_f32_32x32x16_bf16 v[176:191], v[220:223], v[36:39], v[176:191]
    ds_read_b64_tr_b16 v[208:209], v7 offset:7168
    ds_read_b64_tr_b16 v[210:211], v7 offset:7424
    ds_read_b64_tr_b16 v[212:213], v7 offset:35840
    ds_read_b64_tr_b16 v[214:215], v7 offset:36096
    ds_read_b64_tr_b16 v[216:217], v224 offset:7168
    ds_read_b64_tr_b16 v[218:219], v224 offset:7424
    ds_read_b64_tr_b16 v[220:221], v224 offset:35840
    ds_read_b64_tr_b16 v[222:223], v224 offset:36096
    s_waitcnt lgkmcnt(8)
    v_mfma_f32_32x32x16_bf16 v[128:143], v[192:195], v[40:43], v[128:143]
    v_mfma_f32_32x32x16_bf16 v[144:159], v[196:199], v[40:43], v[144:159]
    v_mfma_f32_32x32x16_bf16 v[160:175], v[200:203], v[40:43], v[160:175]
    v_mfma_f32_32x32x16_bf16 v[176:191], v[204:207], v[40:43], v[176:191]
    ds_read_b64_tr_b16 v[192:193], v7 offset:8192
    ds_read_b64_tr_b16 v[194:195], v7 offset:8448
    ds_read_b64_tr_b16 v[196:197], v7 offset:36864
    ds_read_b64_tr_b16 v[198:199], v7 offset:37120
    ds_read_b64_tr_b16 v[200:201], v224 offset:8192
    ds_read_b64_tr_b16 v[202:203], v224 offset:8448
    ds_read_b64_tr_b16 v[204:205], v224 offset:36864
    ds_read_b64_tr_b16 v[206:207], v224 offset:37120
    s_waitcnt lgkmcnt(8)
    v_mfma_f32_32x32x16_bf16 v[128:143], v[208:211], v[44:47], v[128:143]
    v_mfma_f32_32x32x16_bf16 v[144:159], v[212:215], v[44:47], v[144:159]
    v_mfma_f32_32x32x16_bf16 v[160:175], v[216:219], v[44:47], v[160:175]
    v_mfma_f32_32x32x16_bf16 v[176:191], v[220:223], v[44:47], v[176:191]
    ds_read_b64_tr_b16 v[208:209], v7 offset:9216
    ds_read_b64_tr_b16 v[210:211], v7 offset:9472
    ds_read_b64_tr_b16 v[212:213], v7 offset:37888
    ds_read_b64_tr_b16 v[214:215], v7 offset:38144
    ds_read_b64_tr_b16 v[216:217], v224 offset:9216
    ds_read_b64_tr_b16 v[218:219], v224 offset:9472
    ds_read_b64_tr_b16 v[220:221], v224 offset:37888
    ds_read_b64_tr_b16 v[222:223], v224 offset:38144
    s_waitcnt lgkmcnt(8)
    v_mfma_f32_32x32x16_bf16 v[128:143], v[192:195], v[48:51], v[128:143]
    v_mfma_f32_32x32x16_bf16 v[144:159], v[196:199], v[48:51], v[144:159]
    v_mfma_f32_32x32x16_bf16 v[160:175], v[200:203], v[48:51], v[160:175]
    v_mfma_f32_32x32x16_bf16 v[176:191], v[204:207], v[48:51], v[176:191]
    ds_read_b64_tr_b16 v[192:193], v7 offset:10240
    ds_read_b64_tr_b16 v[194:195], v7 offset:10496
    ds_read_b64_tr_b16 v[196:197], v7 offset:38912
    ds_read_b64_tr_b16 v[198:199], v7 offset:39168
    ds_read_b64_tr_b16 v[200:201], v224 offset:10240
    ds_read_b64_tr_b16 v[202:203], v224 offset:10496
    ds_read_b64_tr_b16 v[204:205], v224 offset:38912
    ds_read_b64_tr_b16 v[206:207], v224 offset:39168
    s_waitcnt lgkmcnt(8)
    v_mfma_f32_32x32x16_bf16 v[128:143], v[208:211], v[52:55], v[128:143]
    v_mfma_f32_32x32x16_bf16 v[144:159], v[212:215], v[52:55], v[144:159]
    v_mfma_f32_32x32x16_bf16 v[160:175], v[216:219], v[52:55], v[160:175]
    v_mfma_f32_32x32x16_bf16 v[176:191], v[220:223], v[52:55], v[176:191]
    ds_read_b64_tr_b16 v[208:209], v7 offset:11264
    ds_read_b64_tr_b16 v[210:211], v7 offset:11520
    ds_read_b64_tr_b16 v[212:213], v7 offset:39936
    ds_read_b64_tr_b16 v[214:215], v7 offset:40192
    ds_read_b64_tr_b16 v[216:217], v224 offset:11264
    ds_read_b64_tr_b16 v[218:219], v224 offset:11520
    ds_read_b64_tr_b16 v[220:221], v224 offset:39936
    ds_read_b64_tr_b16 v[222:223], v224 offset:40192
    s_waitcnt lgkmcnt(8)
    v_mfma_f32_32x32x16_bf16 v[128:143], v[192:195], v[56:59], v[128:143]
    v_mfma_f32_32x32x16_bf16 v[144:159], v[196:199], v[56:59], v[144:159]
    v_mfma_f32_32x32x16_bf16 v[160:175], v[200:203], v[56:59], v[160:175]
    v_mfma_f32_32x32x16_bf16 v[176:191], v[204:207], v[56:59], v[176:191]
    ds_read_b64_tr_b16 v[192:193], v7 offset:12288
    ds_read_b64_tr_b16 v[194:195], v7 offset:12544
    ds_read_b64_tr_b16 v[196:197], v7 offset:40960
    ds_read_b64_tr_b16 v[198:199], v7 offset:41216
    ds_read_b64_tr_b16 v[200:201], v224 offset:12288
    ds_read_b64_tr_b16 v[202:203], v224 offset:12544
    ds_read_b64_tr_b16 v[204:205], v224 offset:40960
    ds_read_b64_tr_b16 v[206:207], v224 offset:41216
    s_waitcnt lgkmcnt(8)
    v_mfma_f32_32x32x16_bf16 v[128:143], v[208:211], v[60:63], v[128:143]
    v_mfma_f32_32x32x16_bf16 v[144:159], v[212:215], v[60:63], v[144:159]
    v_mfma_f32_32x32x16_bf16 v[160:175], v[216:219], v[60:63], v[160:175]
    v_mfma_f32_32x32x16_bf16 v[176:191], v[220:223], v[60:63], v[176:191]
    ds_read_b64_tr_b16 v[208:209], v7 offset:13312
    ds_read_b64_tr_b16 v[210:211], v7 offset:13568
    ds_read_b64_tr_b16 v[212:213], v7 offset:41984
    ds_read_b64_tr_b16 v[214:215], v7 offset:42240
    ds_read_b64_tr_b16 v[216:217], v224 offset:13312
    ds_read_b64_tr_b16 v[218:219], v224 offset:13568
    ds_read_b64_tr_b16 v[220:221], v224 offset:41984
    ds_read_b64_tr_b16 v[222:223], v224 offset:42240
    s_waitcnt lgkmcnt(8)
    v_mfma_f32_32x32x16_bf16 v[128:143], v[192:195], v[64:67], v[128:143]
    v_mfma_f32_32x32x16_bf16 v[144:159], v[196:199], v[64:67], v[144:159]
    v_mfma_f32_32x32x16_bf16 v[160:175], v[200:203], v[64:67], v[160:175]
    v_mfma_f32_32x32x16_bf16 v[176:191], v[204:207], v[64:67], v[176:191]
    ds_read_b64_tr_b16 v[192:193], v7 offset:14336
    ds_read_b64_tr_b16 v[194:195], v7 offset:14592
    ds_read_b64_tr_b16 v[196:197], v7 offset:43008
    ds_read_b64_tr_b16 v[198:199], v7 offset:43264
    ds_read_b64_tr_b16 v[200:201], v224 offset:14336
    ds_read_b64_tr_b16 v[202:203], v224 offset:14592
    ds_read_b64_tr_b16 v[204:205], v224 offset:43008
    ds_read_b64_tr_b16 v[206:207], v224 offset:43264
    s_waitcnt lgkmcnt(8)
    v_mfma_f32_32x32x16_bf16 v[128:143], v[208:211], v[68:71], v[128:143]
    v_mfma_f32_32x32x16_bf16 v[144:159], v[212:215], v[68:71], v[144:159]
    v_mfma_f32_32x32x16_bf16 v[160:175], v[216:219], v[68:71], v[160:175]
    v_mfma_f32_32x32x16_bf16 v[176:191], v[220:223], v[68:71], v[176:191]
    ds_read_b64_tr_b16 v[208:209], v7 offset:15360
    ds_read_b64_tr_b16 v[210:211], v7 offset:15616
    ds_read_b64_tr_b16 v[212:213], v7 offset:44032
    ds_read_b64_tr_b16 v[214:215], v7 offset:44288
    ds_read_b64_tr_b16 v[216:217], v224 offset:15360
    ds_read_b64_tr_b16 v[218:219], v224 offset:15616
    ds_read_b64_tr_b16 v[220:221], v224 offset:44032
    ds_read_b64_tr_b16 v[222:223], v224 offset:44288
    s_waitcnt lgkmcnt(8)
    v_mfma_f32_32x32x16_bf16 v[128:143], v[192:195], v[72:75], v[128:143]
    v_mfma_f32_32x32x16_bf16 v[144:159], v[196:199], v[72:75], v[144:159]
    v_mfma_f32_32x32x16_bf16 v[160:175], v[200:203], v[72:75], v[160:175]
    v_mfma_f32_32x32x16_bf16 v[176:191], v[204:207], v[72:75], v[176:191]
    ds_read_b64_tr_b16 v[192:193], v7 offset:16384
    ds_read_b64_tr_b16 v[194:195], v7 offset:16640
    ds_read_b64_tr_b16 v[196:197], v7 offset:45056
    ds_read_b64_tr_b16 v[198:199], v7 offset:45312
    ds_read_b64_tr_b16 v[200:201], v224 offset:16384
    ds_read_b64_tr_b16 v[202:203], v224 offset:16640
    ds_read_b64_tr_b16 v[204:205], v224 offset:45056
    ds_read_b64_tr_b16 v[206:207], v224 offset:45312
    s_waitcnt lgkmcnt(8)
    v_mfma_f32_32x32x16_bf16 v[128:143], v[208:211], v[76:79], v[128:143]
    v_mfma_f32_32x32x16_bf16 v[144:159], v[212:215], v[76:79], v[144:159]
    v_mfma_f32_32x32x16_bf16 v[160:175], v[216:219], v[76:79], v[160:175]
    v_mfma_f32_32x32x16_bf16 v[176:191], v[220:223], v[76:79], v[176:191]
    ds_read_b64_tr_b16 v[208:209], v7 offset:17408
    ds_read_b64_tr_b16 v[210:211], v7 offset:17664
    ds_read_b64_tr_b16 v[212:213], v7 offset:46080
    ds_read_b64_tr_b16 v[214:215], v7 offset:46336
    ds_read_b64_tr_b16 v[216:217], v224 offset:17408
    ds_read_b64_tr_b16 v[218:219], v224 offset:17664
    ds_read_b64_tr_b16 v[220:221], v224 offset:46080
    ds_read_b64_tr_b16 v[222:223], v224 offset:46336
    s_waitcnt lgkmcnt(8)
    v_mfma_f32_32x32x16_bf16 v[128:143], v[192:195], v[80:83], v[128:143]
    v_mfma_f32_32x32x16_bf16 v[144:159], v[196:199], v[80:83], v[144:159]
    v_mfma_f32_32x32x16_bf16 v[160:175], v[200:203], v[80:83], v[160:175]
    v_mfma_f32_32x32x16_bf16 v[176:191], v[204:207], v[80:83], v[176:191]
    ds_read_b64_tr_b16 v[192:193], v7 offset:18432
    ds_read_b64_tr_b16 v[194:195], v7 offset:18688
    ds_read_b64_tr_b16 v[196:197], v7 offset:47104
    ds_read_b64_tr_b16 v[198:199], v7 offset:47360
    ds_read_b64_tr_b16 v[200:201], v224 offset:18432
    ds_read_b64_tr_b16 v[202:203], v224 offset:18688
    ds_read_b64_tr_b16 v[204:205], v224 offset:47104
    ds_read_b64_tr_b16 v[206:207], v224 offset:47360
    s_waitcnt lgkmcnt(8)
    v_mfma_f32_32x32x16_bf16 v[128:143], v[208:211], v[84:87], v[128:143]
    v_mfma_f32_32x32x16_bf16 v[144:159], v[212:215], v[84:87], v[144:159]
    v_mfma_f32_32x32x16_bf16 v[160:175], v[216:219], v[84:87], v[160:175]
    v_mfma_f32_32x32x16_bf16 v[176:191], v[220:223], v[84:87], v[176:191]
    ds_read_b64_tr_b16 v[208:209], v7 offset:19456
    ds_read_b64_tr_b16 v[210:211], v7 offset:19712
    ds_read_b64_tr_b16 v[212:213], v7 offset:48128
    ds_read_b64_tr_b16 v[214:215], v7 offset:48384
    ds_read_b64_tr_b16 v[216:217], v224 offset:19456
    ds_read_b64_tr_b16 v[218:219], v224 offset:19712
    ds_read_b64_tr_b16 v[220:221], v224 offset:48128
    ds_read_b64_tr_b16 v[222:223], v224 offset:48384
    s_waitcnt lgkmcnt(8)
    v_mfma_f32_32x32x16_bf16 v[128:143], v[192:195], v[88:91], v[128:143]
    v_mfma_f32_32x32x16_bf16 v[144:159], v[196:199], v[88:91], v[144:159]
    v_mfma_f32_32x32x16_bf16 v[160:175], v[200:203], v[88:91], v[160:175]
    v_mfma_f32_32x32x16_bf16 v[176:191], v[204:207], v[88:91], v[176:191]
    ds_read_b64_tr_b16 v[192:193], v7 offset:20480
    ds_read_b64_tr_b16 v[194:195], v7 offset:20736
    ds_read_b64_tr_b16 v[196:197], v7 offset:49152
    ds_read_b64_tr_b16 v[198:199], v7 offset:49408
    ds_read_b64_tr_b16 v[200:201], v224 offset:20480
    ds_read_b64_tr_b16 v[202:203], v224 offset:20736
    ds_read_b64_tr_b16 v[204:205], v224 offset:49152
    ds_read_b64_tr_b16 v[206:207], v224 offset:49408
    s_waitcnt lgkmcnt(8)
    v_mfma_f32_32x32x16_bf16 v[128:143], v[208:211], v[92:95], v[128:143]
    v_mfma_f32_32x32x16_bf16 v[144:159], v[212:215], v[92:95], v[144:159]
    v_mfma_f32_32x32x16_bf16 v[160:175], v[216:219], v[92:95], v[160:175]
    v_mfma_f32_32x32x16_bf16 v[176:191], v[220:223], v[92:95], v[176:191]
    ds_read_b64_tr_b16 v[208:209], v7 offset:21504
    ds_read_b64_tr_b16 v[210:211], v7 offset:21760
    ds_read_b64_tr_b16 v[212:213], v7 offset:50176
    ds_read_b64_tr_b16 v[214:215], v7 offset:50432
    ds_read_b64_tr_b16 v[216:217], v224 offset:21504
    ds_read_b64_tr_b16 v[218:219], v224 offset:21760
    ds_read_b64_tr_b16 v[220:221], v224 offset:50176
    ds_read_b64_tr_b16 v[222:223], v224 offset:50432
    s_waitcnt lgkmcnt(8)
    v_mfma_f32_32x32x16_bf16 v[128:143], v[192:195], v[96:99], v[128:143]
    v_mfma_f32_32x32x16_bf16 v[144:159], v[196:199], v[96:99], v[144:159]
    v_mfma_f32_32x32x16_bf16 v[160:175], v[200:203], v[96:99], v[160:175]
    v_mfma_f32_32x32x16_bf16 v[176:191], v[204:207], v[96:99], v[176:191]
    ds_read_b64_tr_b16 v[192:193], v7 offset:22528
    ds_read_b64_tr_b16 v[194:195], v7 offset:22784
    ds_read_b64_tr_b16 v[196:197], v7 offset:51200
    ds_read_b64_tr_b16 v[198:199], v7 offset:51456
    ds_read_b64_tr_b16 v[200:201], v224 offset:22528
    ds_read_b64_tr_b16 v[202:203], v224 offset:22784
    ds_read_b64_tr_b16 v[204:205], v224 offset:51200
    ds_read_b64_tr_b16 v[206:207], v224 offset:51456
    s_waitcnt lgkmcnt(8)
    v_mfma_f32_32x32x16_bf16 v[128:143], v[208:211], v[100:103], v[128:143]
    v_mfma_f32_32x32x16_bf16 v[144:159], v[212:215], v[100:103], v[144:159]
    v_mfma_f32_32x32x16_bf16 v[160:175], v[216:219], v[100:103], v[160:175]
    v_mfma_f32_32x32x16_bf16 v[176:191], v[220:223], v[100:103], v[176:191]
    ds_read_b64_tr_b16 v[208:209], v7 offset:23552
    ds_read_b64_tr_b16 v[210:211], v7 offset:23808
    ds_read_b64_tr_b16 v[212:213], v7 offset:52224
    ds_read_b64_tr_b16 v[214:215], v7 offset:52480
    ds_read_b64_tr_b16 v[216:217], v224 offset:23552
    ds_read_b64_tr_b16 v[218:219], v224 offset:23808
    ds_read_b64_tr_b16 v[220:221], v224 offset:52224
    ds_read_b64_tr_b16 v[222:223], v224 offset:52480
    s_waitcnt lgkmcnt(8)
    v_mfma_f32_32x32x16_bf16 v[128:143], v[192:195], v[104:107], v[128:143]
    v_mfma_f32_32x32x16_bf16 v[144:159], v[196:199], v[104:107], v[144:159]
    v_mfma_f32_32x32x16_bf16 v[160:175], v[200:203], v[104:107], v[160:175]
    v_mfma_f32_32x32x16_bf16 v[176:191], v[204:207], v[104:107], v[176:191]
    ds_read_b64_tr_b16 v[192:193], v7 offset:24576
    ds_read_b64_tr_b16 v[194:195], v7 offset:24832
    ds_read_b64_tr_b16 v[196:197], v7 offset:53248
    ds_read_b64_tr_b16 v[198:199], v7 offset:53504
    ds_read_b64_tr_b16 v[200:201], v224 offset:24576
    ds_read_b64_tr_b16 v[202:203], v224 offset:24832
    ds_read_b64_tr_b16 v[204:205], v224 offset:53248
    ds_read_b64_tr_b16 v[206:207], v224 offset:53504
    s_waitcnt lgkmcnt(8)
    v_mfma_f32_32x32x16_bf16 v[128:143], v[208:211], v[108:111], v[128:143]
    v_mfma_f32_32x32x16_bf16 v[144:159], v[212:215], v[108:111], v[144:159]
    v_mfma_f32_32x32x16_bf16 v[160:175], v[216:219], v[108:111], v[160:175]
    v_mfma_f32_32x32x16_bf16 v[176:191], v[220:223], v[108:111], v[176:191]
    ds_read_b64_tr_b16 v[208:209], v7 offset:25600
    ds_read_b64_tr_b16 v[210:211], v7 offset:25856
    ds_read_b64_tr_b16 v[212:213], v7 offset:54272
    ds_read_b64_tr_b16 v[214:215], v7 offset:54528
    ds_read_b64_tr_b16 v[216:217], v224 offset:25600
    ds_read_b64_tr_b16 v[218:219], v224 offset:25856
    ds_read_b64_tr_b16 v[220:221], v224 offset:54272
    ds_read_b64_tr_b16 v[222:223], v224 offset:54528
    s_waitcnt lgkmcnt(8)
    v_mfma_f32_32x32x16_bf16 v[128:143], v[192:195], v[112:115], v[128:143]
    v_mfma_f32_32x32x16_bf16 v[144:159], v[196:199], v[112:115], v[144:159]
    v_mfma_f32_32x32x16_bf16 v[160:175], v[200:203], v[112:115], v[160:175]
    v_mfma_f32_32x32x16_bf16 v[176:191], v[204:207], v[112:115], v[176:191]
    ds_read_b64_tr_b16 v[192:193], v7 offset:26624
    ds_read_b64_tr_b16 v[194:195], v7 offset:26880
    ds_read_b64_tr_b16 v[196:197], v7 offset:55296
    ds_read_b64_tr_b16 v[198:199], v7 offset:55552
    ds_read_b64_tr_b16 v[200:201], v224 offset:26624
    ds_read_b64_tr_b16 v[202:203], v224 offset:26880
    ds_read_b64_tr_b16 v[204:205], v224 offset:55296
    ds_read_b64_tr_b16 v[206:207], v224 offset:55552
    s_waitcnt lgkmcnt(8)
    v_mfma_f32_32x32x16_bf16 v[128:143], v[208:211], v[116:119], v[128:143]
    v_mfma_f32_32x32x16_bf16 v[144:159], v[212:215], v[116:119], v[144:159]
    v_mfma_f32_32x32x16_bf16 v[160:175], v[216:219], v[116:119], v[160:175]
    v_mfma_f32_32x32x16_bf16 v[176:191], v[220:223], v[116:119], v[176:191]
    ds_read_b64_tr_b16 v[208:209], v7 offset:27648
    ds_read_b64_tr_b16 v[210:211], v7 offset:27904
    ds_read_b64_tr_b16 v[212:213], v7 offset:56320
    ds_read_b64_tr_b16 v[214:215], v7 offset:56576
    ds_read_b64_tr_b16 v[216:217], v224 offset:27648
    ds_read_b64_tr_b16 v[218:219], v224 offset:27904
    ds_read_b64_tr_b16 v[220:221], v224 offset:56320
    ds_read_b64_tr_b16 v[222:223], v224 offset:56576
    s_waitcnt lgkmcnt(8)
    v_mfma_f32_32x32x16_bf16 v[128:143], v[192:195], v[120:123], v[128:143]
    v_mfma_f32_32x32x16_bf16 v[144:159], v[196:199], v[120:123], v[144:159]
    v_mfma_f32_32x32x16_bf16 v[160:175], v[200:203], v[120:123], v[160:175]
    v_mfma_f32_32x32x16_bf16 v[176:191], v[204:207], v[120:123], v[176:191]
    s_waitcnt lgkmcnt(0)
    v_mfma_f32_32x32x16_bf16 v[128:143], v[208:211], v[124:127], v[128:143]
    v_mfma_f32_32x32x16_bf16 v[144:159], v[212:215], v[124:127], v[144:159]
    v_mfma_f32_32x32x16_bf16 v[160:175], v[216:219], v[124:127], v[160:175]
    v_mfma_f32_32x32x16_bf16 v[176:191], v[220:223], v[124:127], v[176:191]
    s_nop 15
    s_nop 3
    s_movk_i32 s35, 1792
    v_mul_lo_u32 v13, v5, s35
    v_lshl_add_u32 v13, v4, 3, v13
    v_add_u32 v13, 2360064, v13
    v_cvt_pk_bf16_f32 v128, v128, v129
    v_cvt_pk_bf16_f32 v129, v130, v131
    buffer_store_dwordx2 v[128:129], v13, s[16:19], 0 offen offset:0
    v_cvt_pk_bf16_f32 v132, v132, v133
    v_cvt_pk_bf16_f32 v133, v134, v135
    buffer_store_dwordx2 v[132:133], v13, s[16:19], 0 offen offset:16
    v_cvt_pk_bf16_f32 v136, v136, v137
    v_cvt_pk_bf16_f32 v137, v138, v139
    buffer_store_dwordx2 v[136:137], v13, s[16:19], 0 offen offset:32
    v_cvt_pk_bf16_f32 v140, v140, v141
    v_cvt_pk_bf16_f32 v141, v142, v143
    buffer_store_dwordx2 v[140:141], v13, s[16:19], 0 offen offset:48
    s_movk_i32 s35, 1792
    v_mul_lo_u32 v13, v5, s35
    v_lshl_add_u32 v13, v4, 3, v13
    v_add_u32 v13, 2360128, v13
    v_cvt_pk_bf16_f32 v144, v144, v145
    v_cvt_pk_bf16_f32 v145, v146, v147
    buffer_store_dwordx2 v[144:145], v13, s[16:19], 0 offen offset:0
    v_cvt_pk_bf16_f32 v148, v148, v149
    v_cvt_pk_bf16_f32 v149, v150, v151
    buffer_store_dwordx2 v[148:149], v13, s[16:19], 0 offen offset:16
    v_cvt_pk_bf16_f32 v152, v152, v153
    v_cvt_pk_bf16_f32 v153, v154, v155
    buffer_store_dwordx2 v[152:153], v13, s[16:19], 0 offen offset:32
    v_cvt_pk_bf16_f32 v156, v156, v157
    v_cvt_pk_bf16_f32 v157, v158, v159
    buffer_store_dwordx2 v[156:157], v13, s[16:19], 0 offen offset:48
    s_movk_i32 s35, 1792
    v_mul_lo_u32 v13, v5, s35
    v_lshl_add_u32 v13, v4, 3, v13
    v_add_u32 v13, 2360192, v13
    v_cvt_pk_bf16_f32 v160, v160, v161
    v_cvt_pk_bf16_f32 v161, v162, v163
    buffer_store_dwordx2 v[160:161], v13, s[16:19], 0 offen offset:0
    v_cvt_pk_bf16_f32 v164, v164, v165
    v_cvt_pk_bf16_f32 v165, v166, v167
    buffer_store_dwordx2 v[164:165], v13, s[16:19], 0 offen offset:16
    v_cvt_pk_bf16_f32 v168, v168, v169
    v_cvt_pk_bf16_f32 v169, v170, v171
    buffer_store_dwordx2 v[168:169], v13, s[16:19], 0 offen offset:32
    v_cvt_pk_bf16_f32 v172, v172, v173
    v_cvt_pk_bf16_f32 v173, v174, v175
    buffer_store_dwordx2 v[172:173], v13, s[16:19], 0 offen offset:48
    s_movk_i32 s35, 1792
    v_mul_lo_u32 v13, v5, s35
    v_lshl_add_u32 v13, v4, 3, v13
    v_add_u32 v13, 2360256, v13
    v_cvt_pk_bf16_f32 v176, v176, v177
    v_cvt_pk_bf16_f32 v177, v178, v179
    buffer_store_dwordx2 v[176:177], v13, s[16:19], 0 offen offset:0
    v_cvt_pk_bf16_f32 v180, v180, v181
    v_cvt_pk_bf16_f32 v181, v182, v183
    buffer_store_dwordx2 v[180:181], v13, s[16:19], 0 offen offset:16
    v_cvt_pk_bf16_f32 v184, v184, v185
    v_cvt_pk_bf16_f32 v185, v186, v187
    buffer_store_dwordx2 v[184:185], v13, s[16:19], 0 offen offset:32
    v_cvt_pk_bf16_f32 v188, v188, v189
    v_cvt_pk_bf16_f32 v189, v190, v191
    buffer_store_dwordx2 v[188:189], v13, s[16:19], 0 offen offset:48
    s_endpgm
K1_v8:
    s_mov_b32 s12, s44
    s_and_b32 s13, s45, 0xffff
    s_mov_b32 s14, 1204224
    s_mov_b32 s15, 0x00020000
    s_movk_i32 s35, 2688
    v_lshrrev_b32 v227, 2, v0
    v_mul_lo_u32 v227, v227, s35
    v_and_b32 v14, 3, v0
    v_lshl_add_u32 v227, v14, 4, v227
    s_mov_b32 s35, 1024
    buffer_load_dwordx4 v[128:131], v227, s[12:15], s35 offen
    s_mov_b32 s35, 173056
    buffer_load_dwordx4 v[132:135], v227, s[12:15], s35 offen
    s_mov_b32 s35, 345088
    buffer_load_dwordx4 v[136:139], v227, s[12:15], s35 offen
    s_mov_b32 s35, 517120
    buffer_load_dwordx4 v[140:143], v227, s[12:15], s35 offen
    s_mov_b32 s35, 689152
    buffer_load_dwordx4 v[144:147], v227, s[12:15], s35 offen
    s_mov_b32 s35, 861184
    buffer_load_dwordx4 v[148:151], v227, s[12:15], s35 offen
    s_mov_b32 s35, 1033216
    buffer_load_dwordx4 v[152:155], v227, s[12:15], s35 offen
    s_mov_b32 s12, s44
    s_and_b32 s13, s45, 0xffff
    s_mov_b32 s14, 1204224
    s_mov_b32 s15, 0x00020000
    s_movk_i32 s35, 2688
    v_lshrrev_b32 v227, 2, v0
    v_mul_lo_u32 v227, v227, s35
    v_and_b32 v14, 3, v0
    v_lshl_add_u32 v227, v14, 4, v227
    s_mov_b32 s35, 1088
    buffer_load_dwordx4 v[156:159], v227, s[12:15], s35 offen
    s_mov_b32 s35, 173120
    buffer_load_dwordx4 v[160:163], v227, s[12:15], s35 offen
    s_mov_b32 s35, 345152
    buffer_load_dwordx4 v[164:167], v227, s[12:15], s35 offen
    s_mov_b32 s35, 517184
    buffer_load_dwordx4 v[168:171], v227, s[12:15], s35 offen
    s_mov_b32 s35, 689216
    buffer_load_dwordx4 v[172:175], v227, s[12:15], s35 offen
    s_mov_b32 s35, 861248
    buffer_load_dwordx4 v[176:179], v227, s[12:15], s35 offen
    s_mov_b32 s35, 1033280
    buffer_load_dwordx4 v[180:183], v227, s[12:15], s35 offen
    s_mov_b32 s54, 0x4924925
    v_add_u32 v13, 0, v2
    v_mul_hi_u32 v14, v13, s54
    v_lshlrev_b32 v13, 4, v13
    v_lshl_add_u32 v13, v14, 4, v13
    v_add_u32 v13, s53, v13
    s_waitcnt vmcnt(41)
    ds_write_b128 v13, v[16:19]
    v_add_u32 v13, 64, v2
    v_mul_hi_u32 v14, v13, s54
    v_lshlrev_b32 v13, 4, v13
    v_lshl_add_u32 v13, v14, 4, v13
    v_add_u32 v13, s53, v13
    s_waitcnt vmcnt(40)
    ds_write_b128 v13, v[20:23]
    v_add_u32 v13, 128, v2
    v_mul_hi_u32 v14, v13, s54
    v_lshlrev_b32 v13, 4, v13
    v_lshl_add_u32 v13, v14, 4, v13
    v_add_u32 v13, s53, v13
    s_waitcnt vmcnt(39)
    ds_write_b128 v13, v[24:27]
    v_add_u32 v13, 192, v2
    v_mul_hi_u32 v14, v13, s54
    v_lshlrev_b32 v13, 4, v13
    v_lshl_add_u32 v13, v14, 4, v13
    v_add_u32 v13, s53, v13
    s_waitcnt vmcnt(38)
    ds_write_b128 v13, v[28:31]
    v_add_u32 v13, 256, v2
    v_mul_hi_u32 v14, v13, s54
    v_lshlrev_b32 v13, 4, v13
    v_lshl_add_u32 v13, v14, 4, v13
    v_add_u32 v13, s53, v13
    s_waitcnt vmcnt(37)
    ds_write_b128 v13, v[32:35]
    v_add_u32 v13, 320, v2
    v_mul_hi_u32 v14, v13, s54
    v_lshlrev_b32 v13, 4, v13
    v_lshl_add_u32 v13, v14, 4, v13
    v_add_u32 v13, s53, v13
    s_waitcnt vmcnt(36)
    ds_write_b128 v13, v[36:39]
    v_add_u32 v13, 384, v2
    v_mul_hi_u32 v14, v13, s54
    v_lshlrev_b32 v13, 4, v13
    v_lshl_add_u32 v13, v14, 4, v13
    v_add_u32 v13, s53, v13
    s_waitcnt vmcnt(35)
    ds_write_b128 v13, v[40:43]
    v_add_u32 v13, 448, v2
    v_mul_hi_u32 v14, v13, s54
    v_lshlrev_b32 v13, 4, v13
    v_lshl_add_u32 v13, v14, 4, v13
    v_add_u32 v13, s53, v13
    s_waitcnt vmcnt(34)
    ds_write_b128 v13, v[44:47]
    v_add_u32 v13, 512, v2
    v_mul_hi_u32 v14, v13, s54
    v_lshlrev_b32 v13, 4, v13
    v_lshl_add_u32 v13, v14, 4, v13
    v_add_u32 v13, s53, v13
    s_waitcnt vmcnt(33)
    ds_write_b128 v13, v[48:51]
    v_add_u32 v13, 576, v2
    v_mul_hi_u32 v14, v13, s54
    v_lshlrev_b32 v13, 4, v13
    v_lshl_add_u32 v13, v14, 4, v13
    v_add_u32 v13, s53, v13
    s_waitcnt vmcnt(32)
    ds_write_b128 v13, v[52:55]
    v_add_u32 v13, 640, v2
    v_mul_hi_u32 v14, v13, s54
    v_lshlrev_b32 v13, 4, v13
    v_lshl_add_u32 v13, v14, 4, v13
    v_add_u32 v13, s53, v13
    s_waitcnt vmcnt(31)
    ds_write_b128 v13, v[56:59]
    v_add_u32 v13, 704, v2
    v_mul_hi_u32 v14, v13, s54
    v_lshlrev_b32 v13, 4, v13
    v_lshl_add_u32 v13, v14, 4, v13
    v_add_u32 v13, s53, v13
    s_waitcnt vmcnt(30)
    ds_write_b128 v13, v[60:63]
    v_add_u32 v13, 768, v2
    v_mul_hi_u32 v14, v13, s54
    v_lshlrev_b32 v13, 4, v13
    v_lshl_add_u32 v13, v14, 4, v13
    v_add_u32 v13, s53, v13
    s_waitcnt vmcnt(29)
    ds_write_b128 v13, v[64:67]
    v_add_u32 v13, 832, v2
    v_mul_hi_u32 v14, v13, s54
    v_lshlrev_b32 v13, 4, v13
    v_lshl_add_u32 v13, v14, 4, v13
    v_add_u32 v13, s53, v13
    s_waitcnt vmcnt(28)
    ds_write_b128 v13, v[68:71]
    v_add_u32 v13, 896, v2
    v_mul_hi_u32 v14, v13, s54
    v_lshlrev_b32 v13, 4, v13
    v_lshl_add_u32 v13, v14, 4, v13
    v_add_u32 v13, s53, v13
    s_waitcnt vmcnt(27)
    ds_write_b128 v13, v[72:75]
    v_add_u32 v13, 960, v2
    v_mul_hi_u32 v14, v13, s54
    v_lshlrev_b32 v13, 4, v13
    v_lshl_add_u32 v13, v14, 4, v13
    v_add_u32 v13, s53, v13
    s_waitcnt vmcnt(26)
    ds_write_b128 v13, v[76:79]
    v_add_u32 v13, 1024, v2
    v_mul_hi_u32 v14, v13, s54
    v_lshlrev_b32 v13, 4, v13
    v_lshl_add_u32 v13, v14, 4, v13
    v_add_u32 v13, s53, v13
    s_waitcnt vmcnt(25)
    ds_write_b128 v13, v[80:83]
    v_add_u32 v13, 1088, v2
    v_mul_hi_u32 v14, v13, s54
    v_lshlrev_b32 v13, 4, v13
    v_lshl_add_u32 v13, v14, 4, v13
    v_add_u32 v13, s53, v13
    s_waitcnt vmcnt(24)
    ds_write_b128 v13, v[84:87]
    v_add_u32 v13, 1152, v2
    v_mul_hi_u32 v14, v13, s54
    v_lshlrev_b32 v13, 4, v13
    v_lshl_add_u32 v13, v14, 4, v13
    v_add_u32 v13, s53, v13
    s_waitcnt vmcnt(23)
    ds_write_b128 v13, v[88:91]
    v_add_u32 v13, 1216, v2
    v_mul_hi_u32 v14, v13, s54
    v_lshlrev_b32 v13, 4, v13
    v_lshl_add_u32 v13, v14, 4, v13
    v_add_u32 v13, s53, v13
    s_waitcnt vmcnt(22)
    ds_write_b128 v13, v[92:95]
    v_add_u32 v13, 1280, v2
    v_mul_hi_u32 v14, v13, s54
    v_lshlrev_b32 v13, 4, v13
    v_lshl_add_u32 v13, v14, 4, v13
    v_add_u32 v13, s53, v13
    s_waitcnt vmcnt(21)
    ds_write_b128 v13, v[96:99]
    v_add_u32 v13, 1344, v2
    v_mul_hi_u32 v14, v13, s54
    v_lshlrev_b32 v13, 4, v13
    v_lshl_add_u32 v13, v14, 4, v13
    v_add_u32 v13, s53, v13
    s_waitcnt vmcnt(20)
    ds_write_b128 v13, v[100:103]
    v_add_u32 v13, 1408, v2
    v_mul_hi_u32 v14, v13, s54
    v_lshlrev_b32 v13, 4, v13
    v_lshl_add_u32 v13, v14, 4, v13
    v_add_u32 v13, s53, v13
    s_waitcnt vmcnt(19)
    ds_write_b128 v13, v[104:107]
    v_add_u32 v13, 1472, v2
    v_mul_hi_u32 v14, v13, s54
    v_lshlrev_b32 v13, 4, v13
    v_lshl_add_u32 v13, v14, 4, v13
    v_add_u32 v13, s53, v13
    s_waitcnt vmcnt(18)
    ds_write_b128 v13, v[108:111]
    v_add_u32 v13, 1536, v2
    v_mul_hi_u32 v14, v13, s54
    v_lshlrev_b32 v13, 4, v13
    v_lshl_add_u32 v13, v14, 4, v13
    v_add_u32 v13, s53, v13
    s_waitcnt vmcnt(17)
    ds_write_b128 v13, v[112:115]
    v_add_u32 v13, 1600, v2
    v_mul_hi_u32 v14, v13, s54
    v_lshlrev_b32 v13, 4, v13
    v_lshl_add_u32 v13, v14, 4, v13
    v_add_u32 v13, s53, v13
    s_waitcnt vmcnt(16)
    ds_write_b128 v13, v[116:119]
    v_add_u32 v13, 1664, v2
    v_mul_hi_u32 v14, v13, s54
    v_lshlrev_b32 v13, 4, v13
    v_lshl_add_u32 v13, v14, 4, v13
    v_add_u32 v13, s53, v13
    s_waitcnt vmcnt(15)
    ds_write_b128 v13, v[120:123]
    v_add_u32 v13, 1728, v2
    v_mul_hi_u32 v14, v13, s54
    v_lshlrev_b32 v13, 4, v13
    v_lshl_add_u32 v13, v14, 4, v13
    v_add_u32 v13, s53, v13
    s_waitcnt vmcnt(14)
    ds_write_b128 v13, v[124:127]
    v_mul_u32_u24 v13, 912, v3
    v_lshl_add_u32 v13, v4, 4, v13
    v_add_u32 v13, s53, v13
    s_waitcnt lgkmcnt(0)
    ds_read_b128 v[16:19], v13 offset:0
    ds_read_b128 v[20:23], v13 offset:32
    ds_read_b128 v[24:27], v13 offset:64
    ds_read_b128 v[28:31], v13 offset:96
    ds_read_b128 v[32:35], v13 offset:128
    ds_read_b128 v[36:39], v13 offset:160
    ds_read_b128 v[40:43], v13 offset:192
    ds_read_b128 v[44:47], v13 offset:224
    ds_read_b128 v[48:51], v13 offset:256
    ds_read_b128 v[52:55], v13 offset:288
    ds_read_b128 v[56:59], v13 offset:320
    ds_read_b128 v[60:63], v13 offset:352
    ds_read_b128 v[64:67], v13 offset:384
    ds_read_b128 v[68:71], v13 offset:416
    ds_read_b128 v[72:75], v13 offset:448
    ds_read_b128 v[76:79], v13 offset:480
    ds_read_b128 v[80:83], v13 offset:512
    ds_read_b128 v[84:87], v13 offset:544
    ds_read_b128 v[88:91], v13 offset:576
    ds_read_b128 v[92:95], v13 offset:608
    ds_read_b128 v[96:99], v13 offset:640
    ds_read_b128 v[100:103], v13 offset:672
    ds_read_b128 v[104:107], v13 offset:704
    ds_read_b128 v[108:111], v13 offset:736
    ds_read_b128 v[112:115], v13 offset:768
    ds_read_b128 v[116:119], v13 offset:800
    ds_read_b128 v[120:123], v13 offset:832
    ds_read_b128 v[124:127], v13 offset:864
    s_waitcnt lgkmcnt(0)
    s_barrier
    s_waitcnt vmcnt(13)
    ds_write_b128 v11, v[128:131] offset:0
    s_waitcnt vmcnt(12)
    ds_write_b128 v11, v[132:135] offset:4096
    s_waitcnt vmcnt(11)
    ds_write_b128 v11, v[136:139] offset:8192
    s_waitcnt vmcnt(10)
    ds_write_b128 v11, v[140:143] offset:12288
    s_waitcnt vmcnt(9)
    ds_write_b128 v11, v[144:147] offset:16384
    s_waitcnt vmcnt(8)
    ds_write_b128 v11, v[148:151] offset:20480
    s_waitcnt vmcnt(7)
    ds_write_b128 v11, v[152:155] offset:24576
    s_waitcnt vmcnt(6)
    ds_write_b128 v11, v[156:159] offset:28672
    s_waitcnt vmcnt(5)
    ds_write_b128 v11, v[160:163] offset:32768
    s_waitcnt vmcnt(4)
    ds_write_b128 v11, v[164:167] offset:36864
    s_waitcnt vmcnt(3)
    ds_write_b128 v11, v[168:171] offset:40960
    s_waitcnt vmcnt(2)
    ds_write_b128 v11, v[172:175] offset:45056
    s_waitcnt vmcnt(1)
    ds_write_b128 v11, v[176:179] offset:49152
    s_waitcnt vmcnt(0)
    ds_write_b128 v11, v[180:183] offset:53248
    s_mov_b32 s12, s44
    s_and_b32 s13, s45, 0xffff
    s_mov_b32 s14, 1204224
    s_mov_b32 s15, 0x00020000
    s_movk_i32 s35, 2688
    v_lshrrev_b32 v13, 2, v0
    v_mul_lo_u32 v13, v13, s35
    v_and_b32 v14, 3, v0
    v_lshl_add_u32 v13, v14, 4, v13
    s_mov_b32 s35, 1152
    buffer_load_dwordx4 v[128:131], v13, s[12:15], s35 offen
    s_mov_b32 s35, 173184
    buffer_load_dwordx4 v[132:135], v13, s[12:15], s35 offen
    s_mov_b32 s35, 345216
    buffer_load_dwordx4 v[136:139], v13, s[12:15], s35 offen
    s_mov_b32 s35, 517248
    buffer_load_dwordx4 v[140:143], v13, s[12:15], s35 offen
    s_mov_b32 s35, 689280
    buffer_load_dwordx4 v[144:147], v13, s[12:15], s35 offen
    s_mov_b32 s35, 861312
    buffer_load_dwordx4 v[148:151], v13, s[12:15], s35 offen
    s_mov_b32 s35, 1033344
    buffer_load_dwordx4 v[152:155], v13, s[12:15], s35 offen
    s_waitcnt vmcnt(6)
    ds_write_b128 v225, v[128:131] offset:0
    s_waitcnt vmcnt(5)
    ds_write_b128 v225, v[132:135] offset:4096
    s_waitcnt vmcnt(4)
    ds_write_b128 v225, v[136:139] offset:8192
    s_waitcnt vmcnt(3)
    ds_write_b128 v225, v[140:143] offset:12288
    s_waitcnt vmcnt(2)
    ds_write_b128 v225, v[144:147] offset:16384
    s_waitcnt vmcnt(1)
    ds_write_b128 v225, v[148:151] offset:20480
    s_waitcnt vmcnt(0)
    ds_write_b128 v225, v[152:155] offset:24576
    s_mov_b32 s12, s44
    s_and_b32 s13, s45, 0xffff
    s_mov_b32 s14, 1204224
    s_mov_b32 s15, 0x00020000
    s_movk_i32 s35, 2688
    v_lshrrev_b32 v13, 2, v0
    v_mul_lo_u32 v13, v13, s35
    v_and_b32 v14, 3, v0
    v_lshl_add_u32 v13, v14, 4, v13
    s_mov_b32 s35, 1216
    buffer_load_dwordx4 v[128:131], v13, s[12:15], s35 offen
    s_mov_b32 s35, 173248
    buffer_load_dwordx4 v[132:135], v13, s[12:15], s35 offen
    s_mov_b32 s35, 345280
    buffer_load_dwordx4 v[136:139], v13, s[12:15], s35 offen
    s_mov_b32 s35, 517312
    buffer_load_dwordx4 v[140:143], v13, s[12:15], s35 offen
    s_mov_b32 s35, 689344
    buffer_load_dwordx4 v[144:147], v13, s[12:15], s35 offen
    s_mov_b32 s35, 861376
    buffer_load_dwordx4 v[148:151], v13, s[12:15], s35 offen
    s_mov_b32 s35, 1033408
    buffer_load_dwordx4 v[152:155], v13, s[12:15], s35 offen
    s_waitcnt vmcnt(6)
    ds_write_b128 v225, v[128:131] offset:28672
    s_waitcnt vmcnt(5)
    ds_write_b128 v225, v[132:135] offset:32768
    s_waitcnt vmcnt(4)
    ds_write_b128 v225, v[136:139] offset:36864
    s_waitcnt vmcnt(3)
    ds_write_b128 v225, v[140:143] offset:40960
    s_waitcnt vmcnt(2)
    ds_write_b128 v225, v[144:147] offset:45056
    s_waitcnt vmcnt(1)
    ds_write_b128 v225, v[148:151] offset:49152
    s_waitcnt vmcnt(0)
    ds_write_b128 v225, v[152:155] offset:53248
    s_waitcnt lgkmcnt(0)
    s_barrier
    ds_read_b64_tr_b16 v[192:193], v7 offset:0
    ds_read_b64_tr_b16 v[194:195], v7 offset:256
    ds_read_b64_tr_b16 v[196:197], v7 offset:28672
    ds_read_b64_tr_b16 v[198:199], v7 offset:28928
    ds_read_b64_tr_b16 v[200:201], v224 offset:0
    ds_read_b64_tr_b16 v[202:203], v224 offset:256
    ds_read_b64_tr_b16 v[204:205], v224 offset:28672
    ds_read_b64_tr_b16 v[206:207], v224 offset:28928
    ds_read_b64_tr_b16 v[208:209], v7 offset:1024
    ds_read_b64_tr_b16 v[210:211], v7 offset:1280
    ds_read_b64_tr_b16 v[212:213], v7 offset:29696
    ds_read_b64_tr_b16 v[214:215], v7 offset:29952
    ds_read_b64_tr_b16 v[216:217], v224 offset:1024
    ds_read_b64_tr_b16 v[218:219], v224 offset:1280
    ds_read_b64_tr_b16 v[220:221], v224 offset:29696
    ds_read_b64_tr_b16 v[222:223], v224 offset:29952
    s_waitcnt lgkmcnt(8)
    v_mfma_f32_32x32x16_bf16 v[128:143], v[192:195], v[16:19], 0
    v_mfma_f32_32x32x16_bf16 v[144:159], v[196:199], v[16:19], 0
    v_mfma_f32_32x32x16_bf16 v[160:175], v[200:203], v[16:19], 0
    v_mfma_f32_32x32x16_bf16 v[176:191], v[204:207], v[16:19], 0
    ds_read_b64_tr_b16 v[192:193], v7 offset:2048
    ds_read_b64_tr_b16 v[194:195], v7 offset:2304
    ds_read_b64_tr_b16 v[196:197], v7 offset:30720
    ds_read_b64_tr_b16 v[198:199], v7 offset:30976
    ds_read_b64_tr_b16 v[200:201], v224 offset:2048
    ds_read_b64_tr_b16 v[202:203], v224 offset:2304
    ds_read_b64_tr_b16 v[204:205], v224 offset:30720
    ds_read_b64_tr_b16 v[206:207], v224 offset:30976
    s_waitcnt lgkmcnt(8)
    v_mfma_f32_32x32x16_bf16 v[128:143], v[208:211], v[20:23], v[128:143]
    v_mfma_f32_32x32x16_bf16 v[144:159], v[212:215], v[20:23], v[144:159]
    v_mfma_f32_32x32x16_bf16 v[160:175], v[216:219], v[20:23], v[160:175]
    v_mfma_f32_32x32x16_bf16 v[176:191], v[220:223], v[20:23], v[176:191]
    ds_read_b64_tr_b16 v[208:209], v7 offset:3072
    ds_read_b64_tr_b16 v[210:211], v7 offset:3328
    ds_read_b64_tr_b16 v[212:213], v7 offset:31744
    ds_read_b64_tr_b16 v[214:215], v7 offset:32000
    ds_read_b64_tr_b16 v[216:217], v224 offset:3072
    ds_read_b64_tr_b16 v[218:219], v224 offset:3328
    ds_read_b64_tr_b16 v[220:221], v224 offset:31744
    ds_read_b64_tr_b16 v[222:223], v224 offset:32000
    s_waitcnt lgkmcnt(8)
    v_mfma_f32_32x32x16_bf16 v[128:143], v[192:195], v[24:27], v[128:143]
    v_mfma_f32_32x32x16_bf16 v[144:159], v[196:199], v[24:27], v[144:159]
    v_mfma_f32_32x32x16_bf16 v[160:175], v[200:203], v[24:27], v[160:175]
    v_mfma_f32_32x32x16_bf16 v[176:191], v[204:207], v[24:27], v[176:191]
    ds_read_b64_tr_b16 v[192:193], v7 offset:4096
    ds_read_b64_tr_b16 v[194:195], v7 offset:4352
    ds_read_b64_tr_b16 v[196:197], v7 offset:32768
    ds_read_b64_tr_b16 v[198:199], v7 offset:33024
    ds_read_b64_tr_b16 v[200:201], v224 offset:4096
    ds_read_b64_tr_b16 v[202:203], v224 offset:4352
    ds_read_b64_tr_b16 v[204:205], v224 offset:32768
    ds_read_b64_tr_b16 v[206:207], v224 offset:33024
    s_waitcnt lgkmcnt(8)
    v_mfma_f32_32x32x16_bf16 v[128:143], v[208:211], v[28:31], v[128:143]
    v_mfma_f32_32x32x16_bf16 v[144:159], v[212:215], v[28:31], v[144:159]
    v_mfma_f32_32x32x16_bf16 v[160:175], v[216:219], v[28:31], v[160:175]
    v_mfma_f32_32x32x16_bf16 v[176:191], v[220:223], v[28:31], v[176:191]
    ds_read_b64_tr_b16 v[208:209], v7 offset:5120
    ds_read_b64_tr_b16 v[210:211], v7 offset:5376
    ds_read_b64_tr_b16 v[212:213], v7 offset:33792
    ds_read_b64_tr_b16 v[214:215], v7 offset:34048
    ds_read_b64_tr_b16 v[216:217], v224 offset:5120
    ds_read_b64_tr_b16 v[218:219], v224 offset:5376
    ds_read_b64_tr_b16 v[220:221], v224 offset:33792
    ds_read_b64_tr_b16 v[222:223], v224 offset:34048
    s_waitcnt lgkmcnt(8)
    v_mfma_f32_32x32x16_bf16 v[128:143], v[192:195], v[32:35], v[128:143]
    v_mfma_f32_32x32x16_bf16 v[144:159], v[196:199], v[32:35], v[144:159]
    v_mfma_f32_32x32x16_bf16 v[160:175], v[200:203], v[32:35], v[160:175]
    v_mfma_f32_32x32x16_bf16 v[176:191], v[204:207], v[32:35], v[176:191]
    ds_read_b64_tr_b16 v[192:193], v7 offset:6144
    ds_read_b64_tr_b16 v[194:195], v7 offset:6400
    ds_read_b64_tr_b16 v[196:197], v7 offset:34816
    ds_read_b64_tr_b16 v[198:199], v7 offset:35072
    ds_read_b64_tr_b16 v[200:201], v224 offset:6144
    ds_read_b64_tr_b16 v[202:203], v224 offset:6400
    ds_read_b64_tr_b16 v[204:205], v224 offset:34816
    ds_read_b64_tr_b16 v[206:207], v224 offset:35072
    s_waitcnt lgkmcnt(8)
    v_mfma_f32_32x32x16_bf16 v[128:143], v[208:211], v[36:39], v[128:143]
    v_mfma_f32_32x32x16_bf16 v[144:159], v[212:215], v[36:39], v[144:159]
    v_mfma_f32_32x32x16_bf16 v[160:175], v[216:219], v[36:39], v[160:175]
    v_mfma_f32_32x32x16_bf16 v[176:191], v[220:223], v[36:39], v[176:191]
    ds_read_b64_tr_b16 v[208:209], v7 offset:7168
    ds_read_b64_tr_b16 v[210:211], v7 offset:7424
    ds_read_b64_tr_b16 v[212:213], v7 offset:35840
    ds_read_b64_tr_b16 v[214:215], v7 offset:36096
    ds_read_b64_tr_b16 v[216:217], v224 offset:7168
    ds_read_b64_tr_b16 v[218:219], v224 offset:7424
    ds_read_b64_tr_b16 v[220:221], v224 offset:35840
    ds_read_b64_tr_b16 v[222:223], v224 offset:36096
    s_waitcnt lgkmcnt(8)
    v_mfma_f32_32x32x16_bf16 v[128:143], v[192:195], v[40:43], v[128:143]
    v_mfma_f32_32x32x16_bf16 v[144:159], v[196:199], v[40:43], v[144:159]
    v_mfma_f32_32x32x16_bf16 v[160:175], v[200:203], v[40:43], v[160:175]
    v_mfma_f32_32x32x16_bf16 v[176:191], v[204:207], v[40:43], v[176:191]
    ds_read_b64_tr_b16 v[192:193], v7 offset:8192
    ds_read_b64_tr_b16 v[194:195], v7 offset:8448
    ds_read_b64_tr_b16 v[196:197], v7 offset:36864
    ds_read_b64_tr_b16 v[198:199], v7 offset:37120
    ds_read_b64_tr_b16 v[200:201], v224 offset:8192
    ds_read_b64_tr_b16 v[202:203], v224 offset:8448
    ds_read_b64_tr_b16 v[204:205], v224 offset:36864
    ds_read_b64_tr_b16 v[206:207], v224 offset:37120
    s_waitcnt lgkmcnt(8)
    v_mfma_f32_32x32x16_bf16 v[128:143], v[208:211], v[44:47], v[128:143]
    v_mfma_f32_32x32x16_bf16 v[144:159], v[212:215], v[44:47], v[144:159]
    v_mfma_f32_32x32x16_bf16 v[160:175], v[216:219], v[44:47], v[160:175]
    v_mfma_f32_32x32x16_bf16 v[176:191], v[220:223], v[44:47], v[176:191]
    ds_read_b64_tr_b16 v[208:209], v7 offset:9216
    ds_read_b64_tr_b16 v[210:211], v7 offset:9472
    ds_read_b64_tr_b16 v[212:213], v7 offset:37888
    ds_read_b64_tr_b16 v[214:215], v7 offset:38144
    ds_read_b64_tr_b16 v[216:217], v224 offset:9216
    ds_read_b64_tr_b16 v[218:219], v224 offset:9472
    ds_read_b64_tr_b16 v[220:221], v224 offset:37888
    ds_read_b64_tr_b16 v[222:223], v224 offset:38144
    s_waitcnt lgkmcnt(8)
    v_mfma_f32_32x32x16_bf16 v[128:143], v[192:195], v[48:51], v[128:143]
    v_mfma_f32_32x32x16_bf16 v[144:159], v[196:199], v[48:51], v[144:159]
    v_mfma_f32_32x32x16_bf16 v[160:175], v[200:203], v[48:51], v[160:175]
    v_mfma_f32_32x32x16_bf16 v[176:191], v[204:207], v[48:51], v[176:191]
    ds_read_b64_tr_b16 v[192:193], v7 offset:10240
    ds_read_b64_tr_b16 v[194:195], v7 offset:10496
    ds_read_b64_tr_b16 v[196:197], v7 offset:38912
    ds_read_b64_tr_b16 v[198:199], v7 offset:39168
    ds_read_b64_tr_b16 v[200:201], v224 offset:10240
    ds_read_b64_tr_b16 v[202:203], v224 offset:10496
    ds_read_b64_tr_b16 v[204:205], v224 offset:38912
    ds_read_b64_tr_b16 v[206:207], v224 offset:39168
    s_waitcnt lgkmcnt(8)
    v_mfma_f32_32x32x16_bf16 v[128:143], v[208:211], v[52:55], v[128:143]
    v_mfma_f32_32x32x16_bf16 v[144:159], v[212:215], v[52:55], v[144:159]
    v_mfma_f32_32x32x16_bf16 v[160:175], v[216:219], v[52:55], v[160:175]
    v_mfma_f32_32x32x16_bf16 v[176:191], v[220:223], v[52:55], v[176:191]
    ds_read_b64_tr_b16 v[208:209], v7 offset:11264
    ds_read_b64_tr_b16 v[210:211], v7 offset:11520
    ds_read_b64_tr_b16 v[212:213], v7 offset:39936
    ds_read_b64_tr_b16 v[214:215], v7 offset:40192
    ds_read_b64_tr_b16 v[216:217], v224 offset:11264
    ds_read_b64_tr_b16 v[218:219], v224 offset:11520
    ds_read_b64_tr_b16 v[220:221], v224 offset:39936
    ds_read_b64_tr_b16 v[222:223], v224 offset:40192
    s_waitcnt lgkmcnt(8)
    v_mfma_f32_32x32x16_bf16 v[128:143], v[192:195], v[56:59], v[128:143]
    v_mfma_f32_32x32x16_bf16 v[144:159], v[196:199], v[56:59], v[144:159]
    v_mfma_f32_32x32x16_bf16 v[160:175], v[200:203], v[56:59], v[160:175]
    v_mfma_f32_32x32x16_bf16 v[176:191], v[204:207], v[56:59], v[176:191]
    ds_read_b64_tr_b16 v[192:193], v7 offset:12288
    ds_read_b64_tr_b16 v[194:195], v7 offset:12544
    ds_read_b64_tr_b16 v[196:197], v7 offset:40960
    ds_read_b64_tr_b16 v[198:199], v7 offset:41216
    ds_read_b64_tr_b16 v[200:201], v224 offset:12288
    ds_read_b64_tr_b16 v[202:203], v224 offset:12544
    ds_read_b64_tr_b16 v[204:205], v224 offset:40960
    ds_read_b64_tr_b16 v[206:207], v224 offset:41216
    s_waitcnt lgkmcnt(8)
    v_mfma_f32_32x32x16_bf16 v[128:143], v[208:211], v[60:63], v[128:143]
    v_mfma_f32_32x32x16_bf16 v[144:159], v[212:215], v[60:63], v[144:159]
    v_mfma_f32_32x32x16_bf16 v[160:175], v[216:219], v[60:63], v[160:175]
    v_mfma_f32_32x32x16_bf16 v[176:191], v[220:223], v[60:63], v[176:191]
    ds_read_b64_tr_b16 v[208:209], v7 offset:13312
    ds_read_b64_tr_b16 v[210:211], v7 offset:13568
    ds_read_b64_tr_b16 v[212:213], v7 offset:41984
    ds_read_b64_tr_b16 v[214:215], v7 offset:42240
    ds_read_b64_tr_b16 v[216:217], v224 offset:13312
    ds_read_b64_tr_b16 v[218:219], v224 offset:13568
    ds_read_b64_tr_b16 v[220:221], v224 offset:41984
    ds_read_b64_tr_b16 v[222:223], v224 offset:42240
    s_waitcnt lgkmcnt(8)
    v_mfma_f32_32x32x16_bf16 v[128:143], v[192:195], v[64:67], v[128:143]
    v_mfma_f32_32x32x16_bf16 v[144:159], v[196:199], v[64:67], v[144:159]
    v_mfma_f32_32x32x16_bf16 v[160:175], v[200:203], v[64:67], v[160:175]
    v_mfma_f32_32x32x16_bf16 v[176:191], v[204:207], v[64:67], v[176:191]
    ds_read_b64_tr_b16 v[192:193], v7 offset:14336
    ds_read_b64_tr_b16 v[194:195], v7 offset:14592
    ds_read_b64_tr_b16 v[196:197], v7 offset:43008
    ds_read_b64_tr_b16 v[198:199], v7 offset:43264
    ds_read_b64_tr_b16 v[200:201], v224 offset:14336
    ds_read_b64_tr_b16 v[202:203], v224 offset:14592
    ds_read_b64_tr_b16 v[204:205], v224 offset:43008
    ds_read_b64_tr_b16 v[206:207], v224 offset:43264
    s_waitcnt lgkmcnt(8)
    v_mfma_f32_32x32x16_bf16 v[128:143], v[208:211], v[68:71], v[128:143]
    v_mfma_f32_32x32x16_bf16 v[144:159], v[212:215], v[68:71], v[144:159]
    v_mfma_f32_32x32x16_bf16 v[160:175], v[216:219], v[68:71], v[160:175]
    v_mfma_f32_32x32x16_bf16 v[176:191], v[220:223], v[68:71], v[176:191]
    ds_read_b64_tr_b16 v[208:209], v7 offset:15360
    ds_read_b64_tr_b16 v[210:211], v7 offset:15616
    ds_read_b64_tr_b16 v[212:213], v7 offset:44032
    ds_read_b64_tr_b16 v[214:215], v7 offset:44288
    ds_read_b64_tr_b16 v[216:217], v224 offset:15360
    ds_read_b64_tr_b16 v[218:219], v224 offset:15616
    ds_read_b64_tr_b16 v[220:221], v224 offset:44032
    ds_read_b64_tr_b16 v[222:223], v224 offset:44288
    s_waitcnt lgkmcnt(8)
    v_mfma_f32_32x32x16_bf16 v[128:143], v[192:195], v[72:75], v[128:143]
    v_mfma_f32_32x32x16_bf16 v[144:159], v[196:199], v[72:75], v[144:159]
    v_mfma_f32_32x32x16_bf16 v[160:175], v[200:203], v[72:75], v[160:175]
    v_mfma_f32_32x32x16_bf16 v[176:191], v[204:207], v[72:75], v[176:191]
    ds_read_b64_tr_b16 v[192:193], v7 offset:16384
    ds_read_b64_tr_b16 v[194:195], v7 offset:16640
    ds_read_b64_tr_b16 v[196:197], v7 offset:45056
    ds_read_b64_tr_b16 v[198:199], v7 offset:45312
    ds_read_b64_tr_b16 v[200:201], v224 offset:16384
    ds_read_b64_tr_b16 v[202:203], v224 offset:16640
    ds_read_b64_tr_b16 v[204:205], v224 offset:45056
    ds_read_b64_tr_b16 v[206:207], v224 offset:45312
    s_waitcnt lgkmcnt(8)
    v_mfma_f32_32x32x16_bf16 v[128:143], v[208:211], v[76:79], v[128:143]
    v_mfma_f32_32x32x16_bf16 v[144:159], v[212:215], v[76:79], v[144:159]
    v_mfma_f32_32x32x16_bf16 v[160:175], v[216:219], v[76:79], v[160:175]
    v_mfma_f32_32x32x16_bf16 v[176:191], v[220:223], v[76:79], v[176:191]
    ds_read_b64_tr_b16 v[208:209], v7 offset:17408
    ds_read_b64_tr_b16 v[210:211], v7 offset:17664
    ds_read_b64_tr_b16 v[212:213], v7 offset:46080
    ds_read_b64_tr_b16 v[214:215], v7 offset:46336
    ds_read_b64_tr_b16 v[216:217], v224 offset:17408
    ds_read_b64_tr_b16 v[218:219], v224 offset:17664
    ds_read_b64_tr_b16 v[220:221], v224 offset:46080
    ds_read_b64_tr_b16 v[222:223], v224 offset:46336
    s_waitcnt lgkmcnt(8)
    v_mfma_f32_32x32x16_bf16 v[128:143], v[192:195], v[80:83], v[128:143]
    v_mfma_f32_32x32x16_bf16 v[144:159], v[196:199], v[80:83], v[144:159]
    v_mfma_f32_32x32x16_bf16 v[160:175], v[200:203], v[80:83], v[160:175]
    v_mfma_f32_32x32x16_bf16 v[176:191], v[204:207], v[80:83], v[176:191]
    ds_read_b64_tr_b16 v[192:193], v7 offset:18432
    ds_read_b64_tr_b16 v[194:195], v7 offset:18688
    ds_read_b64_tr_b16 v[196:197], v7 offset:47104
    ds_read_b64_tr_b16 v[198:199], v7 offset:47360
    ds_read_b64_tr_b16 v[200:201], v224 offset:18432
    ds_read_b64_tr_b16 v[202:203], v224 offset:18688
    ds_read_b64_tr_b16 v[204:205], v224 offset:47104
    ds_read_b64_tr_b16 v[206:207], v224 offset:47360
    s_waitcnt lgkmcnt(8)
    v_mfma_f32_32x32x16_bf16 v[128:143], v[208:211], v[84:87], v[128:143]
    v_mfma_f32_32x32x16_bf16 v[144:159], v[212:215], v[84:87], v[144:159]
    v_mfma_f32_32x32x16_bf16 v[160:175], v[216:219], v[84:87], v[160:175]
    v_mfma_f32_32x32x16_bf16 v[176:191], v[220:223], v[84:87], v[176:191]
    ds_read_b64_tr_b16 v[208:209], v7 offset:19456
    ds_read_b64_tr_b16 v[210:211], v7 offset:19712
    ds_read_b64_tr_b16 v[212:213], v7 offset:48128
    ds_read_b64_tr_b16 v[214:215], v7 offset:48384
    ds_read_b64_tr_b16 v[216:217], v224 offset:19456
    ds_read_b64_tr_b16 v[218:219], v224 offset:19712
    ds_read_b64_tr_b16 v[220:221], v224 offset:48128
    ds_read_b64_tr_b16 v[222:223], v224 offset:48384
    s_waitcnt lgkmcnt(8)
    v_mfma_f32_32x32x16_bf16 v[128:143], v[192:195], v[88:91], v[128:143]
    v_mfma_f32_32x32x16_bf16 v[144:159], v[196:199], v[88:91], v[144:159]
    v_mfma_f32_32x32x16_bf16 v[160:175], v[200:203], v[88:91], v[160:175]
    v_mfma_f32_32x32x16_bf16 v[176:191], v[204:207], v[88:91], v[176:191]
    ds_read_b64_tr_b16 v[192:193], v7 offset:20480
    ds_read_b64_tr_b16 v[194:195], v7 offset:20736
    ds_read_b64_tr_b16 v[196:197], v7 offset:49152
    ds_read_b64_tr_b16 v[198:199], v7 offset:49408
    ds_read_b64_tr_b16 v[200:201], v224 offset:20480
    ds_read_b64_tr_b16 v[202:203], v224 offset:20736
    ds_read_b64_tr_b16 v[204:205], v224 offset:49152
    ds_read_b64_tr_b16 v[206:207], v224 offset:49408
    s_waitcnt lgkmcnt(8)
    v_mfma_f32_32x32x16_bf16 v[128:143], v[208:211], v[92:95], v[128:143]
    v_mfma_f32_32x32x16_bf16 v[144:159], v[212:215], v[92:95], v[144:159]
    v_mfma_f32_32x32x16_bf16 v[160:175], v[216:219], v[92:95], v[160:175]
    v_mfma_f32_32x32x16_bf16 v[176:191], v[220:223], v[92:95], v[176:191]
    ds_read_b64_tr_b16 v[208:209], v7 offset:21504
    ds_read_b64_tr_b16 v[210:211], v7 offset:21760
    ds_read_b64_tr_b16 v[212:213], v7 offset:50176
    ds_read_b64_tr_b16 v[214:215], v7 offset:50432
    ds_read_b64_tr_b16 v[216:217], v224 offset:21504
    ds_read_b64_tr_b16 v[218:219], v224 offset:21760
    ds_read_b64_tr_b16 v[220:221], v224 offset:50176
    ds_read_b64_tr_b16 v[222:223], v224 offset:50432
    s_waitcnt lgkmcnt(8)
    v_mfma_f32_32x32x16_bf16 v[128:143], v[192:195], v[96:99], v[128:143]
    v_mfma_f32_32x32x16_bf16 v[144:159], v[196:199], v[96:99], v[144:159]
    v_mfma_f32_32x32x16_bf16 v[160:175], v[200:203], v[96:99], v[160:175]
    v_mfma_f32_32x32x16_bf16 v[176:191], v[204:207], v[96:99], v[176:191]
    ds_read_b64_tr_b16 v[192:193], v7 offset:22528
    ds_read_b64_tr_b16 v[194:195], v7 offset:22784
    ds_read_b64_tr_b16 v[196:197], v7 offset:51200
    ds_read_b64_tr_b16 v[198:199], v7 offset:51456
    ds_read_b64_tr_b16 v[200:201], v224 offset:22528
    ds_read_b64_tr_b16 v[202:203], v224 offset:22784
    ds_read_b64_tr_b16 v[204:205], v224 offset:51200
    ds_read_b64_tr_b16 v[206:207], v224 offset:51456
    s_waitcnt lgkmcnt(8)
    v_mfma_f32_32x32x16_bf16 v[128:143], v[208:211], v[100:103], v[128:143]
    v_mfma_f32_32x32x16_bf16 v[144:159], v[212:215], v[100:103], v[144:159]
    v_mfma_f32_32x32x16_bf16 v[160:175], v[216:219], v[100:103], v[160:175]
    v_mfma_f32_32x32x16_bf16 v[176:191], v[220:223], v[100:103], v[176:191]
    ds_read_b64_tr_b16 v[208:209], v7 offset:23552
    ds_read_b64_tr_b16 v[210:211], v7 offset:23808
    ds_read_b64_tr_b16 v[212:213], v7 offset:52224
    ds_read_b64_tr_b16 v[214:215], v7 offset:52480
    ds_read_b64_tr_b16 v[216:217], v224 offset:23552
    ds_read_b64_tr_b16 v[218:219], v224 offset:23808
    ds_read_b64_tr_b16 v[220:221], v224 offset:52224
    ds_read_b64_tr_b16 v[222:223], v224 offset:52480
    s_waitcnt lgkmcnt(8)
    v_mfma_f32_32x32x16_bf16 v[128:143], v[192:195], v[104:107], v[128:143]
    v_mfma_f32_32x32x16_bf16 v[144:159], v[196:199], v[104:107], v[144:159]
    v_mfma_f32_32x32x16_bf16 v[160:175], v[200:203], v[104:107], v[160:175]
    v_mfma_f32_32x32x16_bf16 v[176:191], v[204:207], v[104:107], v[176:191]
    ds_read_b64_tr_b16 v[192:193], v7 offset:24576
    ds_read_b64_tr_b16 v[194:195], v7 offset:24832
    ds_read_b64_tr_b16 v[196:197], v7 offset:53248
    ds_read_b64_tr_b16 v[198:199], v7 offset:53504
    ds_read_b64_tr_b16 v[200:201], v224 offset:24576
    ds_read_b64_tr_b16 v[202:203], v224 offset:24832
    ds_read_b64_tr_b16 v[204:205], v224 offset:53248
    ds_read_b64_tr_b16 v[206:207], v224 offset:53504
    s_waitcnt lgkmcnt(8)
    v_mfma_f32_32x32x16_bf16 v[128:143], v[208:211], v[108:111], v[128:143]
    v_mfma_f32_32x32x16_bf16 v[144:159], v[212:215], v[108:111], v[144:159]
    v_mfma_f32_32x32x16_bf16 v[160:175], v[216:219], v[108:111], v[160:175]
    v_mfma_f32_32x32x16_bf16 v[176:191], v[220:223], v[108:111], v[176:191]
    ds_read_b64_tr_b16 v[208:209], v7 offset:25600
    ds_read_b64_tr_b16 v[210:211], v7 offset:25856
    ds_read_b64_tr_b16 v[212:213], v7 offset:54272
    ds_read_b64_tr_b16 v[214:215], v7 offset:54528
    ds_read_b64_tr_b16 v[216:217], v224 offset:25600
    ds_read_b64_tr_b16 v[218:219], v224 offset:25856
    ds_read_b64_tr_b16 v[220:221], v224 offset:54272
    ds_read_b64_tr_b16 v[222:223], v224 offset:54528
    s_waitcnt lgkmcnt(8)
    v_mfma_f32_32x32x16_bf16 v[128:143], v[192:195], v[112:115], v[128:143]
    v_mfma_f32_32x32x16_bf16 v[144:159], v[196:199], v[112:115], v[144:159]
    v_mfma_f32_32x32x16_bf16 v[160:175], v[200:203], v[112:115], v[160:175]
    v_mfma_f32_32x32x16_bf16 v[176:191], v[204:207], v[112:115], v[176:191]
    ds_read_b64_tr_b16 v[192:193], v7 offset:26624
    ds_read_b64_tr_b16 v[194:195], v7 offset:26880
    ds_read_b64_tr_b16 v[196:197], v7 offset:55296
    ds_read_b64_tr_b16 v[198:199], v7 offset:55552
    ds_read_b64_tr_b16 v[200:201], v224 offset:26624
    ds_read_b64_tr_b16 v[202:203], v224 offset:26880
    ds_read_b64_tr_b16 v[204:205], v224 offset:55296
    ds_read_b64_tr_b16 v[206:207], v224 offset:55552
    s_waitcnt lgkmcnt(8)
    v_mfma_f32_32x32x16_bf16 v[128:143], v[208:211], v[116:119], v[128:143]
    v_mfma_f32_32x32x16_bf16 v[144:159], v[212:215], v[116:119], v[144:159]
    v_mfma_f32_32x32x16_bf16 v[160:175], v[216:219], v[116:119], v[160:175]
    v_mfma_f32_32x32x16_bf16 v[176:191], v[220:223], v[116:119], v[176:191]
    ds_read_b64_tr_b16 v[208:209], v7 offset:27648
    ds_read_b64_tr_b16 v[210:211], v7 offset:27904
    ds_read_b64_tr_b16 v[212:213], v7 offset:56320
    ds_read_b64_tr_b16 v[214:215], v7 offset:56576
    ds_read_b64_tr_b16 v[216:217], v224 offset:27648
    ds_read_b64_tr_b16 v[218:219], v224 offset:27904
    ds_read_b64_tr_b16 v[220:221], v224 offset:56320
    ds_read_b64_tr_b16 v[222:223], v224 offset:56576
    s_waitcnt lgkmcnt(8)
    v_mfma_f32_32x32x16_bf16 v[128:143], v[192:195], v[120:123], v[128:143]
    v_mfma_f32_32x32x16_bf16 v[144:159], v[196:199], v[120:123], v[144:159]
    v_mfma_f32_32x32x16_bf16 v[160:175], v[200:203], v[120:123], v[160:175]
    v_mfma_f32_32x32x16_bf16 v[176:191], v[204:207], v[120:123], v[176:191]
    s_waitcnt lgkmcnt(0)
    v_mfma_f32_32x32x16_bf16 v[128:143], v[208:211], v[124:127], v[128:143]
    v_mfma_f32_32x32x16_bf16 v[144:159], v[212:215], v[124:127], v[144:159]
    v_mfma_f32_32x32x16_bf16 v[160:175], v[216:219], v[124:127], v[160:175]
    v_mfma_f32_32x32x16_bf16 v[176:191], v[220:223], v[124:127], v[176:191]
    s_nop 15
    s_nop 3
    s_movk_i32 s35, 1792
    v_mul_lo_u32 v13, v5, s35
    v_lshl_add_u32 v13, v4, 3, v13
    v_add_u32 v13, 2360320, v13
    v_cvt_pk_bf16_f32 v128, v128, v129
    v_cvt_pk_bf16_f32 v129, v130, v131
    buffer_store_dwordx2 v[128:129], v13, s[16:19], 0 offen offset:0
    v_cvt_pk_bf16_f32 v132, v132, v133
    v_cvt_pk_bf16_f32 v133, v134, v135
    buffer_store_dwordx2 v[132:133], v13, s[16:19], 0 offen offset:16
    v_cvt_pk_bf16_f32 v136, v136, v137
    v_cvt_pk_bf16_f32 v137, v138, v139
    buffer_store_dwordx2 v[136:137], v13, s[16:19], 0 offen offset:32
    v_cvt_pk_bf16_f32 v140, v140, v141
    v_cvt_pk_bf16_f32 v141, v142, v143
    buffer_store_dwordx2 v[140:141], v13, s[16:19], 0 offen offset:48
    s_movk_i32 s35, 1792
    v_mul_lo_u32 v13, v5, s35
    v_lshl_add_u32 v13, v4, 3, v13
    v_add_u32 v13, 2360384, v13
    v_cvt_pk_bf16_f32 v144, v144, v145
    v_cvt_pk_bf16_f32 v145, v146, v147
    buffer_store_dwordx2 v[144:145], v13, s[16:19], 0 offen offset:0
    v_cvt_pk_bf16_f32 v148, v148, v149
    v_cvt_pk_bf16_f32 v149, v150, v151
    buffer_store_dwordx2 v[148:149], v13, s[16:19], 0 offen offset:16
    v_cvt_pk_bf16_f32 v152, v152, v153
    v_cvt_pk_bf16_f32 v153, v154, v155
    buffer_store_dwordx2 v[152:153], v13, s[16:19], 0 offen offset:32
    v_cvt_pk_bf16_f32 v156, v156, v157
    v_cvt_pk_bf16_f32 v157, v158, v159
    buffer_store_dwordx2 v[156:157], v13, s[16:19], 0 offen offset:48
    s_movk_i32 s35, 1792
    v_mul_lo_u32 v13, v5, s35
    v_lshl_add_u32 v13, v4, 3, v13
    v_add_u32 v13, 2360448, v13
    v_cvt_pk_bf16_f32 v160, v160, v161
    v_cvt_pk_bf16_f32 v161, v162, v163
    buffer_store_dwordx2 v[160:161], v13, s[16:19], 0 offen offset:0
    v_cvt_pk_bf16_f32 v164, v164, v165
    v_cvt_pk_bf16_f32 v165, v166, v167
    buffer_store_dwordx2 v[164:165], v13, s[16:19], 0 offen offset:16
    v_cvt_pk_bf16_f32 v168, v168, v169
    v_cvt_pk_bf16_f32 v169, v170, v171
    buffer_store_dwordx2 v[168:169], v13, s[16:19], 0 offen offset:32
    v_cvt_pk_bf16_f32 v172, v172, v173
    v_cvt_pk_bf16_f32 v173, v174, v175
    buffer_store_dwordx2 v[172:173], v13, s[16:19], 0 offen offset:48
    s_movk_i32 s35, 1792
    v_mul_lo_u32 v13, v5, s35
    v_lshl_add_u32 v13, v4, 3, v13
    v_add_u32 v13, 2360512, v13
    v_cvt_pk_bf16_f32 v176, v176, v177
    v_cvt_pk_bf16_f32 v177, v178, v179
    buffer_store_dwordx2 v[176:177], v13, s[16:19], 0 offen offset:0
    v_cvt_pk_bf16_f32 v180, v180, v181
    v_cvt_pk_bf16_f32 v181, v182, v183
    buffer_store_dwordx2 v[180:181], v13, s[16:19], 0 offen offset:16
    v_cvt_pk_bf16_f32 v184, v184, v185
    v_cvt_pk_bf16_f32 v185, v186, v187
    buffer_store_dwordx2 v[184:185], v13, s[16:19], 0 offen offset:32
    v_cvt_pk_bf16_f32 v188, v188, v189
    v_cvt_pk_bf16_f32 v189, v190, v191
    buffer_store_dwordx2 v[188:189], v13, s[16:19], 0 offen offset:48
    s_endpgm
K1_v9:
    s_mov_b32 s12, s44
    s_and_b32 s13, s45, 0xffff
    s_mov_b32 s14, 1204224
    s_mov_b32 s15, 0x00020000
    s_movk_i32 s35, 2688
    v_lshrrev_b32 v227, 2, v0
    v_mul_lo_u32 v227, v227, s35
    v_and_b32 v14, 3, v0
    v_lshl_add_u32 v227, v14, 4, v227
    s_mov_b32 s35, 1280
    buffer_load_dwordx4 v[128:131], v227, s[12:15], s35 offen
    s_mov_b32 s35, 173312
    buffer_load_dwordx4 v[132:135], v227, s[12:15], s35 offen
    s_mov_b32 s35, 345344
    buffer_load_dwordx4 v[136:139], v227, s[12:15], s35 offen
    s_mov_b32 s35, 517376
    buffer_load_dwordx4 v[140:143], v227, s[12:15], s35 offen
    s_mov_b32 s35, 689408
    buffer_load_dwordx4 v[144:147], v227, s[12:15], s35 offen
    s_mov_b32 s35, 861440
    buffer_load_dwordx4 v[148:151], v227, s[12:15], s35 offen
    s_mov_b32 s35, 1033472
    buffer_load_dwordx4 v[152:155], v227, s[12:15], s35 offen
    s_mov_b32 s12, s44
    s_and_b32 s13, s45, 0xffff
    s_mov_b32 s14, 1204224
    s_mov_b32 s15, 0x00020000
    s_movk_i32 s35, 2688
    v_lshrrev_b32 v227, 2, v0
    v_mul_lo_u32 v227, v227, s35
    v_and_b32 v14, 3, v0
    v_lshl_add_u32 v227, v14, 4, v227
    s_mov_b32 s35, 1344
    buffer_load_dwordx4 v[156:159], v227, s[12:15], s35 offen
    s_mov_b32 s35, 173376
    buffer_load_dwordx4 v[160:163], v227, s[12:15], s35 offen
    s_mov_b32 s35, 345408
    buffer_load_dwordx4 v[164:167], v227, s[12:15], s35 offen
    s_mov_b32 s35, 517440
    buffer_load_dwordx4 v[168:171], v227, s[12:15], s35 offen
    s_mov_b32 s35, 689472
    buffer_load_dwordx4 v[172:175], v227, s[12:15], s35 offen
    s_mov_b32 s35, 861504
    buffer_load_dwordx4 v[176:179], v227, s[12:15], s35 offen
    s_mov_b32 s35, 1033536
    buffer_load_dwordx4 v[180:183], v227, s[12:15], s35 offen
    s_mov_b32 s54, 0x4924925
    v_add_u32 v13, 0, v2
    v_mul_hi_u32 v14, v13, s54
    v_lshlrev_b32 v13, 4, v13
    v_lshl_add_u32 v13, v14, 4, v13
    v_add_u32 v13, s53, v13
    s_waitcnt vmcnt(41)
    ds_write_b128 v13, v[16:19]
    v_add_u32 v13, 64, v2
    v_mul_hi_u32 v14, v13, s54
    v_lshlrev_b32 v13, 4, v13
    v_lshl_add_u32 v13, v14, 4, v13
    v_add_u32 v13, s53, v13
    s_waitcnt vmcnt(40)
    ds_write_b128 v13, v[20:23]
    v_add_u32 v13, 128, v2
    v_mul_hi_u32 v14, v13, s54
    v_lshlrev_b32 v13, 4, v13
    v_lshl_add_u32 v13, v14, 4, v13
    v_add_u32 v13, s53, v13
    s_waitcnt vmcnt(39)
    ds_write_b128 v13, v[24:27]
    v_add_u32 v13, 192, v2
    v_mul_hi_u32 v14, v13, s54
    v_lshlrev_b32 v13, 4, v13
    v_lshl_add_u32 v13, v14, 4, v13
    v_add_u32 v13, s53, v13
    s_waitcnt vmcnt(38)
    ds_write_b128 v13, v[28:31]
    v_add_u32 v13, 256, v2
    v_mul_hi_u32 v14, v13, s54
    v_lshlrev_b32 v13, 4, v13
    v_lshl_add_u32 v13, v14, 4, v13
    v_add_u32 v13, s53, v13
    s_waitcnt vmcnt(37)
    ds_write_b128 v13, v[32:35]
    v_add_u32 v13, 320, v2
    v_mul_hi_u32 v14, v13, s54
    v_lshlrev_b32 v13, 4, v13
    v_lshl_add_u32 v13, v14, 4, v13
    v_add_u32 v13, s53, v13
    s_waitcnt vmcnt(36)
    ds_write_b128 v13, v[36:39]
    v_add_u32 v13, 384, v2
    v_mul_hi_u32 v14, v13, s54
    v_lshlrev_b32 v13, 4, v13
    v_lshl_add_u32 v13, v14, 4, v13
    v_add_u32 v13, s53, v13
    s_waitcnt vmcnt(35)
    ds_write_b128 v13, v[40:43]
    v_add_u32 v13, 448, v2
    v_mul_hi_u32 v14, v13, s54
    v_lshlrev_b32 v13, 4, v13
    v_lshl_add_u32 v13, v14, 4, v13
    v_add_u32 v13, s53, v13
    s_waitcnt vmcnt(34)
    ds_write_b128 v13, v[44:47]
    v_add_u32 v13, 512, v2
    v_mul_hi_u32 v14, v13, s54
    v_lshlrev_b32 v13, 4, v13
    v_lshl_add_u32 v13, v14, 4, v13
    v_add_u32 v13, s53, v13
    s_waitcnt vmcnt(33)
    ds_write_b128 v13, v[48:51]
    v_add_u32 v13, 576, v2
    v_mul_hi_u32 v14, v13, s54
    v_lshlrev_b32 v13, 4, v13
    v_lshl_add_u32 v13, v14, 4, v13
    v_add_u32 v13, s53, v13
    s_waitcnt vmcnt(32)
    ds_write_b128 v13, v[52:55]
    v_add_u32 v13, 640, v2
    v_mul_hi_u32 v14, v13, s54
    v_lshlrev_b32 v13, 4, v13
    v_lshl_add_u32 v13, v14, 4, v13
    v_add_u32 v13, s53, v13
    s_waitcnt vmcnt(31)
    ds_write_b128 v13, v[56:59]
    v_add_u32 v13, 704, v2
    v_mul_hi_u32 v14, v13, s54
    v_lshlrev_b32 v13, 4, v13
    v_lshl_add_u32 v13, v14, 4, v13
    v_add_u32 v13, s53, v13
    s_waitcnt vmcnt(30)
    ds_write_b128 v13, v[60:63]
    v_add_u32 v13, 768, v2
    v_mul_hi_u32 v14, v13, s54
    v_lshlrev_b32 v13, 4, v13
    v_lshl_add_u32 v13, v14, 4, v13
    v_add_u32 v13, s53, v13
    s_waitcnt vmcnt(29)
    ds_write_b128 v13, v[64:67]
    v_add_u32 v13, 832, v2
    v_mul_hi_u32 v14, v13, s54
    v_lshlrev_b32 v13, 4, v13
    v_lshl_add_u32 v13, v14, 4, v13
    v_add_u32 v13, s53, v13
    s_waitcnt vmcnt(28)
    ds_write_b128 v13, v[68:71]
    v_add_u32 v13, 896, v2
    v_mul_hi_u32 v14, v13, s54
    v_lshlrev_b32 v13, 4, v13
    v_lshl_add_u32 v13, v14, 4, v13
    v_add_u32 v13, s53, v13
    s_waitcnt vmcnt(27)
    ds_write_b128 v13, v[72:75]
    v_add_u32 v13, 960, v2
    v_mul_hi_u32 v14, v13, s54
    v_lshlrev_b32 v13, 4, v13
    v_lshl_add_u32 v13, v14, 4, v13
    v_add_u32 v13, s53, v13
    s_waitcnt vmcnt(26)
    ds_write_b128 v13, v[76:79]
    v_add_u32 v13, 1024, v2
    v_mul_hi_u32 v14, v13, s54
    v_lshlrev_b32 v13, 4, v13
    v_lshl_add_u32 v13, v14, 4, v13
    v_add_u32 v13, s53, v13
    s_waitcnt vmcnt(25)
    ds_write_b128 v13, v[80:83]
    v_add_u32 v13, 1088, v2
    v_mul_hi_u32 v14, v13, s54
    v_lshlrev_b32 v13, 4, v13
    v_lshl_add_u32 v13, v14, 4, v13
    v_add_u32 v13, s53, v13
    s_waitcnt vmcnt(24)
    ds_write_b128 v13, v[84:87]
    v_add_u32 v13, 1152, v2
    v_mul_hi_u32 v14, v13, s54
    v_lshlrev_b32 v13, 4, v13
    v_lshl_add_u32 v13, v14, 4, v13
    v_add_u32 v13, s53, v13
    s_waitcnt vmcnt(23)
    ds_write_b128 v13, v[88:91]
    v_add_u32 v13, 1216, v2
    v_mul_hi_u32 v14, v13, s54
    v_lshlrev_b32 v13, 4, v13
    v_lshl_add_u32 v13, v14, 4, v13
    v_add_u32 v13, s53, v13
    s_waitcnt vmcnt(22)
    ds_write_b128 v13, v[92:95]
    v_add_u32 v13, 1280, v2
    v_mul_hi_u32 v14, v13, s54
    v_lshlrev_b32 v13, 4, v13
    v_lshl_add_u32 v13, v14, 4, v13
    v_add_u32 v13, s53, v13
    s_waitcnt vmcnt(21)
    ds_write_b128 v13, v[96:99]
    v_add_u32 v13, 1344, v2
    v_mul_hi_u32 v14, v13, s54
    v_lshlrev_b32 v13, 4, v13
    v_lshl_add_u32 v13, v14, 4, v13
    v_add_u32 v13, s53, v13
    s_waitcnt vmcnt(20)
    ds_write_b128 v13, v[100:103]
    v_add_u32 v13, 1408, v2
    v_mul_hi_u32 v14, v13, s54
    v_lshlrev_b32 v13, 4, v13
    v_lshl_add_u32 v13, v14, 4, v13
    v_add_u32 v13, s53, v13
    s_waitcnt vmcnt(19)
    ds_write_b128 v13, v[104:107]
    v_add_u32 v13, 1472, v2
    v_mul_hi_u32 v14, v13, s54
    v_lshlrev_b32 v13, 4, v13
    v_lshl_add_u32 v13, v14, 4, v13
    v_add_u32 v13, s53, v13
    s_waitcnt vmcnt(18)
    ds_write_b128 v13, v[108:111]
    v_add_u32 v13, 1536, v2
    v_mul_hi_u32 v14, v13, s54
    v_lshlrev_b32 v13, 4, v13
    v_lshl_add_u32 v13, v14, 4, v13
    v_add_u32 v13, s53, v13
    s_waitcnt vmcnt(17)
    ds_write_b128 v13, v[112:115]
    v_add_u32 v13, 1600, v2
    v_mul_hi_u32 v14, v13, s54
    v_lshlrev_b32 v13, 4, v13
    v_lshl_add_u32 v13, v14, 4, v13
    v_add_u32 v13, s53, v13
    s_waitcnt vmcnt(16)
    ds_write_b128 v13, v[116:119]
    v_add_u32 v13, 1664, v2
    v_mul_hi_u32 v14, v13, s54
    v_lshlrev_b32 v13, 4, v13
    v_lshl_add_u32 v13, v14, 4, v13
    v_add_u32 v13, s53, v13
    s_waitcnt vmcnt(15)
    ds_write_b128 v13, v[120:123]
    v_add_u32 v13, 1728, v2
    v_mul_hi_u32 v14, v13, s54
    v_lshlrev_b32 v13, 4, v13
    v_lshl_add_u32 v13, v14, 4, v13
    v_add_u32 v13, s53, v13
    s_waitcnt vmcnt(14)
    ds_write_b128 v13, v[124:127]
    v_mul_u32_u24 v13, 912, v3
    v_lshl_add_u32 v13, v4, 4, v13
    v_add_u32 v13, s53, v13
    s_waitcnt lgkmcnt(0)
    ds_read_b128 v[16:19], v13 offset:0
    ds_read_b128 v[20:23], v13 offset:32
    ds_read_b128 v[24:27], v13 offset:64
    ds_read_b128 v[28:31], v13 offset:96
    ds_read_b128 v[32:35], v13 offset:128
    ds_read_b128 v[36:39], v13 offset:160
    ds_read_b128 v[40:43], v13 offset:192
    ds_read_b128 v[44:47], v13 offset:224
    ds_read_b128 v[48:51], v13 offset:256
    ds_read_b128 v[52:55], v13 offset:288
    ds_read_b128 v[56:59], v13 offset:320
    ds_read_b128 v[60:63], v13 offset:352
    ds_read_b128 v[64:67], v13 offset:384
    ds_read_b128 v[68:71], v13 offset:416
    ds_read_b128 v[72:75], v13 offset:448
    ds_read_b128 v[76:79], v13 offset:480
    ds_read_b128 v[80:83], v13 offset:512
    ds_read_b128 v[84:87], v13 offset:544
    ds_read_b128 v[88:91], v13 offset:576
    ds_read_b128 v[92:95], v13 offset:608
    ds_read_b128 v[96:99], v13 offset:640
    ds_read_b128 v[100:103], v13 offset:672
    ds_read_b128 v[104:107], v13 offset:704
    ds_read_b128 v[108:111], v13 offset:736
    ds_read_b128 v[112:115], v13 offset:768
    ds_read_b128 v[116:119], v13 offset:800
    ds_read_b128 v[120:123], v13 offset:832
    ds_read_b128 v[124:127], v13 offset:864
    s_waitcnt lgkmcnt(0)
    s_barrier
    s_waitcnt vmcnt(13)
    ds_write_b128 v11, v[128:131] offset:0
    s_waitcnt vmcnt(12)
    ds_write_b128 v11, v[132:135] offset:4096
    s_waitcnt vmcnt(11)
    ds_write_b128 v11, v[136:139] offset:8192
    s_waitcnt vmcnt(10)
    ds_write_b128 v11, v[140:143] offset:12288
    s_waitcnt vmcnt(9)
    ds_write_b128 v11, v[144:147] offset:16384
    s_waitcnt vmcnt(8)
    ds_write_b128 v11, v[148:151] offset:20480
    s_waitcnt vmcnt(7)
    ds_write_b128 v11, v[152:155] offset:24576
    s_waitcnt vmcnt(6)
    ds_write_b128 v11, v[156:159] offset:28672
    s_waitcnt vmcnt(5)
    ds_write_b128 v11, v[160:163] offset:32768
    s_waitcnt vmcnt(4)
    ds_write_b128 v11, v[164:167] offset:36864
    s_waitcnt vmcnt(3)
    ds_write_b128 v11, v[168:171] offset:40960
    s_waitcnt vmcnt(2)
    ds_write_b128 v11, v[172:175] offset:45056
    s_waitcnt vmcnt(1)
    ds_write_b128 v11, v[176:179] offset:49152
    s_waitcnt vmcnt(0)
    ds_write_b128 v11, v[180:183] offset:53248
    s_mov_b32 s12, s44
    s_and_b32 s13, s45, 0xffff
    s_mov_b32 s14, 1204224
    s_mov_b32 s15, 0x00020000
    s_movk_i32 s35, 2688
    v_lshrrev_b32 v13, 2, v0
    v_mul_lo_u32 v13, v13, s35
    v_and_b32 v14, 3, v0
    v_lshl_add_u32 v13, v14, 4, v13
    s_mov_b32 s35, 1408
    buffer_load_dwordx4 v[128:131], v13, s[12:15], s35 offen
    s_mov_b32 s35, 173440
    buffer_load_dwordx4 v[132:135], v13, s[12:15], s35 offen
    s_mov_b32 s35, 345472
    buffer_load_dwordx4 v[136:139], v13, s[12:15], s35 offen
    s_mov_b32 s35, 517504
    buffer_load_dwordx4 v[140:143], v13, s[12:15], s35 offen
    s_mov_b32 s35, 689536
    buffer_load_dwordx4 v[144:147], v13, s[12:15], s35 offen
    s_mov_b32 s35, 861568
    buffer_load_dwordx4 v[148:151], v13, s[12:15], s35 offen
    s_mov_b32 s35, 1033600
    buffer_load_dwordx4 v[152:155], v13, s[12:15], s35 offen
    s_waitcnt vmcnt(6)
    ds_write_b128 v225, v[128:131] offset:0
    s_waitcnt vmcnt(5)
    ds_write_b128 v225, v[132:135] offset:4096
    s_waitcnt vmcnt(4)
    ds_write_b128 v225, v[136:139] offset:8192
    s_waitcnt vmcnt(3)
    ds_write_b128 v225, v[140:143] offset:12288
    s_waitcnt vmcnt(2)
    ds_write_b128 v225, v[144:147] offset:16384
    s_waitcnt vmcnt(1)
    ds_write_b128 v225, v[148:151] offset:20480
    s_waitcnt vmcnt(0)
    ds_write_b128 v225, v[152:155] offset:24576
    s_mov_b32 s12, s44
    s_and_b32 s13, s45, 0xffff
    s_mov_b32 s14, 1204224
    s_mov_b32 s15, 0x00020000
    s_movk_i32 s35, 2688
    v_lshrrev_b32 v13, 2, v0
    v_mul_lo_u32 v13, v13, s35
    v_and_b32 v14, 3, v0
    v_lshl_add_u32 v13, v14, 4, v13
    s_mov_b32 s35, 1472
    buffer_load_dwordx4 v[128:131], v13, s[12:15], s35 offen
    s_mov_b32 s35, 173504
    buffer_load_dwordx4 v[132:135], v13, s[12:15], s35 offen
    s_mov_b32 s35, 345536
    buffer_load_dwordx4 v[136:139], v13, s[12:15], s35 offen
    s_mov_b32 s35, 517568
    buffer_load_dwordx4 v[140:143], v13, s[12:15], s35 offen
    s_mov_b32 s35, 689600
    buffer_load_dwordx4 v[144:147], v13, s[12:15], s35 offen
    s_mov_b32 s35, 861632
    buffer_load_dwordx4 v[148:151], v13, s[12:15], s35 offen
    s_mov_b32 s35, 1033664
    buffer_load_dwordx4 v[152:155], v13, s[12:15], s35 offen
    s_waitcnt vmcnt(6)
    ds_write_b128 v225, v[128:131] offset:28672
    s_waitcnt vmcnt(5)
    ds_write_b128 v225, v[132:135] offset:32768
    s_waitcnt vmcnt(4)
    ds_write_b128 v225, v[136:139] offset:36864
    s_waitcnt vmcnt(3)
    ds_write_b128 v225, v[140:143] offset:40960
    s_waitcnt vmcnt(2)
    ds_write_b128 v225, v[144:147] offset:45056
    s_waitcnt vmcnt(1)
    ds_write_b128 v225, v[148:151] offset:49152
    s_waitcnt vmcnt(0)
    ds_write_b128 v225, v[152:155] offset:53248
    s_waitcnt lgkmcnt(0)
    s_barrier
    ds_read_b64_tr_b16 v[192:193], v7 offset:0
    ds_read_b64_tr_b16 v[194:195], v7 offset:256
    ds_read_b64_tr_b16 v[196:197], v7 offset:28672
    ds_read_b64_tr_b16 v[198:199], v7 offset:28928
    ds_read_b64_tr_b16 v[200:201], v224 offset:0
    ds_read_b64_tr_b16 v[202:203], v224 offset:256
    ds_read_b64_tr_b16 v[204:205], v224 offset:28672
    ds_read_b64_tr_b16 v[206:207], v224 offset:28928
    ds_read_b64_tr_b16 v[208:209], v7 offset:1024
    ds_read_b64_tr_b16 v[210:211], v7 offset:1280
    ds_read_b64_tr_b16 v[212:213], v7 offset:29696
    ds_read_b64_tr_b16 v[214:215], v7 offset:29952
    ds_read_b64_tr_b16 v[216:217], v224 offset:1024
    ds_read_b64_tr_b16 v[218:219], v224 offset:1280
    ds_read_b64_tr_b16 v[220:221], v224 offset:29696
    ds_read_b64_tr_b16 v[222:223], v224 offset:29952
    s_waitcnt lgkmcnt(8)
    v_mfma_f32_32x32x16_bf16 v[128:143], v[192:195], v[16:19], 0
    v_mfma_f32_32x32x16_bf16 v[144:159], v[196:199], v[16:19], 0
    v_mfma_f32_32x32x16_bf16 v[160:175], v[200:203], v[16:19], 0
    v_mfma_f32_32x32x16_bf16 v[176:191], v[204:207], v[16:19], 0
    ds_read_b64_tr_b16 v[192:193], v7 offset:2048
    ds_read_b64_tr_b16 v[194:195], v7 offset:2304
    ds_read_b64_tr_b16 v[196:197], v7 offset:30720
    ds_read_b64_tr_b16 v[198:199], v7 offset:30976
    ds_read_b64_tr_b16 v[200:201], v224 offset:2048
    ds_read_b64_tr_b16 v[202:203], v224 offset:2304
    ds_read_b64_tr_b16 v[204:205], v224 offset:30720
    ds_read_b64_tr_b16 v[206:207], v224 offset:30976
    s_waitcnt lgkmcnt(8)
    v_mfma_f32_32x32x16_bf16 v[128:143], v[208:211], v[20:23], v[128:143]
    v_mfma_f32_32x32x16_bf16 v[144:159], v[212:215], v[20:23], v[144:159]
    v_mfma_f32_32x32x16_bf16 v[160:175], v[216:219], v[20:23], v[160:175]
    v_mfma_f32_32x32x16_bf16 v[176:191], v[220:223], v[20:23], v[176:191]
    ds_read_b64_tr_b16 v[208:209], v7 offset:3072
    ds_read_b64_tr_b16 v[210:211], v7 offset:3328
    ds_read_b64_tr_b16 v[212:213], v7 offset:31744
    ds_read_b64_tr_b16 v[214:215], v7 offset:32000
    ds_read_b64_tr_b16 v[216:217], v224 offset:3072
    ds_read_b64_tr_b16 v[218:219], v224 offset:3328
    ds_read_b64_tr_b16 v[220:221], v224 offset:31744
    ds_read_b64_tr_b16 v[222:223], v224 offset:32000
    s_waitcnt lgkmcnt(8)
    v_mfma_f32_32x32x16_bf16 v[128:143], v[192:195], v[24:27], v[128:143]
    v_mfma_f32_32x32x16_bf16 v[144:159], v[196:199], v[24:27], v[144:159]
    v_mfma_f32_32x32x16_bf16 v[160:175], v[200:203], v[24:27], v[160:175]
    v_mfma_f32_32x32x16_bf16 v[176:191], v[204:207], v[24:27], v[176:191]
    ds_read_b64_tr_b16 v[192:193], v7 offset:4096
    ds_read_b64_tr_b16 v[194:195], v7 offset:4352
    ds_read_b64_tr_b16 v[196:197], v7 offset:32768
    ds_read_b64_tr_b16 v[198:199], v7 offset:33024
    ds_read_b64_tr_b16 v[200:201], v224 offset:4096
    ds_read_b64_tr_b16 v[202:203], v224 offset:4352
    ds_read_b64_tr_b16 v[204:205], v224 offset:32768
    ds_read_b64_tr_b16 v[206:207], v224 offset:33024
    s_waitcnt lgkmcnt(8)
    v_mfma_f32_32x32x16_bf16 v[128:143], v[208:211], v[28:31], v[128:143]
    v_mfma_f32_32x32x16_bf16 v[144:159], v[212:215], v[28:31], v[144:159]
    v_mfma_f32_32x32x16_bf16 v[160:175], v[216:219], v[28:31], v[160:175]
    v_mfma_f32_32x32x16_bf16 v[176:191], v[220:223], v[28:31], v[176:191]
    ds_read_b64_tr_b16 v[208:209], v7 offset:5120
    ds_read_b64_tr_b16 v[210:211], v7 offset:5376
    ds_read_b64_tr_b16 v[212:213], v7 offset:33792
    ds_read_b64_tr_b16 v[214:215], v7 offset:34048
    ds_read_b64_tr_b16 v[216:217], v224 offset:5120
    ds_read_b64_tr_b16 v[218:219], v224 offset:5376
    ds_read_b64_tr_b16 v[220:221], v224 offset:33792
    ds_read_b64_tr_b16 v[222:223], v224 offset:34048
    s_waitcnt lgkmcnt(8)
    v_mfma_f32_32x32x16_bf16 v[128:143], v[192:195], v[32:35], v[128:143]
    v_mfma_f32_32x32x16_bf16 v[144:159], v[196:199], v[32:35], v[144:159]
    v_mfma_f32_32x32x16_bf16 v[160:175], v[200:203], v[32:35], v[160:175]
    v_mfma_f32_32x32x16_bf16 v[176:191], v[204:207], v[32:35], v[176:191]
    ds_read_b64_tr_b16 v[192:193], v7 offset:6144
    ds_read_b64_tr_b16 v[194:195], v7 offset:6400
    ds_read_b64_tr_b16 v[196:197], v7 offset:34816
    ds_read_b64_tr_b16 v[198:199], v7 offset:35072
    ds_read_b64_tr_b16 v[200:201], v224 offset:6144
    ds_read_b64_tr_b16 v[202:203], v224 offset:6400
    ds_read_b64_tr_b16 v[204:205], v224 offset:34816
    ds_read_b64_tr_b16 v[206:207], v224 offset:35072
    s_waitcnt lgkmcnt(8)
    v_mfma_f32_32x32x16_bf16 v[128:143], v[208:211], v[36:39], v[128:143]
    v_mfma_f32_32x32x16_bf16 v[144:159], v[212:215], v[36:39], v[144:159]
    v_mfma_f32_32x32x16_bf16 v[160:175], v[216:219], v[36:39], v[160:175]
    v_mfma_f32_32x32x16_bf16 v[176:191], v[220:223], v[36:39], v[176:191]
    ds_read_b64_tr_b16 v[208:209], v7 offset:7168
    ds_read_b64_tr_b16 v[210:211], v7 offset:7424
    ds_read_b64_tr_b16 v[212:213], v7 offset:35840
    ds_read_b64_tr_b16 v[214:215], v7 offset:36096
    ds_read_b64_tr_b16 v[216:217], v224 offset:7168
    ds_read_b64_tr_b16 v[218:219], v224 offset:7424
    ds_read_b64_tr_b16 v[220:221], v224 offset:35840
    ds_read_b64_tr_b16 v[222:223], v224 offset:36096
    s_waitcnt lgkmcnt(8)
    v_mfma_f32_32x32x16_bf16 v[128:143], v[192:195], v[40:43], v[128:143]
    v_mfma_f32_32x32x16_bf16 v[144:159], v[196:199], v[40:43], v[144:159]
    v_mfma_f32_32x32x16_bf16 v[160:175], v[200:203], v[40:43], v[160:175]
    v_mfma_f32_32x32x16_bf16 v[176:191], v[204:207], v[40:43], v[176:191]
    ds_read_b64_tr_b16 v[192:193], v7 offset:8192
    ds_read_b64_tr_b16 v[194:195], v7 offset:8448
    ds_read_b64_tr_b16 v[196:197], v7 offset:36864
    ds_read_b64_tr_b16 v[198:199], v7 offset:37120
    ds_read_b64_tr_b16 v[200:201], v224 offset:8192
    ds_read_b64_tr_b16 v[202:203], v224 offset:8448
    ds_read_b64_tr_b16 v[204:205], v224 offset:36864
    ds_read_b64_tr_b16 v[206:207], v224 offset:37120
    s_waitcnt lgkmcnt(8)
    v_mfma_f32_32x32x16_bf16 v[128:143], v[208:211], v[44:47], v[128:143]
    v_mfma_f32_32x32x16_bf16 v[144:159], v[212:215], v[44:47], v[144:159]
    v_mfma_f32_32x32x16_bf16 v[160:175], v[216:219], v[44:47], v[160:175]
    v_mfma_f32_32x32x16_bf16 v[176:191], v[220:223], v[44:47], v[176:191]
    ds_read_b64_tr_b16 v[208:209], v7 offset:9216
    ds_read_b64_tr_b16 v[210:211], v7 offset:9472
    ds_read_b64_tr_b16 v[212:213], v7 offset:37888
    ds_read_b64_tr_b16 v[214:215], v7 offset:38144
    ds_read_b64_tr_b16 v[216:217], v224 offset:9216
    ds_read_b64_tr_b16 v[218:219], v224 offset:9472
    ds_read_b64_tr_b16 v[220:221], v224 offset:37888
    ds_read_b64_tr_b16 v[222:223], v224 offset:38144
    s_waitcnt lgkmcnt(8)
    v_mfma_f32_32x32x16_bf16 v[128:143], v[192:195], v[48:51], v[128:143]
    v_mfma_f32_32x32x16_bf16 v[144:159], v[196:199], v[48:51], v[144:159]
    v_mfma_f32_32x32x16_bf16 v[160:175], v[200:203], v[48:51], v[160:175]
    v_mfma_f32_32x32x16_bf16 v[176:191], v[204:207], v[48:51], v[176:191]
    ds_read_b64_tr_b16 v[192:193], v7 offset:10240
    ds_read_b64_tr_b16 v[194:195], v7 offset:10496
    ds_read_b64_tr_b16 v[196:197], v7 offset:38912
    ds_read_b64_tr_b16 v[198:199], v7 offset:39168
    ds_read_b64_tr_b16 v[200:201], v224 offset:10240
    ds_read_b64_tr_b16 v[202:203], v224 offset:10496
    ds_read_b64_tr_b16 v[204:205], v224 offset:38912
    ds_read_b64_tr_b16 v[206:207], v224 offset:39168
    s_waitcnt lgkmcnt(8)
    v_mfma_f32_32x32x16_bf16 v[128:143], v[208:211], v[52:55], v[128:143]
    v_mfma_f32_32x32x16_bf16 v[144:159], v[212:215], v[52:55], v[144:159]
    v_mfma_f32_32x32x16_bf16 v[160:175], v[216:219], v[52:55], v[160:175]
    v_mfma_f32_32x32x16_bf16 v[176:191], v[220:223], v[52:55], v[176:191]
    ds_read_b64_tr_b16 v[208:209], v7 offset:11264
    ds_read_b64_tr_b16 v[210:211], v7 offset:11520
    ds_read_b64_tr_b16 v[212:213], v7 offset:39936
    ds_read_b64_tr_b16 v[214:215], v7 offset:40192
    ds_read_b64_tr_b16 v[216:217], v224 offset:11264
    ds_read_b64_tr_b16 v[218:219], v224 offset:11520
    ds_read_b64_tr_b16 v[220:221], v224 offset:39936
    ds_read_b64_tr_b16 v[222:223], v224 offset:40192
    s_waitcnt lgkmcnt(8)
    v_mfma_f32_32x32x16_bf16 v[128:143], v[192:195], v[56:59], v[128:143]
    v_mfma_f32_32x32x16_bf16 v[144:159], v[196:199], v[56:59], v[144:159]
    v_mfma_f32_32x32x16_bf16 v[160:175], v[200:203], v[56:59], v[160:175]
    v_mfma_f32_32x32x16_bf16 v[176:191], v[204:207], v[56:59], v[176:191]
    ds_read_b64_tr_b16 v[192:193], v7 offset:12288
    ds_read_b64_tr_b16 v[194:195], v7 offset:12544
    ds_read_b64_tr_b16 v[196:197], v7 offset:40960
    ds_read_b64_tr_b16 v[198:199], v7 offset:41216
    ds_read_b64_tr_b16 v[200:201], v224 offset:12288
    ds_read_b64_tr_b16 v[202:203], v224 offset:12544
    ds_read_b64_tr_b16 v[204:205], v224 offset:40960
    ds_read_b64_tr_b16 v[206:207], v224 offset:41216
    s_waitcnt lgkmcnt(8)
    v_mfma_f32_32x32x16_bf16 v[128:143], v[208:211], v[60:63], v[128:143]
    v_mfma_f32_32x32x16_bf16 v[144:159], v[212:215], v[60:63], v[144:159]
    v_mfma_f32_32x32x16_bf16 v[160:175], v[216:219], v[60:63], v[160:175]
    v_mfma_f32_32x32x16_bf16 v[176:191], v[220:223], v[60:63], v[176:191]
    ds_read_b64_tr_b16 v[208:209], v7 offset:13312
    ds_read_b64_tr_b16 v[210:211], v7 offset:13568
    ds_read_b64_tr_b16 v[212:213], v7 offset:41984
    ds_read_b64_tr_b16 v[214:215], v7 offset:42240
    ds_read_b64_tr_b16 v[216:217], v224 offset:13312
    ds_read_b64_tr_b16 v[218:219], v224 offset:13568
    ds_read_b64_tr_b16 v[220:221], v224 offset:41984
    ds_read_b64_tr_b16 v[222:223], v224 offset:42240
    s_waitcnt lgkmcnt(8)
    v_mfma_f32_32x32x16_bf16 v[128:143], v[192:195], v[64:67], v[128:143]
    v_mfma_f32_32x32x16_bf16 v[144:159], v[196:199], v[64:67], v[144:159]
    v_mfma_f32_32x32x16_bf16 v[160:175], v[200:203], v[64:67], v[160:175]
    v_mfma_f32_32x32x16_bf16 v[176:191], v[204:207], v[64:67], v[176:191]
    ds_read_b64_tr_b16 v[192:193], v7 offset:14336
    ds_read_b64_tr_b16 v[194:195], v7 offset:14592
    ds_read_b64_tr_b16 v[196:197], v7 offset:43008
    ds_read_b64_tr_b16 v[198:199], v7 offset:43264
    ds_read_b64_tr_b16 v[200:201], v224 offset:14336
    ds_read_b64_tr_b16 v[202:203], v224 offset:14592
    ds_read_b64_tr_b16 v[204:205], v224 offset:43008
    ds_read_b64_tr_b16 v[206:207], v224 offset:43264
    s_waitcnt lgkmcnt(8)
    v_mfma_f32_32x32x16_bf16 v[128:143], v[208:211], v[68:71], v[128:143]
    v_mfma_f32_32x32x16_bf16 v[144:159], v[212:215], v[68:71], v[144:159]
    v_mfma_f32_32x32x16_bf16 v[160:175], v[216:219], v[68:71], v[160:175]
    v_mfma_f32_32x32x16_bf16 v[176:191], v[220:223], v[68:71], v[176:191]
    ds_read_b64_tr_b16 v[208:209], v7 offset:15360
    ds_read_b64_tr_b16 v[210:211], v7 offset:15616
    ds_read_b64_tr_b16 v[212:213], v7 offset:44032
    ds_read_b64_tr_b16 v[214:215], v7 offset:44288
    ds_read_b64_tr_b16 v[216:217], v224 offset:15360
    ds_read_b64_tr_b16 v[218:219], v224 offset:15616
    ds_read_b64_tr_b16 v[220:221], v224 offset:44032
    ds_read_b64_tr_b16 v[222:223], v224 offset:44288
    s_waitcnt lgkmcnt(8)
    v_mfma_f32_32x32x16_bf16 v[128:143], v[192:195], v[72:75], v[128:143]
    v_mfma_f32_32x32x16_bf16 v[144:159], v[196:199], v[72:75], v[144:159]
    v_mfma_f32_32x32x16_bf16 v[160:175], v[200:203], v[72:75], v[160:175]
    v_mfma_f32_32x32x16_bf16 v[176:191], v[204:207], v[72:75], v[176:191]
    ds_read_b64_tr_b16 v[192:193], v7 offset:16384
    ds_read_b64_tr_b16 v[194:195], v7 offset:16640
    ds_read_b64_tr_b16 v[196:197], v7 offset:45056
    ds_read_b64_tr_b16 v[198:199], v7 offset:45312
    ds_read_b64_tr_b16 v[200:201], v224 offset:16384
    ds_read_b64_tr_b16 v[202:203], v224 offset:16640
    ds_read_b64_tr_b16 v[204:205], v224 offset:45056
    ds_read_b64_tr_b16 v[206:207], v224 offset:45312
    s_waitcnt lgkmcnt(8)
    v_mfma_f32_32x32x16_bf16 v[128:143], v[208:211], v[76:79], v[128:143]
    v_mfma_f32_32x32x16_bf16 v[144:159], v[212:215], v[76:79], v[144:159]
    v_mfma_f32_32x32x16_bf16 v[160:175], v[216:219], v[76:79], v[160:175]
    v_mfma_f32_32x32x16_bf16 v[176:191], v[220:223], v[76:79], v[176:191]
    ds_read_b64_tr_b16 v[208:209], v7 offset:17408
    ds_read_b64_tr_b16 v[210:211], v7 offset:17664
    ds_read_b64_tr_b16 v[212:213], v7 offset:46080
    ds_read_b64_tr_b16 v[214:215], v7 offset:46336
    ds_read_b64_tr_b16 v[216:217], v224 offset:17408
    ds_read_b64_tr_b16 v[218:219], v224 offset:17664
    ds_read_b64_tr_b16 v[220:221], v224 offset:46080
    ds_read_b64_tr_b16 v[222:223], v224 offset:46336
    s_waitcnt lgkmcnt(8)
    v_mfma_f32_32x32x16_bf16 v[128:143], v[192:195], v[80:83], v[128:143]
    v_mfma_f32_32x32x16_bf16 v[144:159], v[196:199], v[80:83], v[144:159]
    v_mfma_f32_32x32x16_bf16 v[160:175], v[200:203], v[80:83], v[160:175]
    v_mfma_f32_32x32x16_bf16 v[176:191], v[204:207], v[80:83], v[176:191]
    ds_read_b64_tr_b16 v[192:193], v7 offset:18432
    ds_read_b64_tr_b16 v[194:195], v7 offset:18688
    ds_read_b64_tr_b16 v[196:197], v7 offset:47104
    ds_read_b64_tr_b16 v[198:199], v7 offset:47360
    ds_read_b64_tr_b16 v[200:201], v224 offset:18432
    ds_read_b64_tr_b16 v[202:203], v224 offset:18688
    ds_read_b64_tr_b16 v[204:205], v224 offset:47104
    ds_read_b64_tr_b16 v[206:207], v224 offset:47360
    s_waitcnt lgkmcnt(8)
    v_mfma_f32_32x32x16_bf16 v[128:143], v[208:211], v[84:87], v[128:143]
    v_mfma_f32_32x32x16_bf16 v[144:159], v[212:215], v[84:87], v[144:159]
    v_mfma_f32_32x32x16_bf16 v[160:175], v[216:219], v[84:87], v[160:175]
    v_mfma_f32_32x32x16_bf16 v[176:191], v[220:223], v[84:87], v[176:191]
    ds_read_b64_tr_b16 v[208:209], v7 offset:19456
    ds_read_b64_tr_b16 v[210:211], v7 offset:19712
    ds_read_b64_tr_b16 v[212:213], v7 offset:48128
    ds_read_b64_tr_b16 v[214:215], v7 offset:48384
    ds_read_b64_tr_b16 v[216:217], v224 offset:19456
    ds_read_b64_tr_b16 v[218:219], v224 offset:19712
    ds_read_b64_tr_b16 v[220:221], v224 offset:48128
    ds_read_b64_tr_b16 v[222:223], v224 offset:48384
    s_waitcnt lgkmcnt(8)
    v_mfma_f32_32x32x16_bf16 v[128:143], v[192:195], v[88:91], v[128:143]
    v_mfma_f32_32x32x16_bf16 v[144:159], v[196:199], v[88:91], v[144:159]
    v_mfma_f32_32x32x16_bf16 v[160:175], v[200:203], v[88:91], v[160:175]
    v_mfma_f32_32x32x16_bf16 v[176:191], v[204:207], v[88:91], v[176:191]
    ds_read_b64_tr_b16 v[192:193], v7 offset:20480
    ds_read_b64_tr_b16 v[194:195], v7 offset:20736
    ds_read_b64_tr_b16 v[196:197], v7 offset:49152
    ds_read_b64_tr_b16 v[198:199], v7 offset:49408
    ds_read_b64_tr_b16 v[200:201], v224 offset:20480
    ds_read_b64_tr_b16 v[202:203], v224 offset:20736
    ds_read_b64_tr_b16 v[204:205], v224 offset:49152
    ds_read_b64_tr_b16 v[206:207], v224 offset:49408
    s_waitcnt lgkmcnt(8)
    v_mfma_f32_32x32x16_bf16 v[128:143], v[208:211], v[92:95], v[128:143]
    v_mfma_f32_32x32x16_bf16 v[144:159], v[212:215], v[92:95], v[144:159]
    v_mfma_f32_32x32x16_bf16 v[160:175], v[216:219], v[92:95], v[160:175]
    v_mfma_f32_32x32x16_bf16 v[176:191], v[220:223], v[92:95], v[176:191]
    ds_read_b64_tr_b16 v[208:209], v7 offset:21504
    ds_read_b64_tr_b16 v[210:211], v7 offset:21760
    ds_read_b64_tr_b16 v[212:213], v7 offset:50176
    ds_read_b64_tr_b16 v[214:215], v7 offset:50432
    ds_read_b64_tr_b16 v[216:217], v224 offset:21504
    ds_read_b64_tr_b16 v[218:219], v224 offset:21760
    ds_read_b64_tr_b16 v[220:221], v224 offset:50176
    ds_read_b64_tr_b16 v[222:223], v224 offset:50432
    s_waitcnt lgkmcnt(8)
    v_mfma_f32_32x32x16_bf16 v[128:143], v[192:195], v[96:99], v[128:143]
    v_mfma_f32_32x32x16_bf16 v[144:159], v[196:199], v[96:99], v[144:159]
    v_mfma_f32_32x32x16_bf16 v[160:175], v[200:203], v[96:99], v[160:175]
    v_mfma_f32_32x32x16_bf16 v[176:191], v[204:207], v[96:99], v[176:191]
    ds_read_b64_tr_b16 v[192:193], v7 offset:22528
    ds_read_b64_tr_b16 v[194:195], v7 offset:22784
    ds_read_b64_tr_b16 v[196:197], v7 offset:51200
    ds_read_b64_tr_b16 v[198:199], v7 offset:51456
    ds_read_b64_tr_b16 v[200:201], v224 offset:22528
    ds_read_b64_tr_b16 v[202:203], v224 offset:22784
    ds_read_b64_tr_b16 v[204:205], v224 offset:51200
    ds_read_b64_tr_b16 v[206:207], v224 offset:51456
    s_waitcnt lgkmcnt(8)
    v_mfma_f32_32x32x16_bf16 v[128:143], v[208:211], v[100:103], v[128:143]
    v_mfma_f32_32x32x16_bf16 v[144:159], v[212:215], v[100:103], v[144:159]
    v_mfma_f32_32x32x16_bf16 v[160:175], v[216:219], v[100:103], v[160:175]
    v_mfma_f32_32x32x16_bf16 v[176:191], v[220:223], v[100:103], v[176:191]
    ds_read_b64_tr_b16 v[208:209], v7 offset:23552
    ds_read_b64_tr_b16 v[210:211], v7 offset:23808
    ds_read_b64_tr_b16 v[212:213], v7 offset:52224
    ds_read_b64_tr_b16 v[214:215], v7 offset:52480
    ds_read_b64_tr_b16 v[216:217], v224 offset:23552
    ds_read_b64_tr_b16 v[218:219], v224 offset:23808
    ds_read_b64_tr_b16 v[220:221], v224 offset:52224
    ds_read_b64_tr_b16 v[222:223], v224 offset:52480
    s_waitcnt lgkmcnt(8)
    v_mfma_f32_32x32x16_bf16 v[128:143], v[192:195], v[104:107], v[128:143]
    v_mfma_f32_32x32x16_bf16 v[144:159], v[196:199], v[104:107], v[144:159]
    v_mfma_f32_32x32x16_bf16 v[160:175], v[200:203], v[104:107], v[160:175]
    v_mfma_f32_32x32x16_bf16 v[176:191], v[204:207], v[104:107], v[176:191]
    ds_read_b64_tr_b16 v[192:193], v7 offset:24576
    ds_read_b64_tr_b16 v[194:195], v7 offset:24832
    ds_read_b64_tr_b16 v[196:197], v7 offset:53248
    ds_read_b64_tr_b16 v[198:199], v7 offset:53504
    ds_read_b64_tr_b16 v[200:201], v224 offset:24576
    ds_read_b64_tr_b16 v[202:203], v224 offset:24832
    ds_read_b64_tr_b16 v[204:205], v224 offset:53248
    ds_read_b64_tr_b16 v[206:207], v224 offset:53504
    s_waitcnt lgkmcnt(8)
    v_mfma_f32_32x32x16_bf16 v[128:143], v[208:211], v[108:111], v[128:143]
    v_mfma_f32_32x32x16_bf16 v[144:159], v[212:215], v[108:111], v[144:159]
    v_mfma_f32_32x32x16_bf16 v[160:175], v[216:219], v[108:111], v[160:175]
    v_mfma_f32_32x32x16_bf16 v[176:191], v[220:223], v[108:111], v[176:191]
    ds_read_b64_tr_b16 v[208:209], v7 offset:25600
    ds_read_b64_tr_b16 v[210:211], v7 offset:25856
    ds_read_b64_tr_b16 v[212:213], v7 offset:54272
    ds_read_b64_tr_b16 v[214:215], v7 offset:54528
    ds_read_b64_tr_b16 v[216:217], v224 offset:25600
    ds_read_b64_tr_b16 v[218:219], v224 offset:25856
    ds_read_b64_tr_b16 v[220:221], v224 offset:54272
    ds_read_b64_tr_b16 v[222:223], v224 offset:54528
    s_waitcnt lgkmcnt(8)
    v_mfma_f32_32x32x16_bf16 v[128:143], v[192:195], v[112:115], v[128:143]
    v_mfma_f32_32x32x16_bf16 v[144:159], v[196:199], v[112:115], v[144:159]
    v_mfma_f32_32x32x16_bf16 v[160:175], v[200:203], v[112:115], v[160:175]
    v_mfma_f32_32x32x16_bf16 v[176:191], v[204:207], v[112:115], v[176:191]
    ds_read_b64_tr_b16 v[192:193], v7 offset:26624
    ds_read_b64_tr_b16 v[194:195], v7 offset:26880
    ds_read_b64_tr_b16 v[196:197], v7 offset:55296
    ds_read_b64_tr_b16 v[198:199], v7 offset:55552
    ds_read_b64_tr_b16 v[200:201], v224 offset:26624
    ds_read_b64_tr_b16 v[202:203], v224 offset:26880
    ds_read_b64_tr_b16 v[204:205], v224 offset:55296
    ds_read_b64_tr_b16 v[206:207], v224 offset:55552
    s_waitcnt lgkmcnt(8)
    v_mfma_f32_32x32x16_bf16 v[128:143], v[208:211], v[116:119], v[128:143]
    v_mfma_f32_32x32x16_bf16 v[144:159], v[212:215], v[116:119], v[144:159]
    v_mfma_f32_32x32x16_bf16 v[160:175], v[216:219], v[116:119], v[160:175]
    v_mfma_f32_32x32x16_bf16 v[176:191], v[220:223], v[116:119], v[176:191]
    ds_read_b64_tr_b16 v[208:209], v7 offset:27648
    ds_read_b64_tr_b16 v[210:211], v7 offset:27904
    ds_read_b64_tr_b16 v[212:213], v7 offset:56320
    ds_read_b64_tr_b16 v[214:215], v7 offset:56576
    ds_read_b64_tr_b16 v[216:217], v224 offset:27648
    ds_read_b64_tr_b16 v[218:219], v224 offset:27904
    ds_read_b64_tr_b16 v[220:221], v224 offset:56320
    ds_read_b64_tr_b16 v[222:223], v224 offset:56576
    s_waitcnt lgkmcnt(8)
    v_mfma_f32_32x32x16_bf16 v[128:143], v[192:195], v[120:123], v[128:143]
    v_mfma_f32_32x32x16_bf16 v[144:159], v[196:199], v[120:123], v[144:159]
    v_mfma_f32_32x32x16_bf16 v[160:175], v[200:203], v[120:123], v[160:175]
    v_mfma_f32_32x32x16_bf16 v[176:191], v[204:207], v[120:123], v[176:191]
    s_waitcnt lgkmcnt(0)
    v_mfma_f32_32x32x16_bf16 v[128:143], v[208:211], v[124:127], v[128:143]
    v_mfma_f32_32x32x16_bf16 v[144:159], v[212:215], v[124:127], v[144:159]
    v_mfma_f32_32x32x16_bf16 v[160:175], v[216:219], v[124:127], v[160:175]
    v_mfma_f32_32x32x16_bf16 v[176:191], v[220:223], v[124:127], v[176:191]
    s_nop 15
    s_nop 3
    s_movk_i32 s35, 1792
    v_mul_lo_u32 v13, v5, s35
    v_lshl_add_u32 v13, v4, 3, v13
    v_add_u32 v13, 2360576, v13
    v_cvt_pk_bf16_f32 v128, v128, v129
    v_cvt_pk_bf16_f32 v129, v130, v131
    buffer_store_dwordx2 v[128:129], v13, s[16:19], 0 offen offset:0
    v_cvt_pk_bf16_f32 v132, v132, v133
    v_cvt_pk_bf16_f32 v133, v134, v135
    buffer_store_dwordx2 v[132:133], v13, s[16:19], 0 offen offset:16
    v_cvt_pk_bf16_f32 v136, v136, v137
    v_cvt_pk_bf16_f32 v137, v138, v139
    buffer_store_dwordx2 v[136:137], v13, s[16:19], 0 offen offset:32
    v_cvt_pk_bf16_f32 v140, v140, v141
    v_cvt_pk_bf16_f32 v141, v142, v143
    buffer_store_dwordx2 v[140:141], v13, s[16:19], 0 offen offset:48
    s_movk_i32 s35, 1792
    v_mul_lo_u32 v13, v5, s35
    v_lshl_add_u32 v13, v4, 3, v13
    v_add_u32 v13, 2360640, v13
    v_cvt_pk_bf16_f32 v144, v144, v145
    v_cvt_pk_bf16_f32 v145, v146, v147
    buffer_store_dwordx2 v[144:145], v13, s[16:19], 0 offen offset:0
    v_cvt_pk_bf16_f32 v148, v148, v149
    v_cvt_pk_bf16_f32 v149, v150, v151
    buffer_store_dwordx2 v[148:149], v13, s[16:19], 0 offen offset:16
    v_cvt_pk_bf16_f32 v152, v152, v153
    v_cvt_pk_bf16_f32 v153, v154, v155
    buffer_store_dwordx2 v[152:153], v13, s[16:19], 0 offen offset:32
    v_cvt_pk_bf16_f32 v156, v156, v157
    v_cvt_pk_bf16_f32 v157, v158, v159
    buffer_store_dwordx2 v[156:157], v13, s[16:19], 0 offen offset:48
    s_movk_i32 s35, 1792
    v_mul_lo_u32 v13, v5, s35
    v_lshl_add_u32 v13, v4, 3, v13
    v_add_u32 v13, 2360704, v13
    v_cvt_pk_bf16_f32 v160, v160, v161
    v_cvt_pk_bf16_f32 v161, v162, v163
    buffer_store_dwordx2 v[160:161], v13, s[16:19], 0 offen offset:0
    v_cvt_pk_bf16_f32 v164, v164, v165
    v_cvt_pk_bf16_f32 v165, v166, v167
    buffer_store_dwordx2 v[164:165], v13, s[16:19], 0 offen offset:16
    v_cvt_pk_bf16_f32 v168, v168, v169
    v_cvt_pk_bf16_f32 v169, v170, v171
    buffer_store_dwordx2 v[168:169], v13, s[16:19], 0 offen offset:32
    v_cvt_pk_bf16_f32 v172, v172, v173
    v_cvt_pk_bf16_f32 v173, v174, v175
    buffer_store_dwordx2 v[172:173], v13, s[16:19], 0 offen offset:48
    s_movk_i32 s35, 1792
    v_mul_lo_u32 v13, v5, s35
    v_lshl_add_u32 v13, v4, 3, v13
    v_add_u32 v13, 2360768, v13
    v_cvt_pk_bf16_f32 v176, v176, v177
    v_cvt_pk_bf16_f32 v177, v178, v179
    buffer_store_dwordx2 v[176:177], v13, s[16:19], 0 offen offset:0
    v_cvt_pk_bf16_f32 v180, v180, v181
    v_cvt_pk_bf16_f32 v181, v182, v183
    buffer_store_dwordx2 v[180:181], v13, s[16:19], 0 offen offset:16
    v_cvt_pk_bf16_f32 v184, v184, v185
    v_cvt_pk_bf16_f32 v185, v186, v187
    buffer_store_dwordx2 v[184:185], v13, s[16:19], 0 offen offset:32
    v_cvt_pk_bf16_f32 v188, v188, v189
    v_cvt_pk_bf16_f32 v189, v190, v191
    buffer_store_dwordx2 v[188:189], v13, s[16:19], 0 offen offset:48
    s_endpgm
K1_v10:
    s_mov_b32 s12, s44
    s_and_b32 s13, s45, 0xffff
    s_mov_b32 s14, 1204224
    s_mov_b32 s15, 0x00020000
    s_movk_i32 s35, 2688
    v_lshrrev_b32 v227, 2, v0
    v_mul_lo_u32 v227, v227, s35
    v_and_b32 v14, 3, v0
    v_lshl_add_u32 v227, v14, 4, v227
    s_mov_b32 s35, 1536
    buffer_load_dwordx4 v[128:131], v227, s[12:15], s35 offen
    s_mov_b32 s35, 173568
    buffer_load_dwordx4 v[132:135], v227, s[12:15], s35 offen
    s_mov_b32 s35, 345600
    buffer_load_dwordx4 v[136:139], v227, s[12:15], s35 offen
    s_mov_b32 s35, 517632
    buffer_load_dwordx4 v[140:143], v227, s[12:15], s35 offen
    s_mov_b32 s35, 689664
    buffer_load_dwordx4 v[144:147], v227, s[12:15], s35 offen
    s_mov_b32 s35, 861696
    buffer_load_dwordx4 v[148:151], v227, s[12:15], s35 offen
    s_mov_b32 s35, 1033728
    buffer_load_dwordx4 v[152:155], v227, s[12:15], s35 offen
    s_mov_b32 s12, s44
    s_and_b32 s13, s45, 0xffff
    s_mov_b32 s14, 1204224
    s_mov_b32 s15, 0x00020000
    s_movk_i32 s35, 2688
    v_lshrrev_b32 v227, 2, v0
    v_mul_lo_u32 v227, v227, s35
    v_and_b32 v14, 3, v0
    v_lshl_add_u32 v227, v14, 4, v227
    s_mov_b32 s35, 1600
    buffer_load_dwordx4 v[156:159], v227, s[12:15], s35 offen
    s_mov_b32 s35, 173632
    buffer_load_dwordx4 v[160:163], v227, s[12:15], s35 offen
    s_mov_b32 s35, 345664
    buffer_load_dwordx4 v[164:167], v227, s[12:15], s35 offen
    s_mov_b32 s35, 517696
    buffer_load_dwordx4 v[168:171], v227, s[12:15], s35 offen
    s_mov_b32 s35, 689728
    buffer_load_dwordx4 v[172:175], v227, s[12:15], s35 offen
    s_mov_b32 s35, 861760
    buffer_load_dwordx4 v[176:179], v227, s[12:15], s35 offen
    s_mov_b32 s35, 1033792
    buffer_load_dwordx4 v[180:183], v227, s[12:15], s35 offen
    s_mov_b32 s54, 0x4924925
    v_add_u32 v13, 0, v2
    v_mul_hi_u32 v14, v13, s54
    v_lshlrev_b32 v13, 4, v13
    v_lshl_add_u32 v13, v14, 4, v13
    v_add_u32 v13, s53, v13
    s_waitcnt vmcnt(41)
    ds_write_b128 v13, v[16:19]
    v_add_u32 v13, 64, v2
    v_mul_hi_u32 v14, v13, s54
    v_lshlrev_b32 v13, 4, v13
    v_lshl_add_u32 v13, v14, 4, v13
    v_add_u32 v13, s53, v13
    s_waitcnt vmcnt(40)
    ds_write_b128 v13, v[20:23]
    v_add_u32 v13, 128, v2
    v_mul_hi_u32 v14, v13, s54
    v_lshlrev_b32 v13, 4, v13
    v_lshl_add_u32 v13, v14, 4, v13
    v_add_u32 v13, s53, v13
    s_waitcnt vmcnt(39)
    ds_write_b128 v13, v[24:27]
    v_add_u32 v13, 192, v2
    v_mul_hi_u32 v14, v13, s54
    v_lshlrev_b32 v13, 4, v13
    v_lshl_add_u32 v13, v14, 4, v13
    v_add_u32 v13, s53, v13
    s_waitcnt vmcnt(38)
    ds_write_b128 v13, v[28:31]
    v_add_u32 v13, 256, v2
    v_mul_hi_u32 v14, v13, s54
    v_lshlrev_b32 v13, 4, v13
    v_lshl_add_u32 v13, v14, 4, v13
    v_add_u32 v13, s53, v13
    s_waitcnt vmcnt(37)
    ds_write_b128 v13, v[32:35]
    v_add_u32 v13, 320, v2
    v_mul_hi_u32 v14, v13, s54
    v_lshlrev_b32 v13, 4, v13
    v_lshl_add_u32 v13, v14, 4, v13
    v_add_u32 v13, s53, v13
    s_waitcnt vmcnt(36)
    ds_write_b128 v13, v[36:39]
    v_add_u32 v13, 384, v2
    v_mul_hi_u32 v14, v13, s54
    v_lshlrev_b32 v13, 4, v13
    v_lshl_add_u32 v13, v14, 4, v13
    v_add_u32 v13, s53, v13
    s_waitcnt vmcnt(35)
    ds_write_b128 v13, v[40:43]
    v_add_u32 v13, 448, v2
    v_mul_hi_u32 v14, v13, s54
    v_lshlrev_b32 v13, 4, v13
    v_lshl_add_u32 v13, v14, 4, v13
    v_add_u32 v13, s53, v13
    s_waitcnt vmcnt(34)
    ds_write_b128 v13, v[44:47]
    v_add_u32 v13, 512, v2
    v_mul_hi_u32 v14, v13, s54
    v_lshlrev_b32 v13, 4, v13
    v_lshl_add_u32 v13, v14, 4, v13
    v_add_u32 v13, s53, v13
    s_waitcnt vmcnt(33)
    ds_write_b128 v13, v[48:51]
    v_add_u32 v13, 576, v2
    v_mul_hi_u32 v14, v13, s54
    v_lshlrev_b32 v13, 4, v13
    v_lshl_add_u32 v13, v14, 4, v13
    v_add_u32 v13, s53, v13
    s_waitcnt vmcnt(32)
    ds_write_b128 v13, v[52:55]
    v_add_u32 v13, 640, v2
    v_mul_hi_u32 v14, v13, s54
    v_lshlrev_b32 v13, 4, v13
    v_lshl_add_u32 v13, v14, 4, v13
    v_add_u32 v13, s53, v13
    s_waitcnt vmcnt(31)
    ds_write_b128 v13, v[56:59]
    v_add_u32 v13, 704, v2
    v_mul_hi_u32 v14, v13, s54
    v_lshlrev_b32 v13, 4, v13
    v_lshl_add_u32 v13, v14, 4, v13
    v_add_u32 v13, s53, v13
    s_waitcnt vmcnt(30)
    ds_write_b128 v13, v[60:63]
    v_add_u32 v13, 768, v2
    v_mul_hi_u32 v14, v13, s54
    v_lshlrev_b32 v13, 4, v13
    v_lshl_add_u32 v13, v14, 4, v13
    v_add_u32 v13, s53, v13
    s_waitcnt vmcnt(29)
    ds_write_b128 v13, v[64:67]
    v_add_u32 v13, 832, v2
    v_mul_hi_u32 v14, v13, s54
    v_lshlrev_b32 v13, 4, v13
    v_lshl_add_u32 v13, v14, 4, v13
    v_add_u32 v13, s53, v13
    s_waitcnt vmcnt(28)
    ds_write_b128 v13, v[68:71]
    v_add_u32 v13, 896, v2
    v_mul_hi_u32 v14, v13, s54
    v_lshlrev_b32 v13, 4, v13
    v_lshl_add_u32 v13, v14, 4, v13
    v_add_u32 v13, s53, v13
    s_waitcnt vmcnt(27)
    ds_write_b128 v13, v[72:75]
    v_add_u32 v13, 960, v2
    v_mul_hi_u32 v14, v13, s54
    v_lshlrev_b32 v13, 4, v13
    v_lshl_add_u32 v13, v14, 4, v13
    v_add_u32 v13, s53, v13
    s_waitcnt vmcnt(26)
    ds_write_b128 v13, v[76:79]
    v_add_u32 v13, 1024, v2
    v_mul_hi_u32 v14, v13, s54
    v_lshlrev_b32 v13, 4, v13
    v_lshl_add_u32 v13, v14, 4, v13
    v_add_u32 v13, s53, v13
    s_waitcnt vmcnt(25)
    ds_write_b128 v13, v[80:83]
    v_add_u32 v13, 1088, v2
    v_mul_hi_u32 v14, v13, s54
    v_lshlrev_b32 v13, 4, v13
    v_lshl_add_u32 v13, v14, 4, v13
    v_add_u32 v13, s53, v13
    s_waitcnt vmcnt(24)
    ds_write_b128 v13, v[84:87]
    v_add_u32 v13, 1152, v2
    v_mul_hi_u32 v14, v13, s54
    v_lshlrev_b32 v13, 4, v13
    v_lshl_add_u32 v13, v14, 4, v13
    v_add_u32 v13, s53, v13
    s_waitcnt vmcnt(23)
    ds_write_b128 v13, v[88:91]
    v_add_u32 v13, 1216, v2
    v_mul_hi_u32 v14, v13, s54
    v_lshlrev_b32 v13, 4, v13
    v_lshl_add_u32 v13, v14, 4, v13
    v_add_u32 v13, s53, v13
    s_waitcnt vmcnt(22)
    ds_write_b128 v13, v[92:95]
    v_add_u32 v13, 1280, v2
    v_mul_hi_u32 v14, v13, s54
    v_lshlrev_b32 v13, 4, v13
    v_lshl_add_u32 v13, v14, 4, v13
    v_add_u32 v13, s53, v13
    s_waitcnt vmcnt(21)
    ds_write_b128 v13, v[96:99]
    v_add_u32 v13, 1344, v2
    v_mul_hi_u32 v14, v13, s54
    v_lshlrev_b32 v13, 4, v13
    v_lshl_add_u32 v13, v14, 4, v13
    v_add_u32 v13, s53, v13
    s_waitcnt vmcnt(20)
    ds_write_b128 v13, v[100:103]
    v_add_u32 v13, 1408, v2
    v_mul_hi_u32 v14, v13, s54
    v_lshlrev_b32 v13, 4, v13
    v_lshl_add_u32 v13, v14, 4, v13
    v_add_u32 v13, s53, v13
    s_waitcnt vmcnt(19)
    ds_write_b128 v13, v[104:107]
    v_add_u32 v13, 1472, v2
    v_mul_hi_u32 v14, v13, s54
    v_lshlrev_b32 v13, 4, v13
    v_lshl_add_u32 v13, v14, 4, v13
    v_add_u32 v13, s53, v13
    s_waitcnt vmcnt(18)
    ds_write_b128 v13, v[108:111]
    v_add_u32 v13, 1536, v2
    v_mul_hi_u32 v14, v13, s54
    v_lshlrev_b32 v13, 4, v13
    v_lshl_add_u32 v13, v14, 4, v13
    v_add_u32 v13, s53, v13
    s_waitcnt vmcnt(17)
    ds_write_b128 v13, v[112:115]
    v_add_u32 v13, 1600, v2
    v_mul_hi_u32 v14, v13, s54
    v_lshlrev_b32 v13, 4, v13
    v_lshl_add_u32 v13, v14, 4, v13
    v_add_u32 v13, s53, v13
    s_waitcnt vmcnt(16)
    ds_write_b128 v13, v[116:119]
    v_add_u32 v13, 1664, v2
    v_mul_hi_u32 v14, v13, s54
    v_lshlrev_b32 v13, 4, v13
    v_lshl_add_u32 v13, v14, 4, v13
    v_add_u32 v13, s53, v13
    s_waitcnt vmcnt(15)
    ds_write_b128 v13, v[120:123]
    v_add_u32 v13, 1728, v2
    v_mul_hi_u32 v14, v13, s54
    v_lshlrev_b32 v13, 4, v13
    v_lshl_add_u32 v13, v14, 4, v13
    v_add_u32 v13, s53, v13
    s_waitcnt vmcnt(14)
    ds_write_b128 v13, v[124:127]
    v_mul_u32_u24 v13, 912, v3
    v_lshl_add_u32 v13, v4, 4, v13
    v_add_u32 v13, s53, v13
    s_waitcnt lgkmcnt(0)
    ds_read_b128 v[16:19], v13 offset:0
    ds_read_b128 v[20:23], v13 offset:32
    ds_read_b128 v[24:27], v13 offset:64
    ds_read_b128 v[28:31], v13 offset:96
    ds_read_b128 v[32:35], v13 offset:128
    ds_read_b128 v[36:39], v13 offset:160
    ds_read_b128 v[40:43], v13 offset:192
    ds_read_b128 v[44:47], v13 offset:224
    ds_read_b128 v[48:51], v13 offset:256
    ds_read_b128 v[52:55], v13 offset:288
    ds_read_b128 v[56:59], v13 offset:320
    ds_read_b128 v[60:63], v13 offset:352
    ds_read_b128 v[64:67], v13 offset:384
    ds_read_b128 v[68:71], v13 offset:416
    ds_read_b128 v[72:75], v13 offset:448
    ds_read_b128 v[76:79], v13 offset:480
    ds_read_b128 v[80:83], v13 offset:512
    ds_read_b128 v[84:87], v13 offset:544
    ds_read_b128 v[88:91], v13 offset:576
    ds_read_b128 v[92:95], v13 offset:608
    ds_read_b128 v[96:99], v13 offset:640
    ds_read_b128 v[100:103], v13 offset:672
    ds_read_b128 v[104:107], v13 offset:704
    ds_read_b128 v[108:111], v13 offset:736
    ds_read_b128 v[112:115], v13 offset:768
    ds_read_b128 v[116:119], v13 offset:800
    ds_read_b128 v[120:123], v13 offset:832
    ds_read_b128 v[124:127], v13 offset:864
    s_waitcnt lgkmcnt(0)
    s_barrier
    s_waitcnt vmcnt(13)
    ds_write_b128 v11, v[128:131] offset:0
    s_waitcnt vmcnt(12)
    ds_write_b128 v11, v[132:135] offset:4096
    s_waitcnt vmcnt(11)
    ds_write_b128 v11, v[136:139] offset:8192
    s_waitcnt vmcnt(10)
    ds_write_b128 v11, v[140:143] offset:12288
    s_waitcnt vmcnt(9)
    ds_write_b128 v11, v[144:147] offset:16384
    s_waitcnt vmcnt(8)
    ds_write_b128 v11, v[148:151] offset:20480
    s_waitcnt vmcnt(7)
    ds_write_b128 v11, v[152:155] offset:24576
    s_waitcnt vmcnt(6)
    ds_write_b128 v11, v[156:159] offset:28672
    s_waitcnt vmcnt(5)
    ds_write_b128 v11, v[160:163] offset:32768
    s_waitcnt vmcnt(4)
    ds_write_b128 v11, v[164:167] offset:36864
    s_waitcnt vmcnt(3)
    ds_write_b128 v11, v[168:171] offset:40960
    s_waitcnt vmcnt(2)
    ds_write_b128 v11, v[172:175] offset:45056
    s_waitcnt vmcnt(1)
    ds_write_b128 v11, v[176:179] offset:49152
    s_waitcnt vmcnt(0)
    ds_write_b128 v11, v[180:183] offset:53248
    s_mov_b32 s12, s44
    s_and_b32 s13, s45, 0xffff
    s_mov_b32 s14, 1204224
    s_mov_b32 s15, 0x00020000
    s_movk_i32 s35, 2688
    v_lshrrev_b32 v13, 2, v0
    v_mul_lo_u32 v13, v13, s35
    v_and_b32 v14, 3, v0
    v_lshl_add_u32 v13, v14, 4, v13
    s_mov_b32 s35, 1664
    buffer_load_dwordx4 v[128:131], v13, s[12:15], s35 offen
    s_mov_b32 s35, 173696
    buffer_load_dwordx4 v[132:135], v13, s[12:15], s35 offen
    s_mov_b32 s35, 345728
    buffer_load_dwordx4 v[136:139], v13, s[12:15], s35 offen
    s_mov_b32 s35, 517760
    buffer_load_dwordx4 v[140:143], v13, s[12:15], s35 offen
    s_mov_b32 s35, 689792
    buffer_load_dwordx4 v[144:147], v13, s[12:15], s35 offen
    s_mov_b32 s35, 861824
    buffer_load_dwordx4 v[148:151], v13, s[12:15], s35 offen
    s_mov_b32 s35, 1033856
    buffer_load_dwordx4 v[152:155], v13, s[12:15], s35 offen
    s_waitcnt vmcnt(6)
    ds_write_b128 v225, v[128:131] offset:0
    s_waitcnt vmcnt(5)
    ds_write_b128 v225, v[132:135] offset:4096
    s_waitcnt vmcnt(4)
    ds_write_b128 v225, v[136:139] offset:8192
    s_waitcnt vmcnt(3)
    ds_write_b128 v225, v[140:143] offset:12288
    s_waitcnt vmcnt(2)
    ds_write_b128 v225, v[144:147] offset:16384
    s_waitcnt vmcnt(1)
    ds_write_b128 v225, v[148:151] offset:20480
    s_waitcnt vmcnt(0)
    ds_write_b128 v225, v[152:155] offset:24576
    s_mov_b32 s12, s44
    s_and_b32 s13, s45, 0xffff
    s_mov_b32 s14, 1204224
    s_mov_b32 s15, 0x00020000
    s_movk_i32 s35, 2688
    v_lshrrev_b32 v13, 2, v0
    v_mul_lo_u32 v13, v13, s35
    v_and_b32 v14, 3, v0
    v_lshl_add_u32 v13, v14, 4, v13
    s_mov_b32 s35, 1728
    buffer_load_dwordx4 v[128:131], v13, s[12:15], s35 offen
    s_mov_b32 s35, 173760
    buffer_load_dwordx4 v[132:135], v13, s[12:15], s35 offen
    s_mov_b32 s35, 345792
    buffer_load_dwordx4 v[136:139], v13, s[12:15], s35 offen
    s_mov_b32 s35, 517824
    buffer_load_dwordx4 v[140:143], v13, s[12:15], s35 offen
    s_mov_b32 s35, 689856
    buffer_load_dwordx4 v[144:147], v13, s[12:15], s35 offen
    s_mov_b32 s35, 861888
    buffer_load_dwordx4 v[148:151], v13, s[12:15], s35 offen
    s_mov_b32 s35, 1033920
    buffer_load_dwordx4 v[152:155], v13, s[12:15], s35 offen
    s_waitcnt vmcnt(6)
    ds_write_b128 v225, v[128:131] offset:28672
    s_waitcnt vmcnt(5)
    ds_write_b128 v225, v[132:135] offset:32768
    s_waitcnt vmcnt(4)
    ds_write_b128 v225, v[136:139] offset:36864
    s_waitcnt vmcnt(3)
    ds_write_b128 v225, v[140:143] offset:40960
    s_waitcnt vmcnt(2)
    ds_write_b128 v225, v[144:147] offset:45056
    s_waitcnt vmcnt(1)
    ds_write_b128 v225, v[148:151] offset:49152
    s_waitcnt vmcnt(0)
    ds_write_b128 v225, v[152:155] offset:53248
    s_waitcnt lgkmcnt(0)
    s_barrier
    ds_read_b64_tr_b16 v[192:193], v7 offset:0
    ds_read_b64_tr_b16 v[194:195], v7 offset:256
    ds_read_b64_tr_b16 v[196:197], v7 offset:28672
    ds_read_b64_tr_b16 v[198:199], v7 offset:28928
    ds_read_b64_tr_b16 v[200:201], v224 offset:0
    ds_read_b64_tr_b16 v[202:203], v224 offset:256
    ds_read_b64_tr_b16 v[204:205], v224 offset:28672
    ds_read_b64_tr_b16 v[206:207], v224 offset:28928
    ds_read_b64_tr_b16 v[208:209], v7 offset:1024
    ds_read_b64_tr_b16 v[210:211], v7 offset:1280
    ds_read_b64_tr_b16 v[212:213], v7 offset:29696
    ds_read_b64_tr_b16 v[214:215], v7 offset:29952
    ds_read_b64_tr_b16 v[216:217], v224 offset:1024
    ds_read_b64_tr_b16 v[218:219], v224 offset:1280
    ds_read_b64_tr_b16 v[220:221], v224 offset:29696
    ds_read_b64_tr_b16 v[222:223], v224 offset:29952
    s_waitcnt lgkmcnt(8)
    v_mfma_f32_32x32x16_bf16 v[128:143], v[192:195], v[16:19], 0
    v_mfma_f32_32x32x16_bf16 v[144:159], v[196:199], v[16:19], 0
    v_mfma_f32_32x32x16_bf16 v[160:175], v[200:203], v[16:19], 0
    v_mfma_f32_32x32x16_bf16 v[176:191], v[204:207], v[16:19], 0
    ds_read_b64_tr_b16 v[192:193], v7 offset:2048
    ds_read_b64_tr_b16 v[194:195], v7 offset:2304
    ds_read_b64_tr_b16 v[196:197], v7 offset:30720
    ds_read_b64_tr_b16 v[198:199], v7 offset:30976
    ds_read_b64_tr_b16 v[200:201], v224 offset:2048
    ds_read_b64_tr_b16 v[202:203], v224 offset:2304
    ds_read_b64_tr_b16 v[204:205], v224 offset:30720
    ds_read_b64_tr_b16 v[206:207], v224 offset:30976
    s_waitcnt lgkmcnt(8)
    v_mfma_f32_32x32x16_bf16 v[128:143], v[208:211], v[20:23], v[128:143]
    v_mfma_f32_32x32x16_bf16 v[144:159], v[212:215], v[20:23], v[144:159]
    v_mfma_f32_32x32x16_bf16 v[160:175], v[216:219], v[20:23], v[160:175]
    v_mfma_f32_32x32x16_bf16 v[176:191], v[220:223], v[20:23], v[176:191]
    ds_read_b64_tr_b16 v[208:209], v7 offset:3072
    ds_read_b64_tr_b16 v[210:211], v7 offset:3328
    ds_read_b64_tr_b16 v[212:213], v7 offset:31744
    ds_read_b64_tr_b16 v[214:215], v7 offset:32000
    ds_read_b64_tr_b16 v[216:217], v224 offset:3072
    ds_read_b64_tr_b16 v[218:219], v224 offset:3328
    ds_read_b64_tr_b16 v[220:221], v224 offset:31744
    ds_read_b64_tr_b16 v[222:223], v224 offset:32000
    s_waitcnt lgkmcnt(8)
    v_mfma_f32_32x32x16_bf16 v[128:143], v[192:195], v[24:27], v[128:143]
    v_mfma_f32_32x32x16_bf16 v[144:159], v[196:199], v[24:27], v[144:159]
    v_mfma_f32_32x32x16_bf16 v[160:175], v[200:203], v[24:27], v[160:175]
    v_mfma_f32_32x32x16_bf16 v[176:191], v[204:207], v[24:27], v[176:191]
    ds_read_b64_tr_b16 v[192:193], v7 offset:4096
    ds_read_b64_tr_b16 v[194:195], v7 offset:4352
    ds_read_b64_tr_b16 v[196:197], v7 offset:32768
    ds_read_b64_tr_b16 v[198:199], v7 offset:33024
    ds_read_b64_tr_b16 v[200:201], v224 offset:4096
    ds_read_b64_tr_b16 v[202:203], v224 offset:4352
    ds_read_b64_tr_b16 v[204:205], v224 offset:32768
    ds_read_b64_tr_b16 v[206:207], v224 offset:33024
    s_waitcnt lgkmcnt(8)
    v_mfma_f32_32x32x16_bf16 v[128:143], v[208:211], v[28:31], v[128:143]
    v_mfma_f32_32x32x16_bf16 v[144:159], v[212:215], v[28:31], v[144:159]
    v_mfma_f32_32x32x16_bf16 v[160:175], v[216:219], v[28:31], v[160:175]
    v_mfma_f32_32x32x16_bf16 v[176:191], v[220:223], v[28:31], v[176:191]
    ds_read_b64_tr_b16 v[208:209], v7 offset:5120
    ds_read_b64_tr_b16 v[210:211], v7 offset:5376
    ds_read_b64_tr_b16 v[212:213], v7 offset:33792
    ds_read_b64_tr_b16 v[214:215], v7 offset:34048
    ds_read_b64_tr_b16 v[216:217], v224 offset:5120
    ds_read_b64_tr_b16 v[218:219], v224 offset:5376
    ds_read_b64_tr_b16 v[220:221], v224 offset:33792
    ds_read_b64_tr_b16 v[222:223], v224 offset:34048
    s_waitcnt lgkmcnt(8)
    v_mfma_f32_32x32x16_bf16 v[128:143], v[192:195], v[32:35], v[128:143]
    v_mfma_f32_32x32x16_bf16 v[144:159], v[196:199], v[32:35], v[144:159]
    v_mfma_f32_32x32x16_bf16 v[160:175], v[200:203], v[32:35], v[160:175]
    v_mfma_f32_32x32x16_bf16 v[176:191], v[204:207], v[32:35], v[176:191]
    ds_read_b64_tr_b16 v[192:193], v7 offset:6144
    ds_read_b64_tr_b16 v[194:195], v7 offset:6400
    ds_read_b64_tr_b16 v[196:197], v7 offset:34816
    ds_read_b64_tr_b16 v[198:199], v7 offset:35072
    ds_read_b64_tr_b16 v[200:201], v224 offset:6144
    ds_read_b64_tr_b16 v[202:203], v224 offset:6400
    ds_read_b64_tr_b16 v[204:205], v224 offset:34816
    ds_read_b64_tr_b16 v[206:207], v224 offset:35072
    s_waitcnt lgkmcnt(8)
    v_mfma_f32_32x32x16_bf16 v[128:143], v[208:211], v[36:39], v[128:143]
    v_mfma_f32_32x32x16_bf16 v[144:159], v[212:215], v[36:39], v[144:159]
    v_mfma_f32_32x32x16_bf16 v[160:175], v[216:219], v[36:39], v[160:175]
    v_mfma_f32_32x32x16_bf16 v[176:191], v[220:223], v[36:39], v[176:191]
    ds_read_b64_tr_b16 v[208:209], v7 offset:7168
    ds_read_b64_tr_b16 v[210:211], v7 offset:7424
    ds_read_b64_tr_b16 v[212:213], v7 offset:35840
    ds_read_b64_tr_b16 v[214:215], v7 offset:36096
    ds_read_b64_tr_b16 v[216:217], v224 offset:7168
    ds_read_b64_tr_b16 v[218:219], v224 offset:7424
    ds_read_b64_tr_b16 v[220:221], v224 offset:35840
    ds_read_b64_tr_b16 v[222:223], v224 offset:36096
    s_waitcnt lgkmcnt(8)
    v_mfma_f32_32x32x16_bf16 v[128:143], v[192:195], v[40:43], v[128:143]
    v_mfma_f32_32x32x16_bf16 v[144:159], v[196:199], v[40:43], v[144:159]
    v_mfma_f32_32x32x16_bf16 v[160:175], v[200:203], v[40:43], v[160:175]
    v_mfma_f32_32x32x16_bf16 v[176:191], v[204:207], v[40:43], v[176:191]
    ds_read_b64_tr_b16 v[192:193], v7 offset:8192
    ds_read_b64_tr_b16 v[194:195], v7 offset:8448
    ds_read_b64_tr_b16 v[196:197], v7 offset:36864
    ds_read_b64_tr_b16 v[198:199], v7 offset:37120
    ds_read_b64_tr_b16 v[200:201], v224 offset:8192
    ds_read_b64_tr_b16 v[202:203], v224 offset:8448
    ds_read_b64_tr_b16 v[204:205], v224 offset:36864
    ds_read_b64_tr_b16 v[206:207], v224 offset:37120
    s_waitcnt lgkmcnt(8)
    v_mfma_f32_32x32x16_bf16 v[128:143], v[208:211], v[44:47], v[128:143]
    v_mfma_f32_32x32x16_bf16 v[144:159], v[212:215], v[44:47], v[144:159]
    v_mfma_f32_32x32x16_bf16 v[160:175], v[216:219], v[44:47], v[160:175]
    v_mfma_f32_32x32x16_bf16 v[176:191], v[220:223], v[44:47], v[176:191]
    ds_read_b64_tr_b16 v[208:209], v7 offset:9216
    ds_read_b64_tr_b16 v[210:211], v7 offset:9472
    ds_read_b64_tr_b16 v[212:213], v7 offset:37888
    ds_read_b64_tr_b16 v[214:215], v7 offset:38144
    ds_read_b64_tr_b16 v[216:217], v224 offset:9216
    ds_read_b64_tr_b16 v[218:219], v224 offset:9472
    ds_read_b64_tr_b16 v[220:221], v224 offset:37888
    ds_read_b64_tr_b16 v[222:223], v224 offset:38144
    s_waitcnt lgkmcnt(8)
    v_mfma_f32_32x32x16_bf16 v[128:143], v[192:195], v[48:51], v[128:143]
    v_mfma_f32_32x32x16_bf16 v[144:159], v[196:199], v[48:51], v[144:159]
    v_mfma_f32_32x32x16_bf16 v[160:175], v[200:203], v[48:51], v[160:175]
    v_mfma_f32_32x32x16_bf16 v[176:191], v[204:207], v[48:51], v[176:191]
    ds_read_b64_tr_b16 v[192:193], v7 offset:10240
    ds_read_b64_tr_b16 v[194:195], v7 offset:10496
    ds_read_b64_tr_b16 v[196:197], v7 offset:38912
    ds_read_b64_tr_b16 v[198:199], v7 offset:39168
    ds_read_b64_tr_b16 v[200:201], v224 offset:10240
    ds_read_b64_tr_b16 v[202:203], v224 offset:10496
    ds_read_b64_tr_b16 v[204:205], v224 offset:38912
    ds_read_b64_tr_b16 v[206:207], v224 offset:39168
    s_waitcnt lgkmcnt(8)
    v_mfma_f32_32x32x16_bf16 v[128:143], v[208:211], v[52:55], v[128:143]
    v_mfma_f32_32x32x16_bf16 v[144:159], v[212:215], v[52:55], v[144:159]
    v_mfma_f32_32x32x16_bf16 v[160:175], v[216:219], v[52:55], v[160:175]
    v_mfma_f32_32x32x16_bf16 v[176:191], v[220:223], v[52:55], v[176:191]
    ds_read_b64_tr_b16 v[208:209], v7 offset:11264
    ds_read_b64_tr_b16 v[210:211], v7 offset:11520
    ds_read_b64_tr_b16 v[212:213], v7 offset:39936
    ds_read_b64_tr_b16 v[214:215], v7 offset:40192
    ds_read_b64_tr_b16 v[216:217], v224 offset:11264
    ds_read_b64_tr_b16 v[218:219], v224 offset:11520
    ds_read_b64_tr_b16 v[220:221], v224 offset:39936
    ds_read_b64_tr_b16 v[222:223], v224 offset:40192
    s_waitcnt lgkmcnt(8)
    v_mfma_f32_32x32x16_bf16 v[128:143], v[192:195], v[56:59], v[128:143]
    v_mfma_f32_32x32x16_bf16 v[144:159], v[196:199], v[56:59], v[144:159]
    v_mfma_f32_32x32x16_bf16 v[160:175], v[200:203], v[56:59], v[160:175]
    v_mfma_f32_32x32x16_bf16 v[176:191], v[204:207], v[56:59], v[176:191]
    ds_read_b64_tr_b16 v[192:193], v7 offset:12288
    ds_read_b64_tr_b16 v[194:195], v7 offset:12544
    ds_read_b64_tr_b16 v[196:197], v7 offset:40960
    ds_read_b64_tr_b16 v[198:199], v7 offset:41216
    ds_read_b64_tr_b16 v[200:201], v224 offset:12288
    ds_read_b64_tr_b16 v[202:203], v224 offset:12544
    ds_read_b64_tr_b16 v[204:205], v224 offset:40960
    ds_read_b64_tr_b16 v[206:207], v224 offset:41216
    s_waitcnt lgkmcnt(8)
    v_mfma_f32_32x32x16_bf16 v[128:143], v[208:211], v[60:63], v[128:143]
    v_mfma_f32_32x32x16_bf16 v[144:159], v[212:215], v[60:63], v[144:159]
    v_mfma_f32_32x32x16_bf16 v[160:175], v[216:219], v[60:63], v[160:175]
    v_mfma_f32_32x32x16_bf16 v[176:191], v[220:223], v[60:63], v[176:191]
    ds_read_b64_tr_b16 v[208:209], v7 offset:13312
    ds_read_b64_tr_b16 v[210:211], v7 offset:13568
    ds_read_b64_tr_b16 v[212:213], v7 offset:41984
    ds_read_b64_tr_b16 v[214:215], v7 offset:42240
    ds_read_b64_tr_b16 v[216:217], v224 offset:13312
    ds_read_b64_tr_b16 v[218:219], v224 offset:13568
    ds_read_b64_tr_b16 v[220:221], v224 offset:41984
    ds_read_b64_tr_b16 v[222:223], v224 offset:42240
    s_waitcnt lgkmcnt(8)
    v_mfma_f32_32x32x16_bf16 v[128:143], v[192:195], v[64:67], v[128:143]
    v_mfma_f32_32x32x16_bf16 v[144:159], v[196:199], v[64:67], v[144:159]
    v_mfma_f32_32x32x16_bf16 v[160:175], v[200:203], v[64:67], v[160:175]
    v_mfma_f32_32x32x16_bf16 v[176:191], v[204:207], v[64:67], v[176:191]
    ds_read_b64_tr_b16 v[192:193], v7 offset:14336
    ds_read_b64_tr_b16 v[194:195], v7 offset:14592
    ds_read_b64_tr_b16 v[196:197], v7 offset:43008
    ds_read_b64_tr_b16 v[198:199], v7 offset:43264
    ds_read_b64_tr_b16 v[200:201], v224 offset:14336
    ds_read_b64_tr_b16 v[202:203], v224 offset:14592
    ds_read_b64_tr_b16 v[204:205], v224 offset:43008
    ds_read_b64_tr_b16 v[206:207], v224 offset:43264
    s_waitcnt lgkmcnt(8)
    v_mfma_f32_32x32x16_bf16 v[128:143], v[208:211], v[68:71], v[128:143]
    v_mfma_f32_32x32x16_bf16 v[144:159], v[212:215], v[68:71], v[144:159]
    v_mfma_f32_32x32x16_bf16 v[160:175], v[216:219], v[68:71], v[160:175]
    v_mfma_f32_32x32x16_bf16 v[176:191], v[220:223], v[68:71], v[176:191]
    ds_read_b64_tr_b16 v[208:209], v7 offset:15360
    ds_read_b64_tr_b16 v[210:211], v7 offset:15616
    ds_read_b64_tr_b16 v[212:213], v7 offset:44032
    ds_read_b64_tr_b16 v[214:215], v7 offset:44288
    ds_read_b64_tr_b16 v[216:217], v224 offset:15360
    ds_read_b64_tr_b16 v[218:219], v224 offset:15616
    ds_read_b64_tr_b16 v[220:221], v224 offset:44032
    ds_read_b64_tr_b16 v[222:223], v224 offset:44288
    s_waitcnt lgkmcnt(8)
    v_mfma_f32_32x32x16_bf16 v[128:143], v[192:195], v[72:75], v[128:143]
    v_mfma_f32_32x32x16_bf16 v[144:159], v[196:199], v[72:75], v[144:159]
    v_mfma_f32_32x32x16_bf16 v[160:175], v[200:203], v[72:75], v[160:175]
    v_mfma_f32_32x32x16_bf16 v[176:191], v[204:207], v[72:75], v[176:191]
    ds_read_b64_tr_b16 v[192:193], v7 offset:16384
    ds_read_b64_tr_b16 v[194:195], v7 offset:16640
    ds_read_b64_tr_b16 v[196:197], v7 offset:45056
    ds_read_b64_tr_b16 v[198:199], v7 offset:45312
    ds_read_b64_tr_b16 v[200:201], v224 offset:16384
    ds_read_b64_tr_b16 v[202:203], v224 offset:16640
    ds_read_b64_tr_b16 v[204:205], v224 offset:45056
    ds_read_b64_tr_b16 v[206:207], v224 offset:45312
    s_waitcnt lgkmcnt(8)
    v_mfma_f32_32x32x16_bf16 v[128:143], v[208:211], v[76:79], v[128:143]
    v_mfma_f32_32x32x16_bf16 v[144:159], v[212:215], v[76:79], v[144:159]
    v_mfma_f32_32x32x16_bf16 v[160:175], v[216:219], v[76:79], v[160:175]
    v_mfma_f32_32x32x16_bf16 v[176:191], v[220:223], v[76:79], v[176:191]
    ds_read_b64_tr_b16 v[208:209], v7 offset:17408
    ds_read_b64_tr_b16 v[210:211], v7 offset:17664
    ds_read_b64_tr_b16 v[212:213], v7 offset:46080
    ds_read_b64_tr_b16 v[214:215], v7 offset:46336
    ds_read_b64_tr_b16 v[216:217], v224 offset:17408
    ds_read_b64_tr_b16 v[218:219], v224 offset:17664
    ds_read_b64_tr_b16 v[220:221], v224 offset:46080
    ds_read_b64_tr_b16 v[222:223], v224 offset:46336
    s_waitcnt lgkmcnt(8)
    v_mfma_f32_32x32x16_bf16 v[128:143], v[192:195], v[80:83], v[128:143]
    v_mfma_f32_32x32x16_bf16 v[144:159], v[196:199], v[80:83], v[144:159]
    v_mfma_f32_32x32x16_bf16 v[160:175], v[200:203], v[80:83], v[160:175]
    v_mfma_f32_32x32x16_bf16 v[176:191], v[204:207], v[80:83], v[176:191]
    ds_read_b64_tr_b16 v[192:193], v7 offset:18432
    ds_read_b64_tr_b16 v[194:195], v7 offset:18688
    ds_read_b64_tr_b16 v[196:197], v7 offset:47104
    ds_read_b64_tr_b16 v[198:199], v7 offset:47360
    ds_read_b64_tr_b16 v[200:201], v224 offset:18432
    ds_read_b64_tr_b16 v[202:203], v224 offset:18688
    ds_read_b64_tr_b16 v[204:205], v224 offset:47104
    ds_read_b64_tr_b16 v[206:207], v224 offset:47360
    s_waitcnt lgkmcnt(8)
    v_mfma_f32_32x32x16_bf16 v[128:143], v[208:211], v[84:87], v[128:143]
    v_mfma_f32_32x32x16_bf16 v[144:159], v[212:215], v[84:87], v[144:159]
    v_mfma_f32_32x32x16_bf16 v[160:175], v[216:219], v[84:87], v[160:175]
    v_mfma_f32_32x32x16_bf16 v[176:191], v[220:223], v[84:87], v[176:191]
    ds_read_b64_tr_b16 v[208:209], v7 offset:19456
    ds_read_b64_tr_b16 v[210:211], v7 offset:19712
    ds_read_b64_tr_b16 v[212:213], v7 offset:48128
    ds_read_b64_tr_b16 v[214:215], v7 offset:48384
    ds_read_b64_tr_b16 v[216:217], v224 offset:19456
    ds_read_b64_tr_b16 v[218:219], v224 offset:19712
    ds_read_b64_tr_b16 v[220:221], v224 offset:48128
    ds_read_b64_tr_b16 v[222:223], v224 offset:48384
    s_waitcnt lgkmcnt(8)
    v_mfma_f32_32x32x16_bf16 v[128:143], v[192:195], v[88:91], v[128:143]
    v_mfma_f32_32x32x16_bf16 v[144:159], v[196:199], v[88:91], v[144:159]
    v_mfma_f32_32x32x16_bf16 v[160:175], v[200:203], v[88:91], v[160:175]
    v_mfma_f32_32x32x16_bf16 v[176:191], v[204:207], v[88:91], v[176:191]
    ds_read_b64_tr_b16 v[192:193], v7 offset:20480
    ds_read_b64_tr_b16 v[194:195], v7 offset:20736
    ds_read_b64_tr_b16 v[196:197], v7 offset:49152
    ds_read_b64_tr_b16 v[198:199], v7 offset:49408
    ds_read_b64_tr_b16 v[200:201], v224 offset:20480
    ds_read_b64_tr_b16 v[202:203], v224 offset:20736
    ds_read_b64_tr_b16 v[204:205], v224 offset:49152
    ds_read_b64_tr_b16 v[206:207], v224 offset:49408
    s_waitcnt lgkmcnt(8)
    v_mfma_f32_32x32x16_bf16 v[128:143], v[208:211], v[92:95], v[128:143]
    v_mfma_f32_32x32x16_bf16 v[144:159], v[212:215], v[92:95], v[144:159]
    v_mfma_f32_32x32x16_bf16 v[160:175], v[216:219], v[92:95], v[160:175]
    v_mfma_f32_32x32x16_bf16 v[176:191], v[220:223], v[92:95], v[176:191]
    ds_read_b64_tr_b16 v[208:209], v7 offset:21504
    ds_read_b64_tr_b16 v[210:211], v7 offset:21760
    ds_read_b64_tr_b16 v[212:213], v7 offset:50176
    ds_read_b64_tr_b16 v[214:215], v7 offset:50432
    ds_read_b64_tr_b16 v[216:217], v224 offset:21504
    ds_read_b64_tr_b16 v[218:219], v224 offset:21760
    ds_read_b64_tr_b16 v[220:221], v224 offset:50176
    ds_read_b64_tr_b16 v[222:223], v224 offset:50432
    s_waitcnt lgkmcnt(8)
    v_mfma_f32_32x32x16_bf16 v[128:143], v[192:195], v[96:99], v[128:143]
    v_mfma_f32_32x32x16_bf16 v[144:159], v[196:199], v[96:99], v[144:159]
    v_mfma_f32_32x32x16_bf16 v[160:175], v[200:203], v[96:99], v[160:175]
    v_mfma_f32_32x32x16_bf16 v[176:191], v[204:207], v[96:99], v[176:191]
    ds_read_b64_tr_b16 v[192:193], v7 offset:22528
    ds_read_b64_tr_b16 v[194:195], v7 offset:22784
    ds_read_b64_tr_b16 v[196:197], v7 offset:51200
    ds_read_b64_tr_b16 v[198:199], v7 offset:51456
    ds_read_b64_tr_b16 v[200:201], v224 offset:22528
    ds_read_b64_tr_b16 v[202:203], v224 offset:22784
    ds_read_b64_tr_b16 v[204:205], v224 offset:51200
    ds_read_b64_tr_b16 v[206:207], v224 offset:51456
    s_waitcnt lgkmcnt(8)
    v_mfma_f32_32x32x16_bf16 v[128:143], v[208:211], v[100:103], v[128:143]
    v_mfma_f32_32x32x16_bf16 v[144:159], v[212:215], v[100:103], v[144:159]
    v_mfma_f32_32x32x16_bf16 v[160:175], v[216:219], v[100:103], v[160:175]
    v_mfma_f32_32x32x16_bf16 v[176:191], v[220:223], v[100:103], v[176:191]
    ds_read_b64_tr_b16 v[208:209], v7 offset:23552
    ds_read_b64_tr_b16 v[210:211], v7 offset:23808
    ds_read_b64_tr_b16 v[212:213], v7 offset:52224
    ds_read_b64_tr_b16 v[214:215], v7 offset:52480
    ds_read_b64_tr_b16 v[216:217], v224 offset:23552
    ds_read_b64_tr_b16 v[218:219], v224 offset:23808
    ds_read_b64_tr_b16 v[220:221], v224 offset:52224
    ds_read_b64_tr_b16 v[222:223], v224 offset:52480
    s_waitcnt lgkmcnt(8)
    v_mfma_f32_32x32x16_bf16 v[128:143], v[192:195], v[104:107], v[128:143]
    v_mfma_f32_32x32x16_bf16 v[144:159], v[196:199], v[104:107], v[144:159]
    v_mfma_f32_32x32x16_bf16 v[160:175], v[200:203], v[104:107], v[160:175]
    v_mfma_f32_32x32x16_bf16 v[176:191], v[204:207], v[104:107], v[176:191]
    ds_read_b64_tr_b16 v[192:193], v7 offset:24576
    ds_read_b64_tr_b16 v[194:195], v7 offset:24832
    ds_read_b64_tr_b16 v[196:197], v7 offset:53248
    ds_read_b64_tr_b16 v[198:199], v7 offset:53504
    ds_read_b64_tr_b16 v[200:201], v224 offset:24576
    ds_read_b64_tr_b16 v[202:203], v224 offset:24832
    ds_read_b64_tr_b16 v[204:205], v224 offset:53248
    ds_read_b64_tr_b16 v[206:207], v224 offset:53504
    s_waitcnt lgkmcnt(8)
    v_mfma_f32_32x32x16_bf16 v[128:143], v[208:211], v[108:111], v[128:143]
    v_mfma_f32_32x32x16_bf16 v[144:159], v[212:215], v[108:111], v[144:159]
    v_mfma_f32_32x32x16_bf16 v[160:175], v[216:219], v[108:111], v[160:175]
    v_mfma_f32_32x32x16_bf16 v[176:191], v[220:223], v[108:111], v[176:191]
    ds_read_b64_tr_b16 v[208:209], v7 offset:25600
    ds_read_b64_tr_b16 v[210:211], v7 offset:25856
    ds_read_b64_tr_b16 v[212:213], v7 offset:54272
    ds_read_b64_tr_b16 v[214:215], v7 offset:54528
    ds_read_b64_tr_b16 v[216:217], v224 offset:25600
    ds_read_b64_tr_b16 v[218:219], v224 offset:25856
    ds_read_b64_tr_b16 v[220:221], v224 offset:54272
    ds_read_b64_tr_b16 v[222:223], v224 offset:54528
    s_waitcnt lgkmcnt(8)
    v_mfma_f32_32x32x16_bf16 v[128:143], v[192:195], v[112:115], v[128:143]
    v_mfma_f32_32x32x16_bf16 v[144:159], v[196:199], v[112:115], v[144:159]
    v_mfma_f32_32x32x16_bf16 v[160:175], v[200:203], v[112:115], v[160:175]
    v_mfma_f32_32x32x16_bf16 v[176:191], v[204:207], v[112:115], v[176:191]
    ds_read_b64_tr_b16 v[192:193], v7 offset:26624
    ds_read_b64_tr_b16 v[194:195], v7 offset:26880
    ds_read_b64_tr_b16 v[196:197], v7 offset:55296
    ds_read_b64_tr_b16 v[198:199], v7 offset:55552
    ds_read_b64_tr_b16 v[200:201], v224 offset:26624
    ds_read_b64_tr_b16 v[202:203], v224 offset:26880
    ds_read_b64_tr_b16 v[204:205], v224 offset:55296
    ds_read_b64_tr_b16 v[206:207], v224 offset:55552
    s_waitcnt lgkmcnt(8)
    v_mfma_f32_32x32x16_bf16 v[128:143], v[208:211], v[116:119], v[128:143]
    v_mfma_f32_32x32x16_bf16 v[144:159], v[212:215], v[116:119], v[144:159]
    v_mfma_f32_32x32x16_bf16 v[160:175], v[216:219], v[116:119], v[160:175]
    v_mfma_f32_32x32x16_bf16 v[176:191], v[220:223], v[116:119], v[176:191]
    ds_read_b64_tr_b16 v[208:209], v7 offset:27648
    ds_read_b64_tr_b16 v[210:211], v7 offset:27904
    ds_read_b64_tr_b16 v[212:213], v7 offset:56320
    ds_read_b64_tr_b16 v[214:215], v7 offset:56576
    ds_read_b64_tr_b16 v[216:217], v224 offset:27648
    ds_read_b64_tr_b16 v[218:219], v224 offset:27904
    ds_read_b64_tr_b16 v[220:221], v224 offset:56320
    ds_read_b64_tr_b16 v[222:223], v224 offset:56576
    s_waitcnt lgkmcnt(8)
    v_mfma_f32_32x32x16_bf16 v[128:143], v[192:195], v[120:123], v[128:143]
    v_mfma_f32_32x32x16_bf16 v[144:159], v[196:199], v[120:123], v[144:159]
    v_mfma_f32_32x32x16_bf16 v[160:175], v[200:203], v[120:123], v[160:175]
    v_mfma_f32_32x32x16_bf16 v[176:191], v[204:207], v[120:123], v[176:191]
    s_waitcnt lgkmcnt(0)
    v_mfma_f32_32x32x16_bf16 v[128:143], v[208:211], v[124:127], v[128:143]
    v_mfma_f32_32x32x16_bf16 v[144:159], v[212:215], v[124:127], v[144:159]
    v_mfma_f32_32x32x16_bf16 v[160:175], v[216:219], v[124:127], v[160:175]
    v_mfma_f32_32x32x16_bf16 v[176:191], v[220:223], v[124:127], v[176:191]
    s_nop 15
    s_nop 3
    s_movk_i32 s35, 1792
    v_mul_lo_u32 v13, v5, s35
    v_lshl_add_u32 v13, v4, 3, v13
    v_add_u32 v13, 2360832, v13
    v_cvt_pk_bf16_f32 v128, v128, v129
    v_cvt_pk_bf16_f32 v129, v130, v131
    buffer_store_dwordx2 v[128:129], v13, s[16:19], 0 offen offset:0
    v_cvt_pk_bf16_f32 v132, v132, v133
    v_cvt_pk_bf16_f32 v133, v134, v135
    buffer_store_dwordx2 v[132:133], v13, s[16:19], 0 offen offset:16
    v_cvt_pk_bf16_f32 v136, v136, v137
    v_cvt_pk_bf16_f32 v137, v138, v139
    buffer_store_dwordx2 v[136:137], v13, s[16:19], 0 offen offset:32
    v_cvt_pk_bf16_f32 v140, v140, v141
    v_cvt_pk_bf16_f32 v141, v142, v143
    buffer_store_dwordx2 v[140:141], v13, s[16:19], 0 offen offset:48
    s_movk_i32 s35, 1792
    v_mul_lo_u32 v13, v5, s35
    v_lshl_add_u32 v13, v4, 3, v13
    v_add_u32 v13, 2360896, v13
    v_cvt_pk_bf16_f32 v144, v144, v145
    v_cvt_pk_bf16_f32 v145, v146, v147
    buffer_store_dwordx2 v[144:145], v13, s[16:19], 0 offen offset:0
    v_cvt_pk_bf16_f32 v148, v148, v149
    v_cvt_pk_bf16_f32 v149, v150, v151
    buffer_store_dwordx2 v[148:149], v13, s[16:19], 0 offen offset:16
    v_cvt_pk_bf16_f32 v152, v152, v153
    v_cvt_pk_bf16_f32 v153, v154, v155
    buffer_store_dwordx2 v[152:153], v13, s[16:19], 0 offen offset:32
    v_cvt_pk_bf16_f32 v156, v156, v157
    v_cvt_pk_bf16_f32 v157, v158, v159
    buffer_store_dwordx2 v[156:157], v13, s[16:19], 0 offen offset:48
    s_movk_i32 s35, 1792
    v_mul_lo_u32 v13, v5, s35
    v_lshl_add_u32 v13, v4, 3, v13
    v_add_u32 v13, 2360960, v13
    v_cvt_pk_bf16_f32 v160, v160, v161
    v_cvt_pk_bf16_f32 v161, v162, v163
    buffer_store_dwordx2 v[160:161], v13, s[16:19], 0 offen offset:0
    v_cvt_pk_bf16_f32 v164, v164, v165
    v_cvt_pk_bf16_f32 v165, v166, v167
    buffer_store_dwordx2 v[164:165], v13, s[16:19], 0 offen offset:16
    v_cvt_pk_bf16_f32 v168, v168, v169
    v_cvt_pk_bf16_f32 v169, v170, v171
    buffer_store_dwordx2 v[168:169], v13, s[16:19], 0 offen offset:32
    v_cvt_pk_bf16_f32 v172, v172, v173
    v_cvt_pk_bf16_f32 v173, v174, v175
    buffer_store_dwordx2 v[172:173], v13, s[16:19], 0 offen offset:48
    s_movk_i32 s35, 1792
    v_mul_lo_u32 v13, v5, s35
    v_lshl_add_u32 v13, v4, 3, v13
    v_add_u32 v13, 2361024, v13
    v_cvt_pk_bf16_f32 v176, v176, v177
    v_cvt_pk_bf16_f32 v177, v178, v179
    buffer_store_dwordx2 v[176:177], v13, s[16:19], 0 offen offset:0
    v_cvt_pk_bf16_f32 v180, v180, v181
    v_cvt_pk_bf16_f32 v181, v182, v183
    buffer_store_dwordx2 v[180:181], v13, s[16:19], 0 offen offset:16
    v_cvt_pk_bf16_f32 v184, v184, v185
    v_cvt_pk_bf16_f32 v185, v186, v187
    buffer_store_dwordx2 v[184:185], v13, s[16:19], 0 offen offset:32
    v_cvt_pk_bf16_f32 v188, v188, v189
    v_cvt_pk_bf16_f32 v189, v190, v191
    buffer_store_dwordx2 v[188:189], v13, s[16:19], 0 offen offset:48
    s_endpgm
K1_v11:
    s_mov_b32 s12, s44
    s_and_b32 s13, s45, 0xffff
    s_mov_b32 s14, 1204224
    s_mov_b32 s15, 0x00020000
    s_movk_i32 s35, 2688
    v_lshrrev_b32 v227, 2, v0
    v_mul_lo_u32 v227, v227, s35
    v_and_b32 v14, 3, v0
    v_lshl_add_u32 v227, v14, 4, v227
    s_mov_b32 s35, 1792
    buffer_load_dwordx4 v[128:131], v227, s[12:15], s35 offen
    s_mov_b32 s35, 173824
    buffer_load_dwordx4 v[132:135], v227, s[12:15], s35 offen
    s_mov_b32 s35, 345856
    buffer_load_dwordx4 v[136:139], v227, s[12:15], s35 offen
    s_mov_b32 s35, 517888
    buffer_load_dwordx4 v[140:143], v227, s[12:15], s35 offen
    s_mov_b32 s35, 689920
    buffer_load_dwordx4 v[144:147], v227, s[12:15], s35 offen
    s_mov_b32 s35, 861952
    buffer_load_dwordx4 v[148:151], v227, s[12:15], s35 offen
    s_mov_b32 s35, 1033984
    buffer_load_dwordx4 v[152:155], v227, s[12:15], s35 offen
    s_mov_b32 s12, s44
    s_and_b32 s13, s45, 0xffff
    s_mov_b32 s14, 1204224
    s_mov_b32 s15, 0x00020000
    s_movk_i32 s35, 2688
    v_lshrrev_b32 v227, 2, v0
    v_mul_lo_u32 v227, v227, s35
    v_and_b32 v14, 3, v0
    v_lshl_add_u32 v227, v14, 4, v227
    s_mov_b32 s35, 1856
    buffer_load_dwordx4 v[156:159], v227, s[12:15], s35 offen
    s_mov_b32 s35, 173888
    buffer_load_dwordx4 v[160:163], v227, s[12:15], s35 offen
    s_mov_b32 s35, 345920
    buffer_load_dwordx4 v[164:167], v227, s[12:15], s35 offen
    s_mov_b32 s35, 517952
    buffer_load_dwordx4 v[168:171], v227, s[12:15], s35 offen
    s_mov_b32 s35, 689984
    buffer_load_dwordx4 v[172:175], v227, s[12:15], s35 offen
    s_mov_b32 s35, 862016
    buffer_load_dwordx4 v[176:179], v227, s[12:15], s35 offen
    s_mov_b32 s35, 1034048
    buffer_load_dwordx4 v[180:183], v227, s[12:15], s35 offen
    s_mov_b32 s54, 0x4924925
    v_add_u32 v13, 0, v2
    v_mul_hi_u32 v14, v13, s54
    v_lshlrev_b32 v13, 4, v13
    v_lshl_add_u32 v13, v14, 4, v13
    v_add_u32 v13, s53, v13
    s_waitcnt vmcnt(41)
    ds_write_b128 v13, v[16:19]
    v_add_u32 v13, 64, v2
    v_mul_hi_u32 v14, v13, s54
    v_lshlrev_b32 v13, 4, v13
    v_lshl_add_u32 v13, v14, 4, v13
    v_add_u32 v13, s53, v13
    s_waitcnt vmcnt(40)
    ds_write_b128 v13, v[20:23]
    v_add_u32 v13, 128, v2
    v_mul_hi_u32 v14, v13, s54
    v_lshlrev_b32 v13, 4, v13
    v_lshl_add_u32 v13, v14, 4, v13
    v_add_u32 v13, s53, v13
    s_waitcnt vmcnt(39)
    ds_write_b128 v13, v[24:27]
    v_add_u32 v13, 192, v2
    v_mul_hi_u32 v14, v13, s54
    v_lshlrev_b32 v13, 4, v13
    v_lshl_add_u32 v13, v14, 4, v13
    v_add_u32 v13, s53, v13
    s_waitcnt vmcnt(38)
    ds_write_b128 v13, v[28:31]
    v_add_u32 v13, 256, v2
    v_mul_hi_u32 v14, v13, s54
    v_lshlrev_b32 v13, 4, v13
    v_lshl_add_u32 v13, v14, 4, v13
    v_add_u32 v13, s53, v13
    s_waitcnt vmcnt(37)
    ds_write_b128 v13, v[32:35]
    v_add_u32 v13, 320, v2
    v_mul_hi_u32 v14, v13, s54
    v_lshlrev_b32 v13, 4, v13
    v_lshl_add_u32 v13, v14, 4, v13
    v_add_u32 v13, s53, v13
    s_waitcnt vmcnt(36)
    ds_write_b128 v13, v[36:39]
    v_add_u32 v13, 384, v2
    v_mul_hi_u32 v14, v13, s54
    v_lshlrev_b32 v13, 4, v13
    v_lshl_add_u32 v13, v14, 4, v13
    v_add_u32 v13, s53, v13
    s_waitcnt vmcnt(35)
    ds_write_b128 v13, v[40:43]
    v_add_u32 v13, 448, v2
    v_mul_hi_u32 v14, v13, s54
    v_lshlrev_b32 v13, 4, v13
    v_lshl_add_u32 v13, v14, 4, v13
    v_add_u32 v13, s53, v13
    s_waitcnt vmcnt(34)
    ds_write_b128 v13, v[44:47]
    v_add_u32 v13, 512, v2
    v_mul_hi_u32 v14, v13, s54
    v_lshlrev_b32 v13, 4, v13
    v_lshl_add_u32 v13, v14, 4, v13
    v_add_u32 v13, s53, v13
    s_waitcnt vmcnt(33)
    ds_write_b128 v13, v[48:51]
    v_add_u32 v13, 576, v2
    v_mul_hi_u32 v14, v13, s54
    v_lshlrev_b32 v13, 4, v13
    v_lshl_add_u32 v13, v14, 4, v13
    v_add_u32 v13, s53, v13
    s_waitcnt vmcnt(32)
    ds_write_b128 v13, v[52:55]
    v_add_u32 v13, 640, v2
    v_mul_hi_u32 v14, v13, s54
    v_lshlrev_b32 v13, 4, v13
    v_lshl_add_u32 v13, v14, 4, v13
    v_add_u32 v13, s53, v13
    s_waitcnt vmcnt(31)
    ds_write_b128 v13, v[56:59]
    v_add_u32 v13, 704, v2
    v_mul_hi_u32 v14, v13, s54
    v_lshlrev_b32 v13, 4, v13
    v_lshl_add_u32 v13, v14, 4, v13
    v_add_u32 v13, s53, v13
    s_waitcnt vmcnt(30)
    ds_write_b128 v13, v[60:63]
    v_add_u32 v13, 768, v2
    v_mul_hi_u32 v14, v13, s54
    v_lshlrev_b32 v13, 4, v13
    v_lshl_add_u32 v13, v14, 4, v13
    v_add_u32 v13, s53, v13
    s_waitcnt vmcnt(29)
    ds_write_b128 v13, v[64:67]
    v_add_u32 v13, 832, v2
    v_mul_hi_u32 v14, v13, s54
    v_lshlrev_b32 v13, 4, v13
    v_lshl_add_u32 v13, v14, 4, v13
    v_add_u32 v13, s53, v13
    s_waitcnt vmcnt(28)
    ds_write_b128 v13, v[68:71]
    v_add_u32 v13, 896, v2
    v_mul_hi_u32 v14, v13, s54
    v_lshlrev_b32 v13, 4, v13
    v_lshl_add_u32 v13, v14, 4, v13
    v_add_u32 v13, s53, v13
    s_waitcnt vmcnt(27)
    ds_write_b128 v13, v[72:75]
    v_add_u32 v13, 960, v2
    v_mul_hi_u32 v14, v13, s54
    v_lshlrev_b32 v13, 4, v13
    v_lshl_add_u32 v13, v14, 4, v13
    v_add_u32 v13, s53, v13
    s_waitcnt vmcnt(26)
    ds_write_b128 v13, v[76:79]
    v_add_u32 v13, 1024, v2
    v_mul_hi_u32 v14, v13, s54
    v_lshlrev_b32 v13, 4, v13
    v_lshl_add_u32 v13, v14, 4, v13
    v_add_u32 v13, s53, v13
    s_waitcnt vmcnt(25)
    ds_write_b128 v13, v[80:83]
    v_add_u32 v13, 1088, v2
    v_mul_hi_u32 v14, v13, s54
    v_lshlrev_b32 v13, 4, v13
    v_lshl_add_u32 v13, v14, 4, v13
    v_add_u32 v13, s53, v13
    s_waitcnt vmcnt(24)
    ds_write_b128 v13, v[84:87]
    v_add_u32 v13, 1152, v2
    v_mul_hi_u32 v14, v13, s54
    v_lshlrev_b32 v13, 4, v13
    v_lshl_add_u32 v13, v14, 4, v13
    v_add_u32 v13, s53, v13
    s_waitcnt vmcnt(23)
    ds_write_b128 v13, v[88:91]
    v_add_u32 v13, 1216, v2
    v_mul_hi_u32 v14, v13, s54
    v_lshlrev_b32 v13, 4, v13
    v_lshl_add_u32 v13, v14, 4, v13
    v_add_u32 v13, s53, v13
    s_waitcnt vmcnt(22)
    ds_write_b128 v13, v[92:95]
    v_add_u32 v13, 1280, v2
    v_mul_hi_u32 v14, v13, s54
    v_lshlrev_b32 v13, 4, v13
    v_lshl_add_u32 v13, v14, 4, v13
    v_add_u32 v13, s53, v13
    s_waitcnt vmcnt(21)
    ds_write_b128 v13, v[96:99]
    v_add_u32 v13, 1344, v2
    v_mul_hi_u32 v14, v13, s54
    v_lshlrev_b32 v13, 4, v13
    v_lshl_add_u32 v13, v14, 4, v13
    v_add_u32 v13, s53, v13
    s_waitcnt vmcnt(20)
    ds_write_b128 v13, v[100:103]
    v_add_u32 v13, 1408, v2
    v_mul_hi_u32 v14, v13, s54
    v_lshlrev_b32 v13, 4, v13
    v_lshl_add_u32 v13, v14, 4, v13
    v_add_u32 v13, s53, v13
    s_waitcnt vmcnt(19)
    ds_write_b128 v13, v[104:107]
    v_add_u32 v13, 1472, v2
    v_mul_hi_u32 v14, v13, s54
    v_lshlrev_b32 v13, 4, v13
    v_lshl_add_u32 v13, v14, 4, v13
    v_add_u32 v13, s53, v13
    s_waitcnt vmcnt(18)
    ds_write_b128 v13, v[108:111]
    v_add_u32 v13, 1536, v2
    v_mul_hi_u32 v14, v13, s54
    v_lshlrev_b32 v13, 4, v13
    v_lshl_add_u32 v13, v14, 4, v13
    v_add_u32 v13, s53, v13
    s_waitcnt vmcnt(17)
    ds_write_b128 v13, v[112:115]
    v_add_u32 v13, 1600, v2
    v_mul_hi_u32 v14, v13, s54
    v_lshlrev_b32 v13, 4, v13
    v_lshl_add_u32 v13, v14, 4, v13
    v_add_u32 v13, s53, v13
    s_waitcnt vmcnt(16)
    ds_write_b128 v13, v[116:119]
    v_add_u32 v13, 1664, v2
    v_mul_hi_u32 v14, v13, s54
    v_lshlrev_b32 v13, 4, v13
    v_lshl_add_u32 v13, v14, 4, v13
    v_add_u32 v13, s53, v13
    s_waitcnt vmcnt(15)
    ds_write_b128 v13, v[120:123]
    v_add_u32 v13, 1728, v2
    v_mul_hi_u32 v14, v13, s54
    v_lshlrev_b32 v13, 4, v13
    v_lshl_add_u32 v13, v14, 4, v13
    v_add_u32 v13, s53, v13
    s_waitcnt vmcnt(14)
    ds_write_b128 v13, v[124:127]
    v_mul_u32_u24 v13, 912, v3
    v_lshl_add_u32 v13, v4, 4, v13
    v_add_u32 v13, s53, v13
    s_waitcnt lgkmcnt(0)
    ds_read_b128 v[16:19], v13 offset:0
    ds_read_b128 v[20:23], v13 offset:32
    ds_read_b128 v[24:27], v13 offset:64
    ds_read_b128 v[28:31], v13 offset:96
    ds_read_b128 v[32:35], v13 offset:128
    ds_read_b128 v[36:39], v13 offset:160
    ds_read_b128 v[40:43], v13 offset:192
    ds_read_b128 v[44:47], v13 offset:224
    ds_read_b128 v[48:51], v13 offset:256
    ds_read_b128 v[52:55], v13 offset:288
    ds_read_b128 v[56:59], v13 offset:320
    ds_read_b128 v[60:63], v13 offset:352
    ds_read_b128 v[64:67], v13 offset:384
    ds_read_b128 v[68:71], v13 offset:416
    ds_read_b128 v[72:75], v13 offset:448
    ds_read_b128 v[76:79], v13 offset:480
    ds_read_b128 v[80:83], v13 offset:512
    ds_read_b128 v[84:87], v13 offset:544
    ds_read_b128 v[88:91], v13 offset:576
    ds_read_b128 v[92:95], v13 offset:608
    ds_read_b128 v[96:99], v13 offset:640
    ds_read_b128 v[100:103], v13 offset:672
    ds_read_b128 v[104:107], v13 offset:704
    ds_read_b128 v[108:111], v13 offset:736
    ds_read_b128 v[112:115], v13 offset:768
    ds_read_b128 v[116:119], v13 offset:800
    ds_read_b128 v[120:123], v13 offset:832
    ds_read_b128 v[124:127], v13 offset:864
    s_waitcnt lgkmcnt(0)
    s_barrier
    s_waitcnt vmcnt(13)
    ds_write_b128 v11, v[128:131] offset:0
    s_waitcnt vmcnt(12)
    ds_write_b128 v11, v[132:135] offset:4096
    s_waitcnt vmcnt(11)
    ds_write_b128 v11, v[136:139] offset:8192
    s_waitcnt vmcnt(10)
    ds_write_b128 v11, v[140:143] offset:12288
    s_waitcnt vmcnt(9)
    ds_write_b128 v11, v[144:147] offset:16384
    s_waitcnt vmcnt(8)
    ds_write_b128 v11, v[148:151] offset:20480
    s_waitcnt vmcnt(7)
    ds_write_b128 v11, v[152:155] offset:24576
    s_waitcnt vmcnt(6)
    ds_write_b128 v11, v[156:159] offset:28672
    s_waitcnt vmcnt(5)
    ds_write_b128 v11, v[160:163] offset:32768
    s_waitcnt vmcnt(4)
    ds_write_b128 v11, v[164:167] offset:36864
    s_waitcnt vmcnt(3)
    ds_write_b128 v11, v[168:171] offset:40960
    s_waitcnt vmcnt(2)
    ds_write_b128 v11, v[172:175] offset:45056
    s_waitcnt vmcnt(1)
    ds_write_b128 v11, v[176:179] offset:49152
    s_waitcnt vmcnt(0)
    ds_write_b128 v11, v[180:183] offset:53248
    s_mov_b32 s12, s44
    s_and_b32 s13, s45, 0xffff
    s_mov_b32 s14, 1204224
    s_mov_b32 s15, 0x00020000
    s_movk_i32 s35, 2688
    v_lshrrev_b32 v13, 2, v0
    v_mul_lo_u32 v13, v13, s35
    v_and_b32 v14, 3, v0
    v_lshl_add_u32 v13, v14, 4, v13
    s_mov_b32 s35, 1920
    buffer_load_dwordx4 v[128:131], v13, s[12:15], s35 offen
    s_mov_b32 s35, 173952
    buffer_load_dwordx4 v[132:135], v13, s[12:15], s35 offen
    s_mov_b32 s35, 345984
    buffer_load_dwordx4 v[136:139], v13, s[12:15], s35 offen
    s_mov_b32 s35, 518016
    buffer_load_dwordx4 v[140:143], v13, s[12:15], s35 offen
    s_mov_b32 s35, 690048
    buffer_load_dwordx4 v[144:147], v13, s[12:15], s35 offen
    s_mov_b32 s35, 862080
    buffer_load_dwordx4 v[148:151], v13, s[12:15], s35 offen
    s_mov_b32 s35, 1034112
    buffer_load_dwordx4 v[152:155], v13, s[12:15], s35 offen
    s_waitcnt vmcnt(6)
    ds_write_b128 v225, v[128:131] offset:0
    s_waitcnt vmcnt(5)
    ds_write_b128 v225, v[132:135] offset:4096
    s_waitcnt vmcnt(4)
    ds_write_b128 v225, v[136:139] offset:8192
    s_waitcnt vmcnt(3)
    ds_write_b128 v225, v[140:143] offset:12288
    s_waitcnt vmcnt(2)
    ds_write_b128 v225, v[144:147] offset:16384
    s_waitcnt vmcnt(1)
    ds_write_b128 v225, v[148:151] offset:20480
    s_waitcnt vmcnt(0)
    ds_write_b128 v225, v[152:155] offset:24576
    s_mov_b32 s12, s44
    s_and_b32 s13, s45, 0xffff
    s_mov_b32 s14, 1204224
    s_mov_b32 s15, 0x00020000
    s_movk_i32 s35, 2688
    v_lshrrev_b32 v13, 2, v0
    v_mul_lo_u32 v13, v13, s35
    v_and_b32 v14, 3, v0
    v_lshl_add_u32 v13, v14, 4, v13
    s_mov_b32 s35, 1984
    buffer_load_dwordx4 v[128:131], v13, s[12:15], s35 offen
    s_mov_b32 s35, 174016
    buffer_load_dwordx4 v[132:135], v13, s[12:15], s35 offen
    s_mov_b32 s35, 346048
    buffer_load_dwordx4 v[136:139], v13, s[12:15], s35 offen
    s_mov_b32 s35, 518080
    buffer_load_dwordx4 v[140:143], v13, s[12:15], s35 offen
    s_mov_b32 s35, 690112
    buffer_load_dwordx4 v[144:147], v13, s[12:15], s35 offen
    s_mov_b32 s35, 862144
    buffer_load_dwordx4 v[148:151], v13, s[12:15], s35 offen
    s_mov_b32 s35, 1034176
    buffer_load_dwordx4 v[152:155], v13, s[12:15], s35 offen
    s_waitcnt vmcnt(6)
    ds_write_b128 v225, v[128:131] offset:28672
    s_waitcnt vmcnt(5)
    ds_write_b128 v225, v[132:135] offset:32768
    s_waitcnt vmcnt(4)
    ds_write_b128 v225, v[136:139] offset:36864
    s_waitcnt vmcnt(3)
    ds_write_b128 v225, v[140:143] offset:40960
    s_waitcnt vmcnt(2)
    ds_write_b128 v225, v[144:147] offset:45056
    s_waitcnt vmcnt(1)
    ds_write_b128 v225, v[148:151] offset:49152
    s_waitcnt vmcnt(0)
    ds_write_b128 v225, v[152:155] offset:53248
    s_waitcnt lgkmcnt(0)
    s_barrier
    ds_read_b64_tr_b16 v[192:193], v7 offset:0
    ds_read_b64_tr_b16 v[194:195], v7 offset:256
    ds_read_b64_tr_b16 v[196:197], v7 offset:28672
    ds_read_b64_tr_b16 v[198:199], v7 offset:28928
    ds_read_b64_tr_b16 v[200:201], v224 offset:0
    ds_read_b64_tr_b16 v[202:203], v224 offset:256
    ds_read_b64_tr_b16 v[204:205], v224 offset:28672
    ds_read_b64_tr_b16 v[206:207], v224 offset:28928
    ds_read_b64_tr_b16 v[208:209], v7 offset:1024
    ds_read_b64_tr_b16 v[210:211], v7 offset:1280
    ds_read_b64_tr_b16 v[212:213], v7 offset:29696
    ds_read_b64_tr_b16 v[214:215], v7 offset:29952
    ds_read_b64_tr_b16 v[216:217], v224 offset:1024
    ds_read_b64_tr_b16 v[218:219], v224 offset:1280
    ds_read_b64_tr_b16 v[220:221], v224 offset:29696
    ds_read_b64_tr_b16 v[222:223], v224 offset:29952
    s_waitcnt lgkmcnt(8)
    v_mfma_f32_32x32x16_bf16 v[128:143], v[16:19], v[192:195], 0
    v_mfma_f32_32x32x16_bf16 v[144:159], v[16:19], v[196:199], 0
    v_mfma_f32_32x32x16_bf16 v[160:175], v[16:19], v[200:203], 0
    v_mfma_f32_32x32x16_bf16 v[176:191], v[16:19], v[204:207], 0
    ds_read_b64_tr_b16 v[192:193], v7 offset:2048
    ds_read_b64_tr_b16 v[194:195], v7 offset:2304
    ds_read_b64_tr_b16 v[196:197], v7 offset:30720
    ds_read_b64_tr_b16 v[198:199], v7 offset:30976
    ds_read_b64_tr_b16 v[200:201], v224 offset:2048
    ds_read_b64_tr_b16 v[202:203], v224 offset:2304
    ds_read_b64_tr_b16 v[204:205], v224 offset:30720
    ds_read_b64_tr_b16 v[206:207], v224 offset:30976
    s_waitcnt lgkmcnt(8)
    v_mfma_f32_32x32x16_bf16 v[128:143], v[20:23], v[208:211], v[128:143]
    v_mfma_f32_32x32x16_bf16 v[144:159], v[20:23], v[212:215], v[144:159]
    v_mfma_f32_32x32x16_bf16 v[160:175], v[20:23], v[216:219], v[160:175]
    v_mfma_f32_32x32x16_bf16 v[176:191], v[20:23], v[220:223], v[176:191]
    ds_read_b64_tr_b16 v[208:209], v7 offset:3072
    ds_read_b64_tr_b16 v[210:211], v7 offset:3328
    ds_read_b64_tr_b16 v[212:213], v7 offset:31744
    ds_read_b64_tr_b16 v[214:215], v7 offset:32000
    ds_read_b64_tr_b16 v[216:217], v224 offset:3072
    ds_read_b64_tr_b16 v[218:219], v224 offset:3328
    ds_read_b64_tr_b16 v[220:221], v224 offset:31744
    ds_read_b64_tr_b16 v[222:223], v224 offset:32000
    s_waitcnt lgkmcnt(8)
    v_mfma_f32_32x32x16_bf16 v[128:143], v[24:27], v[192:195], v[128:143]
    v_mfma_f32_32x32x16_bf16 v[144:159], v[24:27], v[196:199], v[144:159]
    v_mfma_f32_32x32x16_bf16 v[160:175], v[24:27], v[200:203], v[160:175]
    v_mfma_f32_32x32x16_bf16 v[176:191], v[24:27], v[204:207], v[176:191]
    ds_read_b64_tr_b16 v[192:193], v7 offset:4096
    ds_read_b64_tr_b16 v[194:195], v7 offset:4352
    ds_read_b64_tr_b16 v[196:197], v7 offset:32768
    ds_read_b64_tr_b16 v[198:199], v7 offset:33024
    ds_read_b64_tr_b16 v[200:201], v224 offset:4096
    ds_read_b64_tr_b16 v[202:203], v224 offset:4352
    ds_read_b64_tr_b16 v[204:205], v224 offset:32768
    ds_read_b64_tr_b16 v[206:207], v224 offset:33024
    s_waitcnt lgkmcnt(8)
    v_mfma_f32_32x32x16_bf16 v[128:143], v[28:31], v[208:211], v[128:143]
    v_mfma_f32_32x32x16_bf16 v[144:159], v[28:31], v[212:215], v[144:159]
    v_mfma_f32_32x32x16_bf16 v[160:175], v[28:31], v[216:219], v[160:175]
    v_mfma_f32_32x32x16_bf16 v[176:191], v[28:31], v[220:223], v[176:191]
    ds_read_b64_tr_b16 v[208:209], v7 offset:5120
    ds_read_b64_tr_b16 v[210:211], v7 offset:5376
    ds_read_b64_tr_b16 v[212:213], v7 offset:33792
    ds_read_b64_tr_b16 v[214:215], v7 offset:34048
    ds_read_b64_tr_b16 v[216:217], v224 offset:5120
    ds_read_b64_tr_b16 v[218:219], v224 offset:5376
    ds_read_b64_tr_b16 v[220:221], v224 offset:33792
    ds_read_b64_tr_b16 v[222:223], v224 offset:34048
    s_waitcnt lgkmcnt(8)
    v_mfma_f32_32x32x16_bf16 v[128:143], v[32:35], v[192:195], v[128:143]
    v_mfma_f32_32x32x16_bf16 v[144:159], v[32:35], v[196:199], v[144:159]
    v_mfma_f32_32x32x16_bf16 v[160:175], v[32:35], v[200:203], v[160:175]
    v_mfma_f32_32x32x16_bf16 v[176:191], v[32:35], v[204:207], v[176:191]
    ds_read_b64_tr_b16 v[192:193], v7 offset:6144
    ds_read_b64_tr_b16 v[194:195], v7 offset:6400
    ds_read_b64_tr_b16 v[196:197], v7 offset:34816
    ds_read_b64_tr_b16 v[198:199], v7 offset:35072
    ds_read_b64_tr_b16 v[200:201], v224 offset:6144
    ds_read_b64_tr_b16 v[202:203], v224 offset:6400
    ds_read_b64_tr_b16 v[204:205], v224 offset:34816
    ds_read_b64_tr_b16 v[206:207], v224 offset:35072
    s_waitcnt lgkmcnt(8)
    v_mfma_f32_32x32x16_bf16 v[128:143], v[36:39], v[208:211], v[128:143]
    v_mfma_f32_32x32x16_bf16 v[144:159], v[36:39], v[212:215], v[144:159]
    v_mfma_f32_32x32x16_bf16 v[160:175], v[36:39], v[216:219], v[160:175]
    v_mfma_f32_32x32x16_bf16 v[176:191], v[36:39], v[220:223], v[176:191]
    ds_read_b64_tr_b16 v[208:209], v7 offset:7168
    ds_read_b64_tr_b16 v[210:211], v7 offset:7424
    ds_read_b64_tr_b16 v[212:213], v7 offset:35840
    ds_read_b64_tr_b16 v[214:215], v7 offset:36096
    ds_read_b64_tr_b16 v[216:217], v224 offset:7168
    ds_read_b64_tr_b16 v[218:219], v224 offset:7424
    ds_read_b64_tr_b16 v[220:221], v224 offset:35840
    ds_read_b64_tr_b16 v[222:223], v224 offset:36096
    s_waitcnt lgkmcnt(8)
    v_mfma_f32_32x32x16_bf16 v[128:143], v[40:43], v[192:195], v[128:143]
    v_mfma_f32_32x32x16_bf16 v[144:159], v[40:43], v[196:199], v[144:159]
    v_mfma_f32_32x32x16_bf16 v[160:175], v[40:43], v[200:203], v[160:175]
    v_mfma_f32_32x32x16_bf16 v[176:191], v[40:43], v[204:207], v[176:191]
    ds_read_b64_tr_b16 v[192:193], v7 offset:8192
    ds_read_b64_tr_b16 v[194:195], v7 offset:8448
    ds_read_b64_tr_b16 v[196:197], v7 offset:36864
    ds_read_b64_tr_b16 v[198:199], v7 offset:37120
    ds_read_b64_tr_b16 v[200:201], v224 offset:8192
    ds_read_b64_tr_b16 v[202:203], v224 offset:8448
    ds_read_b64_tr_b16 v[204:205], v224 offset:36864
    ds_read_b64_tr_b16 v[206:207], v224 offset:37120
    s_waitcnt lgkmcnt(8)
    v_mfma_f32_32x32x16_bf16 v[128:143], v[44:47], v[208:211], v[128:143]
    v_mfma_f32_32x32x16_bf16 v[144:159], v[44:47], v[212:215], v[144:159]
    v_mfma_f32_32x32x16_bf16 v[160:175], v[44:47], v[216:219], v[160:175]
    v_mfma_f32_32x32x16_bf16 v[176:191], v[44:47], v[220:223], v[176:191]
    ds_read_b64_tr_b16 v[208:209], v7 offset:9216
    ds_read_b64_tr_b16 v[210:211], v7 offset:9472
    ds_read_b64_tr_b16 v[212:213], v7 offset:37888
    ds_read_b64_tr_b16 v[214:215], v7 offset:38144
    ds_read_b64_tr_b16 v[216:217], v224 offset:9216
    ds_read_b64_tr_b16 v[218:219], v224 offset:9472
    ds_read_b64_tr_b16 v[220:221], v224 offset:37888
    ds_read_b64_tr_b16 v[222:223], v224 offset:38144
    s_waitcnt lgkmcnt(8)
    v_mfma_f32_32x32x16_bf16 v[128:143], v[48:51], v[192:195], v[128:143]
    v_mfma_f32_32x32x16_bf16 v[144:159], v[48:51], v[196:199], v[144:159]
    v_mfma_f32_32x32x16_bf16 v[160:175], v[48:51], v[200:203], v[160:175]
    v_mfma_f32_32x32x16_bf16 v[176:191], v[48:51], v[204:207], v[176:191]
    ds_read_b64_tr_b16 v[192:193], v7 offset:10240
    ds_read_b64_tr_b16 v[194:195], v7 offset:10496
    ds_read_b64_tr_b16 v[196:197], v7 offset:38912
    ds_read_b64_tr_b16 v[198:199], v7 offset:39168
    ds_read_b64_tr_b16 v[200:201], v224 offset:10240
    ds_read_b64_tr_b16 v[202:203], v224 offset:10496
    ds_read_b64_tr_b16 v[204:205], v224 offset:38912
    ds_read_b64_tr_b16 v[206:207], v224 offset:39168
    s_waitcnt lgkmcnt(8)
    v_mfma_f32_32x32x16_bf16 v[128:143], v[52:55], v[208:211], v[128:143]
    v_mfma_f32_32x32x16_bf16 v[144:159], v[52:55], v[212:215], v[144:159]
    v_mfma_f32_32x32x16_bf16 v[160:175], v[52:55], v[216:219], v[160:175]
    v_mfma_f32_32x32x16_bf16 v[176:191], v[52:55], v[220:223], v[176:191]
    ds_read_b64_tr_b16 v[208:209], v7 offset:11264
    ds_read_b64_tr_b16 v[210:211], v7 offset:11520
    ds_read_b64_tr_b16 v[212:213], v7 offset:39936
    ds_read_b64_tr_b16 v[214:215], v7 offset:40192
    ds_read_b64_tr_b16 v[216:217], v224 offset:11264
    ds_read_b64_tr_b16 v[218:219], v224 offset:11520
    ds_read_b64_tr_b16 v[220:221], v224 offset:39936
    ds_read_b64_tr_b16 v[222:223], v224 offset:40192
    s_waitcnt lgkmcnt(8)
    v_mfma_f32_32x32x16_bf16 v[128:143], v[56:59], v[192:195], v[128:143]
    v_mfma_f32_32x32x16_bf16 v[144:159], v[56:59], v[196:199], v[144:159]
    v_mfma_f32_32x32x16_bf16 v[160:175], v[56:59], v[200:203], v[160:175]
    v_mfma_f32_32x32x16_bf16 v[176:191], v[56:59], v[204:207], v[176:191]
    ds_read_b64_tr_b16 v[192:193], v7 offset:12288
    ds_read_b64_tr_b16 v[194:195], v7 offset:12544
    ds_read_b64_tr_b16 v[196:197], v7 offset:40960
    ds_read_b64_tr_b16 v[198:199], v7 offset:41216
    ds_read_b64_tr_b16 v[200:201], v224 offset:12288
    ds_read_b64_tr_b16 v[202:203], v224 offset:12544
    ds_read_b64_tr_b16 v[204:205], v224 offset:40960
    ds_read_b64_tr_b16 v[206:207], v224 offset:41216
    s_waitcnt lgkmcnt(8)
    v_mfma_f32_32x32x16_bf16 v[128:143], v[60:63], v[208:211], v[128:143]
    v_mfma_f32_32x32x16_bf16 v[144:159], v[60:63], v[212:215], v[144:159]
    v_mfma_f32_32x32x16_bf16 v[160:175], v[60:63], v[216:219], v[160:175]
    v_mfma_f32_32x32x16_bf16 v[176:191], v[60:63], v[220:223], v[176:191]
    ds_read_b64_tr_b16 v[208:209], v7 offset:13312
    ds_read_b64_tr_b16 v[210:211], v7 offset:13568
    ds_read_b64_tr_b16 v[212:213], v7 offset:41984
    ds_read_b64_tr_b16 v[214:215], v7 offset:42240
    ds_read_b64_tr_b16 v[216:217], v224 offset:13312
    ds_read_b64_tr_b16 v[218:219], v224 offset:13568
    ds_read_b64_tr_b16 v[220:221], v224 offset:41984
    ds_read_b64_tr_b16 v[222:223], v224 offset:42240
    s_waitcnt lgkmcnt(8)
    v_mfma_f32_32x32x16_bf16 v[128:143], v[64:67], v[192:195], v[128:143]
    v_mfma_f32_32x32x16_bf16 v[144:159], v[64:67], v[196:199], v[144:159]
    v_mfma_f32_32x32x16_bf16 v[160:175], v[64:67], v[200:203], v[160:175]
    v_mfma_f32_32x32x16_bf16 v[176:191], v[64:67], v[204:207], v[176:191]
    ds_read_b64_tr_b16 v[192:193], v7 offset:14336
    ds_read_b64_tr_b16 v[194:195], v7 offset:14592
    ds_read_b64_tr_b16 v[196:197], v7 offset:43008
    ds_read_b64_tr_b16 v[198:199], v7 offset:43264
    ds_read_b64_tr_b16 v[200:201], v224 offset:14336
    ds_read_b64_tr_b16 v[202:203], v224 offset:14592
    ds_read_b64_tr_b16 v[204:205], v224 offset:43008
    ds_read_b64_tr_b16 v[206:207], v224 offset:43264
    s_waitcnt lgkmcnt(8)
    v_mfma_f32_32x32x16_bf16 v[128:143], v[68:71], v[208:211], v[128:143]
    v_mfma_f32_32x32x16_bf16 v[144:159], v[68:71], v[212:215], v[144:159]
    v_mfma_f32_32x32x16_bf16 v[160:175], v[68:71], v[216:219], v[160:175]
    v_mfma_f32_32x32x16_bf16 v[176:191], v[68:71], v[220:223], v[176:191]
    ds_read_b64_tr_b16 v[208:209], v7 offset:15360
    ds_read_b64_tr_b16 v[210:211], v7 offset:15616
    ds_read_b64_tr_b16 v[212:213], v7 offset:44032
    ds_read_b64_tr_b16 v[214:215], v7 offset:44288
    ds_read_b64_tr_b16 v[216:217], v224 offset:15360
    ds_read_b64_tr_b16 v[218:219], v224 offset:15616
    ds_read_b64_tr_b16 v[220:221], v224 offset:44032
    ds_read_b64_tr_b16 v[222:223], v224 offset:44288
    s_waitcnt lgkmcnt(8)
    v_mfma_f32_32x32x16_bf16 v[128:143], v[72:75], v[192:195], v[128:143]
    v_mfma_f32_32x32x16_bf16 v[144:159], v[72:75], v[196:199], v[144:159]
    v_mfma_f32_32x32x16_bf16 v[160:175], v[72:75], v[200:203], v[160:175]
    v_mfma_f32_32x32x16_bf16 v[176:191], v[72:75], v[204:207], v[176:191]
    ds_read_b64_tr_b16 v[192:193], v7 offset:16384
    ds_read_b64_tr_b16 v[194:195], v7 offset:16640
    ds_read_b64_tr_b16 v[196:197], v7 offset:45056
    ds_read_b64_tr_b16 v[198:199], v7 offset:45312
    ds_read_b64_tr_b16 v[200:201], v224 offset:16384
    ds_read_b64_tr_b16 v[202:203], v224 offset:16640
    ds_read_b64_tr_b16 v[204:205], v224 offset:45056
    ds_read_b64_tr_b16 v[206:207], v224 offset:45312
    s_waitcnt lgkmcnt(8)
    v_mfma_f32_32x32x16_bf16 v[128:143], v[76:79], v[208:211], v[128:143]
    v_mfma_f32_32x32x16_bf16 v[144:159], v[76:79], v[212:215], v[144:159]
    v_mfma_f32_32x32x16_bf16 v[160:175], v[76:79], v[216:219], v[160:175]
    v_mfma_f32_32x32x16_bf16 v[176:191], v[76:79], v[220:223], v[176:191]
    ds_read_b64_tr_b16 v[208:209], v7 offset:17408
    ds_read_b64_tr_b16 v[210:211], v7 offset:17664
    ds_read_b64_tr_b16 v[212:213], v7 offset:46080
    ds_read_b64_tr_b16 v[214:215], v7 offset:46336
    ds_read_b64_tr_b16 v[216:217], v224 offset:17408
    ds_read_b64_tr_b16 v[218:219], v224 offset:17664
    ds_read_b64_tr_b16 v[220:221], v224 offset:46080
    ds_read_b64_tr_b16 v[222:223], v224 offset:46336
    s_waitcnt lgkmcnt(8)
    v_mfma_f32_32x32x16_bf16 v[128:143], v[80:83], v[192:195], v[128:143]
    v_mfma_f32_32x32x16_bf16 v[144:159], v[80:83], v[196:199], v[144:159]
    v_mfma_f32_32x32x16_bf16 v[160:175], v[80:83], v[200:203], v[160:175]
    v_mfma_f32_32x32x16_bf16 v[176:191], v[80:83], v[204:207], v[176:191]
    ds_read_b64_tr_b16 v[192:193], v7 offset:18432
    ds_read_b64_tr_b16 v[194:195], v7 offset:18688
    ds_read_b64_tr_b16 v[196:197], v7 offset:47104
    ds_read_b64_tr_b16 v[198:199], v7 offset:47360
    ds_read_b64_tr_b16 v[200:201], v224 offset:18432
    ds_read_b64_tr_b16 v[202:203], v224 offset:18688
    ds_read_b64_tr_b16 v[204:205], v224 offset:47104
    ds_read_b64_tr_b16 v[206:207], v224 offset:47360
    s_waitcnt lgkmcnt(8)
    v_mfma_f32_32x32x16_bf16 v[128:143], v[84:87], v[208:211], v[128:143]
    v_mfma_f32_32x32x16_bf16 v[144:159], v[84:87], v[212:215], v[144:159]
    v_mfma_f32_32x32x16_bf16 v[160:175], v[84:87], v[216:219], v[160:175]
    v_mfma_f32_32x32x16_bf16 v[176:191], v[84:87], v[220:223], v[176:191]
    ds_read_b64_tr_b16 v[208:209], v7 offset:19456
    ds_read_b64_tr_b16 v[210:211], v7 offset:19712
    ds_read_b64_tr_b16 v[212:213], v7 offset:48128
    ds_read_b64_tr_b16 v[214:215], v7 offset:48384
    ds_read_b64_tr_b16 v[216:217], v224 offset:19456
    ds_read_b64_tr_b16 v[218:219], v224 offset:19712
    ds_read_b64_tr_b16 v[220:221], v224 offset:48128
    ds_read_b64_tr_b16 v[222:223], v224 offset:48384
    s_waitcnt lgkmcnt(8)
    v_mfma_f32_32x32x16_bf16 v[128:143], v[88:91], v[192:195], v[128:143]
    v_mfma_f32_32x32x16_bf16 v[144:159], v[88:91], v[196:199], v[144:159]
    v_mfma_f32_32x32x16_bf16 v[160:175], v[88:91], v[200:203], v[160:175]
    v_mfma_f32_32x32x16_bf16 v[176:191], v[88:91], v[204:207], v[176:191]
    ds_read_b64_tr_b16 v[192:193], v7 offset:20480
    ds_read_b64_tr_b16 v[194:195], v7 offset:20736
    ds_read_b64_tr_b16 v[196:197], v7 offset:49152
    ds_read_b64_tr_b16 v[198:199], v7 offset:49408
    ds_read_b64_tr_b16 v[200:201], v224 offset:20480
    ds_read_b64_tr_b16 v[202:203], v224 offset:20736
    ds_read_b64_tr_b16 v[204:205], v224 offset:49152
    ds_read_b64_tr_b16 v[206:207], v224 offset:49408
    s_waitcnt lgkmcnt(8)
    v_mfma_f32_32x32x16_bf16 v[128:143], v[92:95], v[208:211], v[128:143]
    v_mfma_f32_32x32x16_bf16 v[144:159], v[92:95], v[212:215], v[144:159]
    v_mfma_f32_32x32x16_bf16 v[160:175], v[92:95], v[216:219], v[160:175]
    v_mfma_f32_32x32x16_bf16 v[176:191], v[92:95], v[220:223], v[176:191]
    ds_read_b64_tr_b16 v[208:209], v7 offset:21504
    ds_read_b64_tr_b16 v[210:211], v7 offset:21760
    ds_read_b64_tr_b16 v[212:213], v7 offset:50176
    ds_read_b64_tr_b16 v[214:215], v7 offset:50432
    ds_read_b64_tr_b16 v[216:217], v224 offset:21504
    ds_read_b64_tr_b16 v[218:219], v224 offset:21760
    ds_read_b64_tr_b16 v[220:221], v224 offset:50176
    ds_read_b64_tr_b16 v[222:223], v224 offset:50432
    s_waitcnt lgkmcnt(8)
    v_mfma_f32_32x32x16_bf16 v[128:143], v[96:99], v[192:195], v[128:143]
    v_mfma_f32_32x32x16_bf16 v[144:159], v[96:99], v[196:199], v[144:159]
    v_mfma_f32_32x32x16_bf16 v[160:175], v[96:99], v[200:203], v[160:175]
    v_mfma_f32_32x32x16_bf16 v[176:191], v[96:99], v[204:207], v[176:191]
    ds_read_b64_tr_b16 v[192:193], v7 offset:22528
    ds_read_b64_tr_b16 v[194:195], v7 offset:22784
    ds_read_b64_tr_b16 v[196:197], v7 offset:51200
    ds_read_b64_tr_b16 v[198:199], v7 offset:51456
    ds_read_b64_tr_b16 v[200:201], v224 offset:22528
    ds_read_b64_tr_b16 v[202:203], v224 offset:22784
    ds_read_b64_tr_b16 v[204:205], v224 offset:51200
    ds_read_b64_tr_b16 v[206:207], v224 offset:51456
    s_waitcnt lgkmcnt(8)
    v_mfma_f32_32x32x16_bf16 v[128:143], v[100:103], v[208:211], v[128:143]
    v_mfma_f32_32x32x16_bf16 v[144:159], v[100:103], v[212:215], v[144:159]
    v_mfma_f32_32x32x16_bf16 v[160:175], v[100:103], v[216:219], v[160:175]
    v_mfma_f32_32x32x16_bf16 v[176:191], v[100:103], v[220:223], v[176:191]
    ds_read_b64_tr_b16 v[208:209], v7 offset:23552
    ds_read_b64_tr_b16 v[210:211], v7 offset:23808
    ds_read_b64_tr_b16 v[212:213], v7 offset:52224
    ds_read_b64_tr_b16 v[214:215], v7 offset:52480
    ds_read_b64_tr_b16 v[216:217], v224 offset:23552
    ds_read_b64_tr_b16 v[218:219], v224 offset:23808
    ds_read_b64_tr_b16 v[220:221], v224 offset:52224
    ds_read_b64_tr_b16 v[222:223], v224 offset:52480
    s_waitcnt lgkmcnt(8)
    v_mfma_f32_32x32x16_bf16 v[128:143], v[104:107], v[192:195], v[128:143]
    v_mfma_f32_32x32x16_bf16 v[144:159], v[104:107], v[196:199], v[144:159]
    v_mfma_f32_32x32x16_bf16 v[160:175], v[104:107], v[200:203], v[160:175]
    v_mfma_f32_32x32x16_bf16 v[176:191], v[104:107], v[204:207], v[176:191]
    ds_read_b64_tr_b16 v[192:193], v7 offset:24576
    ds_read_b64_tr_b16 v[194:195], v7 offset:24832
    ds_read_b64_tr_b16 v[196:197], v7 offset:53248
    ds_read_b64_tr_b16 v[198:199], v7 offset:53504
    ds_read_b64_tr_b16 v[200:201], v224 offset:24576
    ds_read_b64_tr_b16 v[202:203], v224 offset:24832
    ds_read_b64_tr_b16 v[204:205], v224 offset:53248
    ds_read_b64_tr_b16 v[206:207], v224 offset:53504
    s_waitcnt lgkmcnt(8)
    v_mfma_f32_32x32x16_bf16 v[128:143], v[108:111], v[208:211], v[128:143]
    v_mfma_f32_32x32x16_bf16 v[144:159], v[108:111], v[212:215], v[144:159]
    v_mfma_f32_32x32x16_bf16 v[160:175], v[108:111], v[216:219], v[160:175]
    v_mfma_f32_32x32x16_bf16 v[176:191], v[108:111], v[220:223], v[176:191]
    ds_read_b64_tr_b16 v[208:209], v7 offset:25600
    ds_read_b64_tr_b16 v[210:211], v7 offset:25856
    ds_read_b64_tr_b16 v[212:213], v7 offset:54272
    ds_read_b64_tr_b16 v[214:215], v7 offset:54528
    ds_read_b64_tr_b16 v[216:217], v224 offset:25600
    ds_read_b64_tr_b16 v[218:219], v224 offset:25856
    ds_read_b64_tr_b16 v[220:221], v224 offset:54272
    ds_read_b64_tr_b16 v[222:223], v224 offset:54528
    s_waitcnt lgkmcnt(8)
    v_mfma_f32_32x32x16_bf16 v[128:143], v[112:115], v[192:195], v[128:143]
    v_mfma_f32_32x32x16_bf16 v[144:159], v[112:115], v[196:199], v[144:159]
    v_mfma_f32_32x32x16_bf16 v[160:175], v[112:115], v[200:203], v[160:175]
    v_mfma_f32_32x32x16_bf16 v[176:191], v[112:115], v[204:207], v[176:191]
    ds_read_b64_tr_b16 v[192:193], v7 offset:26624
    ds_read_b64_tr_b16 v[194:195], v7 offset:26880
    ds_read_b64_tr_b16 v[196:197], v7 offset:55296
    ds_read_b64_tr_b16 v[198:199], v7 offset:55552
    ds_read_b64_tr_b16 v[200:201], v224 offset:26624
    ds_read_b64_tr_b16 v[202:203], v224 offset:26880
    ds_read_b64_tr_b16 v[204:205], v224 offset:55296
    ds_read_b64_tr_b16 v[206:207], v224 offset:55552
    s_waitcnt lgkmcnt(8)
    v_mfma_f32_32x32x16_bf16 v[128:143], v[116:119], v[208:211], v[128:143]
    v_mfma_f32_32x32x16_bf16 v[144:159], v[116:119], v[212:215], v[144:159]
    v_mfma_f32_32x32x16_bf16 v[160:175], v[116:119], v[216:219], v[160:175]
    v_mfma_f32_32x32x16_bf16 v[176:191], v[116:119], v[220:223], v[176:191]
    ds_read_b64_tr_b16 v[208:209], v7 offset:27648
    ds_read_b64_tr_b16 v[210:211], v7 offset:27904
    ds_read_b64_tr_b16 v[212:213], v7 offset:56320
    ds_read_b64_tr_b16 v[214:215], v7 offset:56576
    ds_read_b64_tr_b16 v[216:217], v224 offset:27648
    ds_read_b64_tr_b16 v[218:219], v224 offset:27904
    ds_read_b64_tr_b16 v[220:221], v224 offset:56320
    ds_read_b64_tr_b16 v[222:223], v224 offset:56576
    s_waitcnt lgkmcnt(8)
    v_mfma_f32_32x32x16_bf16 v[128:143], v[120:123], v[192:195], v[128:143]
    v_mfma_f32_32x32x16_bf16 v[144:159], v[120:123], v[196:199], v[144:159]
    v_mfma_f32_32x32x16_bf16 v[160:175], v[120:123], v[200:203], v[160:175]
    v_mfma_f32_32x32x16_bf16 v[176:191], v[120:123], v[204:207], v[176:191]
    s_waitcnt lgkmcnt(0)
    v_mfma_f32_32x32x16_bf16 v[128:143], v[124:127], v[208:211], v[128:143]
    v_mfma_f32_32x32x16_bf16 v[144:159], v[124:127], v[212:215], v[144:159]
    v_mfma_f32_32x32x16_bf16 v[160:175], v[124:127], v[216:219], v[160:175]
    v_mfma_f32_32x32x16_bf16 v[176:191], v[124:127], v[220:223], v[176:191]
    s_nop 15
    s_nop 3
    v_add_u32 v13, 0, v3
    v_lshlrev_b32 v13, 12, v13
    v_sub_u32 v14, v5, v3
    v_lshl_add_u32 v13, v14, 1, v13
    v_lshl_add_u32 v13, v4, 3, v13
    v_add_u32 v13, 6029312, v13
    v_cvt_pk_bf16_f32 v128, v128, v129
    v_cvt_pk_bf16_f32 v129, v130, v131
    buffer_store_dwordx2 v[128:129], v13, s[16:19], 0 offen offset:0
    v_cvt_pk_bf16_f32 v132, v132, v133
    v_cvt_pk_bf16_f32 v133, v134, v135
    buffer_store_dwordx2 v[132:133], v13, s[16:19], 0 offen offset:16
    v_cvt_pk_bf16_f32 v136, v136, v137
    v_cvt_pk_bf16_f32 v137, v138, v139
    buffer_store_dwordx2 v[136:137], v13, s[16:19], 0 offen offset:32
    v_cvt_pk_bf16_f32 v140, v140, v141
    v_cvt_pk_bf16_f32 v141, v142, v143
    buffer_store_dwordx2 v[140:141], v13, s[16:19], 0 offen offset:48
    v_add_u32 v13, 32, v3
    v_lshlrev_b32 v13, 12, v13
    v_sub_u32 v14, v5, v3
    v_lshl_add_u32 v13, v14, 1, v13
    v_lshl_add_u32 v13, v4, 3, v13
    v_add_u32 v13, 6029312, v13
    v_cvt_pk_bf16_f32 v144, v144, v145
    v_cvt_pk_bf16_f32 v145, v146, v147
    buffer_store_dwordx2 v[144:145], v13, s[16:19], 0 offen offset:0
    v_cvt_pk_bf16_f32 v148, v148, v149
    v_cvt_pk_bf16_f32 v149, v150, v151
    buffer_store_dwordx2 v[148:149], v13, s[16:19], 0 offen offset:16
    v_cvt_pk_bf16_f32 v152, v152, v153
    v_cvt_pk_bf16_f32 v153, v154, v155
    buffer_store_dwordx2 v[152:153], v13, s[16:19], 0 offen offset:32
    v_cvt_pk_bf16_f32 v156, v156, v157
    v_cvt_pk_bf16_f32 v157, v158, v159
    buffer_store_dwordx2 v[156:157], v13, s[16:19], 0 offen offset:48
    v_add_u32 v13, 64, v3
    v_lshlrev_b32 v13, 12, v13
    v_sub_u32 v14, v5, v3
    v_lshl_add_u32 v13, v14, 1, v13
    v_lshl_add_u32 v13, v4, 3, v13
    v_add_u32 v13, 6029312, v13
    v_cvt_pk_bf16_f32 v160, v160, v161
    v_cvt_pk_bf16_f32 v161, v162, v163
    buffer_store_dwordx2 v[160:161], v13, s[16:19], 0 offen offset:0
    v_cvt_pk_bf16_f32 v164, v164, v165
    v_cvt_pk_bf16_f32 v165, v166, v167
    buffer_store_dwordx2 v[164:165], v13, s[16:19], 0 offen offset:16
    v_cvt_pk_bf16_f32 v168, v168, v169
    v_cvt_pk_bf16_f32 v169, v170, v171
    buffer_store_dwordx2 v[168:169], v13, s[16:19], 0 offen offset:32
    v_cvt_pk_bf16_f32 v172, v172, v173
    v_cvt_pk_bf16_f32 v173, v174, v175
    buffer_store_dwordx2 v[172:173], v13, s[16:19], 0 offen offset:48
    v_add_u32 v13, 96, v3
    v_lshlrev_b32 v13, 12, v13
    v_sub_u32 v14, v5, v3
    v_lshl_add_u32 v13, v14, 1, v13
    v_lshl_add_u32 v13, v4, 3, v13
    v_add_u32 v13, 6029312, v13
    v_cvt_pk_bf16_f32 v176, v176, v177
    v_cvt_pk_bf16_f32 v177, v178, v179
    buffer_store_dwordx2 v[176:177], v13, s[16:19], 0 offen offset:0
    v_cvt_pk_bf16_f32 v180, v180, v181
    v_cvt_pk_bf16_f32 v181, v182, v183
    buffer_store_dwordx2 v[180:181], v13, s[16:19], 0 offen offset:16
    v_cvt_pk_bf16_f32 v184, v184, v185
    v_cvt_pk_bf16_f32 v185, v186, v187
    buffer_store_dwordx2 v[184:185], v13, s[16:19], 0 offen offset:32
    v_cvt_pk_bf16_f32 v188, v188, v189
    v_cvt_pk_bf16_f32 v189, v190, v191
    buffer_store_dwordx2 v[188:189], v13, s[16:19], 0 offen offset:48
    s_endpgm
K1_v12:
    s_mov_b32 s12, s44
    s_and_b32 s13, s45, 0xffff
    s_mov_b32 s14, 1204224
    s_mov_b32 s15, 0x00020000
    s_movk_i32 s35, 2688
    v_lshrrev_b32 v227, 2, v0
    v_mul_lo_u32 v227, v227, s35
    v_and_b32 v14, 3, v0
    v_lshl_add_u32 v227, v14, 4, v227
    s_mov_b32 s35, 2048
    buffer_load_dwordx4 v[128:131], v227, s[12:15], s35 offen
    s_mov_b32 s35, 174080
    buffer_load_dwordx4 v[132:135], v227, s[12:15], s35 offen
    s_mov_b32 s35, 346112
    buffer_load_dwordx4 v[136:139], v227, s[12:15], s35 offen
    s_mov_b32 s35, 518144
    buffer_load_dwordx4 v[140:143], v227, s[12:15], s35 offen
    s_mov_b32 s35, 690176
    buffer_load_dwordx4 v[144:147], v227, s[12:15], s35 offen
    s_mov_b32 s35, 862208
    buffer_load_dwordx4 v[148:151], v227, s[12:15], s35 offen
    s_mov_b32 s35, 1034240
    buffer_load_dwordx4 v[152:155], v227, s[12:15], s35 offen
    s_mov_b32 s12, s44
    s_and_b32 s13, s45, 0xffff
    s_mov_b32 s14, 1204224
    s_mov_b32 s15, 0x00020000
    s_movk_i32 s35, 2688
    v_lshrrev_b32 v227, 2, v0
    v_mul_lo_u32 v227, v227, s35
    v_and_b32 v14, 3, v0
    v_lshl_add_u32 v227, v14, 4, v227
    s_mov_b32 s35, 2112
    buffer_load_dwordx4 v[156:159], v227, s[12:15], s35 offen
    s_mov_b32 s35, 174144
    buffer_load_dwordx4 v[160:163], v227, s[12:15], s35 offen
    s_mov_b32 s35, 346176
    buffer_load_dwordx4 v[164:167], v227, s[12:15], s35 offen
    s_mov_b32 s35, 518208
    buffer_load_dwordx4 v[168:171], v227, s[12:15], s35 offen
    s_mov_b32 s35, 690240
    buffer_load_dwordx4 v[172:175], v227, s[12:15], s35 offen
    s_mov_b32 s35, 862272
    buffer_load_dwordx4 v[176:179], v227, s[12:15], s35 offen
    s_mov_b32 s35, 1034304
    buffer_load_dwordx4 v[180:183], v227, s[12:15], s35 offen
    s_mov_b32 s54, 0x4924925
    v_add_u32 v13, 0, v2
    v_mul_hi_u32 v14, v13, s54
    v_lshlrev_b32 v13, 4, v13
    v_lshl_add_u32 v13, v14, 4, v13
    v_add_u32 v13, s53, v13
    s_waitcnt vmcnt(41)
    ds_write_b128 v13, v[16:19]
    v_add_u32 v13, 64, v2
    v_mul_hi_u32 v14, v13, s54
    v_lshlrev_b32 v13, 4, v13
    v_lshl_add_u32 v13, v14, 4, v13
    v_add_u32 v13, s53, v13
    s_waitcnt vmcnt(40)
    ds_write_b128 v13, v[20:23]
    v_add_u32 v13, 128, v2
    v_mul_hi_u32 v14, v13, s54
    v_lshlrev_b32 v13, 4, v13
    v_lshl_add_u32 v13, v14, 4, v13
    v_add_u32 v13, s53, v13
    s_waitcnt vmcnt(39)
    ds_write_b128 v13, v[24:27]
    v_add_u32 v13, 192, v2
    v_mul_hi_u32 v14, v13, s54
    v_lshlrev_b32 v13, 4, v13
    v_lshl_add_u32 v13, v14, 4, v13
    v_add_u32 v13, s53, v13
    s_waitcnt vmcnt(38)
    ds_write_b128 v13, v[28:31]
    v_add_u32 v13, 256, v2
    v_mul_hi_u32 v14, v13, s54
    v_lshlrev_b32 v13, 4, v13
    v_lshl_add_u32 v13, v14, 4, v13
    v_add_u32 v13, s53, v13
    s_waitcnt vmcnt(37)
    ds_write_b128 v13, v[32:35]
    v_add_u32 v13, 320, v2
    v_mul_hi_u32 v14, v13, s54
    v_lshlrev_b32 v13, 4, v13
    v_lshl_add_u32 v13, v14, 4, v13
    v_add_u32 v13, s53, v13
    s_waitcnt vmcnt(36)
    ds_write_b128 v13, v[36:39]
    v_add_u32 v13, 384, v2
    v_mul_hi_u32 v14, v13, s54
    v_lshlrev_b32 v13, 4, v13
    v_lshl_add_u32 v13, v14, 4, v13
    v_add_u32 v13, s53, v13
    s_waitcnt vmcnt(35)
    ds_write_b128 v13, v[40:43]
    v_add_u32 v13, 448, v2
    v_mul_hi_u32 v14, v13, s54
    v_lshlrev_b32 v13, 4, v13
    v_lshl_add_u32 v13, v14, 4, v13
    v_add_u32 v13, s53, v13
    s_waitcnt vmcnt(34)
    ds_write_b128 v13, v[44:47]
    v_add_u32 v13, 512, v2
    v_mul_hi_u32 v14, v13, s54
    v_lshlrev_b32 v13, 4, v13
    v_lshl_add_u32 v13, v14, 4, v13
    v_add_u32 v13, s53, v13
    s_waitcnt vmcnt(33)
    ds_write_b128 v13, v[48:51]
    v_add_u32 v13, 576, v2
    v_mul_hi_u32 v14, v13, s54
    v_lshlrev_b32 v13, 4, v13
    v_lshl_add_u32 v13, v14, 4, v13
    v_add_u32 v13, s53, v13
    s_waitcnt vmcnt(32)
    ds_write_b128 v13, v[52:55]
    v_add_u32 v13, 640, v2
    v_mul_hi_u32 v14, v13, s54
    v_lshlrev_b32 v13, 4, v13
    v_lshl_add_u32 v13, v14, 4, v13
    v_add_u32 v13, s53, v13
    s_waitcnt vmcnt(31)
    ds_write_b128 v13, v[56:59]
    v_add_u32 v13, 704, v2
    v_mul_hi_u32 v14, v13, s54
    v_lshlrev_b32 v13, 4, v13
    v_lshl_add_u32 v13, v14, 4, v13
    v_add_u32 v13, s53, v13
    s_waitcnt vmcnt(30)
    ds_write_b128 v13, v[60:63]
    v_add_u32 v13, 768, v2
    v_mul_hi_u32 v14, v13, s54
    v_lshlrev_b32 v13, 4, v13
    v_lshl_add_u32 v13, v14, 4, v13
    v_add_u32 v13, s53, v13
    s_waitcnt vmcnt(29)
    ds_write_b128 v13, v[64:67]
    v_add_u32 v13, 832, v2
    v_mul_hi_u32 v14, v13, s54
    v_lshlrev_b32 v13, 4, v13
    v_lshl_add_u32 v13, v14, 4, v13
    v_add_u32 v13, s53, v13
    s_waitcnt vmcnt(28)
    ds_write_b128 v13, v[68:71]
    v_add_u32 v13, 896, v2
    v_mul_hi_u32 v14, v13, s54
    v_lshlrev_b32 v13, 4, v13
    v_lshl_add_u32 v13, v14, 4, v13
    v_add_u32 v13, s53, v13
    s_waitcnt vmcnt(27)
    ds_write_b128 v13, v[72:75]
    v_add_u32 v13, 960, v2
    v_mul_hi_u32 v14, v13, s54
    v_lshlrev_b32 v13, 4, v13
    v_lshl_add_u32 v13, v14, 4, v13
    v_add_u32 v13, s53, v13
    s_waitcnt vmcnt(26)
    ds_write_b128 v13, v[76:79]
    v_add_u32 v13, 1024, v2
    v_mul_hi_u32 v14, v13, s54
    v_lshlrev_b32 v13, 4, v13
    v_lshl_add_u32 v13, v14, 4, v13
    v_add_u32 v13, s53, v13
    s_waitcnt vmcnt(25)
    ds_write_b128 v13, v[80:83]
    v_add_u32 v13, 1088, v2
    v_mul_hi_u32 v14, v13, s54
    v_lshlrev_b32 v13, 4, v13
    v_lshl_add_u32 v13, v14, 4, v13
    v_add_u32 v13, s53, v13
    s_waitcnt vmcnt(24)
    ds_write_b128 v13, v[84:87]
    v_add_u32 v13, 1152, v2
    v_mul_hi_u32 v14, v13, s54
    v_lshlrev_b32 v13, 4, v13
    v_lshl_add_u32 v13, v14, 4, v13
    v_add_u32 v13, s53, v13
    s_waitcnt vmcnt(23)
    ds_write_b128 v13, v[88:91]
    v_add_u32 v13, 1216, v2
    v_mul_hi_u32 v14, v13, s54
    v_lshlrev_b32 v13, 4, v13
    v_lshl_add_u32 v13, v14, 4, v13
    v_add_u32 v13, s53, v13
    s_waitcnt vmcnt(22)
    ds_write_b128 v13, v[92:95]
    v_add_u32 v13, 1280, v2
    v_mul_hi_u32 v14, v13, s54
    v_lshlrev_b32 v13, 4, v13
    v_lshl_add_u32 v13, v14, 4, v13
    v_add_u32 v13, s53, v13
    s_waitcnt vmcnt(21)
    ds_write_b128 v13, v[96:99]
    v_add_u32 v13, 1344, v2
    v_mul_hi_u32 v14, v13, s54
    v_lshlrev_b32 v13, 4, v13
    v_lshl_add_u32 v13, v14, 4, v13
    v_add_u32 v13, s53, v13
    s_waitcnt vmcnt(20)
    ds_write_b128 v13, v[100:103]
    v_add_u32 v13, 1408, v2
    v_mul_hi_u32 v14, v13, s54
    v_lshlrev_b32 v13, 4, v13
    v_lshl_add_u32 v13, v14, 4, v13
    v_add_u32 v13, s53, v13
    s_waitcnt vmcnt(19)
    ds_write_b128 v13, v[104:107]
    v_add_u32 v13, 1472, v2
    v_mul_hi_u32 v14, v13, s54
    v_lshlrev_b32 v13, 4, v13
    v_lshl_add_u32 v13, v14, 4, v13
    v_add_u32 v13, s53, v13
    s_waitcnt vmcnt(18)
    ds_write_b128 v13, v[108:111]
    v_add_u32 v13, 1536, v2
    v_mul_hi_u32 v14, v13, s54
    v_lshlrev_b32 v13, 4, v13
    v_lshl_add_u32 v13, v14, 4, v13
    v_add_u32 v13, s53, v13
    s_waitcnt vmcnt(17)
    ds_write_b128 v13, v[112:115]
    v_add_u32 v13, 1600, v2
    v_mul_hi_u32 v14, v13, s54
    v_lshlrev_b32 v13, 4, v13
    v_lshl_add_u32 v13, v14, 4, v13
    v_add_u32 v13, s53, v13
    s_waitcnt vmcnt(16)
    ds_write_b128 v13, v[116:119]
    v_add_u32 v13, 1664, v2
    v_mul_hi_u32 v14, v13, s54
    v_lshlrev_b32 v13, 4, v13
    v_lshl_add_u32 v13, v14, 4, v13
    v_add_u32 v13, s53, v13
    s_waitcnt vmcnt(15)
    ds_write_b128 v13, v[120:123]
    v_add_u32 v13, 1728, v2
    v_mul_hi_u32 v14, v13, s54
    v_lshlrev_b32 v13, 4, v13
    v_lshl_add_u32 v13, v14, 4, v13
    v_add_u32 v13, s53, v13
    s_waitcnt vmcnt(14)
    ds_write_b128 v13, v[124:127]
    v_mul_u32_u24 v13, 912, v3
    v_lshl_add_u32 v13, v4, 4, v13
    v_add_u32 v13, s53, v13
    s_waitcnt lgkmcnt(0)
    ds_read_b128 v[16:19], v13 offset:0
    ds_read_b128 v[20:23], v13 offset:32
    ds_read_b128 v[24:27], v13 offset:64
    ds_read_b128 v[28:31], v13 offset:96
    ds_read_b128 v[32:35], v13 offset:128
    ds_read_b128 v[36:39], v13 offset:160
    ds_read_b128 v[40:43], v13 offset:192
    ds_read_b128 v[44:47], v13 offset:224
    ds_read_b128 v[48:51], v13 offset:256
    ds_read_b128 v[52:55], v13 offset:288
    ds_read_b128 v[56:59], v13 offset:320
    ds_read_b128 v[60:63], v13 offset:352
    ds_read_b128 v[64:67], v13 offset:384
    ds_read_b128 v[68:71], v13 offset:416
    ds_read_b128 v[72:75], v13 offset:448
    ds_read_b128 v[76:79], v13 offset:480
    ds_read_b128 v[80:83], v13 offset:512
    ds_read_b128 v[84:87], v13 offset:544
    ds_read_b128 v[88:91], v13 offset:576
    ds_read_b128 v[92:95], v13 offset:608
    ds_read_b128 v[96:99], v13 offset:640
    ds_read_b128 v[100:103], v13 offset:672
    ds_read_b128 v[104:107], v13 offset:704
    ds_read_b128 v[108:111], v13 offset:736
    ds_read_b128 v[112:115], v13 offset:768
    ds_read_b128 v[116:119], v13 offset:800
    ds_read_b128 v[120:123], v13 offset:832
    ds_read_b128 v[124:127], v13 offset:864
    s_waitcnt lgkmcnt(0)
    s_barrier
    s_waitcnt vmcnt(13)
    ds_write_b128 v11, v[128:131] offset:0
    s_waitcnt vmcnt(12)
    ds_write_b128 v11, v[132:135] offset:4096
    s_waitcnt vmcnt(11)
    ds_write_b128 v11, v[136:139] offset:8192
    s_waitcnt vmcnt(10)
    ds_write_b128 v11, v[140:143] offset:12288
    s_waitcnt vmcnt(9)
    ds_write_b128 v11, v[144:147] offset:16384
    s_waitcnt vmcnt(8)
    ds_write_b128 v11, v[148:151] offset:20480
    s_waitcnt vmcnt(7)
    ds_write_b128 v11, v[152:155] offset:24576
    s_waitcnt vmcnt(6)
    ds_write_b128 v11, v[156:159] offset:28672
    s_waitcnt vmcnt(5)
    ds_write_b128 v11, v[160:163] offset:32768
    s_waitcnt vmcnt(4)
    ds_write_b128 v11, v[164:167] offset:36864
    s_waitcnt vmcnt(3)
    ds_write_b128 v11, v[168:171] offset:40960
    s_waitcnt vmcnt(2)
    ds_write_b128 v11, v[172:175] offset:45056
    s_waitcnt vmcnt(1)
    ds_write_b128 v11, v[176:179] offset:49152
    s_waitcnt vmcnt(0)
    ds_write_b128 v11, v[180:183] offset:53248
    s_mov_b32 s12, s44
    s_and_b32 s13, s45, 0xffff
    s_mov_b32 s14, 1204224
    s_mov_b32 s15, 0x00020000
    s_movk_i32 s35, 2688
    v_lshrrev_b32 v13, 2, v0
    v_mul_lo_u32 v13, v13, s35
    v_and_b32 v14, 3, v0
    v_lshl_add_u32 v13, v14, 4, v13
    s_mov_b32 s35, 2176
    buffer_load_dwordx4 v[128:131], v13, s[12:15], s35 offen
    s_mov_b32 s35, 174208
    buffer_load_dwordx4 v[132:135], v13, s[12:15], s35 offen
    s_mov_b32 s35, 346240
    buffer_load_dwordx4 v[136:139], v13, s[12:15], s35 offen
    s_mov_b32 s35, 518272
    buffer_load_dwordx4 v[140:143], v13, s[12:15], s35 offen
    s_mov_b32 s35, 690304
    buffer_load_dwordx4 v[144:147], v13, s[12:15], s35 offen
    s_mov_b32 s35, 862336
    buffer_load_dwordx4 v[148:151], v13, s[12:15], s35 offen
    s_mov_b32 s35, 1034368
    buffer_load_dwordx4 v[152:155], v13, s[12:15], s35 offen
    s_waitcnt vmcnt(6)
    ds_write_b128 v225, v[128:131] offset:0
    s_waitcnt vmcnt(5)
    ds_write_b128 v225, v[132:135] offset:4096
    s_waitcnt vmcnt(4)
    ds_write_b128 v225, v[136:139] offset:8192
    s_waitcnt vmcnt(3)
    ds_write_b128 v225, v[140:143] offset:12288
    s_waitcnt vmcnt(2)
    ds_write_b128 v225, v[144:147] offset:16384
    s_waitcnt vmcnt(1)
    ds_write_b128 v225, v[148:151] offset:20480
    s_waitcnt vmcnt(0)
    ds_write_b128 v225, v[152:155] offset:24576
    s_mov_b32 s12, s44
    s_and_b32 s13, s45, 0xffff
    s_mov_b32 s14, 1204224
    s_mov_b32 s15, 0x00020000
    s_movk_i32 s35, 2688
    v_lshrrev_b32 v13, 2, v0
    v_mul_lo_u32 v13, v13, s35
    v_and_b32 v14, 3, v0
    v_lshl_add_u32 v13, v14, 4, v13
    s_mov_b32 s35, 2240
    buffer_load_dwordx4 v[128:131], v13, s[12:15], s35 offen
    s_mov_b32 s35, 174272
    buffer_load_dwordx4 v[132:135], v13, s[12:15], s35 offen
    s_mov_b32 s35, 346304
    buffer_load_dwordx4 v[136:139], v13, s[12:15], s35 offen
    s_mov_b32 s35, 518336
    buffer_load_dwordx4 v[140:143], v13, s[12:15], s35 offen
    s_mov_b32 s35, 690368
    buffer_load_dwordx4 v[144:147], v13, s[12:15], s35 offen
    s_mov_b32 s35, 862400
    buffer_load_dwordx4 v[148:151], v13, s[12:15], s35 offen
    s_mov_b32 s35, 1034432
    buffer_load_dwordx4 v[152:155], v13, s[12:15], s35 offen
    s_waitcnt vmcnt(6)
    ds_write_b128 v225, v[128:131] offset:28672
    s_waitcnt vmcnt(5)
    ds_write_b128 v225, v[132:135] offset:32768
    s_waitcnt vmcnt(4)
    ds_write_b128 v225, v[136:139] offset:36864
    s_waitcnt vmcnt(3)
    ds_write_b128 v225, v[140:143] offset:40960
    s_waitcnt vmcnt(2)
    ds_write_b128 v225, v[144:147] offset:45056
    s_waitcnt vmcnt(1)
    ds_write_b128 v225, v[148:151] offset:49152
    s_waitcnt vmcnt(0)
    ds_write_b128 v225, v[152:155] offset:53248
    s_waitcnt lgkmcnt(0)
    s_barrier
    ds_read_b64_tr_b16 v[192:193], v7 offset:0
    ds_read_b64_tr_b16 v[194:195], v7 offset:256
    ds_read_b64_tr_b16 v[196:197], v7 offset:28672
    ds_read_b64_tr_b16 v[198:199], v7 offset:28928
    ds_read_b64_tr_b16 v[200:201], v224 offset:0
    ds_read_b64_tr_b16 v[202:203], v224 offset:256
    ds_read_b64_tr_b16 v[204:205], v224 offset:28672
    ds_read_b64_tr_b16 v[206:207], v224 offset:28928
    ds_read_b64_tr_b16 v[208:209], v7 offset:1024
    ds_read_b64_tr_b16 v[210:211], v7 offset:1280
    ds_read_b64_tr_b16 v[212:213], v7 offset:29696
    ds_read_b64_tr_b16 v[214:215], v7 offset:29952
    ds_read_b64_tr_b16 v[216:217], v224 offset:1024
    ds_read_b64_tr_b16 v[218:219], v224 offset:1280
    ds_read_b64_tr_b16 v[220:221], v224 offset:29696
    ds_read_b64_tr_b16 v[222:223], v224 offset:29952
    s_waitcnt lgkmcnt(8)
    v_mfma_f32_32x32x16_bf16 v[128:143], v[16:19], v[192:195], 0
    v_mfma_f32_32x32x16_bf16 v[144:159], v[16:19], v[196:199], 0
    v_mfma_f32_32x32x16_bf16 v[160:175], v[16:19], v[200:203], 0
    v_mfma_f32_32x32x16_bf16 v[176:191], v[16:19], v[204:207], 0
    ds_read_b64_tr_b16 v[192:193], v7 offset:2048
    ds_read_b64_tr_b16 v[194:195], v7 offset:2304
    ds_read_b64_tr_b16 v[196:197], v7 offset:30720
    ds_read_b64_tr_b16 v[198:199], v7 offset:30976
    ds_read_b64_tr_b16 v[200:201], v224 offset:2048
    ds_read_b64_tr_b16 v[202:203], v224 offset:2304
    ds_read_b64_tr_b16 v[204:205], v224 offset:30720
    ds_read_b64_tr_b16 v[206:207], v224 offset:30976
    s_waitcnt lgkmcnt(8)
    v_mfma_f32_32x32x16_bf16 v[128:143], v[20:23], v[208:211], v[128:143]
    v_mfma_f32_32x32x16_bf16 v[144:159], v[20:23], v[212:215], v[144:159]
    v_mfma_f32_32x32x16_bf16 v[160:175], v[20:23], v[216:219], v[160:175]
    v_mfma_f32_32x32x16_bf16 v[176:191], v[20:23], v[220:223], v[176:191]
    ds_read_b64_tr_b16 v[208:209], v7 offset:3072
    ds_read_b64_tr_b16 v[210:211], v7 offset:3328
    ds_read_b64_tr_b16 v[212:213], v7 offset:31744
    ds_read_b64_tr_b16 v[214:215], v7 offset:32000
    ds_read_b64_tr_b16 v[216:217], v224 offset:3072
    ds_read_b64_tr_b16 v[218:219], v224 offset:3328
    ds_read_b64_tr_b16 v[220:221], v224 offset:31744
    ds_read_b64_tr_b16 v[222:223], v224 offset:32000
    s_waitcnt lgkmcnt(8)
    v_mfma_f32_32x32x16_bf16 v[128:143], v[24:27], v[192:195], v[128:143]
    v_mfma_f32_32x32x16_bf16 v[144:159], v[24:27], v[196:199], v[144:159]
    v_mfma_f32_32x32x16_bf16 v[160:175], v[24:27], v[200:203], v[160:175]
    v_mfma_f32_32x32x16_bf16 v[176:191], v[24:27], v[204:207], v[176:191]
    ds_read_b64_tr_b16 v[192:193], v7 offset:4096
    ds_read_b64_tr_b16 v[194:195], v7 offset:4352
    ds_read_b64_tr_b16 v[196:197], v7 offset:32768
    ds_read_b64_tr_b16 v[198:199], v7 offset:33024
    ds_read_b64_tr_b16 v[200:201], v224 offset:4096
    ds_read_b64_tr_b16 v[202:203], v224 offset:4352
    ds_read_b64_tr_b16 v[204:205], v224 offset:32768
    ds_read_b64_tr_b16 v[206:207], v224 offset:33024
    s_waitcnt lgkmcnt(8)
    v_mfma_f32_32x32x16_bf16 v[128:143], v[28:31], v[208:211], v[128:143]
    v_mfma_f32_32x32x16_bf16 v[144:159], v[28:31], v[212:215], v[144:159]
    v_mfma_f32_32x32x16_bf16 v[160:175], v[28:31], v[216:219], v[160:175]
    v_mfma_f32_32x32x16_bf16 v[176:191], v[28:31], v[220:223], v[176:191]
    ds_read_b64_tr_b16 v[208:209], v7 offset:5120
    ds_read_b64_tr_b16 v[210:211], v7 offset:5376
    ds_read_b64_tr_b16 v[212:213], v7 offset:33792
    ds_read_b64_tr_b16 v[214:215], v7 offset:34048
    ds_read_b64_tr_b16 v[216:217], v224 offset:5120
    ds_read_b64_tr_b16 v[218:219], v224 offset:5376
    ds_read_b64_tr_b16 v[220:221], v224 offset:33792
    ds_read_b64_tr_b16 v[222:223], v224 offset:34048
    s_waitcnt lgkmcnt(8)
    v_mfma_f32_32x32x16_bf16 v[128:143], v[32:35], v[192:195], v[128:143]
    v_mfma_f32_32x32x16_bf16 v[144:159], v[32:35], v[196:199], v[144:159]
    v_mfma_f32_32x32x16_bf16 v[160:175], v[32:35], v[200:203], v[160:175]
    v_mfma_f32_32x32x16_bf16 v[176:191], v[32:35], v[204:207], v[176:191]
    ds_read_b64_tr_b16 v[192:193], v7 offset:6144
    ds_read_b64_tr_b16 v[194:195], v7 offset:6400
    ds_read_b64_tr_b16 v[196:197], v7 offset:34816
    ds_read_b64_tr_b16 v[198:199], v7 offset:35072
    ds_read_b64_tr_b16 v[200:201], v224 offset:6144
    ds_read_b64_tr_b16 v[202:203], v224 offset:6400
    ds_read_b64_tr_b16 v[204:205], v224 offset:34816
    ds_read_b64_tr_b16 v[206:207], v224 offset:35072
    s_waitcnt lgkmcnt(8)
    v_mfma_f32_32x32x16_bf16 v[128:143], v[36:39], v[208:211], v[128:143]
    v_mfma_f32_32x32x16_bf16 v[144:159], v[36:39], v[212:215], v[144:159]
    v_mfma_f32_32x32x16_bf16 v[160:175], v[36:39], v[216:219], v[160:175]
    v_mfma_f32_32x32x16_bf16 v[176:191], v[36:39], v[220:223], v[176:191]
    ds_read_b64_tr_b16 v[208:209], v7 offset:7168
    ds_read_b64_tr_b16 v[210:211], v7 offset:7424
    ds_read_b64_tr_b16 v[212:213], v7 offset:35840
    ds_read_b64_tr_b16 v[214:215], v7 offset:36096
    ds_read_b64_tr_b16 v[216:217], v224 offset:7168
    ds_read_b64_tr_b16 v[218:219], v224 offset:7424
    ds_read_b64_tr_b16 v[220:221], v224 offset:35840
    ds_read_b64_tr_b16 v[222:223], v224 offset:36096
    s_waitcnt lgkmcnt(8)
    v_mfma_f32_32x32x16_bf16 v[128:143], v[40:43], v[192:195], v[128:143]
    v_mfma_f32_32x32x16_bf16 v[144:159], v[40:43], v[196:199], v[144:159]
    v_mfma_f32_32x32x16_bf16 v[160:175], v[40:43], v[200:203], v[160:175]
    v_mfma_f32_32x32x16_bf16 v[176:191], v[40:43], v[204:207], v[176:191]
    ds_read_b64_tr_b16 v[192:193], v7 offset:8192
    ds_read_b64_tr_b16 v[194:195], v7 offset:8448
    ds_read_b64_tr_b16 v[196:197], v7 offset:36864
    ds_read_b64_tr_b16 v[198:199], v7 offset:37120
    ds_read_b64_tr_b16 v[200:201], v224 offset:8192
    ds_read_b64_tr_b16 v[202:203], v224 offset:8448
    ds_read_b64_tr_b16 v[204:205], v224 offset:36864
    ds_read_b64_tr_b16 v[206:207], v224 offset:37120
    s_waitcnt lgkmcnt(8)
    v_mfma_f32_32x32x16_bf16 v[128:143], v[44:47], v[208:211], v[128:143]
    v_mfma_f32_32x32x16_bf16 v[144:159], v[44:47], v[212:215], v[144:159]
    v_mfma_f32_32x32x16_bf16 v[160:175], v[44:47], v[216:219], v[160:175]
    v_mfma_f32_32x32x16_bf16 v[176:191], v[44:47], v[220:223], v[176:191]
    ds_read_b64_tr_b16 v[208:209], v7 offset:9216
    ds_read_b64_tr_b16 v[210:211], v7 offset:9472
    ds_read_b64_tr_b16 v[212:213], v7 offset:37888
    ds_read_b64_tr_b16 v[214:215], v7 offset:38144
    ds_read_b64_tr_b16 v[216:217], v224 offset:9216
    ds_read_b64_tr_b16 v[218:219], v224 offset:9472
    ds_read_b64_tr_b16 v[220:221], v224 offset:37888
    ds_read_b64_tr_b16 v[222:223], v224 offset:38144
    s_waitcnt lgkmcnt(8)
    v_mfma_f32_32x32x16_bf16 v[128:143], v[48:51], v[192:195], v[128:143]
    v_mfma_f32_32x32x16_bf16 v[144:159], v[48:51], v[196:199], v[144:159]
    v_mfma_f32_32x32x16_bf16 v[160:175], v[48:51], v[200:203], v[160:175]
    v_mfma_f32_32x32x16_bf16 v[176:191], v[48:51], v[204:207], v[176:191]
    ds_read_b64_tr_b16 v[192:193], v7 offset:10240
    ds_read_b64_tr_b16 v[194:195], v7 offset:10496
    ds_read_b64_tr_b16 v[196:197], v7 offset:38912
    ds_read_b64_tr_b16 v[198:199], v7 offset:39168
    ds_read_b64_tr_b16 v[200:201], v224 offset:10240
    ds_read_b64_tr_b16 v[202:203], v224 offset:10496
    ds_read_b64_tr_b16 v[204:205], v224 offset:38912
    ds_read_b64_tr_b16 v[206:207], v224 offset:39168
    s_waitcnt lgkmcnt(8)
    v_mfma_f32_32x32x16_bf16 v[128:143], v[52:55], v[208:211], v[128:143]
    v_mfma_f32_32x32x16_bf16 v[144:159], v[52:55], v[212:215], v[144:159]
    v_mfma_f32_32x32x16_bf16 v[160:175], v[52:55], v[216:219], v[160:175]
    v_mfma_f32_32x32x16_bf16 v[176:191], v[52:55], v[220:223], v[176:191]
    ds_read_b64_tr_b16 v[208:209], v7 offset:11264
    ds_read_b64_tr_b16 v[210:211], v7 offset:11520
    ds_read_b64_tr_b16 v[212:213], v7 offset:39936
    ds_read_b64_tr_b16 v[214:215], v7 offset:40192
    ds_read_b64_tr_b16 v[216:217], v224 offset:11264
    ds_read_b64_tr_b16 v[218:219], v224 offset:11520
    ds_read_b64_tr_b16 v[220:221], v224 offset:39936
    ds_read_b64_tr_b16 v[222:223], v224 offset:40192
    s_waitcnt lgkmcnt(8)
    v_mfma_f32_32x32x16_bf16 v[128:143], v[56:59], v[192:195], v[128:143]
    v_mfma_f32_32x32x16_bf16 v[144:159], v[56:59], v[196:199], v[144:159]
    v_mfma_f32_32x32x16_bf16 v[160:175], v[56:59], v[200:203], v[160:175]
    v_mfma_f32_32x32x16_bf16 v[176:191], v[56:59], v[204:207], v[176:191]
    ds_read_b64_tr_b16 v[192:193], v7 offset:12288
    ds_read_b64_tr_b16 v[194:195], v7 offset:12544
    ds_read_b64_tr_b16 v[196:197], v7 offset:40960
    ds_read_b64_tr_b16 v[198:199], v7 offset:41216
    ds_read_b64_tr_b16 v[200:201], v224 offset:12288
    ds_read_b64_tr_b16 v[202:203], v224 offset:12544
    ds_read_b64_tr_b16 v[204:205], v224 offset:40960
    ds_read_b64_tr_b16 v[206:207], v224 offset:41216
    s_waitcnt lgkmcnt(8)
    v_mfma_f32_32x32x16_bf16 v[128:143], v[60:63], v[208:211], v[128:143]
    v_mfma_f32_32x32x16_bf16 v[144:159], v[60:63], v[212:215], v[144:159]
    v_mfma_f32_32x32x16_bf16 v[160:175], v[60:63], v[216:219], v[160:175]
    v_mfma_f32_32x32x16_bf16 v[176:191], v[60:63], v[220:223], v[176:191]
    ds_read_b64_tr_b16 v[208:209], v7 offset:13312
    ds_read_b64_tr_b16 v[210:211], v7 offset:13568
    ds_read_b64_tr_b16 v[212:213], v7 offset:41984
    ds_read_b64_tr_b16 v[214:215], v7 offset:42240
    ds_read_b64_tr_b16 v[216:217], v224 offset:13312
    ds_read_b64_tr_b16 v[218:219], v224 offset:13568
    ds_read_b64_tr_b16 v[220:221], v224 offset:41984
    ds_read_b64_tr_b16 v[222:223], v224 offset:42240
    s_waitcnt lgkmcnt(8)
    v_mfma_f32_32x32x16_bf16 v[128:143], v[64:67], v[192:195], v[128:143]
    v_mfma_f32_32x32x16_bf16 v[144:159], v[64:67], v[196:199], v[144:159]
    v_mfma_f32_32x32x16_bf16 v[160:175], v[64:67], v[200:203], v[160:175]
    v_mfma_f32_32x32x16_bf16 v[176:191], v[64:67], v[204:207], v[176:191]
    ds_read_b64_tr_b16 v[192:193], v7 offset:14336
    ds_read_b64_tr_b16 v[194:195], v7 offset:14592
    ds_read_b64_tr_b16 v[196:197], v7 offset:43008
    ds_read_b64_tr_b16 v[198:199], v7 offset:43264
    ds_read_b64_tr_b16 v[200:201], v224 offset:14336
    ds_read_b64_tr_b16 v[202:203], v224 offset:14592
    ds_read_b64_tr_b16 v[204:205], v224 offset:43008
    ds_read_b64_tr_b16 v[206:207], v224 offset:43264
    s_waitcnt lgkmcnt(8)
    v_mfma_f32_32x32x16_bf16 v[128:143], v[68:71], v[208:211], v[128:143]
    v_mfma_f32_32x32x16_bf16 v[144:159], v[68:71], v[212:215], v[144:159]
    v_mfma_f32_32x32x16_bf16 v[160:175], v[68:71], v[216:219], v[160:175]
    v_mfma_f32_32x32x16_bf16 v[176:191], v[68:71], v[220:223], v[176:191]
    ds_read_b64_tr_b16 v[208:209], v7 offset:15360
    ds_read_b64_tr_b16 v[210:211], v7 offset:15616
    ds_read_b64_tr_b16 v[212:213], v7 offset:44032
    ds_read_b64_tr_b16 v[214:215], v7 offset:44288
    ds_read_b64_tr_b16 v[216:217], v224 offset:15360
    ds_read_b64_tr_b16 v[218:219], v224 offset:15616
    ds_read_b64_tr_b16 v[220:221], v224 offset:44032
    ds_read_b64_tr_b16 v[222:223], v224 offset:44288
    s_waitcnt lgkmcnt(8)
    v_mfma_f32_32x32x16_bf16 v[128:143], v[72:75], v[192:195], v[128:143]
    v_mfma_f32_32x32x16_bf16 v[144:159], v[72:75], v[196:199], v[144:159]
    v_mfma_f32_32x32x16_bf16 v[160:175], v[72:75], v[200:203], v[160:175]
    v_mfma_f32_32x32x16_bf16 v[176:191], v[72:75], v[204:207], v[176:191]
    ds_read_b64_tr_b16 v[192:193], v7 offset:16384
    ds_read_b64_tr_b16 v[194:195], v7 offset:16640
    ds_read_b64_tr_b16 v[196:197], v7 offset:45056
    ds_read_b64_tr_b16 v[198:199], v7 offset:45312
    ds_read_b64_tr_b16 v[200:201], v224 offset:16384
    ds_read_b64_tr_b16 v[202:203], v224 offset:16640
    ds_read_b64_tr_b16 v[204:205], v224 offset:45056
    ds_read_b64_tr_b16 v[206:207], v224 offset:45312
    s_waitcnt lgkmcnt(8)
    v_mfma_f32_32x32x16_bf16 v[128:143], v[76:79], v[208:211], v[128:143]
    v_mfma_f32_32x32x16_bf16 v[144:159], v[76:79], v[212:215], v[144:159]
    v_mfma_f32_32x32x16_bf16 v[160:175], v[76:79], v[216:219], v[160:175]
    v_mfma_f32_32x32x16_bf16 v[176:191], v[76:79], v[220:223], v[176:191]
    ds_read_b64_tr_b16 v[208:209], v7 offset:17408
    ds_read_b64_tr_b16 v[210:211], v7 offset:17664
    ds_read_b64_tr_b16 v[212:213], v7 offset:46080
    ds_read_b64_tr_b16 v[214:215], v7 offset:46336
    ds_read_b64_tr_b16 v[216:217], v224 offset:17408
    ds_read_b64_tr_b16 v[218:219], v224 offset:17664
    ds_read_b64_tr_b16 v[220:221], v224 offset:46080
    ds_read_b64_tr_b16 v[222:223], v224 offset:46336
    s_waitcnt lgkmcnt(8)
    v_mfma_f32_32x32x16_bf16 v[128:143], v[80:83], v[192:195], v[128:143]
    v_mfma_f32_32x32x16_bf16 v[144:159], v[80:83], v[196:199], v[144:159]
    v_mfma_f32_32x32x16_bf16 v[160:175], v[80:83], v[200:203], v[160:175]
    v_mfma_f32_32x32x16_bf16 v[176:191], v[80:83], v[204:207], v[176:191]
    ds_read_b64_tr_b16 v[192:193], v7 offset:18432
    ds_read_b64_tr_b16 v[194:195], v7 offset:18688
    ds_read_b64_tr_b16 v[196:197], v7 offset:47104
    ds_read_b64_tr_b16 v[198:199], v7 offset:47360
    ds_read_b64_tr_b16 v[200:201], v224 offset:18432
    ds_read_b64_tr_b16 v[202:203], v224 offset:18688
    ds_read_b64_tr_b16 v[204:205], v224 offset:47104
    ds_read_b64_tr_b16 v[206:207], v224 offset:47360
    s_waitcnt lgkmcnt(8)
    v_mfma_f32_32x32x16_bf16 v[128:143], v[84:87], v[208:211], v[128:143]
    v_mfma_f32_32x32x16_bf16 v[144:159], v[84:87], v[212:215], v[144:159]
    v_mfma_f32_32x32x16_bf16 v[160:175], v[84:87], v[216:219], v[160:175]
    v_mfma_f32_32x32x16_bf16 v[176:191], v[84:87], v[220:223], v[176:191]
    ds_read_b64_tr_b16 v[208:209], v7 offset:19456
    ds_read_b64_tr_b16 v[210:211], v7 offset:19712
    ds_read_b64_tr_b16 v[212:213], v7 offset:48128
    ds_read_b64_tr_b16 v[214:215], v7 offset:48384
    ds_read_b64_tr_b16 v[216:217], v224 offset:19456
    ds_read_b64_tr_b16 v[218:219], v224 offset:19712
    ds_read_b64_tr_b16 v[220:221], v224 offset:48128
    ds_read_b64_tr_b16 v[222:223], v224 offset:48384
    s_waitcnt lgkmcnt(8)
    v_mfma_f32_32x32x16_bf16 v[128:143], v[88:91], v[192:195], v[128:143]
    v_mfma_f32_32x32x16_bf16 v[144:159], v[88:91], v[196:199], v[144:159]
    v_mfma_f32_32x32x16_bf16 v[160:175], v[88:91], v[200:203], v[160:175]
    v_mfma_f32_32x32x16_bf16 v[176:191], v[88:91], v[204:207], v[176:191]
    ds_read_b64_tr_b16 v[192:193], v7 offset:20480
    ds_read_b64_tr_b16 v[194:195], v7 offset:20736
    ds_read_b64_tr_b16 v[196:197], v7 offset:49152
    ds_read_b64_tr_b16 v[198:199], v7 offset:49408
    ds_read_b64_tr_b16 v[200:201], v224 offset:20480
    ds_read_b64_tr_b16 v[202:203], v224 offset:20736
    ds_read_b64_tr_b16 v[204:205], v224 offset:49152
    ds_read_b64_tr_b16 v[206:207], v224 offset:49408
    s_waitcnt lgkmcnt(8)
    v_mfma_f32_32x32x16_bf16 v[128:143], v[92:95], v[208:211], v[128:143]
    v_mfma_f32_32x32x16_bf16 v[144:159], v[92:95], v[212:215], v[144:159]
    v_mfma_f32_32x32x16_bf16 v[160:175], v[92:95], v[216:219], v[160:175]
    v_mfma_f32_32x32x16_bf16 v[176:191], v[92:95], v[220:223], v[176:191]
    ds_read_b64_tr_b16 v[208:209], v7 offset:21504
    ds_read_b64_tr_b16 v[210:211], v7 offset:21760
    ds_read_b64_tr_b16 v[212:213], v7 offset:50176
    ds_read_b64_tr_b16 v[214:215], v7 offset:50432
    ds_read_b64_tr_b16 v[216:217], v224 offset:21504
    ds_read_b64_tr_b16 v[218:219], v224 offset:21760
    ds_read_b64_tr_b16 v[220:221], v224 offset:50176
    ds_read_b64_tr_b16 v[222:223], v224 offset:50432
    s_waitcnt lgkmcnt(8)
    v_mfma_f32_32x32x16_bf16 v[128:143], v[96:99], v[192:195], v[128:143]
    v_mfma_f32_32x32x16_bf16 v[144:159], v[96:99], v[196:199], v[144:159]
    v_mfma_f32_32x32x16_bf16 v[160:175], v[96:99], v[200:203], v[160:175]
    v_mfma_f32_32x32x16_bf16 v[176:191], v[96:99], v[204:207], v[176:191]
    ds_read_b64_tr_b16 v[192:193], v7 offset:22528
    ds_read_b64_tr_b16 v[194:195], v7 offset:22784
    ds_read_b64_tr_b16 v[196:197], v7 offset:51200
    ds_read_b64_tr_b16 v[198:199], v7 offset:51456
    ds_read_b64_tr_b16 v[200:201], v224 offset:22528
    ds_read_b64_tr_b16 v[202:203], v224 offset:22784
    ds_read_b64_tr_b16 v[204:205], v224 offset:51200
    ds_read_b64_tr_b16 v[206:207], v224 offset:51456
    s_waitcnt lgkmcnt(8)
    v_mfma_f32_32x32x16_bf16 v[128:143], v[100:103], v[208:211], v[128:143]
    v_mfma_f32_32x32x16_bf16 v[144:159], v[100:103], v[212:215], v[144:159]
    v_mfma_f32_32x32x16_bf16 v[160:175], v[100:103], v[216:219], v[160:175]
    v_mfma_f32_32x32x16_bf16 v[176:191], v[100:103], v[220:223], v[176:191]
    ds_read_b64_tr_b16 v[208:209], v7 offset:23552
    ds_read_b64_tr_b16 v[210:211], v7 offset:23808
    ds_read_b64_tr_b16 v[212:213], v7 offset:52224
    ds_read_b64_tr_b16 v[214:215], v7 offset:52480
    ds_read_b64_tr_b16 v[216:217], v224 offset:23552
    ds_read_b64_tr_b16 v[218:219], v224 offset:23808
    ds_read_b64_tr_b16 v[220:221], v224 offset:52224
    ds_read_b64_tr_b16 v[222:223], v224 offset:52480
    s_waitcnt lgkmcnt(8)
    v_mfma_f32_32x32x16_bf16 v[128:143], v[104:107], v[192:195], v[128:143]
    v_mfma_f32_32x32x16_bf16 v[144:159], v[104:107], v[196:199], v[144:159]
    v_mfma_f32_32x32x16_bf16 v[160:175], v[104:107], v[200:203], v[160:175]
    v_mfma_f32_32x32x16_bf16 v[176:191], v[104:107], v[204:207], v[176:191]
    ds_read_b64_tr_b16 v[192:193], v7 offset:24576
    ds_read_b64_tr_b16 v[194:195], v7 offset:24832
    ds_read_b64_tr_b16 v[196:197], v7 offset:53248
    ds_read_b64_tr_b16 v[198:199], v7 offset:53504
    ds_read_b64_tr_b16 v[200:201], v224 offset:24576
    ds_read_b64_tr_b16 v[202:203], v224 offset:24832
    ds_read_b64_tr_b16 v[204:205], v224 offset:53248
    ds_read_b64_tr_b16 v[206:207], v224 offset:53504
    s_waitcnt lgkmcnt(8)
    v_mfma_f32_32x32x16_bf16 v[128:143], v[108:111], v[208:211], v[128:143]
    v_mfma_f32_32x32x16_bf16 v[144:159], v[108:111], v[212:215], v[144:159]
    v_mfma_f32_32x32x16_bf16 v[160:175], v[108:111], v[216:219], v[160:175]
    v_mfma_f32_32x32x16_bf16 v[176:191], v[108:111], v[220:223], v[176:191]
    ds_read_b64_tr_b16 v[208:209], v7 offset:25600
    ds_read_b64_tr_b16 v[210:211], v7 offset:25856
    ds_read_b64_tr_b16 v[212:213], v7 offset:54272
    ds_read_b64_tr_b16 v[214:215], v7 offset:54528
    ds_read_b64_tr_b16 v[216:217], v224 offset:25600
    ds_read_b64_tr_b16 v[218:219], v224 offset:25856
    ds_read_b64_tr_b16 v[220:221], v224 offset:54272
    ds_read_b64_tr_b16 v[222:223], v224 offset:54528
    s_waitcnt lgkmcnt(8)
    v_mfma_f32_32x32x16_bf16 v[128:143], v[112:115], v[192:195], v[128:143]
    v_mfma_f32_32x32x16_bf16 v[144:159], v[112:115], v[196:199], v[144:159]
    v_mfma_f32_32x32x16_bf16 v[160:175], v[112:115], v[200:203], v[160:175]
    v_mfma_f32_32x32x16_bf16 v[176:191], v[112:115], v[204:207], v[176:191]
    ds_read_b64_tr_b16 v[192:193], v7 offset:26624
    ds_read_b64_tr_b16 v[194:195], v7 offset:26880
    ds_read_b64_tr_b16 v[196:197], v7 offset:55296
    ds_read_b64_tr_b16 v[198:199], v7 offset:55552
    ds_read_b64_tr_b16 v[200:201], v224 offset:26624
    ds_read_b64_tr_b16 v[202:203], v224 offset:26880
    ds_read_b64_tr_b16 v[204:205], v224 offset:55296
    ds_read_b64_tr_b16 v[206:207], v224 offset:55552
    s_waitcnt lgkmcnt(8)
    v_mfma_f32_32x32x16_bf16 v[128:143], v[116:119], v[208:211], v[128:143]
    v_mfma_f32_32x32x16_bf16 v[144:159], v[116:119], v[212:215], v[144:159]
    v_mfma_f32_32x32x16_bf16 v[160:175], v[116:119], v[216:219], v[160:175]
    v_mfma_f32_32x32x16_bf16 v[176:191], v[116:119], v[220:223], v[176:191]
    ds_read_b64_tr_b16 v[208:209], v7 offset:27648
    ds_read_b64_tr_b16 v[210:211], v7 offset:27904
    ds_read_b64_tr_b16 v[212:213], v7 offset:56320
    ds_read_b64_tr_b16 v[214:215], v7 offset:56576
    ds_read_b64_tr_b16 v[216:217], v224 offset:27648
    ds_read_b64_tr_b16 v[218:219], v224 offset:27904
    ds_read_b64_tr_b16 v[220:221], v224 offset:56320
    ds_read_b64_tr_b16 v[222:223], v224 offset:56576
    s_waitcnt lgkmcnt(8)
    v_mfma_f32_32x32x16_bf16 v[128:143], v[120:123], v[192:195], v[128:143]
    v_mfma_f32_32x32x16_bf16 v[144:159], v[120:123], v[196:199], v[144:159]
    v_mfma_f32_32x32x16_bf16 v[160:175], v[120:123], v[200:203], v[160:175]
    v_mfma_f32_32x32x16_bf16 v[176:191], v[120:123], v[204:207], v[176:191]
    s_waitcnt lgkmcnt(0)
    v_mfma_f32_32x32x16_bf16 v[128:143], v[124:127], v[208:211], v[128:143]
    v_mfma_f32_32x32x16_bf16 v[144:159], v[124:127], v[212:215], v[144:159]
    v_mfma_f32_32x32x16_bf16 v[160:175], v[124:127], v[216:219], v[160:175]
    v_mfma_f32_32x32x16_bf16 v[176:191], v[124:127], v[220:223], v[176:191]
    s_nop 15
    s_nop 3
    v_add_u32 v13, 128, v3
    v_lshlrev_b32 v13, 12, v13
    v_sub_u32 v14, v5, v3
    v_lshl_add_u32 v13, v14, 1, v13
    v_lshl_add_u32 v13, v4, 3, v13
    v_add_u32 v13, 6029312, v13
    v_cvt_pk_bf16_f32 v128, v128, v129
    v_cvt_pk_bf16_f32 v129, v130, v131
    buffer_store_dwordx2 v[128:129], v13, s[16:19], 0 offen offset:0
    v_cvt_pk_bf16_f32 v132, v132, v133
    v_cvt_pk_bf16_f32 v133, v134, v135
    buffer_store_dwordx2 v[132:133], v13, s[16:19], 0 offen offset:16
    v_cvt_pk_bf16_f32 v136, v136, v137
    v_cvt_pk_bf16_f32 v137, v138, v139
    buffer_store_dwordx2 v[136:137], v13, s[16:19], 0 offen offset:32
    v_cvt_pk_bf16_f32 v140, v140, v141
    v_cvt_pk_bf16_f32 v141, v142, v143
    buffer_store_dwordx2 v[140:141], v13, s[16:19], 0 offen offset:48
    v_add_u32 v13, 160, v3
    v_lshlrev_b32 v13, 12, v13
    v_sub_u32 v14, v5, v3
    v_lshl_add_u32 v13, v14, 1, v13
    v_lshl_add_u32 v13, v4, 3, v13
    v_add_u32 v13, 6029312, v13
    v_cvt_pk_bf16_f32 v144, v144, v145
    v_cvt_pk_bf16_f32 v145, v146, v147
    buffer_store_dwordx2 v[144:145], v13, s[16:19], 0 offen offset:0
    v_cvt_pk_bf16_f32 v148, v148, v149
    v_cvt_pk_bf16_f32 v149, v150, v151
    buffer_store_dwordx2 v[148:149], v13, s[16:19], 0 offen offset:16
    v_cvt_pk_bf16_f32 v152, v152, v153
    v_cvt_pk_bf16_f32 v153, v154, v155
    buffer_store_dwordx2 v[152:153], v13, s[16:19], 0 offen offset:32
    v_cvt_pk_bf16_f32 v156, v156, v157
    v_cvt_pk_bf16_f32 v157, v158, v159
    buffer_store_dwordx2 v[156:157], v13, s[16:19], 0 offen offset:48
    v_add_u32 v13, 192, v3
    v_lshlrev_b32 v13, 12, v13
    v_sub_u32 v14, v5, v3
    v_lshl_add_u32 v13, v14, 1, v13
    v_lshl_add_u32 v13, v4, 3, v13
    v_add_u32 v13, 6029312, v13
    v_cvt_pk_bf16_f32 v160, v160, v161
    v_cvt_pk_bf16_f32 v161, v162, v163
    buffer_store_dwordx2 v[160:161], v13, s[16:19], 0 offen offset:0
    v_cvt_pk_bf16_f32 v164, v164, v165
    v_cvt_pk_bf16_f32 v165, v166, v167
    buffer_store_dwordx2 v[164:165], v13, s[16:19], 0 offen offset:16
    v_cvt_pk_bf16_f32 v168, v168, v169
    v_cvt_pk_bf16_f32 v169, v170, v171
    buffer_store_dwordx2 v[168:169], v13, s[16:19], 0 offen offset:32
    v_cvt_pk_bf16_f32 v172, v172, v173
    v_cvt_pk_bf16_f32 v173, v174, v175
    buffer_store_dwordx2 v[172:173], v13, s[16:19], 0 offen offset:48
    v_add_u32 v13, 224, v3
    v_lshlrev_b32 v13, 12, v13
    v_sub_u32 v14, v5, v3
    v_lshl_add_u32 v13, v14, 1, v13
    v_lshl_add_u32 v13, v4, 3, v13
    v_add_u32 v13, 6029312, v13
    v_cvt_pk_bf16_f32 v176, v176, v177
    v_cvt_pk_bf16_f32 v177, v178, v179
    buffer_store_dwordx2 v[176:177], v13, s[16:19], 0 offen offset:0
    v_cvt_pk_bf16_f32 v180, v180, v181
    v_cvt_pk_bf16_f32 v181, v182, v183
    buffer_store_dwordx2 v[180:181], v13, s[16:19], 0 offen offset:16
    v_cvt_pk_bf16_f32 v184, v184, v185
    v_cvt_pk_bf16_f32 v185, v186, v187
    buffer_store_dwordx2 v[184:185], v13, s[16:19], 0 offen offset:32
    v_cvt_pk_bf16_f32 v188, v188, v189
    v_cvt_pk_bf16_f32 v189, v190, v191
    buffer_store_dwordx2 v[188:189], v13, s[16:19], 0 offen offset:48
    s_endpgm
K1_v13:
    s_mov_b32 s12, s44
    s_and_b32 s13, s45, 0xffff
    s_mov_b32 s14, 1204224
    s_mov_b32 s15, 0x00020000
    s_movk_i32 s35, 2688
    v_lshrrev_b32 v227, 2, v0
    v_mul_lo_u32 v227, v227, s35
    v_and_b32 v14, 3, v0
    v_lshl_add_u32 v227, v14, 4, v227
    s_mov_b32 s35, 2304
    buffer_load_dwordx4 v[128:131], v227, s[12:15], s35 offen
    s_mov_b32 s35, 174336
    buffer_load_dwordx4 v[132:135], v227, s[12:15], s35 offen
    s_mov_b32 s35, 346368
    buffer_load_dwordx4 v[136:139], v227, s[12:15], s35 offen
    s_mov_b32 s35, 518400
    buffer_load_dwordx4 v[140:143], v227, s[12:15], s35 offen
    s_mov_b32 s35, 690432
    buffer_load_dwordx4 v[144:147], v227, s[12:15], s35 offen
    s_mov_b32 s35, 862464
    buffer_load_dwordx4 v[148:151], v227, s[12:15], s35 offen
    s_mov_b32 s35, 1034496
    buffer_load_dwordx4 v[152:155], v227, s[12:15], s35 offen
    s_mov_b32 s12, s44
    s_and_b32 s13, s45, 0xffff
    s_mov_b32 s14, 1204224
    s_mov_b32 s15, 0x00020000
    s_movk_i32 s35, 2688
    v_lshrrev_b32 v227, 2, v0
    v_mul_lo_u32 v227, v227, s35
    v_and_b32 v14, 3, v0
    v_lshl_add_u32 v227, v14, 4, v227
    s_mov_b32 s35, 2368
    buffer_load_dwordx4 v[156:159], v227, s[12:15], s35 offen
    s_mov_b32 s35, 174400
    buffer_load_dwordx4 v[160:163], v227, s[12:15], s35 offen
    s_mov_b32 s35, 346432
    buffer_load_dwordx4 v[164:167], v227, s[12:15], s35 offen
    s_mov_b32 s35, 518464
    buffer_load_dwordx4 v[168:171], v227, s[12:15], s35 offen
    s_mov_b32 s35, 690496
    buffer_load_dwordx4 v[172:175], v227, s[12:15], s35 offen
    s_mov_b32 s35, 862528
    buffer_load_dwordx4 v[176:179], v227, s[12:15], s35 offen
    s_mov_b32 s35, 1034560
    buffer_load_dwordx4 v[180:183], v227, s[12:15], s35 offen
    s_mov_b32 s54, 0x4924925
    v_add_u32 v13, 0, v2
    v_mul_hi_u32 v14, v13, s54
    v_lshlrev_b32 v13, 4, v13
    v_lshl_add_u32 v13, v14, 4, v13
    v_add_u32 v13, s53, v13
    s_waitcnt vmcnt(41)
    ds_write_b128 v13, v[16:19]
    v_add_u32 v13, 64, v2
    v_mul_hi_u32 v14, v13, s54
    v_lshlrev_b32 v13, 4, v13
    v_lshl_add_u32 v13, v14, 4, v13
    v_add_u32 v13, s53, v13
    s_waitcnt vmcnt(40)
    ds_write_b128 v13, v[20:23]
    v_add_u32 v13, 128, v2
    v_mul_hi_u32 v14, v13, s54
    v_lshlrev_b32 v13, 4, v13
    v_lshl_add_u32 v13, v14, 4, v13
    v_add_u32 v13, s53, v13
    s_waitcnt vmcnt(39)
    ds_write_b128 v13, v[24:27]
    v_add_u32 v13, 192, v2
    v_mul_hi_u32 v14, v13, s54
    v_lshlrev_b32 v13, 4, v13
    v_lshl_add_u32 v13, v14, 4, v13
    v_add_u32 v13, s53, v13
    s_waitcnt vmcnt(38)
    ds_write_b128 v13, v[28:31]
    v_add_u32 v13, 256, v2
    v_mul_hi_u32 v14, v13, s54
    v_lshlrev_b32 v13, 4, v13
    v_lshl_add_u32 v13, v14, 4, v13
    v_add_u32 v13, s53, v13
    s_waitcnt vmcnt(37)
    ds_write_b128 v13, v[32:35]
    v_add_u32 v13, 320, v2
    v_mul_hi_u32 v14, v13, s54
    v_lshlrev_b32 v13, 4, v13
    v_lshl_add_u32 v13, v14, 4, v13
    v_add_u32 v13, s53, v13
    s_waitcnt vmcnt(36)
    ds_write_b128 v13, v[36:39]
    v_add_u32 v13, 384, v2
    v_mul_hi_u32 v14, v13, s54
    v_lshlrev_b32 v13, 4, v13
    v_lshl_add_u32 v13, v14, 4, v13
    v_add_u32 v13, s53, v13
    s_waitcnt vmcnt(35)
    ds_write_b128 v13, v[40:43]
    v_add_u32 v13, 448, v2
    v_mul_hi_u32 v14, v13, s54
    v_lshlrev_b32 v13, 4, v13
    v_lshl_add_u32 v13, v14, 4, v13
    v_add_u32 v13, s53, v13
    s_waitcnt vmcnt(34)
    ds_write_b128 v13, v[44:47]
    v_add_u32 v13, 512, v2
    v_mul_hi_u32 v14, v13, s54
    v_lshlrev_b32 v13, 4, v13
    v_lshl_add_u32 v13, v14, 4, v13
    v_add_u32 v13, s53, v13
    s_waitcnt vmcnt(33)
    ds_write_b128 v13, v[48:51]
    v_add_u32 v13, 576, v2
    v_mul_hi_u32 v14, v13, s54
    v_lshlrev_b32 v13, 4, v13
    v_lshl_add_u32 v13, v14, 4, v13
    v_add_u32 v13, s53, v13
    s_waitcnt vmcnt(32)
    ds_write_b128 v13, v[52:55]
    v_add_u32 v13, 640, v2
    v_mul_hi_u32 v14, v13, s54
    v_lshlrev_b32 v13, 4, v13
    v_lshl_add_u32 v13, v14, 4, v13
    v_add_u32 v13, s53, v13
    s_waitcnt vmcnt(31)
    ds_write_b128 v13, v[56:59]
    v_add_u32 v13, 704, v2
    v_mul_hi_u32 v14, v13, s54
    v_lshlrev_b32 v13, 4, v13
    v_lshl_add_u32 v13, v14, 4, v13
    v_add_u32 v13, s53, v13
    s_waitcnt vmcnt(30)
    ds_write_b128 v13, v[60:63]
    v_add_u32 v13, 768, v2
    v_mul_hi_u32 v14, v13, s54
    v_lshlrev_b32 v13, 4, v13
    v_lshl_add_u32 v13, v14, 4, v13
    v_add_u32 v13, s53, v13
    s_waitcnt vmcnt(29)
    ds_write_b128 v13, v[64:67]
    v_add_u32 v13, 832, v2
    v_mul_hi_u32 v14, v13, s54
    v_lshlrev_b32 v13, 4, v13
    v_lshl_add_u32 v13, v14, 4, v13
    v_add_u32 v13, s53, v13
    s_waitcnt vmcnt(28)
    ds_write_b128 v13, v[68:71]
    v_add_u32 v13, 896, v2
    v_mul_hi_u32 v14, v13, s54
    v_lshlrev_b32 v13, 4, v13
    v_lshl_add_u32 v13, v14, 4, v13
    v_add_u32 v13, s53, v13
    s_waitcnt vmcnt(27)
    ds_write_b128 v13, v[72:75]
    v_add_u32 v13, 960, v2
    v_mul_hi_u32 v14, v13, s54
    v_lshlrev_b32 v13, 4, v13
    v_lshl_add_u32 v13, v14, 4, v13
    v_add_u32 v13, s53, v13
    s_waitcnt vmcnt(26)
    ds_write_b128 v13, v[76:79]
    v_add_u32 v13, 1024, v2
    v_mul_hi_u32 v14, v13, s54
    v_lshlrev_b32 v13, 4, v13
    v_lshl_add_u32 v13, v14, 4, v13
    v_add_u32 v13, s53, v13
    s_waitcnt vmcnt(25)
    ds_write_b128 v13, v[80:83]
    v_add_u32 v13, 1088, v2
    v_mul_hi_u32 v14, v13, s54
    v_lshlrev_b32 v13, 4, v13
    v_lshl_add_u32 v13, v14, 4, v13
    v_add_u32 v13, s53, v13
    s_waitcnt vmcnt(24)
    ds_write_b128 v13, v[84:87]
    v_add_u32 v13, 1152, v2
    v_mul_hi_u32 v14, v13, s54
    v_lshlrev_b32 v13, 4, v13
    v_lshl_add_u32 v13, v14, 4, v13
    v_add_u32 v13, s53, v13
    s_waitcnt vmcnt(23)
    ds_write_b128 v13, v[88:91]
    v_add_u32 v13, 1216, v2
    v_mul_hi_u32 v14, v13, s54
    v_lshlrev_b32 v13, 4, v13
    v_lshl_add_u32 v13, v14, 4, v13
    v_add_u32 v13, s53, v13
    s_waitcnt vmcnt(22)
    ds_write_b128 v13, v[92:95]
    v_add_u32 v13, 1280, v2
    v_mul_hi_u32 v14, v13, s54
    v_lshlrev_b32 v13, 4, v13
    v_lshl_add_u32 v13, v14, 4, v13
    v_add_u32 v13, s53, v13
    s_waitcnt vmcnt(21)
    ds_write_b128 v13, v[96:99]
    v_add_u32 v13, 1344, v2
    v_mul_hi_u32 v14, v13, s54
    v_lshlrev_b32 v13, 4, v13
    v_lshl_add_u32 v13, v14, 4, v13
    v_add_u32 v13, s53, v13
    s_waitcnt vmcnt(20)
    ds_write_b128 v13, v[100:103]
    v_add_u32 v13, 1408, v2
    v_mul_hi_u32 v14, v13, s54
    v_lshlrev_b32 v13, 4, v13
    v_lshl_add_u32 v13, v14, 4, v13
    v_add_u32 v13, s53, v13
    s_waitcnt vmcnt(19)
    ds_write_b128 v13, v[104:107]
    v_add_u32 v13, 1472, v2
    v_mul_hi_u32 v14, v13, s54
    v_lshlrev_b32 v13, 4, v13
    v_lshl_add_u32 v13, v14, 4, v13
    v_add_u32 v13, s53, v13
    s_waitcnt vmcnt(18)
    ds_write_b128 v13, v[108:111]
    v_add_u32 v13, 1536, v2
    v_mul_hi_u32 v14, v13, s54
    v_lshlrev_b32 v13, 4, v13
    v_lshl_add_u32 v13, v14, 4, v13
    v_add_u32 v13, s53, v13
    s_waitcnt vmcnt(17)
    ds_write_b128 v13, v[112:115]
    v_add_u32 v13, 1600, v2
    v_mul_hi_u32 v14, v13, s54
    v_lshlrev_b32 v13, 4, v13
    v_lshl_add_u32 v13, v14, 4, v13
    v_add_u32 v13, s53, v13
    s_waitcnt vmcnt(16)
    ds_write_b128 v13, v[116:119]
    v_add_u32 v13, 1664, v2
    v_mul_hi_u32 v14, v13, s54
    v_lshlrev_b32 v13, 4, v13
    v_lshl_add_u32 v13, v14, 4, v13
    v_add_u32 v13, s53, v13
    s_waitcnt vmcnt(15)
    ds_write_b128 v13, v[120:123]
    v_add_u32 v13, 1728, v2
    v_mul_hi_u32 v14, v13, s54
    v_lshlrev_b32 v13, 4, v13
    v_lshl_add_u32 v13, v14, 4, v13
    v_add_u32 v13, s53, v13
    s_waitcnt vmcnt(14)
    ds_write_b128 v13, v[124:127]
    v_mul_u32_u24 v13, 912, v3
    v_lshl_add_u32 v13, v4, 4, v13
    v_add_u32 v13, s53, v13
    s_waitcnt lgkmcnt(0)
    ds_read_b128 v[16:19], v13 offset:0
    ds_read_b128 v[20:23], v13 offset:32
    ds_read_b128 v[24:27], v13 offset:64
    ds_read_b128 v[28:31], v13 offset:96
    ds_read_b128 v[32:35], v13 offset:128
    ds_read_b128 v[36:39], v13 offset:160
    ds_read_b128 v[40:43], v13 offset:192
    ds_read_b128 v[44:47], v13 offset:224
    ds_read_b128 v[48:51], v13 offset:256
    ds_read_b128 v[52:55], v13 offset:288
    ds_read_b128 v[56:59], v13 offset:320
    ds_read_b128 v[60:63], v13 offset:352
    ds_read_b128 v[64:67], v13 offset:384
    ds_read_b128 v[68:71], v13 offset:416
    ds_read_b128 v[72:75], v13 offset:448
    ds_read_b128 v[76:79], v13 offset:480
    ds_read_b128 v[80:83], v13 offset:512
    ds_read_b128 v[84:87], v13 offset:544
    ds_read_b128 v[88:91], v13 offset:576
    ds_read_b128 v[92:95], v13 offset:608
    ds_read_b128 v[96:99], v13 offset:640
    ds_read_b128 v[100:103], v13 offset:672
    ds_read_b128 v[104:107], v13 offset:704
    ds_read_b128 v[108:111], v13 offset:736
    ds_read_b128 v[112:115], v13 offset:768
    ds_read_b128 v[116:119], v13 offset:800
    ds_read_b128 v[120:123], v13 offset:832
    ds_read_b128 v[124:127], v13 offset:864
    s_waitcnt lgkmcnt(0)
    s_barrier
    s_waitcnt vmcnt(13)
    ds_write_b128 v11, v[128:131] offset:0
    s_waitcnt vmcnt(12)
    ds_write_b128 v11, v[132:135] offset:4096
    s_waitcnt vmcnt(11)
    ds_write_b128 v11, v[136:139] offset:8192
    s_waitcnt vmcnt(10)
    ds_write_b128 v11, v[140:143] offset:12288
    s_waitcnt vmcnt(9)
    ds_write_b128 v11, v[144:147] offset:16384
    s_waitcnt vmcnt(8)
    ds_write_b128 v11, v[148:151] offset:20480
    s_waitcnt vmcnt(7)
    ds_write_b128 v11, v[152:155] offset:24576
    s_waitcnt vmcnt(6)
    ds_write_b128 v11, v[156:159] offset:28672
    s_waitcnt vmcnt(5)
    ds_write_b128 v11, v[160:163] offset:32768
    s_waitcnt vmcnt(4)
    ds_write_b128 v11, v[164:167] offset:36864
    s_waitcnt vmcnt(3)
    ds_write_b128 v11, v[168:171] offset:40960
    s_waitcnt vmcnt(2)
    ds_write_b128 v11, v[172:175] offset:45056
    s_waitcnt vmcnt(1)
    ds_write_b128 v11, v[176:179] offset:49152
    s_waitcnt vmcnt(0)
    ds_write_b128 v11, v[180:183] offset:53248
    s_mov_b32 s12, s44
    s_and_b32 s13, s45, 0xffff
    s_mov_b32 s14, 1204224
    s_mov_b32 s15, 0x00020000
    s_movk_i32 s35, 2688
    v_lshrrev_b32 v13, 2, v0
    v_mul_lo_u32 v13, v13, s35
    v_and_b32 v14, 3, v0
    v_lshl_add_u32 v13, v14, 4, v13
    s_mov_b32 s35, 2432
    buffer_load_dwordx4 v[128:131], v13, s[12:15], s35 offen
    s_mov_b32 s35, 174464
    buffer_load_dwordx4 v[132:135], v13, s[12:15], s35 offen
    s_mov_b32 s35, 346496
    buffer_load_dwordx4 v[136:139], v13, s[12:15], s35 offen
    s_mov_b32 s35, 518528
    buffer_load_dwordx4 v[140:143], v13, s[12:15], s35 offen
    s_mov_b32 s35, 690560
    buffer_load_dwordx4 v[144:147], v13, s[12:15], s35 offen
    s_mov_b32 s35, 862592
    buffer_load_dwordx4 v[148:151], v13, s[12:15], s35 offen
    s_mov_b32 s35, 1034624
    buffer_load_dwordx4 v[152:155], v13, s[12:15], s35 offen
    s_waitcnt vmcnt(6)
    ds_write_b128 v225, v[128:131] offset:0
    s_waitcnt vmcnt(5)
    ds_write_b128 v225, v[132:135] offset:4096
    s_waitcnt vmcnt(4)
    ds_write_b128 v225, v[136:139] offset:8192
    s_waitcnt vmcnt(3)
    ds_write_b128 v225, v[140:143] offset:12288
    s_waitcnt vmcnt(2)
    ds_write_b128 v225, v[144:147] offset:16384
    s_waitcnt vmcnt(1)
    ds_write_b128 v225, v[148:151] offset:20480
    s_waitcnt vmcnt(0)
    ds_write_b128 v225, v[152:155] offset:24576
    s_mov_b32 s12, s44
    s_and_b32 s13, s45, 0xffff
    s_mov_b32 s14, 1204224
    s_mov_b32 s15, 0x00020000
    s_movk_i32 s35, 2688
    v_lshrrev_b32 v13, 2, v0
    v_mul_lo_u32 v13, v13, s35
    v_and_b32 v14, 3, v0
    v_lshl_add_u32 v13, v14, 4, v13
    s_mov_b32 s35, 2496
    buffer_load_dwordx4 v[128:131], v13, s[12:15], s35 offen
    s_mov_b32 s35, 174528
    buffer_load_dwordx4 v[132:135], v13, s[12:15], s35 offen
    s_mov_b32 s35, 346560
    buffer_load_dwordx4 v[136:139], v13, s[12:15], s35 offen
    s_mov_b32 s35, 518592
    buffer_load_dwordx4 v[140:143], v13, s[12:15], s35 offen
    s_mov_b32 s35, 690624
    buffer_load_dwordx4 v[144:147], v13, s[12:15], s35 offen
    s_mov_b32 s35, 862656
    buffer_load_dwordx4 v[148:151], v13, s[12:15], s35 offen
    s_mov_b32 s35, 1034688
    buffer_load_dwordx4 v[152:155], v13, s[12:15], s35 offen
    s_waitcnt vmcnt(6)
    ds_write_b128 v225, v[128:131] offset:28672
    s_waitcnt vmcnt(5)
    ds_write_b128 v225, v[132:135] offset:32768
    s_waitcnt vmcnt(4)
    ds_write_b128 v225, v[136:139] offset:36864
    s_waitcnt vmcnt(3)
    ds_write_b128 v225, v[140:143] offset:40960
    s_waitcnt vmcnt(2)
    ds_write_b128 v225, v[144:147] offset:45056
    s_waitcnt vmcnt(1)
    ds_write_b128 v225, v[148:151] offset:49152
    s_waitcnt vmcnt(0)
    ds_write_b128 v225, v[152:155] offset:53248
    s_waitcnt lgkmcnt(0)
    s_barrier
    ds_read_b64_tr_b16 v[192:193], v7 offset:0
    ds_read_b64_tr_b16 v[194:195], v7 offset:256
    ds_read_b64_tr_b16 v[196:197], v7 offset:28672
    ds_read_b64_tr_b16 v[198:199], v7 offset:28928
    ds_read_b64_tr_b16 v[200:201], v224 offset:0
    ds_read_b64_tr_b16 v[202:203], v224 offset:256
    ds_read_b64_tr_b16 v[204:205], v224 offset:28672
    ds_read_b64_tr_b16 v[206:207], v224 offset:28928
    ds_read_b64_tr_b16 v[208:209], v7 offset:1024
    ds_read_b64_tr_b16 v[210:211], v7 offset:1280
    ds_read_b64_tr_b16 v[212:213], v7 offset:29696
    ds_read_b64_tr_b16 v[214:215], v7 offset:29952
    ds_read_b64_tr_b16 v[216:217], v224 offset:1024
    ds_read_b64_tr_b16 v[218:219], v224 offset:1280
    ds_read_b64_tr_b16 v[220:221], v224 offset:29696
    ds_read_b64_tr_b16 v[222:223], v224 offset:29952
    s_waitcnt lgkmcnt(8)
    v_mfma_f32_32x32x16_bf16 v[128:143], v[16:19], v[192:195], 0
    v_mfma_f32_32x32x16_bf16 v[144:159], v[16:19], v[196:199], 0
    v_mfma_f32_32x32x16_bf16 v[160:175], v[16:19], v[200:203], 0
    v_mfma_f32_32x32x16_bf16 v[176:191], v[16:19], v[204:207], 0
    ds_read_b64_tr_b16 v[192:193], v7 offset:2048
    ds_read_b64_tr_b16 v[194:195], v7 offset:2304
    ds_read_b64_tr_b16 v[196:197], v7 offset:30720
    ds_read_b64_tr_b16 v[198:199], v7 offset:30976
    ds_read_b64_tr_b16 v[200:201], v224 offset:2048
    ds_read_b64_tr_b16 v[202:203], v224 offset:2304
    ds_read_b64_tr_b16 v[204:205], v224 offset:30720
    ds_read_b64_tr_b16 v[206:207], v224 offset:30976
    s_waitcnt lgkmcnt(8)
    v_mfma_f32_32x32x16_bf16 v[128:143], v[20:23], v[208:211], v[128:143]
    v_mfma_f32_32x32x16_bf16 v[144:159], v[20:23], v[212:215], v[144:159]
    v_mfma_f32_32x32x16_bf16 v[160:175], v[20:23], v[216:219], v[160:175]
    v_mfma_f32_32x32x16_bf16 v[176:191], v[20:23], v[220:223], v[176:191]
    ds_read_b64_tr_b16 v[208:209], v7 offset:3072
    ds_read_b64_tr_b16 v[210:211], v7 offset:3328
    ds_read_b64_tr_b16 v[212:213], v7 offset:31744
    ds_read_b64_tr_b16 v[214:215], v7 offset:32000
    ds_read_b64_tr_b16 v[216:217], v224 offset:3072
    ds_read_b64_tr_b16 v[218:219], v224 offset:3328
    ds_read_b64_tr_b16 v[220:221], v224 offset:31744
    ds_read_b64_tr_b16 v[222:223], v224 offset:32000
    s_waitcnt lgkmcnt(8)
    v_mfma_f32_32x32x16_bf16 v[128:143], v[24:27], v[192:195], v[128:143]
    v_mfma_f32_32x32x16_bf16 v[144:159], v[24:27], v[196:199], v[144:159]
    v_mfma_f32_32x32x16_bf16 v[160:175], v[24:27], v[200:203], v[160:175]
    v_mfma_f32_32x32x16_bf16 v[176:191], v[24:27], v[204:207], v[176:191]
    ds_read_b64_tr_b16 v[192:193], v7 offset:4096
    ds_read_b64_tr_b16 v[194:195], v7 offset:4352
    ds_read_b64_tr_b16 v[196:197], v7 offset:32768
    ds_read_b64_tr_b16 v[198:199], v7 offset:33024
    ds_read_b64_tr_b16 v[200:201], v224 offset:4096
    ds_read_b64_tr_b16 v[202:203], v224 offset:4352
    ds_read_b64_tr_b16 v[204:205], v224 offset:32768
    ds_read_b64_tr_b16 v[206:207], v224 offset:33024
    s_waitcnt lgkmcnt(8)
    v_mfma_f32_32x32x16_bf16 v[128:143], v[28:31], v[208:211], v[128:143]
    v_mfma_f32_32x32x16_bf16 v[144:159], v[28:31], v[212:215], v[144:159]
    v_mfma_f32_32x32x16_bf16 v[160:175], v[28:31], v[216:219], v[160:175]
    v_mfma_f32_32x32x16_bf16 v[176:191], v[28:31], v[220:223], v[176:191]
    ds_read_b64_tr_b16 v[208:209], v7 offset:5120
    ds_read_b64_tr_b16 v[210:211], v7 offset:5376
    ds_read_b64_tr_b16 v[212:213], v7 offset:33792
    ds_read_b64_tr_b16 v[214:215], v7 offset:34048
    ds_read_b64_tr_b16 v[216:217], v224 offset:5120
    ds_read_b64_tr_b16 v[218:219], v224 offset:5376
    ds_read_b64_tr_b16 v[220:221], v224 offset:33792
    ds_read_b64_tr_b16 v[222:223], v224 offset:34048
    s_waitcnt lgkmcnt(8)
    v_mfma_f32_32x32x16_bf16 v[128:143], v[32:35], v[192:195], v[128:143]
    v_mfma_f32_32x32x16_bf16 v[144:159], v[32:35], v[196:199], v[144:159]
    v_mfma_f32_32x32x16_bf16 v[160:175], v[32:35], v[200:203], v[160:175]
    v_mfma_f32_32x32x16_bf16 v[176:191], v[32:35], v[204:207], v[176:191]
    ds_read_b64_tr_b16 v[192:193], v7 offset:6144
    ds_read_b64_tr_b16 v[194:195], v7 offset:6400
    ds_read_b64_tr_b16 v[196:197], v7 offset:34816
    ds_read_b64_tr_b16 v[198:199], v7 offset:35072
    ds_read_b64_tr_b16 v[200:201], v224 offset:6144
    ds_read_b64_tr_b16 v[202:203], v224 offset:6400
    ds_read_b64_tr_b16 v[204:205], v224 offset:34816
    ds_read_b64_tr_b16 v[206:207], v224 offset:35072
    s_waitcnt lgkmcnt(8)
    v_mfma_f32_32x32x16_bf16 v[128:143], v[36:39], v[208:211], v[128:143]
    v_mfma_f32_32x32x16_bf16 v[144:159], v[36:39], v[212:215], v[144:159]
    v_mfma_f32_32x32x16_bf16 v[160:175], v[36:39], v[216:219], v[160:175]
    v_mfma_f32_32x32x16_bf16 v[176:191], v[36:39], v[220:223], v[176:191]
    ds_read_b64_tr_b16 v[208:209], v7 offset:7168
    ds_read_b64_tr_b16 v[210:211], v7 offset:7424
    ds_read_b64_tr_b16 v[212:213], v7 offset:35840
    ds_read_b64_tr_b16 v[214:215], v7 offset:36096
    ds_read_b64_tr_b16 v[216:217], v224 offset:7168
    ds_read_b64_tr_b16 v[218:219], v224 offset:7424
    ds_read_b64_tr_b16 v[220:221], v224 offset:35840
    ds_read_b64_tr_b16 v[222:223], v224 offset:36096
    s_waitcnt lgkmcnt(8)
    v_mfma_f32_32x32x16_bf16 v[128:143], v[40:43], v[192:195], v[128:143]
    v_mfma_f32_32x32x16_bf16 v[144:159], v[40:43], v[196:199], v[144:159]
    v_mfma_f32_32x32x16_bf16 v[160:175], v[40:43], v[200:203], v[160:175]
    v_mfma_f32_32x32x16_bf16 v[176:191], v[40:43], v[204:207], v[176:191]
    ds_read_b64_tr_b16 v[192:193], v7 offset:8192
    ds_read_b64_tr_b16 v[194:195], v7 offset:8448
    ds_read_b64_tr_b16 v[196:197], v7 offset:36864
    ds_read_b64_tr_b16 v[198:199], v7 offset:37120
    ds_read_b64_tr_b16 v[200:201], v224 offset:8192
    ds_read_b64_tr_b16 v[202:203], v224 offset:8448
    ds_read_b64_tr_b16 v[204:205], v224 offset:36864
    ds_read_b64_tr_b16 v[206:207], v224 offset:37120
    s_waitcnt lgkmcnt(8)
    v_mfma_f32_32x32x16_bf16 v[128:143], v[44:47], v[208:211], v[128:143]
    v_mfma_f32_32x32x16_bf16 v[144:159], v[44:47], v[212:215], v[144:159]
    v_mfma_f32_32x32x16_bf16 v[160:175], v[44:47], v[216:219], v[160:175]
    v_mfma_f32_32x32x16_bf16 v[176:191], v[44:47], v[220:223], v[176:191]
    ds_read_b64_tr_b16 v[208:209], v7 offset:9216
    ds_read_b64_tr_b16 v[210:211], v7 offset:9472
    ds_read_b64_tr_b16 v[212:213], v7 offset:37888
    ds_read_b64_tr_b16 v[214:215], v7 offset:38144
    ds_read_b64_tr_b16 v[216:217], v224 offset:9216
    ds_read_b64_tr_b16 v[218:219], v224 offset:9472
    ds_read_b64_tr_b16 v[220:221], v224 offset:37888
    ds_read_b64_tr_b16 v[222:223], v224 offset:38144
    s_waitcnt lgkmcnt(8)
    v_mfma_f32_32x32x16_bf16 v[128:143], v[48:51], v[192:195], v[128:143]
    v_mfma_f32_32x32x16_bf16 v[144:159], v[48:51], v[196:199], v[144:159]
    v_mfma_f32_32x32x16_bf16 v[160:175], v[48:51], v[200:203], v[160:175]
    v_mfma_f32_32x32x16_bf16 v[176:191], v[48:51], v[204:207], v[176:191]
    ds_read_b64_tr_b16 v[192:193], v7 offset:10240
    ds_read_b64_tr_b16 v[194:195], v7 offset:10496
    ds_read_b64_tr_b16 v[196:197], v7 offset:38912
    ds_read_b64_tr_b16 v[198:199], v7 offset:39168
    ds_read_b64_tr_b16 v[200:201], v224 offset:10240
    ds_read_b64_tr_b16 v[202:203], v224 offset:10496
    ds_read_b64_tr_b16 v[204:205], v224 offset:38912
    ds_read_b64_tr_b16 v[206:207], v224 offset:39168
    s_waitcnt lgkmcnt(8)
    v_mfma_f32_32x32x16_bf16 v[128:143], v[52:55], v[208:211], v[128:143]
    v_mfma_f32_32x32x16_bf16 v[144:159], v[52:55], v[212:215], v[144:159]
    v_mfma_f32_32x32x16_bf16 v[160:175], v[52:55], v[216:219], v[160:175]
    v_mfma_f32_32x32x16_bf16 v[176:191], v[52:55], v[220:223], v[176:191]
    ds_read_b64_tr_b16 v[208:209], v7 offset:11264
    ds_read_b64_tr_b16 v[210:211], v7 offset:11520
    ds_read_b64_tr_b16 v[212:213], v7 offset:39936
    ds_read_b64_tr_b16 v[214:215], v7 offset:40192
    ds_read_b64_tr_b16 v[216:217], v224 offset:11264
    ds_read_b64_tr_b16 v[218:219], v224 offset:11520
    ds_read_b64_tr_b16 v[220:221], v224 offset:39936
    ds_read_b64_tr_b16 v[222:223], v224 offset:40192
    s_waitcnt lgkmcnt(8)
    v_mfma_f32_32x32x16_bf16 v[128:143], v[56:59], v[192:195], v[128:143]
    v_mfma_f32_32x32x16_bf16 v[144:159], v[56:59], v[196:199], v[144:159]
    v_mfma_f32_32x32x16_bf16 v[160:175], v[56:59], v[200:203], v[160:175]
    v_mfma_f32_32x32x16_bf16 v[176:191], v[56:59], v[204:207], v[176:191]
    ds_read_b64_tr_b16 v[192:193], v7 offset:12288
    ds_read_b64_tr_b16 v[194:195], v7 offset:12544
    ds_read_b64_tr_b16 v[196:197], v7 offset:40960
    ds_read_b64_tr_b16 v[198:199], v7 offset:41216
    ds_read_b64_tr_b16 v[200:201], v224 offset:12288
    ds_read_b64_tr_b16 v[202:203], v224 offset:12544
    ds_read_b64_tr_b16 v[204:205], v224 offset:40960
    ds_read_b64_tr_b16 v[206:207], v224 offset:41216
    s_waitcnt lgkmcnt(8)
    v_mfma_f32_32x32x16_bf16 v[128:143], v[60:63], v[208:211], v[128:143]
    v_mfma_f32_32x32x16_bf16 v[144:159], v[60:63], v[212:215], v[144:159]
    v_mfma_f32_32x32x16_bf16 v[160:175], v[60:63], v[216:219], v[160:175]
    v_mfma_f32_32x32x16_bf16 v[176:191], v[60:63], v[220:223], v[176:191]
    ds_read_b64_tr_b16 v[208:209], v7 offset:13312
    ds_read_b64_tr_b16 v[210:211], v7 offset:13568
    ds_read_b64_tr_b16 v[212:213], v7 offset:41984
    ds_read_b64_tr_b16 v[214:215], v7 offset:42240
    ds_read_b64_tr_b16 v[216:217], v224 offset:13312
    ds_read_b64_tr_b16 v[218:219], v224 offset:13568
    ds_read_b64_tr_b16 v[220:221], v224 offset:41984
    ds_read_b64_tr_b16 v[222:223], v224 offset:42240
    s_waitcnt lgkmcnt(8)
    v_mfma_f32_32x32x16_bf16 v[128:143], v[64:67], v[192:195], v[128:143]
    v_mfma_f32_32x32x16_bf16 v[144:159], v[64:67], v[196:199], v[144:159]
    v_mfma_f32_32x32x16_bf16 v[160:175], v[64:67], v[200:203], v[160:175]
    v_mfma_f32_32x32x16_bf16 v[176:191], v[64:67], v[204:207], v[176:191]
    ds_read_b64_tr_b16 v[192:193], v7 offset:14336
    ds_read_b64_tr_b16 v[194:195], v7 offset:14592
    ds_read_b64_tr_b16 v[196:197], v7 offset:43008
    ds_read_b64_tr_b16 v[198:199], v7 offset:43264
    ds_read_b64_tr_b16 v[200:201], v224 offset:14336
    ds_read_b64_tr_b16 v[202:203], v224 offset:14592
    ds_read_b64_tr_b16 v[204:205], v224 offset:43008
    ds_read_b64_tr_b16 v[206:207], v224 offset:43264
    s_waitcnt lgkmcnt(8)
    v_mfma_f32_32x32x16_bf16 v[128:143], v[68:71], v[208:211], v[128:143]
    v_mfma_f32_32x32x16_bf16 v[144:159], v[68:71], v[212:215], v[144:159]
    v_mfma_f32_32x32x16_bf16 v[160:175], v[68:71], v[216:219], v[160:175]
    v_mfma_f32_32x32x16_bf16 v[176:191], v[68:71], v[220:223], v[176:191]
    ds_read_b64_tr_b16 v[208:209], v7 offset:15360
    ds_read_b64_tr_b16 v[210:211], v7 offset:15616
    ds_read_b64_tr_b16 v[212:213], v7 offset:44032
    ds_read_b64_tr_b16 v[214:215], v7 offset:44288
    ds_read_b64_tr_b16 v[216:217], v224 offset:15360
    ds_read_b64_tr_b16 v[218:219], v224 offset:15616
    ds_read_b64_tr_b16 v[220:221], v224 offset:44032
    ds_read_b64_tr_b16 v[222:223], v224 offset:44288
    s_waitcnt lgkmcnt(8)
    v_mfma_f32_32x32x16_bf16 v[128:143], v[72:75], v[192:195], v[128:143]
    v_mfma_f32_32x32x16_bf16 v[144:159], v[72:75], v[196:199], v[144:159]
    v_mfma_f32_32x32x16_bf16 v[160:175], v[72:75], v[200:203], v[160:175]
    v_mfma_f32_32x32x16_bf16 v[176:191], v[72:75], v[204:207], v[176:191]
    ds_read_b64_tr_b16 v[192:193], v7 offset:16384
    ds_read_b64_tr_b16 v[194:195], v7 offset:16640
    ds_read_b64_tr_b16 v[196:197], v7 offset:45056
    ds_read_b64_tr_b16 v[198:199], v7 offset:45312
    ds_read_b64_tr_b16 v[200:201], v224 offset:16384
    ds_read_b64_tr_b16 v[202:203], v224 offset:16640
    ds_read_b64_tr_b16 v[204:205], v224 offset:45056
    ds_read_b64_tr_b16 v[206:207], v224 offset:45312
    s_waitcnt lgkmcnt(8)
    v_mfma_f32_32x32x16_bf16 v[128:143], v[76:79], v[208:211], v[128:143]
    v_mfma_f32_32x32x16_bf16 v[144:159], v[76:79], v[212:215], v[144:159]
    v_mfma_f32_32x32x16_bf16 v[160:175], v[76:79], v[216:219], v[160:175]
    v_mfma_f32_32x32x16_bf16 v[176:191], v[76:79], v[220:223], v[176:191]
    ds_read_b64_tr_b16 v[208:209], v7 offset:17408
    ds_read_b64_tr_b16 v[210:211], v7 offset:17664
    ds_read_b64_tr_b16 v[212:213], v7 offset:46080
    ds_read_b64_tr_b16 v[214:215], v7 offset:46336
    ds_read_b64_tr_b16 v[216:217], v224 offset:17408
    ds_read_b64_tr_b16 v[218:219], v224 offset:17664
    ds_read_b64_tr_b16 v[220:221], v224 offset:46080
    ds_read_b64_tr_b16 v[222:223], v224 offset:46336
    s_waitcnt lgkmcnt(8)
    v_mfma_f32_32x32x16_bf16 v[128:143], v[80:83], v[192:195], v[128:143]
    v_mfma_f32_32x32x16_bf16 v[144:159], v[80:83], v[196:199], v[144:159]
    v_mfma_f32_32x32x16_bf16 v[160:175], v[80:83], v[200:203], v[160:175]
    v_mfma_f32_32x32x16_bf16 v[176:191], v[80:83], v[204:207], v[176:191]
    ds_read_b64_tr_b16 v[192:193], v7 offset:18432
    ds_read_b64_tr_b16 v[194:195], v7 offset:18688
    ds_read_b64_tr_b16 v[196:197], v7 offset:47104
    ds_read_b64_tr_b16 v[198:199], v7 offset:47360
    ds_read_b64_tr_b16 v[200:201], v224 offset:18432
    ds_read_b64_tr_b16 v[202:203], v224 offset:18688
    ds_read_b64_tr_b16 v[204:205], v224 offset:47104
    ds_read_b64_tr_b16 v[206:207], v224 offset:47360
    s_waitcnt lgkmcnt(8)
    v_mfma_f32_32x32x16_bf16 v[128:143], v[84:87], v[208:211], v[128:143]
    v_mfma_f32_32x32x16_bf16 v[144:159], v[84:87], v[212:215], v[144:159]
    v_mfma_f32_32x32x16_bf16 v[160:175], v[84:87], v[216:219], v[160:175]
    v_mfma_f32_32x32x16_bf16 v[176:191], v[84:87], v[220:223], v[176:191]
    ds_read_b64_tr_b16 v[208:209], v7 offset:19456
    ds_read_b64_tr_b16 v[210:211], v7 offset:19712
    ds_read_b64_tr_b16 v[212:213], v7 offset:48128
    ds_read_b64_tr_b16 v[214:215], v7 offset:48384
    ds_read_b64_tr_b16 v[216:217], v224 offset:19456
    ds_read_b64_tr_b16 v[218:219], v224 offset:19712
    ds_read_b64_tr_b16 v[220:221], v224 offset:48128
    ds_read_b64_tr_b16 v[222:223], v224 offset:48384
    s_waitcnt lgkmcnt(8)
    v_mfma_f32_32x32x16_bf16 v[128:143], v[88:91], v[192:195], v[128:143]
    v_mfma_f32_32x32x16_bf16 v[144:159], v[88:91], v[196:199], v[144:159]
    v_mfma_f32_32x32x16_bf16 v[160:175], v[88:91], v[200:203], v[160:175]
    v_mfma_f32_32x32x16_bf16 v[176:191], v[88:91], v[204:207], v[176:191]
    ds_read_b64_tr_b16 v[192:193], v7 offset:20480
    ds_read_b64_tr_b16 v[194:195], v7 offset:20736
    ds_read_b64_tr_b16 v[196:197], v7 offset:49152
    ds_read_b64_tr_b16 v[198:199], v7 offset:49408
    ds_read_b64_tr_b16 v[200:201], v224 offset:20480
    ds_read_b64_tr_b16 v[202:203], v224 offset:20736
    ds_read_b64_tr_b16 v[204:205], v224 offset:49152
    ds_read_b64_tr_b16 v[206:207], v224 offset:49408
    s_waitcnt lgkmcnt(8)
    v_mfma_f32_32x32x16_bf16 v[128:143], v[92:95], v[208:211], v[128:143]
    v_mfma_f32_32x32x16_bf16 v[144:159], v[92:95], v[212:215], v[144:159]
    v_mfma_f32_32x32x16_bf16 v[160:175], v[92:95], v[216:219], v[160:175]
    v_mfma_f32_32x32x16_bf16 v[176:191], v[92:95], v[220:223], v[176:191]
    ds_read_b64_tr_b16 v[208:209], v7 offset:21504
    ds_read_b64_tr_b16 v[210:211], v7 offset:21760
    ds_read_b64_tr_b16 v[212:213], v7 offset:50176
    ds_read_b64_tr_b16 v[214:215], v7 offset:50432
    ds_read_b64_tr_b16 v[216:217], v224 offset:21504
    ds_read_b64_tr_b16 v[218:219], v224 offset:21760
    ds_read_b64_tr_b16 v[220:221], v224 offset:50176
    ds_read_b64_tr_b16 v[222:223], v224 offset:50432
    s_waitcnt lgkmcnt(8)
    v_mfma_f32_32x32x16_bf16 v[128:143], v[96:99], v[192:195], v[128:143]
    v_mfma_f32_32x32x16_bf16 v[144:159], v[96:99], v[196:199], v[144:159]
    v_mfma_f32_32x32x16_bf16 v[160:175], v[96:99], v[200:203], v[160:175]
    v_mfma_f32_32x32x16_bf16 v[176:191], v[96:99], v[204:207], v[176:191]
    ds_read_b64_tr_b16 v[192:193], v7 offset:22528
    ds_read_b64_tr_b16 v[194:195], v7 offset:22784
    ds_read_b64_tr_b16 v[196:197], v7 offset:51200
    ds_read_b64_tr_b16 v[198:199], v7 offset:51456
    ds_read_b64_tr_b16 v[200:201], v224 offset:22528
    ds_read_b64_tr_b16 v[202:203], v224 offset:22784
    ds_read_b64_tr_b16 v[204:205], v224 offset:51200
    ds_read_b64_tr_b16 v[206:207], v224 offset:51456
    s_waitcnt lgkmcnt(8)
    v_mfma_f32_32x32x16_bf16 v[128:143], v[100:103], v[208:211], v[128:143]
    v_mfma_f32_32x32x16_bf16 v[144:159], v[100:103], v[212:215], v[144:159]
    v_mfma_f32_32x32x16_bf16 v[160:175], v[100:103], v[216:219], v[160:175]
    v_mfma_f32_32x32x16_bf16 v[176:191], v[100:103], v[220:223], v[176:191]
    ds_read_b64_tr_b16 v[208:209], v7 offset:23552
    ds_read_b64_tr_b16 v[210:211], v7 offset:23808
    ds_read_b64_tr_b16 v[212:213], v7 offset:52224
    ds_read_b64_tr_b16 v[214:215], v7 offset:52480
    ds_read_b64_tr_b16 v[216:217], v224 offset:23552
    ds_read_b64_tr_b16 v[218:219], v224 offset:23808
    ds_read_b64_tr_b16 v[220:221], v224 offset:52224
    ds_read_b64_tr_b16 v[222:223], v224 offset:52480
    s_waitcnt lgkmcnt(8)
    v_mfma_f32_32x32x16_bf16 v[128:143], v[104:107], v[192:195], v[128:143]
    v_mfma_f32_32x32x16_bf16 v[144:159], v[104:107], v[196:199], v[144:159]
    v_mfma_f32_32x32x16_bf16 v[160:175], v[104:107], v[200:203], v[160:175]
    v_mfma_f32_32x32x16_bf16 v[176:191], v[104:107], v[204:207], v[176:191]
    ds_read_b64_tr_b16 v[192:193], v7 offset:24576
    ds_read_b64_tr_b16 v[194:195], v7 offset:24832
    ds_read_b64_tr_b16 v[196:197], v7 offset:53248
    ds_read_b64_tr_b16 v[198:199], v7 offset:53504
    ds_read_b64_tr_b16 v[200:201], v224 offset:24576
    ds_read_b64_tr_b16 v[202:203], v224 offset:24832
    ds_read_b64_tr_b16 v[204:205], v224 offset:53248
    ds_read_b64_tr_b16 v[206:207], v224 offset:53504
    s_waitcnt lgkmcnt(8)
    v_mfma_f32_32x32x16_bf16 v[128:143], v[108:111], v[208:211], v[128:143]
    v_mfma_f32_32x32x16_bf16 v[144:159], v[108:111], v[212:215], v[144:159]
    v_mfma_f32_32x32x16_bf16 v[160:175], v[108:111], v[216:219], v[160:175]
    v_mfma_f32_32x32x16_bf16 v[176:191], v[108:111], v[220:223], v[176:191]
    ds_read_b64_tr_b16 v[208:209], v7 offset:25600
    ds_read_b64_tr_b16 v[210:211], v7 offset:25856
    ds_read_b64_tr_b16 v[212:213], v7 offset:54272
    ds_read_b64_tr_b16 v[214:215], v7 offset:54528
    ds_read_b64_tr_b16 v[216:217], v224 offset:25600
    ds_read_b64_tr_b16 v[218:219], v224 offset:25856
    ds_read_b64_tr_b16 v[220:221], v224 offset:54272
    ds_read_b64_tr_b16 v[222:223], v224 offset:54528
    s_waitcnt lgkmcnt(8)
    v_mfma_f32_32x32x16_bf16 v[128:143], v[112:115], v[192:195], v[128:143]
    v_mfma_f32_32x32x16_bf16 v[144:159], v[112:115], v[196:199], v[144:159]
    v_mfma_f32_32x32x16_bf16 v[160:175], v[112:115], v[200:203], v[160:175]
    v_mfma_f32_32x32x16_bf16 v[176:191], v[112:115], v[204:207], v[176:191]
    ds_read_b64_tr_b16 v[192:193], v7 offset:26624
    ds_read_b64_tr_b16 v[194:195], v7 offset:26880
    ds_read_b64_tr_b16 v[196:197], v7 offset:55296
    ds_read_b64_tr_b16 v[198:199], v7 offset:55552
    ds_read_b64_tr_b16 v[200:201], v224 offset:26624
    ds_read_b64_tr_b16 v[202:203], v224 offset:26880
    ds_read_b64_tr_b16 v[204:205], v224 offset:55296
    ds_read_b64_tr_b16 v[206:207], v224 offset:55552
    s_waitcnt lgkmcnt(8)
    v_mfma_f32_32x32x16_bf16 v[128:143], v[116:119], v[208:211], v[128:143]
    v_mfma_f32_32x32x16_bf16 v[144:159], v[116:119], v[212:215], v[144:159]
    v_mfma_f32_32x32x16_bf16 v[160:175], v[116:119], v[216:219], v[160:175]
    v_mfma_f32_32x32x16_bf16 v[176:191], v[116:119], v[220:223], v[176:191]
    ds_read_b64_tr_b16 v[208:209], v7 offset:27648
    ds_read_b64_tr_b16 v[210:211], v7 offset:27904
    ds_read_b64_tr_b16 v[212:213], v7 offset:56320
    ds_read_b64_tr_b16 v[214:215], v7 offset:56576
    ds_read_b64_tr_b16 v[216:217], v224 offset:27648
    ds_read_b64_tr_b16 v[218:219], v224 offset:27904
    ds_read_b64_tr_b16 v[220:221], v224 offset:56320
    ds_read_b64_tr_b16 v[222:223], v224 offset:56576
    s_waitcnt lgkmcnt(8)
    v_mfma_f32_32x32x16_bf16 v[128:143], v[120:123], v[192:195], v[128:143]
    v_mfma_f32_32x32x16_bf16 v[144:159], v[120:123], v[196:199], v[144:159]
    v_mfma_f32_32x32x16_bf16 v[160:175], v[120:123], v[200:203], v[160:175]
    v_mfma_f32_32x32x16_bf16 v[176:191], v[120:123], v[204:207], v[176:191]
    s_waitcnt lgkmcnt(0)
    v_mfma_f32_32x32x16_bf16 v[128:143], v[124:127], v[208:211], v[128:143]
    v_mfma_f32_32x32x16_bf16 v[144:159], v[124:127], v[212:215], v[144:159]
    v_mfma_f32_32x32x16_bf16 v[160:175], v[124:127], v[216:219], v[160:175]
    v_mfma_f32_32x32x16_bf16 v[176:191], v[124:127], v[220:223], v[176:191]
    s_nop 15
    s_nop 3
    v_add_u32 v13, 256, v3
    v_lshlrev_b32 v13, 12, v13
    v_sub_u32 v14, v5, v3
    v_lshl_add_u32 v13, v14, 1, v13
    v_lshl_add_u32 v13, v4, 3, v13
    v_add_u32 v13, 6029312, v13
    v_cvt_pk_bf16_f32 v128, v128, v129
    v_cvt_pk_bf16_f32 v129, v130, v131
    buffer_store_dwordx2 v[128:129], v13, s[16:19], 0 offen offset:0
    v_cvt_pk_bf16_f32 v132, v132, v133
    v_cvt_pk_bf16_f32 v133, v134, v135
    buffer_store_dwordx2 v[132:133], v13, s[16:19], 0 offen offset:16
    v_cvt_pk_bf16_f32 v136, v136, v137
    v_cvt_pk_bf16_f32 v137, v138, v139
    buffer_store_dwordx2 v[136:137], v13, s[16:19], 0 offen offset:32
    v_cvt_pk_bf16_f32 v140, v140, v141
    v_cvt_pk_bf16_f32 v141, v142, v143
    buffer_store_dwordx2 v[140:141], v13, s[16:19], 0 offen offset:48
    v_add_u32 v13, 288, v3
    v_lshlrev_b32 v13, 12, v13
    v_sub_u32 v14, v5, v3
    v_lshl_add_u32 v13, v14, 1, v13
    v_lshl_add_u32 v13, v4, 3, v13
    v_add_u32 v13, 6029312, v13
    v_cvt_pk_bf16_f32 v144, v144, v145
    v_cvt_pk_bf16_f32 v145, v146, v147
    buffer_store_dwordx2 v[144:145], v13, s[16:19], 0 offen offset:0
    v_cvt_pk_bf16_f32 v148, v148, v149
    v_cvt_pk_bf16_f32 v149, v150, v151
    buffer_store_dwordx2 v[148:149], v13, s[16:19], 0 offen offset:16
    v_cvt_pk_bf16_f32 v152, v152, v153
    v_cvt_pk_bf16_f32 v153, v154, v155
    buffer_store_dwordx2 v[152:153], v13, s[16:19], 0 offen offset:32
    v_cvt_pk_bf16_f32 v156, v156, v157
    v_cvt_pk_bf16_f32 v157, v158, v159
    buffer_store_dwordx2 v[156:157], v13, s[16:19], 0 offen offset:48
    v_add_u32 v13, 320, v3
    v_lshlrev_b32 v13, 12, v13
    v_sub_u32 v14, v5, v3
    v_lshl_add_u32 v13, v14, 1, v13
    v_lshl_add_u32 v13, v4, 3, v13
    v_add_u32 v13, 6029312, v13
    v_cvt_pk_bf16_f32 v160, v160, v161
    v_cvt_pk_bf16_f32 v161, v162, v163
    buffer_store_dwordx2 v[160:161], v13, s[16:19], 0 offen offset:0
    v_cvt_pk_bf16_f32 v164, v164, v165
    v_cvt_pk_bf16_f32 v165, v166, v167
    buffer_store_dwordx2 v[164:165], v13, s[16:19], 0 offen offset:16
    v_cvt_pk_bf16_f32 v168, v168, v169
    v_cvt_pk_bf16_f32 v169, v170, v171
    buffer_store_dwordx2 v[168:169], v13, s[16:19], 0 offen offset:32
    v_cvt_pk_bf16_f32 v172, v172, v173
    v_cvt_pk_bf16_f32 v173, v174, v175
    buffer_store_dwordx2 v[172:173], v13, s[16:19], 0 offen offset:48
    v_add_u32 v13, 352, v3
    v_lshlrev_b32 v13, 12, v13
    v_sub_u32 v14, v5, v3
    v_lshl_add_u32 v13, v14, 1, v13
    v_lshl_add_u32 v13, v4, 3, v13
    v_add_u32 v13, 6029312, v13
    v_cvt_pk_bf16_f32 v176, v176, v177
    v_cvt_pk_bf16_f32 v177, v178, v179
    buffer_store_dwordx2 v[176:177], v13, s[16:19], 0 offen offset:0
    v_cvt_pk_bf16_f32 v180, v180, v181
    v_cvt_pk_bf16_f32 v181, v182, v183
    buffer_store_dwordx2 v[180:181], v13, s[16:19], 0 offen offset:16
    v_cvt_pk_bf16_f32 v184, v184, v185
    v_cvt_pk_bf16_f32 v185, v186, v187
    buffer_store_dwordx2 v[184:185], v13, s[16:19], 0 offen offset:32
    v_cvt_pk_bf16_f32 v188, v188, v189
    v_cvt_pk_bf16_f32 v189, v190, v191
    buffer_store_dwordx2 v[188:189], v13, s[16:19], 0 offen offset:48
    s_endpgm
K1_v14:
    s_mov_b32 s12, s44
    s_and_b32 s13, s45, 0xffff
    s_mov_b32 s14, 1204224
    s_mov_b32 s15, 0x00020000
    s_movk_i32 s35, 2688
    v_lshrrev_b32 v227, 2, v0
    v_mul_lo_u32 v227, v227, s35
    v_and_b32 v14, 3, v0
    v_lshl_add_u32 v227, v14, 4, v227
    s_mov_b32 s35, 2560
    buffer_load_dwordx4 v[128:131], v227, s[12:15], s35 offen
    s_mov_b32 s35, 174592
    buffer_load_dwordx4 v[132:135], v227, s[12:15], s35 offen
    s_mov_b32 s35, 346624
    buffer_load_dwordx4 v[136:139], v227, s[12:15], s35 offen
    s_mov_b32 s35, 518656
    buffer_load_dwordx4 v[140:143], v227, s[12:15], s35 offen
    s_mov_b32 s35, 690688
    buffer_load_dwordx4 v[144:147], v227, s[12:15], s35 offen
    s_mov_b32 s35, 862720
    buffer_load_dwordx4 v[148:151], v227, s[12:15], s35 offen
    s_mov_b32 s35, 1034752
    buffer_load_dwordx4 v[152:155], v227, s[12:15], s35 offen
    s_mov_b32 s12, s44
    s_and_b32 s13, s45, 0xffff
    s_mov_b32 s14, 1204224
    s_mov_b32 s15, 0x00020000
    s_movk_i32 s35, 2688
    v_lshrrev_b32 v227, 2, v0
    v_mul_lo_u32 v227, v227, s35
    v_and_b32 v14, 3, v0
    v_lshl_add_u32 v227, v14, 4, v227
    s_mov_b32 s35, 2624
    buffer_load_dwordx4 v[156:159], v227, s[12:15], s35 offen
    s_mov_b32 s35, 174656
    buffer_load_dwordx4 v[160:163], v227, s[12:15], s35 offen
    s_mov_b32 s35, 346688
    buffer_load_dwordx4 v[164:167], v227, s[12:15], s35 offen
    s_mov_b32 s35, 518720
    buffer_load_dwordx4 v[168:171], v227, s[12:15], s35 offen
    s_mov_b32 s35, 690752
    buffer_load_dwordx4 v[172:175], v227, s[12:15], s35 offen
    s_mov_b32 s35, 862784
    buffer_load_dwordx4 v[176:179], v227, s[12:15], s35 offen
    s_mov_b32 s35, 1034816
    buffer_load_dwordx4 v[180:183], v227, s[12:15], s35 offen
    s_mov_b32 s54, 0x4924925
    v_add_u32 v13, 0, v2
    v_mul_hi_u32 v14, v13, s54
    v_lshlrev_b32 v13, 4, v13
    v_lshl_add_u32 v13, v14, 4, v13
    v_add_u32 v13, s53, v13
    s_waitcnt vmcnt(41)
    ds_write_b128 v13, v[16:19]
    v_add_u32 v13, 64, v2
    v_mul_hi_u32 v14, v13, s54
    v_lshlrev_b32 v13, 4, v13
    v_lshl_add_u32 v13, v14, 4, v13
    v_add_u32 v13, s53, v13
    s_waitcnt vmcnt(40)
    ds_write_b128 v13, v[20:23]
    v_add_u32 v13, 128, v2
    v_mul_hi_u32 v14, v13, s54
    v_lshlrev_b32 v13, 4, v13
    v_lshl_add_u32 v13, v14, 4, v13
    v_add_u32 v13, s53, v13
    s_waitcnt vmcnt(39)
    ds_write_b128 v13, v[24:27]
    v_add_u32 v13, 192, v2
    v_mul_hi_u32 v14, v13, s54
    v_lshlrev_b32 v13, 4, v13
    v_lshl_add_u32 v13, v14, 4, v13
    v_add_u32 v13, s53, v13
    s_waitcnt vmcnt(38)
    ds_write_b128 v13, v[28:31]
    v_add_u32 v13, 256, v2
    v_mul_hi_u32 v14, v13, s54
    v_lshlrev_b32 v13, 4, v13
    v_lshl_add_u32 v13, v14, 4, v13
    v_add_u32 v13, s53, v13
    s_waitcnt vmcnt(37)
    ds_write_b128 v13, v[32:35]
    v_add_u32 v13, 320, v2
    v_mul_hi_u32 v14, v13, s54
    v_lshlrev_b32 v13, 4, v13
    v_lshl_add_u32 v13, v14, 4, v13
    v_add_u32 v13, s53, v13
    s_waitcnt vmcnt(36)
    ds_write_b128 v13, v[36:39]
    v_add_u32 v13, 384, v2
    v_mul_hi_u32 v14, v13, s54
    v_lshlrev_b32 v13, 4, v13
    v_lshl_add_u32 v13, v14, 4, v13
    v_add_u32 v13, s53, v13
    s_waitcnt vmcnt(35)
    ds_write_b128 v13, v[40:43]
    v_add_u32 v13, 448, v2
    v_mul_hi_u32 v14, v13, s54
    v_lshlrev_b32 v13, 4, v13
    v_lshl_add_u32 v13, v14, 4, v13
    v_add_u32 v13, s53, v13
    s_waitcnt vmcnt(34)
    ds_write_b128 v13, v[44:47]
    v_add_u32 v13, 512, v2
    v_mul_hi_u32 v14, v13, s54
    v_lshlrev_b32 v13, 4, v13
    v_lshl_add_u32 v13, v14, 4, v13
    v_add_u32 v13, s53, v13
    s_waitcnt vmcnt(33)
    ds_write_b128 v13, v[48:51]
    v_add_u32 v13, 576, v2
    v_mul_hi_u32 v14, v13, s54
    v_lshlrev_b32 v13, 4, v13
    v_lshl_add_u32 v13, v14, 4, v13
    v_add_u32 v13, s53, v13
    s_waitcnt vmcnt(32)
    ds_write_b128 v13, v[52:55]
    v_add_u32 v13, 640, v2
    v_mul_hi_u32 v14, v13, s54
    v_lshlrev_b32 v13, 4, v13
    v_lshl_add_u32 v13, v14, 4, v13
    v_add_u32 v13, s53, v13
    s_waitcnt vmcnt(31)
    ds_write_b128 v13, v[56:59]
    v_add_u32 v13, 704, v2
    v_mul_hi_u32 v14, v13, s54
    v_lshlrev_b32 v13, 4, v13
    v_lshl_add_u32 v13, v14, 4, v13
    v_add_u32 v13, s53, v13
    s_waitcnt vmcnt(30)
    ds_write_b128 v13, v[60:63]
    v_add_u32 v13, 768, v2
    v_mul_hi_u32 v14, v13, s54
    v_lshlrev_b32 v13, 4, v13
    v_lshl_add_u32 v13, v14, 4, v13
    v_add_u32 v13, s53, v13
    s_waitcnt vmcnt(29)
    ds_write_b128 v13, v[64:67]
    v_add_u32 v13, 832, v2
    v_mul_hi_u32 v14, v13, s54
    v_lshlrev_b32 v13, 4, v13
    v_lshl_add_u32 v13, v14, 4, v13
    v_add_u32 v13, s53, v13
    s_waitcnt vmcnt(28)
    ds_write_b128 v13, v[68:71]
    v_add_u32 v13, 896, v2
    v_mul_hi_u32 v14, v13, s54
    v_lshlrev_b32 v13, 4, v13
    v_lshl_add_u32 v13, v14, 4, v13
    v_add_u32 v13, s53, v13
    s_waitcnt vmcnt(27)
    ds_write_b128 v13, v[72:75]
    v_add_u32 v13, 960, v2
    v_mul_hi_u32 v14, v13, s54
    v_lshlrev_b32 v13, 4, v13
    v_lshl_add_u32 v13, v14, 4, v13
    v_add_u32 v13, s53, v13
    s_waitcnt vmcnt(26)
    ds_write_b128 v13, v[76:79]
    v_add_u32 v13, 1024, v2
    v_mul_hi_u32 v14, v13, s54
    v_lshlrev_b32 v13, 4, v13
    v_lshl_add_u32 v13, v14, 4, v13
    v_add_u32 v13, s53, v13
    s_waitcnt vmcnt(25)
    ds_write_b128 v13, v[80:83]
    v_add_u32 v13, 1088, v2
    v_mul_hi_u32 v14, v13, s54
    v_lshlrev_b32 v13, 4, v13
    v_lshl_add_u32 v13, v14, 4, v13
    v_add_u32 v13, s53, v13
    s_waitcnt vmcnt(24)
    ds_write_b128 v13, v[84:87]
    v_add_u32 v13, 1152, v2
    v_mul_hi_u32 v14, v13, s54
    v_lshlrev_b32 v13, 4, v13
    v_lshl_add_u32 v13, v14, 4, v13
    v_add_u32 v13, s53, v13
    s_waitcnt vmcnt(23)
    ds_write_b128 v13, v[88:91]
    v_add_u32 v13, 1216, v2
    v_mul_hi_u32 v14, v13, s54
    v_lshlrev_b32 v13, 4, v13
    v_lshl_add_u32 v13, v14, 4, v13
    v_add_u32 v13, s53, v13
    s_waitcnt vmcnt(22)
    ds_write_b128 v13, v[92:95]
    v_add_u32 v13, 1280, v2
    v_mul_hi_u32 v14, v13, s54
    v_lshlrev_b32 v13, 4, v13
    v_lshl_add_u32 v13, v14, 4, v13
    v_add_u32 v13, s53, v13
    s_waitcnt vmcnt(21)
    ds_write_b128 v13, v[96:99]
    v_add_u32 v13, 1344, v2
    v_mul_hi_u32 v14, v13, s54
    v_lshlrev_b32 v13, 4, v13
    v_lshl_add_u32 v13, v14, 4, v13
    v_add_u32 v13, s53, v13
    s_waitcnt vmcnt(20)
    ds_write_b128 v13, v[100:103]
    v_add_u32 v13, 1408, v2
    v_mul_hi_u32 v14, v13, s54
    v_lshlrev_b32 v13, 4, v13
    v_lshl_add_u32 v13, v14, 4, v13
    v_add_u32 v13, s53, v13
    s_waitcnt vmcnt(19)
    ds_write_b128 v13, v[104:107]
    v_add_u32 v13, 1472, v2
    v_mul_hi_u32 v14, v13, s54
    v_lshlrev_b32 v13, 4, v13
    v_lshl_add_u32 v13, v14, 4, v13
    v_add_u32 v13, s53, v13
    s_waitcnt vmcnt(18)
    ds_write_b128 v13, v[108:111]
    v_add_u32 v13, 1536, v2
    v_mul_hi_u32 v14, v13, s54
    v_lshlrev_b32 v13, 4, v13
    v_lshl_add_u32 v13, v14, 4, v13
    v_add_u32 v13, s53, v13
    s_waitcnt vmcnt(17)
    ds_write_b128 v13, v[112:115]
    v_add_u32 v13, 1600, v2
    v_mul_hi_u32 v14, v13, s54
    v_lshlrev_b32 v13, 4, v13
    v_lshl_add_u32 v13, v14, 4, v13
    v_add_u32 v13, s53, v13
    s_waitcnt vmcnt(16)
    ds_write_b128 v13, v[116:119]
    v_add_u32 v13, 1664, v2
    v_mul_hi_u32 v14, v13, s54
    v_lshlrev_b32 v13, 4, v13
    v_lshl_add_u32 v13, v14, 4, v13
    v_add_u32 v13, s53, v13
    s_waitcnt vmcnt(15)
    ds_write_b128 v13, v[120:123]
    v_add_u32 v13, 1728, v2
    v_mul_hi_u32 v14, v13, s54
    v_lshlrev_b32 v13, 4, v13
    v_lshl_add_u32 v13, v14, 4, v13
    v_add_u32 v13, s53, v13
    s_waitcnt vmcnt(14)
    ds_write_b128 v13, v[124:127]
    v_mul_u32_u24 v13, 912, v3
    v_lshl_add_u32 v13, v4, 4, v13
    v_add_u32 v13, s53, v13
    s_waitcnt lgkmcnt(0)
    ds_read_b128 v[16:19], v13 offset:0
    ds_read_b128 v[20:23], v13 offset:32
    ds_read_b128 v[24:27], v13 offset:64
    ds_read_b128 v[28:31], v13 offset:96
    ds_read_b128 v[32:35], v13 offset:128
    ds_read_b128 v[36:39], v13 offset:160
    ds_read_b128 v[40:43], v13 offset:192
    ds_read_b128 v[44:47], v13 offset:224
    ds_read_b128 v[48:51], v13 offset:256
    ds_read_b128 v[52:55], v13 offset:288
    ds_read_b128 v[56:59], v13 offset:320
    ds_read_b128 v[60:63], v13 offset:352
    ds_read_b128 v[64:67], v13 offset:384
    ds_read_b128 v[68:71], v13 offset:416
    ds_read_b128 v[72:75], v13 offset:448
    ds_read_b128 v[76:79], v13 offset:480
    ds_read_b128 v[80:83], v13 offset:512
    ds_read_b128 v[84:87], v13 offset:544
    ds_read_b128 v[88:91], v13 offset:576
    ds_read_b128 v[92:95], v13 offset:608
    ds_read_b128 v[96:99], v13 offset:640
    ds_read_b128 v[100:103], v13 offset:672
    ds_read_b128 v[104:107], v13 offset:704
    ds_read_b128 v[108:111], v13 offset:736
    ds_read_b128 v[112:115], v13 offset:768
    ds_read_b128 v[116:119], v13 offset:800
    ds_read_b128 v[120:123], v13 offset:832
    ds_read_b128 v[124:127], v13 offset:864
    s_waitcnt lgkmcnt(0)
    s_barrier
    s_waitcnt vmcnt(13)
    ds_write_b128 v11, v[128:131] offset:0
    s_waitcnt vmcnt(12)
    ds_write_b128 v11, v[132:135] offset:4096
    s_waitcnt vmcnt(11)
    ds_write_b128 v11, v[136:139] offset:8192
    s_waitcnt vmcnt(10)
    ds_write_b128 v11, v[140:143] offset:12288
    s_waitcnt vmcnt(9)
    ds_write_b128 v11, v[144:147] offset:16384
    s_waitcnt vmcnt(8)
    ds_write_b128 v11, v[148:151] offset:20480
    s_waitcnt vmcnt(7)
    ds_write_b128 v11, v[152:155] offset:24576
    s_waitcnt vmcnt(6)
    ds_write_b128 v11, v[156:159] offset:28672
    s_waitcnt vmcnt(5)
    ds_write_b128 v11, v[160:163] offset:32768
    s_waitcnt vmcnt(4)
    ds_write_b128 v11, v[164:167] offset:36864
    s_waitcnt vmcnt(3)
    ds_write_b128 v11, v[168:171] offset:40960
    s_waitcnt vmcnt(2)
    ds_write_b128 v11, v[172:175] offset:45056
    s_waitcnt vmcnt(1)
    ds_write_b128 v11, v[176:179] offset:49152
    s_waitcnt vmcnt(0)
    ds_write_b128 v11, v[180:183] offset:53248
    s_waitcnt lgkmcnt(0)
    s_barrier
    ds_read_b64_tr_b16 v[192:193], v7 offset:0
    ds_read_b64_tr_b16 v[194:195], v7 offset:256
    ds_read_b64_tr_b16 v[196:197], v7 offset:28672
    ds_read_b64_tr_b16 v[198:199], v7 offset:28928
    ds_read_b64_tr_b16 v[208:209], v7 offset:1024
    ds_read_b64_tr_b16 v[210:211], v7 offset:1280
    ds_read_b64_tr_b16 v[212:213], v7 offset:29696
    ds_read_b64_tr_b16 v[214:215], v7 offset:29952
    s_waitcnt lgkmcnt(4)
    v_mfma_f32_32x32x16_bf16 v[128:143], v[16:19], v[192:195], 0
    v_mfma_f32_32x32x16_bf16 v[144:159], v[16:19], v[196:199], 0
    ds_read_b64_tr_b16 v[192:193], v7 offset:2048
    ds_read_b64_tr_b16 v[194:195], v7 offset:2304
    ds_read_b64_tr_b16 v[196:197], v7 offset:30720
    ds_read_b64_tr_b16 v[198:199], v7 offset:30976
    s_waitcnt lgkmcnt(4)
    v_mfma_f32_32x32x16_bf16 v[128:143], v[20:23], v[208:211], v[128:143]
    v_mfma_f32_32x32x16_bf16 v[144:159], v[20:23], v[212:215], v[144:159]
    ds_read_b64_tr_b16 v[208:209], v7 offset:3072
    ds_read_b64_tr_b16 v[210:211], v7 offset:3328
    ds_read_b64_tr_b16 v[212:213], v7 offset:31744
    ds_read_b64_tr_b16 v[214:215], v7 offset:32000
    s_waitcnt lgkmcnt(4)
    v_mfma_f32_32x32x16_bf16 v[128:143], v[24:27], v[192:195], v[128:143]
    v_mfma_f32_32x32x16_bf16 v[144:159], v[24:27], v[196:199], v[144:159]
    ds_read_b64_tr_b16 v[192:193], v7 offset:4096
    ds_read_b64_tr_b16 v[194:195], v7 offset:4352
    ds_read_b64_tr_b16 v[196:197], v7 offset:32768
    ds_read_b64_tr_b16 v[198:199], v7 offset:33024
    s_waitcnt lgkmcnt(4)
    v_mfma_f32_32x32x16_bf16 v[128:143], v[28:31], v[208:211], v[128:143]
    v_mfma_f32_32x32x16_bf16 v[144:159], v[28:31], v[212:215], v[144:159]
    ds_read_b64_tr_b16 v[208:209], v7 offset:5120
    ds_read_b64_tr_b16 v[210:211], v7 offset:5376
    ds_read_b64_tr_b16 v[212:213], v7 offset:33792
    ds_read_b64_tr_b16 v[214:215], v7 offset:34048
    s_waitcnt lgkmcnt(4)
    v_mfma_f32_32x32x16_bf16 v[128:143], v[32:35], v[192:195], v[128:143]
    v_mfma_f32_32x32x16_bf16 v[144:159], v[32:35], v[196:199], v[144:159]
    ds_read_b64_tr_b16 v[192:193], v7 offset:6144
    ds_read_b64_tr_b16 v[194:195], v7 offset:6400
    ds_read_b64_tr_b16 v[196:197], v7 offset:34816
    ds_read_b64_tr_b16 v[198:199], v7 offset:35072
    s_waitcnt lgkmcnt(4)
    v_mfma_f32_32x32x16_bf16 v[128:143], v[36:39], v[208:211], v[128:143]
    v_mfma_f32_32x32x16_bf16 v[144:159], v[36:39], v[212:215], v[144:159]
    ds_read_b64_tr_b16 v[208:209], v7 offset:7168
    ds_read_b64_tr_b16 v[210:211], v7 offset:7424
    ds_read_b64_tr_b16 v[212:213], v7 offset:35840
    ds_read_b64_tr_b16 v[214:215], v7 offset:36096
    s_waitcnt lgkmcnt(4)
    v_mfma_f32_32x32x16_bf16 v[128:143], v[40:43], v[192:195], v[128:143]
    v_mfma_f32_32x32x16_bf16 v[144:159], v[40:43], v[196:199], v[144:159]
    ds_read_b64_tr_b16 v[192:193], v7 offset:8192
    ds_read_b64_tr_b16 v[194:195], v7 offset:8448
    ds_read_b64_tr_b16 v[196:197], v7 offset:36864
    ds_read_b64_tr_b16 v[198:199], v7 offset:37120
    s_waitcnt lgkmcnt(4)
    v_mfma_f32_32x32x16_bf16 v[128:143], v[44:47], v[208:211], v[128:143]
    v_mfma_f32_32x32x16_bf16 v[144:159], v[44:47], v[212:215], v[144:159]
    ds_read_b64_tr_b16 v[208:209], v7 offset:9216
    ds_read_b64_tr_b16 v[210:211], v7 offset:9472
    ds_read_b64_tr_b16 v[212:213], v7 offset:37888
    ds_read_b64_tr_b16 v[214:215], v7 offset:38144
    s_waitcnt lgkmcnt(4)
    v_mfma_f32_32x32x16_bf16 v[128:143], v[48:51], v[192:195], v[128:143]
    v_mfma_f32_32x32x16_bf16 v[144:159], v[48:51], v[196:199], v[144:159]
    ds_read_b64_tr_b16 v[192:193], v7 offset:10240
    ds_read_b64_tr_b16 v[194:195], v7 offset:10496
    ds_read_b64_tr_b16 v[196:197], v7 offset:38912
    ds_read_b64_tr_b16 v[198:199], v7 offset:39168
    s_waitcnt lgkmcnt(4)
    v_mfma_f32_32x32x16_bf16 v[128:143], v[52:55], v[208:211], v[128:143]
    v_mfma_f32_32x32x16_bf16 v[144:159], v[52:55], v[212:215], v[144:159]
    ds_read_b64_tr_b16 v[208:209], v7 offset:11264
    ds_read_b64_tr_b16 v[210:211], v7 offset:11520
    ds_read_b64_tr_b16 v[212:213], v7 offset:39936
    ds_read_b64_tr_b16 v[214:215], v7 offset:40192
    s_waitcnt lgkmcnt(4)
    v_mfma_f32_32x32x16_bf16 v[128:143], v[56:59], v[192:195], v[128:143]
    v_mfma_f32_32x32x16_bf16 v[144:159], v[56:59], v[196:199], v[144:159]
    ds_read_b64_tr_b16 v[192:193], v7 offset:12288
    ds_read_b64_tr_b16 v[194:195], v7 offset:12544
    ds_read_b64_tr_b16 v[196:197], v7 offset:40960
    ds_read_b64_tr_b16 v[198:199], v7 offset:41216
    s_waitcnt lgkmcnt(4)
    v_mfma_f32_32x32x16_bf16 v[128:143], v[60:63], v[208:211], v[128:143]
    v_mfma_f32_32x32x16_bf16 v[144:159], v[60:63], v[212:215], v[144:159]
    ds_read_b64_tr_b16 v[208:209], v7 offset:13312
    ds_read_b64_tr_b16 v[210:211], v7 offset:13568
    ds_read_b64_tr_b16 v[212:213], v7 offset:41984
    ds_read_b64_tr_b16 v[214:215], v7 offset:42240
    s_waitcnt lgkmcnt(4)
    v_mfma_f32_32x32x16_bf16 v[128:143], v[64:67], v[192:195], v[128:143]
    v_mfma_f32_32x32x16_bf16 v[144:159], v[64:67], v[196:199], v[144:159]
    ds_read_b64_tr_b16 v[192:193], v7 offset:14336
    ds_read_b64_tr_b16 v[194:195], v7 offset:14592
    ds_read_b64_tr_b16 v[196:197], v7 offset:43008
    ds_read_b64_tr_b16 v[198:199], v7 offset:43264
    s_waitcnt lgkmcnt(4)
    v_mfma_f32_32x32x16_bf16 v[128:143], v[68:71], v[208:211], v[128:143]
    v_mfma_f32_32x32x16_bf16 v[144:159], v[68:71], v[212:215], v[144:159]
    ds_read_b64_tr_b16 v[208:209], v7 offset:15360
    ds_read_b64_tr_b16 v[210:211], v7 offset:15616
    ds_read_b64_tr_b16 v[212:213], v7 offset:44032
    ds_read_b64_tr_b16 v[214:215], v7 offset:44288
    s_waitcnt lgkmcnt(4)
    v_mfma_f32_32x32x16_bf16 v[128:143], v[72:75], v[192:195], v[128:143]
    v_mfma_f32_32x32x16_bf16 v[144:159], v[72:75], v[196:199], v[144:159]
    ds_read_b64_tr_b16 v[192:193], v7 offset:16384
    ds_read_b64_tr_b16 v[194:195], v7 offset:16640
    ds_read_b64_tr_b16 v[196:197], v7 offset:45056
    ds_read_b64_tr_b16 v[198:199], v7 offset:45312
    s_waitcnt lgkmcnt(4)
    v_mfma_f32_32x32x16_bf16 v[128:143], v[76:79], v[208:211], v[128:143]
    v_mfma_f32_32x32x16_bf16 v[144:159], v[76:79], v[212:215], v[144:159]
    ds_read_b64_tr_b16 v[208:209], v7 offset:17408
    ds_read_b64_tr_b16 v[210:211], v7 offset:17664
    ds_read_b64_tr_b16 v[212:213], v7 offset:46080
    ds_read_b64_tr_b16 v[214:215], v7 offset:46336
    s_waitcnt lgkmcnt(4)
    v_mfma_f32_32x32x16_bf16 v[128:143], v[80:83], v[192:195], v[128:143]
    v_mfma_f32_32x32x16_bf16 v[144:159], v[80:83], v[196:199], v[144:159]
    ds_read_b64_tr_b16 v[192:193], v7 offset:18432
    ds_read_b64_tr_b16 v[194:195], v7 offset:18688
    ds_read_b64_tr_b16 v[196:197], v7 offset:47104
    ds_read_b64_tr_b16 v[198:199], v7 offset:47360
    s_waitcnt lgkmcnt(4)
    v_mfma_f32_32x32x16_bf16 v[128:143], v[84:87], v[208:211], v[128:143]
    v_mfma_f32_32x32x16_bf16 v[144:159], v[84:87], v[212:215], v[144:159]
    ds_read_b64_tr_b16 v[208:209], v7 offset:19456
    ds_read_b64_tr_b16 v[210:211], v7 offset:19712
    ds_read_b64_tr_b16 v[212:213], v7 offset:48128
    ds_read_b64_tr_b16 v[214:215], v7 offset:48384
    s_waitcnt lgkmcnt(4)
    v_mfma_f32_32x32x16_bf16 v[128:143], v[88:91], v[192:195], v[128:143]
    v_mfma_f32_32x32x16_bf16 v[144:159], v[88:91], v[196:199], v[144:159]
    ds_read_b64_tr_b16 v[192:193], v7 offset:20480
    ds_read_b64_tr_b16 v[194:195], v7 offset:20736
    ds_read_b64_tr_b16 v[196:197], v7 offset:49152
    ds_read_b64_tr_b16 v[198:199], v7 offset:49408
    s_waitcnt lgkmcnt(4)
    v_mfma_f32_32x32x16_bf16 v[128:143], v[92:95], v[208:211], v[128:143]
    v_mfma_f32_32x32x16_bf16 v[144:159], v[92:95], v[212:215], v[144:159]
    ds_read_b64_tr_b16 v[208:209], v7 offset:21504
    ds_read_b64_tr_b16 v[210:211], v7 offset:21760
    ds_read_b64_tr_b16 v[212:213], v7 offset:50176
    ds_read_b64_tr_b16 v[214:215], v7 offset:50432
    s_waitcnt lgkmcnt(4)
    v_mfma_f32_32x32x16_bf16 v[128:143], v[96:99], v[192:195], v[128:143]
    v_mfma_f32_32x32x16_bf16 v[144:159], v[96:99], v[196:199], v[144:159]
    ds_read_b64_tr_b16 v[192:193], v7 offset:22528
    ds_read_b64_tr_b16 v[194:195], v7 offset:22784
    ds_read_b64_tr_b16 v[196:197], v7 offset:51200
    ds_read_b64_tr_b16 v[198:199], v7 offset:51456
    s_waitcnt lgkmcnt(4)
    v_mfma_f32_32x32x16_bf16 v[128:143], v[100:103], v[208:211], v[128:143]
    v_mfma_f32_32x32x16_bf16 v[144:159], v[100:103], v[212:215], v[144:159]
    ds_read_b64_tr_b16 v[208:209], v7 offset:23552
    ds_read_b64_tr_b16 v[210:211], v7 offset:23808
    ds_read_b64_tr_b16 v[212:213], v7 offset:52224
    ds_read_b64_tr_b16 v[214:215], v7 offset:52480
    s_waitcnt lgkmcnt(4)
    v_mfma_f32_32x32x16_bf16 v[128:143], v[104:107], v[192:195], v[128:143]
    v_mfma_f32_32x32x16_bf16 v[144:159], v[104:107], v[196:199], v[144:159]
    ds_read_b64_tr_b16 v[192:193], v7 offset:24576
    ds_read_b64_tr_b16 v[194:195], v7 offset:24832
    ds_read_b64_tr_b16 v[196:197], v7 offset:53248
    ds_read_b64_tr_b16 v[198:199], v7 offset:53504
    s_waitcnt lgkmcnt(4)
    v_mfma_f32_32x32x16_bf16 v[128:143], v[108:111], v[208:211], v[128:143]
    v_mfma_f32_32x32x16_bf16 v[144:159], v[108:111], v[212:215], v[144:159]
    ds_read_b64_tr_b16 v[208:209], v7 offset:25600
    ds_read_b64_tr_b16 v[210:211], v7 offset:25856
    ds_read_b64_tr_b16 v[212:213], v7 offset:54272
    ds_read_b64_tr_b16 v[214:215], v7 offset:54528
    s_waitcnt lgkmcnt(4)
    v_mfma_f32_32x32x16_bf16 v[128:143], v[112:115], v[192:195], v[128:143]
    v_mfma_f32_32x32x16_bf16 v[144:159], v[112:115], v[196:199], v[144:159]
    ds_read_b64_tr_b16 v[192:193], v7 offset:26624
    ds_read_b64_tr_b16 v[194:195], v7 offset:26880
    ds_read_b64_tr_b16 v[196:197], v7 offset:55296
    ds_read_b64_tr_b16 v[198:199], v7 offset:55552
    s_waitcnt lgkmcnt(4)
    v_mfma_f32_32x32x16_bf16 v[128:143], v[116:119], v[208:211], v[128:143]
    v_mfma_f32_32x32x16_bf16 v[144:159], v[116:119], v[212:215], v[144:159]
    ds_read_b64_tr_b16 v[208:209], v7 offset:27648
    ds_read_b64_tr_b16 v[210:211], v7 offset:27904
    ds_read_b64_tr_b16 v[212:213], v7 offset:56320
    ds_read_b64_tr_b16 v[214:215], v7 offset:56576
    s_waitcnt lgkmcnt(4)
    v_mfma_f32_32x32x16_bf16 v[128:143], v[120:123], v[192:195], v[128:143]
    v_mfma_f32_32x32x16_bf16 v[144:159], v[120:123], v[196:199], v[144:159]
    s_waitcnt lgkmcnt(0)
    v_mfma_f32_32x32x16_bf16 v[128:143], v[124:127], v[208:211], v[128:143]
    v_mfma_f32_32x32x16_bf16 v[144:159], v[124:127], v[212:215], v[144:159]
    s_nop 15
    s_nop 3
    v_add_u32 v13, 384, v3
    v_lshlrev_b32 v13, 12, v13
    v_sub_u32 v14, v5, v3
    v_lshl_add_u32 v13, v14, 1, v13
    v_lshl_add_u32 v13, v4, 3, v13
    v_add_u32 v13, 6029312, v13
    v_cvt_pk_bf16_f32 v128, v128, v129
    v_cvt_pk_bf16_f32 v129, v130, v131
    buffer_store_dwordx2 v[128:129], v13, s[16:19], 0 offen offset:0
    v_cvt_pk_bf16_f32 v132, v132, v133
    v_cvt_pk_bf16_f32 v133, v134, v135
    buffer_store_dwordx2 v[132:133], v13, s[16:19], 0 offen offset:16
    v_cvt_pk_bf16_f32 v136, v136, v137
    v_cvt_pk_bf16_f32 v137, v138, v139
    buffer_store_dwordx2 v[136:137], v13, s[16:19], 0 offen offset:32
    v_cvt_pk_bf16_f32 v140, v140, v141
    v_cvt_pk_bf16_f32 v141, v142, v143
    buffer_store_dwordx2 v[140:141], v13, s[16:19], 0 offen offset:48
    v_add_u32 v13, 416, v3
    v_lshlrev_b32 v13, 12, v13
    v_sub_u32 v14, v5, v3
    v_lshl_add_u32 v13, v14, 1, v13
    v_lshl_add_u32 v13, v4, 3, v13
    v_add_u32 v13, 6029312, v13
    v_cvt_pk_bf16_f32 v144, v144, v145
    v_cvt_pk_bf16_f32 v145, v146, v147
    buffer_store_dwordx2 v[144:145], v13, s[16:19], 0 offen offset:0
    v_cvt_pk_bf16_f32 v148, v148, v149
    v_cvt_pk_bf16_f32 v149, v150, v151
    buffer_store_dwordx2 v[148:149], v13, s[16:19], 0 offen offset:16
    v_cvt_pk_bf16_f32 v152, v152, v153
    v_cvt_pk_bf16_f32 v153, v154, v155
    buffer_store_dwordx2 v[152:153], v13, s[16:19], 0 offen offset:32
    v_cvt_pk_bf16_f32 v156, v156, v157
    v_cvt_pk_bf16_f32 v157, v158, v159
    buffer_store_dwordx2 v[156:157], v13, s[16:19], 0 offen offset:48
    s_endpgm
K1_end:
    s_endpgm
.globl k2_kernel
.p2align 8
.type k2_kernel,@function
k2_kernel:
    s_cmp_ge_u32 s2, 256
    s_cbranch_scc1 K2_end
    s_load_dwordx2 s[46:47], s[0:1], 88
    v_lshrrev_b32 v1, 6, v0
    v_and_b32 v2, 63, v0
    v_and_b32 v3, 31, v0
    v_bfe_u32 v4, v0, 5, 1
    s_nop 0
    v_readfirstlane_b32 s4, v1
    s_waitcnt lgkmcnt(0)
    s_mov_b32 s16, s46
    s_and_b32 s17, s47, 0xffff
    s_mov_b32 s18, 11665408
    s_mov_b32 s19, 0x00020000
    s_and_b32 s5, s4, 3
    s_lshr_b32 s6, s4, 2
    s_lshl_b32 s7, s2, 2
    s_add_u32 s7, s7, s5
    s_mov_b32 s3, 0x3e8b97f6
    v_cmp_le_u32 s[30:31], 32, v2
    v_lshlrev_b32 v5, 4, v2
    v_lshlrev_b32 v6, 4, v0
    s_lshl_b32 s8, s7, 11
    buffer_load_dwordx4 v[8:11], v5, s[16:19], s8 offen
    buffer_load_dwordx4 v[12:15], v5, s[16:19], s8 offen offset:1024
    s_mov_b32 s9, 2097152
    buffer_load_dwordx4 v[212:215], v6, s[16:19], s9 offen
    s_mov_b32 s9, 2228224
    buffer_load_dwordx4 v[216:219], v6, s[16:19], s9 offen
    s_mov_b32 s9, 2162688
    buffer_load_dwordx4 v[220:223], v6, s[16:19], s9 offen
    s_mov_b32 s9, 2293760
    buffer_load_dwordx4 v[224:227], v6, s[16:19], s9 offen
    s_waitcnt vmcnt(0)
    v_cndmask_b32 v14, v14, 0, s[30:31]
    v_cndmask_b32 v15, v15, 0, s[30:31]
    ds_write_b128 v6, v[212:215] offset:0
    ds_write_b128 v6, v[216:219] offset:8192
    ds_write_b128 v6, v[220:223] offset:16384
    ds_write_b128 v6, v[224:227] offset:24576
    s_mov_b32 s9, 2105344
    buffer_load_dwordx4 v[212:215], v6, s[16:19], s9 offen
    s_mov_b32 s9, 2236416
    buffer_load_dwordx4 v[216:219], v6, s[16:19], s9 offen
    s_mov_b32 s9, 2170880
    buffer_load_dwordx4 v[220:223], v6, s[16:19], s9 offen
    s_mov_b32 s9, 2301952
    buffer_load_dwordx4 v[224:227], v6, s[16:19], s9 offen
    v_mov_b32 v192, 0
    v_mov_b32 v193, 0
    v_mov_b32 v194, 0
    v_mov_b32 v195, 0
    v_mov_b32 v196, 0
    v_mov_b32 v197, 0
    v_mov_b32 v198, 0
    v_mov_b32 v199, 0
    v_mov_b32 v200, 0
    v_mov_b32 v201, 0
    v_mov_b32 v202, 0
    v_mov_b32 v203, 0
    v_mov_b32 v204, 0
    v_mov_b32 v205, 0
    v_mov_b32 v206, 0
    v_mov_b32 v207, 0
    v_mov_b32 v236, 0
    v_mov_b32 v237, 0
    v_mov_b32 v238, 0
    v_mov_b32 v239, 0
    v_mov_b32 v240, 0
    v_mov_b32 v241, 0
    v_mov_b32 v242, 0
    v_mov_b32 v243, 0
    v_mov_b32 v244, 0
    v_mov_b32 v245, 0
    v_mov_b32 v246, 0
    v_mov_b32 v247, 0
    v_mov_b32 v248, 0
    v_mov_b32 v249, 0
    v_mov_b32 v250, 0
    v_mov_b32 v251, 0
    s_lshl_b32 s10, s6, 14
    v_add_u32 v7, s10, v5
    v_add_u32 v16, 0x10000, v7
    v_add_u32 v17, 0x10000, v6
    s_waitcnt vmcnt(0)
    ds_write_b128 v6, v[212:215] offset:32768
    ds_write_b128 v6, v[216:219] offset:40960
    ds_write_b128 v6, v[220:223] offset:49152
    ds_write_b128 v6, v[224:227] offset:57344
    s_waitcnt lgkmcnt(0)
    s_barrier
    ds_read_b128 v[160:163], v7 offset:0
    ds_read_b128 v[164:167], v7 offset:1024
    ds_read_b128 v[168:171], v7 offset:2048
    ds_read_b128 v[172:175], v7 offset:3072
    ds_read_b128 v[176:179], v7 offset:4096
    ds_read_b128 v[180:183], v7 offset:5120
    ds_read_b128 v[184:187], v7 offset:6144
    ds_read_b128 v[188:191], v7 offset:7168
    s_waitcnt lgkmcnt(0)
    v_mfma_f32_32x32x16_bf16 v[32:47], v[160:163], v[8:11], v[236:251]
    v_mfma_f32_32x32x16_bf16 v[32:47], v[164:167], v[12:15], v[32:47]
    v_mfma_f32_32x32x16_bf16 v[48:63], v[168:171], v[8:11], v[236:251]
    v_mfma_f32_32x32x16_bf16 v[48:63], v[172:175], v[12:15], v[48:63]
    v_mfma_f32_32x32x16_bf16 v[64:79], v[176:179], v[8:11], v[236:251]
    v_mfma_f32_32x32x16_bf16 v[64:79], v[180:183], v[12:15], v[64:79]
    v_mfma_f32_32x32x16_bf16 v[80:95], v[184:187], v[8:11], v[236:251]
    v_mfma_f32_32x32x16_bf16 v[80:95], v[188:191], v[12:15], v[80:95]
    s_mov_b32 s9, 2113536
    buffer_load_dwordx4 v[212:215], v6, s[16:19], s9 offen
    s_mov_b32 s9, 2244608
    buffer_load_dwordx4 v[216:219], v6, s[16:19], s9 offen
    s_mov_b32 s9, 2179072
    buffer_load_dwordx4 v[220:223], v6, s[16:19], s9 offen
    s_mov_b32 s9, 2310144
    buffer_load_dwordx4 v[224:227], v6, s[16:19], s9 offen
    ds_read_b128 v[160:163], v7 offset:32768
    ds_read_b128 v[164:167], v7 offset:33792
    ds_read_b128 v[168:171], v7 offset:34816
    ds_read_b128 v[172:175], v7 offset:35840
    ds_read_b128 v[176:179], v7 offset:36864
    ds_read_b128 v[180:183], v7 offset:37888
    ds_read_b128 v[184:187], v7 offset:38912
    ds_read_b128 v[188:191], v7 offset:39936
    s_nop 7
    v_max3_f32 v209, v32, v33, v34
    v_max3_f32 v209, v209, v35, v36
    v_max3_f32 v209, v209, v37, v38
    v_max3_f32 v209, v209, v39, v40
    v_max3_f32 v209, v209, v41, v42
    v_max3_f32 v209, v209, v43, v44
    v_max3_f32 v209, v209, v45, v46
    v_max3_f32 v209, v209, v47, v48
    v_max3_f32 v209, v209, v49, v50
    v_max3_f32 v209, v209, v51, v52
    v_max3_f32 v209, v209, v53, v54
    v_max3_f32 v209, v209, v55, v56
    v_max3_f32 v209, v209, v57, v58
    v_max3_f32 v209, v209, v59, v60
    v_max3_f32 v209, v209, v61, v62
    v_max3_f32 v209, v209, v63, v64
    v_max3_f32 v209, v209, v65, v66
    v_max3_f32 v209, v209, v67, v68
    v_max3_f32 v209, v209, v69, v70
    v_max3_f32 v209, v209, v71, v72
    v_max3_f32 v209, v209, v73, v74
    v_max3_f32 v209, v209, v75, v76
    v_max3_f32 v209, v209, v77, v78
    v_max3_f32 v209, v209, v79, v80
    v_max3_f32 v209, v209, v81, v82
    v_max3_f32 v209, v209, v83, v84
    v_max3_f32 v209, v209, v85, v86
    v_max3_f32 v209, v209, v87, v88
    v_max3_f32 v209, v209, v89, v90
    v_max3_f32 v209, v209, v91, v92
    v_max3_f32 v209, v209, v93, v94
    v_max_f32 v209, v209, v95
    v_mov_b32 v210, v209
    s_nop 1
    v_permlane32_swap_b32 v209, v210
    s_nop 1
    v_max_f32 v209, v209, v210
    v_sub_f32 v210, 0, v209
    v_exp_f32 v210, v210
    v_sub_f32 v32, v32, v209
    v_sub_f32 v33, v33, v209
    v_sub_f32 v34, v34, v209
    v_sub_f32 v35, v35, v209
    v_sub_f32 v36, v36, v209
    v_sub_f32 v37, v37, v209
    v_sub_f32 v38, v38, v209
    v_sub_f32 v39, v39, v209
    v_sub_f32 v40, v40, v209
    v_sub_f32 v41, v41, v209
    v_sub_f32 v42, v42, v209
    v_sub_f32 v43, v43, v209
    v_sub_f32 v44, v44, v209
    v_sub_f32 v45, v45, v209
    v_sub_f32 v46, v46, v209
    v_sub_f32 v47, v47, v209
    v_sub_f32 v48, v48, v209
    v_sub_f32 v49, v49, v209
    v_sub_f32 v50, v50, v209
    v_sub_f32 v51, v51, v209
    v_sub_f32 v52, v52, v209
    v_sub_f32 v53, v53, v209
    v_sub_f32 v54, v54, v209
    v_sub_f32 v55, v55, v209
    v_sub_f32 v56, v56, v209
    v_sub_f32 v57, v57, v209
    v_sub_f32 v58, v58, v209
    v_sub_f32 v59, v59, v209
    v_sub_f32 v60, v60, v209
    v_sub_f32 v61, v61, v209
    v_sub_f32 v62, v62, v209
    v_sub_f32 v63, v63, v209
    v_sub_f32 v64, v64, v209
    v_sub_f32 v65, v65, v209
    v_sub_f32 v66, v66, v209
    v_sub_f32 v67, v67, v209
    v_sub_f32 v68, v68, v209
    v_sub_f32 v69, v69, v209
    v_sub_f32 v70, v70, v209
    v_sub_f32 v71, v71, v209
    v_sub_f32 v72, v72, v209
    v_sub_f32 v73, v73, v209
    v_sub_f32 v74, v74, v209
    v_sub_f32 v75, v75, v209
    v_sub_f32 v76, v76, v209
    v_sub_f32 v77, v77, v209
    v_sub_f32 v78, v78, v209
    v_sub_f32 v79, v79, v209
    v_sub_f32 v80, v80, v209
    v_sub_f32 v81, v81, v209
    v_sub_f32 v82, v82, v209
    v_sub_f32 v83, v83, v209
    v_sub_f32 v84, v84, v209
    v_sub_f32 v85, v85, v209
    v_sub_f32 v86, v86, v209
    v_sub_f32 v87, v87, v209
    v_sub_f32 v88, v88, v209
    v_sub_f32 v89, v89, v209
    v_sub_f32 v90, v90, v209
    v_sub_f32 v91, v91, v209
    v_sub_f32 v92, v92, v209
    v_sub_f32 v93, v93, v209
    v_sub_f32 v94, v94, v209
    v_sub_f32 v95, v95, v209
    v_mul_f32 v192, v192, v210
    v_mul_f32 v193, v193, v210
    v_mul_f32 v194, v194, v210
    v_mul_f32 v195, v195, v210
    v_mul_f32 v196, v196, v210
    v_mul_f32 v197, v197, v210
    v_mul_f32 v198, v198, v210
    v_mul_f32 v199, v199, v210
    v_mul_f32 v200, v200, v210
    v_mul_f32 v201, v201, v210
    v_mul_f32 v202, v202, v210
    v_mul_f32 v203, v203, v210
    v_mul_f32 v204, v204, v210
    v_mul_f32 v205, v205, v210
    v_mul_f32 v206, v206, v210
    v_mul_f32 v207, v207, v210
    v_sub_f32 v236, v236, v209
    v_sub_f32 v237, v237, v209
    v_sub_f32 v238, v238, v209
    v_sub_f32 v239, v239, v209
    v_sub_f32 v240, v240, v209
    v_sub_f32 v241, v241, v209
    v_sub_f32 v242, v242, v209
    v_sub_f32 v243, v243, v209
    v_sub_f32 v244, v244, v209
    v_sub_f32 v245, v245, v209
    v_sub_f32 v246, v246, v209
    v_sub_f32 v247, v247, v209
    v_sub_f32 v248, v248, v209
    v_sub_f32 v249, v249, v209
    v_sub_f32 v250, v250, v209
    v_sub_f32 v251, v251, v209
K2_back0:
    s_waitcnt lgkmcnt(0)
    ds_read_b128 v[228:231], v7 offset:8192
    ds_read_b128 v[232:235], v7 offset:9216
    v_exp_f32 v32, v32
    v_mfma_f32_32x32x16_bf16 v[96:111], v[160:163], v[8:11], v[236:251]
    v_exp_f32 v33, v33
    v_exp_f32 v34, v34
    v_exp_f32 v35, v35
    v_exp_f32 v36, v36
    v_exp_f32 v37, v37
    v_exp_f32 v38, v38
    v_exp_f32 v39, v39
    v_exp_f32 v40, v40
    v_mfma_f32_32x32x16_bf16 v[96:111], v[164:167], v[12:15], v[96:111]
    v_exp_f32 v41, v41
    v_exp_f32 v42, v42
    v_exp_f32 v43, v43
    v_exp_f32 v44, v44
    v_exp_f32 v45, v45
    v_exp_f32 v46, v46
    v_exp_f32 v47, v47
    v_cvt_pk_bf16_f32 v32, v32, v33
    v_cvt_pk_bf16_f32 v33, v34, v35
    v_cvt_pk_bf16_f32 v34, v36, v37
    v_cvt_pk_bf16_f32 v35, v38, v39
    v_cvt_pk_bf16_f32 v36, v40, v41
    v_cvt_pk_bf16_f32 v37, v42, v43
    v_cvt_pk_bf16_f32 v38, v44, v45
    v_cvt_pk_bf16_f32 v39, v46, v47
    s_waitcnt lgkmcnt(0)
    ds_read_b128 v[18:21], v7 offset:10240
    ds_read_b128 v[22:25], v7 offset:11264
    v_mfma_f32_32x32x16_bf16 v[192:207], v[228:231], v[32:35], v[192:207]
    v_mfma_f32_32x32x16_bf16 v[192:207], v[232:235], v[36:39], v[192:207]
    v_exp_f32 v48, v48
    v_mfma_f32_32x32x16_bf16 v[112:127], v[168:171], v[8:11], v[236:251]
    v_exp_f32 v49, v49
    v_exp_f32 v50, v50
    v_exp_f32 v51, v51
    v_exp_f32 v52, v52
    v_exp_f32 v53, v53
    v_exp_f32 v54, v54
    v_exp_f32 v55, v55
    v_exp_f32 v56, v56
    v_mfma_f32_32x32x16_bf16 v[112:127], v[172:175], v[12:15], v[112:127]
    v_exp_f32 v57, v57
    v_exp_f32 v58, v58
    v_exp_f32 v59, v59
    v_exp_f32 v60, v60
    v_exp_f32 v61, v61
    v_exp_f32 v62, v62
    v_exp_f32 v63, v63
    v_cvt_pk_bf16_f32 v48, v48, v49
    v_cvt_pk_bf16_f32 v49, v50, v51
    v_cvt_pk_bf16_f32 v50, v52, v53
    v_cvt_pk_bf16_f32 v51, v54, v55
    v_cvt_pk_bf16_f32 v52, v56, v57
    v_cvt_pk_bf16_f32 v53, v58, v59
    v_cvt_pk_bf16_f32 v54, v60, v61
    v_cvt_pk_bf16_f32 v55, v62, v63
    s_waitcnt lgkmcnt(0)
    ds_read_b128 v[228:231], v7 offset:12288
    ds_read_b128 v[232:235], v7 offset:13312
    v_mfma_f32_32x32x16_bf16 v[192:207], v[18:21], v[48:51], v[192:207]
    v_mfma_f32_32x32x16_bf16 v[192:207], v[22:25], v[52:55], v[192:207]
    v_exp_f32 v64, v64
    v_mfma_f32_32x32x16_bf16 v[128:143], v[176:179], v[8:11], v[236:251]
    v_exp_f32 v65, v65
    v_exp_f32 v66, v66
    v_exp_f32 v67, v67
    v_exp_f32 v68, v68
    v_exp_f32 v69, v69
    v_exp_f32 v70, v70
    v_exp_f32 v71, v71
    v_exp_f32 v72, v72
    v_mfma_f32_32x32x16_bf16 v[128:143], v[180:183], v[12:15], v[128:143]
    v_exp_f32 v73, v73
    v_exp_f32 v74, v74
    v_exp_f32 v75, v75
    v_exp_f32 v76, v76
    v_exp_f32 v77, v77
    v_exp_f32 v78, v78
    v_exp_f32 v79, v79
    v_cvt_pk_bf16_f32 v64, v64, v65
    v_cvt_pk_bf16_f32 v65, v66, v67
    v_cvt_pk_bf16_f32 v66, v68, v69
    v_cvt_pk_bf16_f32 v67, v70, v71
    v_cvt_pk_bf16_f32 v68, v72, v73
    v_cvt_pk_bf16_f32 v69, v74, v75
    v_cvt_pk_bf16_f32 v70, v76, v77
    v_cvt_pk_bf16_f32 v71, v78, v79
    s_waitcnt lgkmcnt(0)
    ds_read_b128 v[18:21], v7 offset:14336
    ds_read_b128 v[22:25], v7 offset:15360
    v_mfma_f32_32x32x16_bf16 v[192:207], v[228:231], v[64:67], v[192:207]
    v_mfma_f32_32x32x16_bf16 v[192:207], v[232:235], v[68:71], v[192:207]
    v_exp_f32 v80, v80
    v_mfma_f32_32x32x16_bf16 v[144:159], v[184:187], v[8:11], v[236:251]
    v_exp_f32 v81, v81
    v_exp_f32 v82, v82
    v_exp_f32 v83, v83
    v_exp_f32 v84, v84
    v_exp_f32 v85, v85
    v_exp_f32 v86, v86
    v_exp_f32 v87, v87
    v_exp_f32 v88, v88
    v_mfma_f32_32x32x16_bf16 v[144:159], v[188:191], v[12:15], v[144:159]
    v_exp_f32 v89, v89
    v_exp_f32 v90, v90
    v_exp_f32 v91, v91
    v_exp_f32 v92, v92
    v_exp_f32 v93, v93
    v_exp_f32 v94, v94
    v_exp_f32 v95, v95
    v_cvt_pk_bf16_f32 v80, v80, v81
    v_cvt_pk_bf16_f32 v81, v82, v83
    v_cvt_pk_bf16_f32 v82, v84, v85
    v_cvt_pk_bf16_f32 v83, v86, v87
    v_cvt_pk_bf16_f32 v84, v88, v89
    v_cvt_pk_bf16_f32 v85, v90, v91
    v_cvt_pk_bf16_f32 v86, v92, v93
    v_cvt_pk_bf16_f32 v87, v94, v95
    s_waitcnt lgkmcnt(0)
    v_mfma_f32_32x32x16_bf16 v[192:207], v[18:21], v[80:83], v[192:207]
    v_mfma_f32_32x32x16_bf16 v[192:207], v[22:25], v[84:87], v[192:207]
    s_waitcnt vmcnt(0)
    ds_write_b128 v17, v[212:215] offset:0
    ds_write_b128 v17, v[216:219] offset:8192
    ds_write_b128 v17, v[220:223] offset:16384
    ds_write_b128 v17, v[224:227] offset:24576
    s_waitcnt lgkmcnt(0)
    s_barrier
    s_mov_b32 s9, 2121728
    buffer_load_dwordx4 v[212:215], v6, s[16:19], s9 offen
    s_mov_b32 s9, 2252800
    buffer_load_dwordx4 v[216:219], v6, s[16:19], s9 offen
    s_mov_b32 s9, 2187264
    buffer_load_dwordx4 v[220:223], v6, s[16:19], s9 offen
    s_mov_b32 s9, 2318336
    buffer_load_dwordx4 v[224:227], v6, s[16:19], s9 offen
    ds_read_b128 v[160:163], v16 offset:0
    ds_read_b128 v[164:167], v16 offset:1024
    ds_read_b128 v[168:171], v16 offset:2048
    ds_read_b128 v[172:175], v16 offset:3072
    ds_read_b128 v[176:179], v16 offset:4096
    ds_read_b128 v[180:183], v16 offset:5120
    ds_read_b128 v[184:187], v16 offset:6144
    ds_read_b128 v[188:191], v16 offset:7168
    s_nop 7
    v_max3_f32 v209, v96, v97, v98
    v_max3_f32 v209, v209, v99, v100
    v_max3_f32 v209, v209, v101, v102
    v_max3_f32 v209, v209, v103, v104
    v_max3_f32 v209, v209, v105, v106
    v_max3_f32 v209, v209, v107, v108
    v_max3_f32 v209, v209, v109, v110
    v_max3_f32 v209, v209, v111, v112
    v_max3_f32 v209, v209, v113, v114
    v_max3_f32 v209, v209, v115, v116
    v_max3_f32 v209, v209, v117, v118
    v_max3_f32 v209, v209, v119, v120
    v_max3_f32 v209, v209, v121, v122
    v_max3_f32 v209, v209, v123, v124
    v_max3_f32 v209, v209, v125, v126
    v_max3_f32 v209, v209, v127, v128
    v_max3_f32 v209, v209, v129, v130
    v_max3_f32 v209, v209, v131, v132
    v_max3_f32 v209, v209, v133, v134
    v_max3_f32 v209, v209, v135, v136
    v_max3_f32 v209, v209, v137, v138
    v_max3_f32 v209, v209, v139, v140
    v_max3_f32 v209, v209, v141, v142
    v_max3_f32 v209, v209, v143, v144
    v_max3_f32 v209, v209, v145, v146
    v_max3_f32 v209, v209, v147, v148
    v_max3_f32 v209, v209, v149, v150
    v_max3_f32 v209, v209, v151, v152
    v_max3_f32 v209, v209, v153, v154
    v_max3_f32 v209, v209, v155, v156
    v_max3_f32 v209, v209, v157, v158
    v_max_f32 v209, v209, v159
    v_mov_b32 v210, v209
    s_nop 1
    v_permlane32_swap_b32 v209, v210
    s_nop 1
    v_max_f32 v209, v209, v210
    v_cmp_lt_f32 vcc, 8.0, v209
    s_cbranch_vccz K2_back1
    v_max_f32 v209, 0, v209
    v_sub_f32 v210, 0, v209
    v_exp_f32 v210, v210
    v_sub_f32 v96, v96, v209
    v_sub_f32 v97, v97, v209
    v_sub_f32 v98, v98, v209
    v_sub_f32 v99, v99, v209
    v_sub_f32 v100, v100, v209
    v_sub_f32 v101, v101, v209
    v_sub_f32 v102, v102, v209
    v_sub_f32 v103, v103, v209
    v_sub_f32 v104, v104, v209
    v_sub_f32 v105, v105, v209
    v_sub_f32 v106, v106, v209
    v_sub_f32 v107, v107, v209
    v_sub_f32 v108, v108, v209
    v_sub_f32 v109, v109, v209
    v_sub_f32 v110, v110, v209
    v_sub_f32 v111, v111, v209
    v_sub_f32 v112, v112, v209
    v_sub_f32 v113, v113, v209
    v_sub_f32 v114, v114, v209
    v_sub_f32 v115, v115, v209
    v_sub_f32 v116, v116, v209
    v_sub_f32 v117, v117, v209
    v_sub_f32 v118, v118, v209
    v_sub_f32 v119, v119, v209
    v_sub_f32 v120, v120, v209
    v_sub_f32 v121, v121, v209
    v_sub_f32 v122, v122, v209
    v_sub_f32 v123, v123, v209
    v_sub_f32 v124, v124, v209
    v_sub_f32 v125, v125, v209
    v_sub_f32 v126, v126, v209
    v_sub_f32 v127, v127, v209
    v_sub_f32 v128, v128, v209
    v_sub_f32 v129, v129, v209
    v_sub_f32 v130, v130, v209
    v_sub_f32 v131, v131, v209
    v_sub_f32 v132, v132, v209
    v_sub_f32 v133, v133, v209
    v_sub_f32 v134, v134, v209
    v_sub_f32 v135, v135, v209
    v_sub_f32 v136, v136, v209
    v_sub_f32 v137, v137, v209
    v_sub_f32 v138, v138, v209
    v_sub_f32 v139, v139, v209
    v_sub_f32 v140, v140, v209
    v_sub_f32 v141, v141, v209
    v_sub_f32 v142, v142, v209
    v_sub_f32 v143, v143, v209
    v_sub_f32 v144, v144, v209
    v_sub_f32 v145, v145, v209
    v_sub_f32 v146, v146, v209
    v_sub_f32 v147, v147, v209
    v_sub_f32 v148, v148, v209
    v_sub_f32 v149, v149, v209
    v_sub_f32 v150, v150, v209
    v_sub_f32 v151, v151, v209
    v_sub_f32 v152, v152, v209
    v_sub_f32 v153, v153, v209
    v_sub_f32 v154, v154, v209
    v_sub_f32 v155, v155, v209
    v_sub_f32 v156, v156, v209
    v_sub_f32 v157, v157, v209
    v_sub_f32 v158, v158, v209
    v_sub_f32 v159, v159, v209
    v_mul_f32 v192, v192, v210
    v_mul_f32 v193, v193, v210
    v_mul_f32 v194, v194, v210
    v_mul_f32 v195, v195, v210
    v_mul_f32 v196, v196, v210
    v_mul_f32 v197, v197, v210
    v_mul_f32 v198, v198, v210
    v_mul_f32 v199, v199, v210
    v_mul_f32 v200, v200, v210
    v_mul_f32 v201, v201, v210
    v_mul_f32 v202, v202, v210
    v_mul_f32 v203, v203, v210
    v_mul_f32 v204, v204, v210
    v_mul_f32 v205, v205, v210
    v_mul_f32 v206, v206, v210
    v_mul_f32 v207, v207, v210
    v_sub_f32 v236, v236, v209
    v_sub_f32 v237, v237, v209
    v_sub_f32 v238, v238, v209
    v_sub_f32 v239, v239, v209
    v_sub_f32 v240, v240, v209
    v_sub_f32 v241, v241, v209
    v_sub_f32 v242, v242, v209
    v_sub_f32 v243, v243, v209
    v_sub_f32 v244, v244, v209
    v_sub_f32 v245, v245, v209
    v_sub_f32 v246, v246, v209
    v_sub_f32 v247, v247, v209
    v_sub_f32 v248, v248, v209
    v_sub_f32 v249, v249, v209
    v_sub_f32 v250, v250, v209
    v_sub_f32 v251, v251, v209
K2_back1:
    s_waitcnt lgkmcnt(0)
    ds_read_b128 v[228:231], v7 offset:40960
    ds_read_b128 v[232:235], v7 offset:41984
    v_exp_f32 v96, v96
    v_mfma_f32_32x32x16_bf16 v[32:47], v[160:163], v[8:11], v[236:251]
    v_exp_f32 v97, v97
    v_exp_f32 v98, v98
    v_exp_f32 v99, v99
    v_exp_f32 v100, v100
    v_exp_f32 v101, v101
    v_exp_f32 v102, v102
    v_exp_f32 v103, v103
    v_exp_f32 v104, v104
    v_mfma_f32_32x32x16_bf16 v[32:47], v[164:167], v[12:15], v[32:47]
    v_exp_f32 v105, v105
    v_exp_f32 v106, v106
    v_exp_f32 v107, v107
    v_exp_f32 v108, v108
    v_exp_f32 v109, v109
    v_exp_f32 v110, v110
    v_exp_f32 v111, v111
    v_cvt_pk_bf16_f32 v96, v96, v97
    v_cvt_pk_bf16_f32 v97, v98, v99
    v_cvt_pk_bf16_f32 v98, v100, v101
    v_cvt_pk_bf16_f32 v99, v102, v103
    v_cvt_pk_bf16_f32 v100, v104, v105
    v_cvt_pk_bf16_f32 v101, v106, v107
    v_cvt_pk_bf16_f32 v102, v108, v109
    v_cvt_pk_bf16_f32 v103, v110, v111
    s_waitcnt lgkmcnt(0)
    ds_read_b128 v[18:21], v7 offset:43008
    ds_read_b128 v[22:25], v7 offset:44032
    v_mfma_f32_32x32x16_bf16 v[192:207], v[228:231], v[96:99], v[192:207]
    v_mfma_f32_32x32x16_bf16 v[192:207], v[232:235], v[100:103], v[192:207]
    v_exp_f32 v112, v112
    v_mfma_f32_32x32x16_bf16 v[48:63], v[168:171], v[8:11], v[236:251]
    v_exp_f32 v113, v113
    v_exp_f32 v114, v114
    v_exp_f32 v115, v115
    v_exp_f32 v116, v116
    v_exp_f32 v117, v117
    v_exp_f32 v118, v118
    v_exp_f32 v119, v119
    v_exp_f32 v120, v120
    v_mfma_f32_32x32x16_bf16 v[48:63], v[172:175], v[12:15], v[48:63]
    v_exp_f32 v121, v121
    v_exp_f32 v122, v122
    v_exp_f32 v123, v123
    v_exp_f32 v124, v124
    v_exp_f32 v125, v125
    v_exp_f32 v126, v126
    v_exp_f32 v127, v127
    v_cvt_pk_bf16_f32 v112, v112, v113
    v_cvt_pk_bf16_f32 v113, v114, v115
    v_cvt_pk_bf16_f32 v114, v116, v117
    v_cvt_pk_bf16_f32 v115, v118, v119
    v_cvt_pk_bf16_f32 v116, v120, v121
    v_cvt_pk_bf16_f32 v117, v122, v123
    v_cvt_pk_bf16_f32 v118, v124, v125
    v_cvt_pk_bf16_f32 v119, v126, v127
    s_waitcnt lgkmcnt(0)
    ds_read_b128 v[228:231], v7 offset:45056
    ds_read_b128 v[232:235], v7 offset:46080
    v_mfma_f32_32x32x16_bf16 v[192:207], v[18:21], v[112:115], v[192:207]
    v_mfma_f32_32x32x16_bf16 v[192:207], v[22:25], v[116:119], v[192:207]
    v_exp_f32 v128, v128
    v_mfma_f32_32x32x16_bf16 v[64:79], v[176:179], v[8:11], v[236:251]
    v_exp_f32 v129, v129
    v_exp_f32 v130, v130
    v_exp_f32 v131, v131
    v_exp_f32 v132, v132
    v_exp_f32 v133, v133
    v_exp_f32 v134, v134
    v_exp_f32 v135, v135
    v_exp_f32 v136, v136
    v_mfma_f32_32x32x16_bf16 v[64:79], v[180:183], v[12:15], v[64:79]
    v_exp_f32 v137, v137
    v_exp_f32 v138, v138
    v_exp_f32 v139, v139
    v_exp_f32 v140, v140
    v_exp_f32 v141, v141
    v_exp_f32 v142, v142
    v_exp_f32 v143, v143
    v_cvt_pk_bf16_f32 v128, v128, v129
    v_cvt_pk_bf16_f32 v129, v130, v131
    v_cvt_pk_bf16_f32 v130, v132, v133
    v_cvt_pk_bf16_f32 v131, v134, v135
    v_cvt_pk_bf16_f32 v132, v136, v137
    v_cvt_pk_bf16_f32 v133, v138, v139
    v_cvt_pk_bf16_f32 v134, v140, v141
    v_cvt_pk_bf16_f32 v135, v142, v143
    s_waitcnt lgkmcnt(0)
    ds_read_b128 v[18:21], v7 offset:47104
    ds_read_b128 v[22:25], v7 offset:48128
    v_mfma_f32_32x32x16_bf16 v[192:207], v[228:231], v[128:131], v[192:207]
    v_mfma_f32_32x32x16_bf16 v[192:207], v[232:235], v[132:135], v[192:207]
    v_exp_f32 v144, v144
    v_mfma_f32_32x32x16_bf16 v[80:95], v[184:187], v[8:11], v[236:251]
    v_exp_f32 v145, v145
    v_exp_f32 v146, v146
    v_exp_f32 v147, v147
    v_exp_f32 v148, v148
    v_exp_f32 v149, v149
    v_exp_f32 v150, v150
    v_exp_f32 v151, v151
    v_exp_f32 v152, v152
    v_mfma_f32_32x32x16_bf16 v[80:95], v[188:191], v[12:15], v[80:95]
    v_exp_f32 v153, v153
    v_exp_f32 v154, v154
    v_exp_f32 v155, v155
    v_exp_f32 v156, v156
    v_exp_f32 v157, v157
    v_exp_f32 v158, v158
    v_exp_f32 v159, v159
    v_cvt_pk_bf16_f32 v144, v144, v145
    v_cvt_pk_bf16_f32 v145, v146, v147
    v_cvt_pk_bf16_f32 v146, v148, v149
    v_cvt_pk_bf16_f32 v147, v150, v151
    v_cvt_pk_bf16_f32 v148, v152, v153
    v_cvt_pk_bf16_f32 v149, v154, v155
    v_cvt_pk_bf16_f32 v150, v156, v157
    v_cvt_pk_bf16_f32 v151, v158, v159
    s_waitcnt lgkmcnt(0)
    v_mfma_f32_32x32x16_bf16 v[192:207], v[18:21], v[144:147], v[192:207]
    v_mfma_f32_32x32x16_bf16 v[192:207], v[22:25], v[148:151], v[192:207]
    s_waitcnt vmcnt(0)
    ds_write_b128 v6, v[212:215] offset:0
    ds_write_b128 v6, v[216:219] offset:8192
    ds_write_b128 v6, v[220:223] offset:16384
    ds_write_b128 v6, v[224:227] offset:24576
    s_waitcnt lgkmcnt(0)
    s_barrier
    s_mov_b32 s9, 2129920
    buffer_load_dwordx4 v[212:215], v6, s[16:19], s9 offen
    s_mov_b32 s9, 2260992
    buffer_load_dwordx4 v[216:219], v6, s[16:19], s9 offen
    s_mov_b32 s9, 2195456
    buffer_load_dwordx4 v[220:223], v6, s[16:19], s9 offen
    s_mov_b32 s9, 2326528
    buffer_load_dwordx4 v[224:227], v6, s[16:19], s9 offen
    ds_read_b128 v[160:163], v7 offset:0
    ds_read_b128 v[164:167], v7 offset:1024
    ds_read_b128 v[168:171], v7 offset:2048
    ds_read_b128 v[172:175], v7 offset:3072
    ds_read_b128 v[176:179], v7 offset:4096
    ds_read_b128 v[180:183], v7 offset:5120
    ds_read_b128 v[184:187], v7 offset:6144
    ds_read_b128 v[188:191], v7 offset:7168
    s_nop 7
    v_max3_f32 v209, v32, v33, v34
    v_max3_f32 v209, v209, v35, v36
    v_max3_f32 v209, v209, v37, v38
    v_max3_f32 v209, v209, v39, v40
    v_max3_f32 v209, v209, v41, v42
    v_max3_f32 v209, v209, v43, v44
    v_max3_f32 v209, v209, v45, v46
    v_max3_f32 v209, v209, v47, v48
    v_max3_f32 v209, v209, v49, v50
    v_max3_f32 v209, v209, v51, v52
    v_max3_f32 v209, v209, v53, v54
    v_max3_f32 v209, v209, v55, v56
    v_max3_f32 v209, v209, v57, v58
    v_max3_f32 v209, v209, v59, v60
    v_max3_f32 v209, v209, v61, v62
    v_max3_f32 v209, v209, v63, v64
    v_max3_f32 v209, v209, v65, v66
    v_max3_f32 v209, v209, v67, v68
    v_max3_f32 v209, v209, v69, v70
    v_max3_f32 v209, v209, v71, v72
    v_max3_f32 v209, v209, v73, v74
    v_max3_f32 v209, v209, v75, v76
    v_max3_f32 v209, v209, v77, v78
    v_max3_f32 v209, v209, v79, v80
    v_max3_f32 v209, v209, v81, v82
    v_max3_f32 v209, v209, v83, v84
    v_max3_f32 v209, v209, v85, v86
    v_max3_f32 v209, v209, v87, v88
    v_max3_f32 v209, v209, v89, v90
    v_max3_f32 v209, v209, v91, v92
    v_max3_f32 v209, v209, v93, v94
    v_max_f32 v209, v209, v95
    v_mov_b32 v210, v209
    s_nop 1
    v_permlane32_swap_b32 v209, v210
    s_nop 1
    v_max_f32 v209, v209, v210
    v_cmp_lt_f32 vcc, 8.0, v209
    s_cbranch_vccz K2_back2
    v_max_f32 v209, 0, v209
    v_sub_f32 v210, 0, v209
    v_exp_f32 v210, v210
    v_sub_f32 v32, v32, v209
    v_sub_f32 v33, v33, v209
    v_sub_f32 v34, v34, v209
    v_sub_f32 v35, v35, v209
    v_sub_f32 v36, v36, v209
    v_sub_f32 v37, v37, v209
    v_sub_f32 v38, v38, v209
    v_sub_f32 v39, v39, v209
    v_sub_f32 v40, v40, v209
    v_sub_f32 v41, v41, v209
    v_sub_f32 v42, v42, v209
    v_sub_f32 v43, v43, v209
    v_sub_f32 v44, v44, v209
    v_sub_f32 v45, v45, v209
    v_sub_f32 v46, v46, v209
    v_sub_f32 v47, v47, v209
    v_sub_f32 v48, v48, v209
    v_sub_f32 v49, v49, v209
    v_sub_f32 v50, v50, v209
    v_sub_f32 v51, v51, v209
    v_sub_f32 v52, v52, v209
    v_sub_f32 v53, v53, v209
    v_sub_f32 v54, v54, v209
    v_sub_f32 v55, v55, v209
    v_sub_f32 v56, v56, v209
    v_sub_f32 v57, v57, v209
    v_sub_f32 v58, v58, v209
    v_sub_f32 v59, v59, v209
    v_sub_f32 v60, v60, v209
    v_sub_f32 v61, v61, v209
    v_sub_f32 v62, v62, v209
    v_sub_f32 v63, v63, v209
    v_sub_f32 v64, v64, v209
    v_sub_f32 v65, v65, v209
    v_sub_f32 v66, v66, v209
    v_sub_f32 v67, v67, v209
    v_sub_f32 v68, v68, v209
    v_sub_f32 v69, v69, v209
    v_sub_f32 v70, v70, v209
    v_sub_f32 v71, v71, v209
    v_sub_f32 v72, v72, v209
    v_sub_f32 v73, v73, v209
    v_sub_f32 v74, v74, v209
    v_sub_f32 v75, v75, v209
    v_sub_f32 v76, v76, v209
    v_sub_f32 v77, v77, v209
    v_sub_f32 v78, v78, v209
    v_sub_f32 v79, v79, v209
    v_sub_f32 v80, v80, v209
    v_sub_f32 v81, v81, v209
    v_sub_f32 v82, v82, v209
    v_sub_f32 v83, v83, v209
    v_sub_f32 v84, v84, v209
    v_sub_f32 v85, v85, v209
    v_sub_f32 v86, v86, v209
    v_sub_f32 v87, v87, v209
    v_sub_f32 v88, v88, v209
    v_sub_f32 v89, v89, v209
    v_sub_f32 v90, v90, v209
    v_sub_f32 v91, v91, v209
    v_sub_f32 v92, v92, v209
    v_sub_f32 v93, v93, v209
    v_sub_f32 v94, v94, v209
    v_sub_f32 v95, v95, v209
    v_mul_f32 v192, v192, v210
    v_mul_f32 v193, v193, v210
    v_mul_f32 v194, v194, v210
    v_mul_f32 v195, v195, v210
    v_mul_f32 v196, v196, v210
    v_mul_f32 v197, v197, v210
    v_mul_f32 v198, v198, v210
    v_mul_f32 v199, v199, v210
    v_mul_f32 v200, v200, v210
    v_mul_f32 v201, v201, v210
    v_mul_f32 v202, v202, v210
    v_mul_f32 v203, v203, v210
    v_mul_f32 v204, v204, v210
    v_mul_f32 v205, v205, v210
    v_mul_f32 v206, v206, v210
    v_mul_f32 v207, v207, v210
    v_sub_f32 v236, v236, v209
    v_sub_f32 v237, v237, v209
    v_sub_f32 v238, v238, v209
    v_sub_f32 v239, v239, v209
    v_sub_f32 v240, v240, v209
    v_sub_f32 v241, v241, v209
    v_sub_f32 v242, v242, v209
    v_sub_f32 v243, v243, v209
    v_sub_f32 v244, v244, v209
    v_sub_f32 v245, v245, v209
    v_sub_f32 v246, v246, v209
    v_sub_f32 v247, v247, v209
    v_sub_f32 v248, v248, v209
    v_sub_f32 v249, v249, v209
    v_sub_f32 v250, v250, v209
    v_sub_f32 v251, v251, v209
K2_back2:
    s_waitcnt lgkmcnt(0)
    ds_read_b128 v[228:231], v16 offset:8192
    ds_read_b128 v[232:235], v16 offset:9216
    v_exp_f32 v32, v32
    v_mfma_f32_32x32x16_bf16 v[96:111], v[160:163], v[8:11], v[236:251]
    v_exp_f32 v33, v33
    v_exp_f32 v34, v34
    v_exp_f32 v35, v35
    v_exp_f32 v36, v36
    v_exp_f32 v37, v37
    v_exp_f32 v38, v38
    v_exp_f32 v39, v39
    v_exp_f32 v40, v40
    v_mfma_f32_32x32x16_bf16 v[96:111], v[164:167], v[12:15], v[96:111]
    v_exp_f32 v41, v41
    v_exp_f32 v42, v42
    v_exp_f32 v43, v43
    v_exp_f32 v44, v44
    v_exp_f32 v45, v45
    v_exp_f32 v46, v46
    v_exp_f32 v47, v47
    v_cvt_pk_bf16_f32 v32, v32, v33
    v_cvt_pk_bf16_f32 v33, v34, v35
    v_cvt_pk_bf16_f32 v34, v36, v37
    v_cvt_pk_bf16_f32 v35, v38, v39
    v_cvt_pk_bf16_f32 v36, v40, v41
    v_cvt_pk_bf16_f32 v37, v42, v43
    v_cvt_pk_bf16_f32 v38, v44, v45
    v_cvt_pk_bf16_f32 v39, v46, v47
    s_waitcnt lgkmcnt(0)
    ds_read_b128 v[18:21], v16 offset:10240
    ds_read_b128 v[22:25], v16 offset:11264
    v_mfma_f32_32x32x16_bf16 v[192:207], v[228:231], v[32:35], v[192:207]
    v_mfma_f32_32x32x16_bf16 v[192:207], v[232:235], v[36:39], v[192:207]
    v_exp_f32 v48, v48
    v_mfma_f32_32x32x16_bf16 v[112:127], v[168:171], v[8:11], v[236:251]
    v_exp_f32 v49, v49
    v_exp_f32 v50, v50
    v_exp_f32 v51, v51
    v_exp_f32 v52, v52
    v_exp_f32 v53, v53
    v_exp_f32 v54, v54
    v_exp_f32 v55, v55
    v_exp_f32 v56, v56
    v_mfma_f32_32x32x16_bf16 v[112:127], v[172:175], v[12:15], v[112:127]
    v_exp_f32 v57, v57
    v_exp_f32 v58, v58
    v_exp_f32 v59, v59
    v_exp_f32 v60, v60
    v_exp_f32 v61, v61
    v_exp_f32 v62, v62
    v_exp_f32 v63, v63
    v_cvt_pk_bf16_f32 v48, v48, v49
    v_cvt_pk_bf16_f32 v49, v50, v51
    v_cvt_pk_bf16_f32 v50, v52, v53
    v_cvt_pk_bf16_f32 v51, v54, v55
    v_cvt_pk_bf16_f32 v52, v56, v57
    v_cvt_pk_bf16_f32 v53, v58, v59
    v_cvt_pk_bf16_f32 v54, v60, v61
    v_cvt_pk_bf16_f32 v55, v62, v63
    s_waitcnt lgkmcnt(0)
    ds_read_b128 v[228:231], v16 offset:12288
    ds_read_b128 v[232:235], v16 offset:13312
    v_mfma_f32_32x32x16_bf16 v[192:207], v[18:21], v[48:51], v[192:207]
    v_mfma_f32_32x32x16_bf16 v[192:207], v[22:25], v[52:55], v[192:207]
    v_exp_f32 v64, v64
    v_mfma_f32_32x32x16_bf16 v[128:143], v[176:179], v[8:11], v[236:251]
    v_exp_f32 v65, v65
    v_exp_f32 v66, v66
    v_exp_f32 v67, v67
    v_exp_f32 v68, v68
    v_exp_f32 v69, v69
    v_exp_f32 v70, v70
    v_exp_f32 v71, v71
    v_exp_f32 v72, v72
    v_mfma_f32_32x32x16_bf16 v[128:143], v[180:183], v[12:15], v[128:143]
    v_exp_f32 v73, v73
    v_exp_f32 v74, v74
    v_exp_f32 v75, v75
    v_exp_f32 v76, v76
    v_exp_f32 v77, v77
    v_exp_f32 v78, v78
    v_exp_f32 v79, v79
    v_cvt_pk_bf16_f32 v64, v64, v65
    v_cvt_pk_bf16_f32 v65, v66, v67
    v_cvt_pk_bf16_f32 v66, v68, v69
    v_cvt_pk_bf16_f32 v67, v70, v71
    v_cvt_pk_bf16_f32 v68, v72, v73
    v_cvt_pk_bf16_f32 v69, v74, v75
    v_cvt_pk_bf16_f32 v70, v76, v77
    v_cvt_pk_bf16_f32 v71, v78, v79
    s_waitcnt lgkmcnt(0)
    ds_read_b128 v[18:21], v16 offset:14336
    ds_read_b128 v[22:25], v16 offset:15360
    v_mfma_f32_32x32x16_bf16 v[192:207], v[228:231], v[64:67], v[192:207]
    v_mfma_f32_32x32x16_bf16 v[192:207], v[232:235], v[68:71], v[192:207]
    v_exp_f32 v80, v80
    v_mfma_f32_32x32x16_bf16 v[144:159], v[184:187], v[8:11], v[236:251]
    v_exp_f32 v81, v81
    v_exp_f32 v82, v82
    v_exp_f32 v83, v83
    v_exp_f32 v84, v84
    v_exp_f32 v85, v85
    v_exp_f32 v86, v86
    v_exp_f32 v87, v87
    v_exp_f32 v88, v88
    v_mfma_f32_32x32x16_bf16 v[144:159], v[188:191], v[12:15], v[144:159]
    v_exp_f32 v89, v89
    v_exp_f32 v90, v90
    v_exp_f32 v91, v91
    v_exp_f32 v92, v92
    v_exp_f32 v93, v93
    v_exp_f32 v94, v94
    v_exp_f32 v95, v95
    v_cvt_pk_bf16_f32 v80, v80, v81
    v_cvt_pk_bf16_f32 v81, v82, v83
    v_cvt_pk_bf16_f32 v82, v84, v85
    v_cvt_pk_bf16_f32 v83, v86, v87
    v_cvt_pk_bf16_f32 v84, v88, v89
    v_cvt_pk_bf16_f32 v85, v90, v91
    v_cvt_pk_bf16_f32 v86, v92, v93
    v_cvt_pk_bf16_f32 v87, v94, v95
    s_waitcnt lgkmcnt(0)
    v_mfma_f32_32x32x16_bf16 v[192:207], v[18:21], v[80:83], v[192:207]
    v_mfma_f32_32x32x16_bf16 v[192:207], v[22:25], v[84:87], v[192:207]
    s_waitcnt vmcnt(0)
    ds_write_b128 v6, v[212:215] offset:32768
    ds_write_b128 v6, v[216:219] offset:40960
    ds_write_b128 v6, v[220:223] offset:49152
    ds_write_b128 v6, v[224:227] offset:57344
    s_waitcnt lgkmcnt(0)
    s_barrier
    s_mov_b32 s9, 2138112
    buffer_load_dwordx4 v[212:215], v6, s[16:19], s9 offen
    s_mov_b32 s9, 2269184
    buffer_load_dwordx4 v[216:219], v6, s[16:19], s9 offen
    s_mov_b32 s9, 2203648
    buffer_load_dwordx4 v[220:223], v6, s[16:19], s9 offen
    s_mov_b32 s9, 2334720
    buffer_load_dwordx4 v[224:227], v6, s[16:19], s9 offen
    ds_read_b128 v[160:163], v7 offset:32768
    ds_read_b128 v[164:167], v7 offset:33792
    ds_read_b128 v[168:171], v7 offset:34816
    ds_read_b128 v[172:175], v7 offset:35840
    ds_read_b128 v[176:179], v7 offset:36864
    ds_read_b128 v[180:183], v7 offset:37888
    ds_read_b128 v[184:187], v7 offset:38912
    ds_read_b128 v[188:191], v7 offset:39936
    s_nop 7
    v_max3_f32 v209, v96, v97, v98
    v_max3_f32 v209, v209, v99, v100
    v_max3_f32 v209, v209, v101, v102
    v_max3_f32 v209, v209, v103, v104
    v_max3_f32 v209, v209, v105, v106
    v_max3_f32 v209, v209, v107, v108
    v_max3_f32 v209, v209, v109, v110
    v_max3_f32 v209, v209, v111, v112
    v_max3_f32 v209, v209, v113, v114
    v_max3_f32 v209, v209, v115, v116
    v_max3_f32 v209, v209, v117, v118
    v_max3_f32 v209, v209, v119, v120
    v_max3_f32 v209, v209, v121, v122
    v_max3_f32 v209, v209, v123, v124
    v_max3_f32 v209, v209, v125, v126
    v_max3_f32 v209, v209, v127, v128
    v_max3_f32 v209, v209, v129, v130
    v_max3_f32 v209, v209, v131, v132
    v_max3_f32 v209, v209, v133, v134
    v_max3_f32 v209, v209, v135, v136
    v_max3_f32 v209, v209, v137, v138
    v_max3_f32 v209, v209, v139, v140
    v_max3_f32 v209, v209, v141, v142
    v_max3_f32 v209, v209, v143, v144
    v_max3_f32 v209, v209, v145, v146
    v_max3_f32 v209, v209, v147, v148
    v_max3_f32 v209, v209, v149, v150
    v_max3_f32 v209, v209, v151, v152
    v_max3_f32 v209, v209, v153, v154
    v_max3_f32 v209, v209, v155, v156
    v_max3_f32 v209, v209, v157, v158
    v_max_f32 v209, v209, v159
    v_mov_b32 v210, v209
    s_nop 1
    v_permlane32_swap_b32 v209, v210
    s_nop 1
    v_max_f32 v209, v209, v210
    v_cmp_lt_f32 vcc, 8.0, v209
    s_cbranch_vccz K2_back3
    v_max_f32 v209, 0, v209
    v_sub_f32 v210, 0, v209
    v_exp_f32 v210, v210
    v_sub_f32 v96, v96, v209
    v_sub_f32 v97, v97, v209
    v_sub_f32 v98, v98, v209
    v_sub_f32 v99, v99, v209
    v_sub_f32 v100, v100, v209
    v_sub_f32 v101, v101, v209
    v_sub_f32 v102, v102, v209
    v_sub_f32 v103, v103, v209
    v_sub_f32 v104, v104, v209
    v_sub_f32 v105, v105, v209
    v_sub_f32 v106, v106, v209
    v_sub_f32 v107, v107, v209
    v_sub_f32 v108, v108, v209
    v_sub_f32 v109, v109, v209
    v_sub_f32 v110, v110, v209
    v_sub_f32 v111, v111, v209
    v_sub_f32 v112, v112, v209
    v_sub_f32 v113, v113, v209
    v_sub_f32 v114, v114, v209
    v_sub_f32 v115, v115, v209
    v_sub_f32 v116, v116, v209
    v_sub_f32 v117, v117, v209
    v_sub_f32 v118, v118, v209
    v_sub_f32 v119, v119, v209
    v_sub_f32 v120, v120, v209
    v_sub_f32 v121, v121, v209
    v_sub_f32 v122, v122, v209
    v_sub_f32 v123, v123, v209
    v_sub_f32 v124, v124, v209
    v_sub_f32 v125, v125, v209
    v_sub_f32 v126, v126, v209
    v_sub_f32 v127, v127, v209
    v_sub_f32 v128, v128, v209
    v_sub_f32 v129, v129, v209
    v_sub_f32 v130, v130, v209
    v_sub_f32 v131, v131, v209
    v_sub_f32 v132, v132, v209
    v_sub_f32 v133, v133, v209
    v_sub_f32 v134, v134, v209
    v_sub_f32 v135, v135, v209
    v_sub_f32 v136, v136, v209
    v_sub_f32 v137, v137, v209
    v_sub_f32 v138, v138, v209
    v_sub_f32 v139, v139, v209
    v_sub_f32 v140, v140, v209
    v_sub_f32 v141, v141, v209
    v_sub_f32 v142, v142, v209
    v_sub_f32 v143, v143, v209
    v_sub_f32 v144, v144, v209
    v_sub_f32 v145, v145, v209
    v_sub_f32 v146, v146, v209
    v_sub_f32 v147, v147, v209
    v_sub_f32 v148, v148, v209
    v_sub_f32 v149, v149, v209
    v_sub_f32 v150, v150, v209
    v_sub_f32 v151, v151, v209
    v_sub_f32 v152, v152, v209
    v_sub_f32 v153, v153, v209
    v_sub_f32 v154, v154, v209
    v_sub_f32 v155, v155, v209
    v_sub_f32 v156, v156, v209
    v_sub_f32 v157, v157, v209
    v_sub_f32 v158, v158, v209
    v_sub_f32 v159, v159, v209
    v_mul_f32 v192, v192, v210
    v_mul_f32 v193, v193, v210
    v_mul_f32 v194, v194, v210
    v_mul_f32 v195, v195, v210
    v_mul_f32 v196, v196, v210
    v_mul_f32 v197, v197, v210
    v_mul_f32 v198, v198, v210
    v_mul_f32 v199, v199, v210
    v_mul_f32 v200, v200, v210
    v_mul_f32 v201, v201, v210
    v_mul_f32 v202, v202, v210
    v_mul_f32 v203, v203, v210
    v_mul_f32 v204, v204, v210
    v_mul_f32 v205, v205, v210
    v_mul_f32 v206, v206, v210
    v_mul_f32 v207, v207, v210
    v_sub_f32 v236, v236, v209
    v_sub_f32 v237, v237, v209
    v_sub_f32 v238, v238, v209
    v_sub_f32 v239, v239, v209
    v_sub_f32 v240, v240, v209
    v_sub_f32 v241, v241, v209
    v_sub_f32 v242, v242, v209
    v_sub_f32 v243, v243, v209
    v_sub_f32 v244, v244, v209
    v_sub_f32 v245, v245, v209
    v_sub_f32 v246, v246, v209
    v_sub_f32 v247, v247, v209
    v_sub_f32 v248, v248, v209
    v_sub_f32 v249, v249, v209
    v_sub_f32 v250, v250, v209
    v_sub_f32 v251, v251, v209
K2_back3:
    s_waitcnt lgkmcnt(0)
    ds_read_b128 v[228:231], v7 offset:8192
    ds_read_b128 v[232:235], v7 offset:9216
    v_exp_f32 v96, v96
    v_mfma_f32_32x32x16_bf16 v[32:47], v[160:163], v[8:11], v[236:251]
    v_exp_f32 v97, v97
    v_exp_f32 v98, v98
    v_exp_f32 v99, v99
    v_exp_f32 v100, v100
    v_exp_f32 v101, v101
    v_exp_f32 v102, v102
    v_exp_f32 v103, v103
    v_exp_f32 v104, v104
    v_mfma_f32_32x32x16_bf16 v[32:47], v[164:167], v[12:15], v[32:47]
    v_exp_f32 v105, v105
    v_exp_f32 v106, v106
    v_exp_f32 v107, v107
    v_exp_f32 v108, v108
    v_exp_f32 v109, v109
    v_exp_f32 v110, v110
    v_exp_f32 v111, v111
    v_cvt_pk_bf16_f32 v96, v96, v97
    v_cvt_pk_bf16_f32 v97, v98, v99
    v_cvt_pk_bf16_f32 v98, v100, v101
    v_cvt_pk_bf16_f32 v99, v102, v103
    v_cvt_pk_bf16_f32 v100, v104, v105
    v_cvt_pk_bf16_f32 v101, v106, v107
    v_cvt_pk_bf16_f32 v102, v108, v109
    v_cvt_pk_bf16_f32 v103, v110, v111
    s_waitcnt lgkmcnt(0)
    ds_read_b128 v[18:21], v7 offset:10240
    ds_read_b128 v[22:25], v7 offset:11264
    v_mfma_f32_32x32x16_bf16 v[192:207], v[228:231], v[96:99], v[192:207]
    v_mfma_f32_32x32x16_bf16 v[192:207], v[232:235], v[100:103], v[192:207]
    v_exp_f32 v112, v112
    v_mfma_f32_32x32x16_bf16 v[48:63], v[168:171], v[8:11], v[236:251]
    v_exp_f32 v113, v113
    v_exp_f32 v114, v114
    v_exp_f32 v115, v115
    v_exp_f32 v116, v116
    v_exp_f32 v117, v117
    v_exp_f32 v118, v118
    v_exp_f32 v119, v119
    v_exp_f32 v120, v120
    v_mfma_f32_32x32x16_bf16 v[48:63], v[172:175], v[12:15], v[48:63]
    v_exp_f32 v121, v121
    v_exp_f32 v122, v122
    v_exp_f32 v123, v123
    v_exp_f32 v124, v124
    v_exp_f32 v125, v125
    v_exp_f32 v126, v126
    v_exp_f32 v127, v127
    v_cvt_pk_bf16_f32 v112, v112, v113
    v_cvt_pk_bf16_f32 v113, v114, v115
    v_cvt_pk_bf16_f32 v114, v116, v117
    v_cvt_pk_bf16_f32 v115, v118, v119
    v_cvt_pk_bf16_f32 v116, v120, v121
    v_cvt_pk_bf16_f32 v117, v122, v123
    v_cvt_pk_bf16_f32 v118, v124, v125
    v_cvt_pk_bf16_f32 v119, v126, v127
    s_waitcnt lgkmcnt(0)
    ds_read_b128 v[228:231], v7 offset:12288
    ds_read_b128 v[232:235], v7 offset:13312
    v_mfma_f32_32x32x16_bf16 v[192:207], v[18:21], v[112:115], v[192:207]
    v_mfma_f32_32x32x16_bf16 v[192:207], v[22:25], v[116:119], v[192:207]
    v_exp_f32 v128, v128
    v_mfma_f32_32x32x16_bf16 v[64:79], v[176:179], v[8:11], v[236:251]
    v_exp_f32 v129, v129
    v_exp_f32 v130, v130
    v_exp_f32 v131, v131
    v_exp_f32 v132, v132
    v_exp_f32 v133, v133
    v_exp_f32 v134, v134
    v_exp_f32 v135, v135
    v_exp_f32 v136, v136
    v_mfma_f32_32x32x16_bf16 v[64:79], v[180:183], v[12:15], v[64:79]
    v_exp_f32 v137, v137
    v_exp_f32 v138, v138
    v_exp_f32 v139, v139
    v_exp_f32 v140, v140
    v_exp_f32 v141, v141
    v_exp_f32 v142, v142
    v_exp_f32 v143, v143
    v_cvt_pk_bf16_f32 v128, v128, v129
    v_cvt_pk_bf16_f32 v129, v130, v131
    v_cvt_pk_bf16_f32 v130, v132, v133
    v_cvt_pk_bf16_f32 v131, v134, v135
    v_cvt_pk_bf16_f32 v132, v136, v137
    v_cvt_pk_bf16_f32 v133, v138, v139
    v_cvt_pk_bf16_f32 v134, v140, v141
    v_cvt_pk_bf16_f32 v135, v142, v143
    s_waitcnt lgkmcnt(0)
    ds_read_b128 v[18:21], v7 offset:14336
    ds_read_b128 v[22:25], v7 offset:15360
    v_mfma_f32_32x32x16_bf16 v[192:207], v[228:231], v[128:131], v[192:207]
    v_mfma_f32_32x32x16_bf16 v[192:207], v[232:235], v[132:135], v[192:207]
    v_exp_f32 v144, v144
    v_mfma_f32_32x32x16_bf16 v[80:95], v[184:187], v[8:11], v[236:251]
    v_exp_f32 v145, v145
    v_exp_f32 v146, v146
    v_exp_f32 v147, v147
    v_exp_f32 v148, v148
    v_exp_f32 v149, v149
    v_exp_f32 v150, v150
    v_exp_f32 v151, v151
    v_exp_f32 v152, v152
    v_mfma_f32_32x32x16_bf16 v[80:95], v[188:191], v[12:15], v[80:95]
    v_exp_f32 v153, v153
    v_exp_f32 v154, v154
    v_exp_f32 v155, v155
    v_exp_f32 v156, v156
    v_exp_f32 v157, v157
    v_exp_f32 v158, v158
    v_exp_f32 v159, v159
    v_cvt_pk_bf16_f32 v144, v144, v145
    v_cvt_pk_bf16_f32 v145, v146, v147
    v_cvt_pk_bf16_f32 v146, v148, v149
    v_cvt_pk_bf16_f32 v147, v150, v151
    v_cvt_pk_bf16_f32 v148, v152, v153
    v_cvt_pk_bf16_f32 v149, v154, v155
    v_cvt_pk_bf16_f32 v150, v156, v157
    v_cvt_pk_bf16_f32 v151, v158, v159
    s_waitcnt lgkmcnt(0)
    v_mfma_f32_32x32x16_bf16 v[192:207], v[18:21], v[144:147], v[192:207]
    v_mfma_f32_32x32x16_bf16 v[192:207], v[22:25], v[148:151], v[192:207]
    s_waitcnt vmcnt(0)
    ds_write_b128 v17, v[212:215] offset:0
    ds_write_b128 v17, v[216:219] offset:8192
    ds_write_b128 v17, v[220:223] offset:16384
    ds_write_b128 v17, v[224:227] offset:24576
    s_waitcnt lgkmcnt(0)
    s_barrier
    s_mov_b32 s9, 2146304
    buffer_load_dwordx4 v[212:215], v6, s[16:19], s9 offen
    s_mov_b32 s9, 2277376
    buffer_load_dwordx4 v[216:219], v6, s[16:19], s9 offen
    s_mov_b32 s9, 2211840
    buffer_load_dwordx4 v[220:223], v6, s[16:19], s9 offen
    s_mov_b32 s9, 2342912
    buffer_load_dwordx4 v[224:227], v6, s[16:19], s9 offen
    ds_read_b128 v[160:163], v16 offset:0
    ds_read_b128 v[164:167], v16 offset:1024
    ds_read_b128 v[168:171], v16 offset:2048
    ds_read_b128 v[172:175], v16 offset:3072
    ds_read_b128 v[176:179], v16 offset:4096
    ds_read_b128 v[180:183], v16 offset:5120
    ds_read_b128 v[184:187], v16 offset:6144
    ds_read_b128 v[188:191], v16 offset:7168
    s_nop 7
    v_max3_f32 v209, v32, v33, v34
    v_max3_f32 v209, v209, v35, v36
    v_max3_f32 v209, v209, v37, v38
    v_max3_f32 v209, v209, v39, v40
    v_max3_f32 v209, v209, v41, v42
    v_max3_f32 v209, v209, v43, v44
    v_max3_f32 v209, v209, v45, v46
    v_max3_f32 v209, v209, v47, v48
    v_max3_f32 v209, v209, v49, v50
    v_max3_f32 v209, v209, v51, v52
    v_max3_f32 v209, v209, v53, v54
    v_max3_f32 v209, v209, v55, v56
    v_max3_f32 v209, v209, v57, v58
    v_max3_f32 v209, v209, v59, v60
    v_max3_f32 v209, v209, v61, v62
    v_max3_f32 v209, v209, v63, v64
    v_max3_f32 v209, v209, v65, v66
    v_max3_f32 v209, v209, v67, v68
    v_max3_f32 v209, v209, v69, v70
    v_max3_f32 v209, v209, v71, v72
    v_max3_f32 v209, v209, v73, v74
    v_max3_f32 v209, v209, v75, v76
    v_max3_f32 v209, v209, v77, v78
    v_max3_f32 v209, v209, v79, v80
    v_max3_f32 v209, v209, v81, v82
    v_max3_f32 v209, v209, v83, v84
    v_max3_f32 v209, v209, v85, v86
    v_max3_f32 v209, v209, v87, v88
    v_max3_f32 v209, v209, v89, v90
    v_max3_f32 v209, v209, v91, v92
    v_max3_f32 v209, v209, v93, v94
    v_max_f32 v209, v209, v95
    v_mov_b32 v210, v209
    s_nop 1
    v_permlane32_swap_b32 v209, v210
    s_nop 1
    v_max_f32 v209, v209, v210
    v_cmp_lt_f32 vcc, 8.0, v209
    s_cbranch_vccz K2_back4
    v_max_f32 v209, 0, v209
    v_sub_f32 v210, 0, v209
    v_exp_f32 v210, v210
    v_sub_f32 v32, v32, v209
    v_sub_f32 v33, v33, v209
    v_sub_f32 v34, v34, v209
    v_sub_f32 v35, v35, v209
    v_sub_f32 v36, v36, v209
    v_sub_f32 v37, v37, v209
    v_sub_f32 v38, v38, v209
    v_sub_f32 v39, v39, v209
    v_sub_f32 v40, v40, v209
    v_sub_f32 v41, v41, v209
    v_sub_f32 v42, v42, v209
    v_sub_f32 v43, v43, v209
    v_sub_f32 v44, v44, v209
    v_sub_f32 v45, v45, v209
    v_sub_f32 v46, v46, v209
    v_sub_f32 v47, v47, v209
    v_sub_f32 v48, v48, v209
    v_sub_f32 v49, v49, v209
    v_sub_f32 v50, v50, v209
    v_sub_f32 v51, v51, v209
    v_sub_f32 v52, v52, v209
    v_sub_f32 v53, v53, v209
    v_sub_f32 v54, v54, v209
    v_sub_f32 v55, v55, v209
    v_sub_f32 v56, v56, v209
    v_sub_f32 v57, v57, v209
    v_sub_f32 v58, v58, v209
    v_sub_f32 v59, v59, v209
    v_sub_f32 v60, v60, v209
    v_sub_f32 v61, v61, v209
    v_sub_f32 v62, v62, v209
    v_sub_f32 v63, v63, v209
    v_sub_f32 v64, v64, v209
    v_sub_f32 v65, v65, v209
    v_sub_f32 v66, v66, v209
    v_sub_f32 v67, v67, v209
    v_sub_f32 v68, v68, v209
    v_sub_f32 v69, v69, v209
    v_sub_f32 v70, v70, v209
    v_sub_f32 v71, v71, v209
    v_sub_f32 v72, v72, v209
    v_sub_f32 v73, v73, v209
    v_sub_f32 v74, v74, v209
    v_sub_f32 v75, v75, v209
    v_sub_f32 v76, v76, v209
    v_sub_f32 v77, v77, v209
    v_sub_f32 v78, v78, v209
    v_sub_f32 v79, v79, v209
    v_sub_f32 v80, v80, v209
    v_sub_f32 v81, v81, v209
    v_sub_f32 v82, v82, v209
    v_sub_f32 v83, v83, v209
    v_sub_f32 v84, v84, v209
    v_sub_f32 v85, v85, v209
    v_sub_f32 v86, v86, v209
    v_sub_f32 v87, v87, v209
    v_sub_f32 v88, v88, v209
    v_sub_f32 v89, v89, v209
    v_sub_f32 v90, v90, v209
    v_sub_f32 v91, v91, v209
    v_sub_f32 v92, v92, v209
    v_sub_f32 v93, v93, v209
    v_sub_f32 v94, v94, v209
    v_sub_f32 v95, v95, v209
    v_mul_f32 v192, v192, v210
    v_mul_f32 v193, v193, v210
    v_mul_f32 v194, v194, v210
    v_mul_f32 v195, v195, v210
    v_mul_f32 v196, v196, v210
    v_mul_f32 v197, v197, v210
    v_mul_f32 v198, v198, v210
    v_mul_f32 v199, v199, v210
    v_mul_f32 v200, v200, v210
    v_mul_f32 v201, v201, v210
    v_mul_f32 v202, v202, v210
    v_mul_f32 v203, v203, v210
    v_mul_f32 v204, v204, v210
    v_mul_f32 v205, v205, v210
    v_mul_f32 v206, v206, v210
    v_mul_f32 v207, v207, v210
    v_sub_f32 v236, v236, v209
    v_sub_f32 v237, v237, v209
    v_sub_f32 v238, v238, v209
    v_sub_f32 v239, v239, v209
    v_sub_f32 v240, v240, v209
    v_sub_f32 v241, v241, v209
    v_sub_f32 v242, v242, v209
    v_sub_f32 v243, v243, v209
    v_sub_f32 v244, v244, v209
    v_sub_f32 v245, v245, v209
    v_sub_f32 v246, v246, v209
    v_sub_f32 v247, v247, v209
    v_sub_f32 v248, v248, v209
    v_sub_f32 v249, v249, v209
    v_sub_f32 v250, v250, v209
    v_sub_f32 v251, v251, v209
K2_back4:
    s_waitcnt lgkmcnt(0)
    ds_read_b128 v[228:231], v7 offset:40960
    ds_read_b128 v[232:235], v7 offset:41984
    v_exp_f32 v32, v32
    v_mfma_f32_32x32x16_bf16 v[96:111], v[160:163], v[8:11], v[236:251]
    v_exp_f32 v33, v33
    v_exp_f32 v34, v34
    v_exp_f32 v35, v35
    v_exp_f32 v36, v36
    v_exp_f32 v37, v37
    v_exp_f32 v38, v38
    v_exp_f32 v39, v39
    v_exp_f32 v40, v40
    v_mfma_f32_32x32x16_bf16 v[96:111], v[164:167], v[12:15], v[96:111]
    v_exp_f32 v41, v41
    v_exp_f32 v42, v42
    v_exp_f32 v43, v43
    v_exp_f32 v44, v44
    v_exp_f32 v45, v45
    v_exp_f32 v46, v46
    v_exp_f32 v47, v47
    v_cvt_pk_bf16_f32 v32, v32, v33
    v_cvt_pk_bf16_f32 v33, v34, v35
    v_cvt_pk_bf16_f32 v34, v36, v37
    v_cvt_pk_bf16_f32 v35, v38, v39
    v_cvt_pk_bf16_f32 v36, v40, v41
    v_cvt_pk_bf16_f32 v37, v42, v43
    v_cvt_pk_bf16_f32 v38, v44, v45
    v_cvt_pk_bf16_f32 v39, v46, v47
    s_waitcnt lgkmcnt(0)
    ds_read_b128 v[18:21], v7 offset:43008
    ds_read_b128 v[22:25], v7 offset:44032
    v_mfma_f32_32x32x16_bf16 v[192:207], v[228:231], v[32:35], v[192:207]
    v_mfma_f32_32x32x16_bf16 v[192:207], v[232:235], v[36:39], v[192:207]
    v_exp_f32 v48, v48
    v_mfma_f32_32x32x16_bf16 v[112:127], v[168:171], v[8:11], v[236:251]
    v_exp_f32 v49, v49
    v_exp_f32 v50, v50
    v_exp_f32 v51, v51
    v_exp_f32 v52, v52
    v_exp_f32 v53, v53
    v_exp_f32 v54, v54
    v_exp_f32 v55, v55
    v_exp_f32 v56, v56
    v_mfma_f32_32x32x16_bf16 v[112:127], v[172:175], v[12:15], v[112:127]
    v_exp_f32 v57, v57
    v_exp_f32 v58, v58
    v_exp_f32 v59, v59
    v_exp_f32 v60, v60
    v_exp_f32 v61, v61
    v_exp_f32 v62, v62
    v_exp_f32 v63, v63
    v_cvt_pk_bf16_f32 v48, v48, v49
    v_cvt_pk_bf16_f32 v49, v50, v51
    v_cvt_pk_bf16_f32 v50, v52, v53
    v_cvt_pk_bf16_f32 v51, v54, v55
    v_cvt_pk_bf16_f32 v52, v56, v57
    v_cvt_pk_bf16_f32 v53, v58, v59
    v_cvt_pk_bf16_f32 v54, v60, v61
    v_cvt_pk_bf16_f32 v55, v62, v63
    s_waitcnt lgkmcnt(0)
    ds_read_b128 v[228:231], v7 offset:45056
    ds_read_b128 v[232:235], v7 offset:46080
    v_mfma_f32_32x32x16_bf16 v[192:207], v[18:21], v[48:51], v[192:207]
    v_mfma_f32_32x32x16_bf16 v[192:207], v[22:25], v[52:55], v[192:207]
    v_exp_f32 v64, v64
    v_mfma_f32_32x32x16_bf16 v[128:143], v[176:179], v[8:11], v[236:251]
    v_exp_f32 v65, v65
    v_exp_f32 v66, v66
    v_exp_f32 v67, v67
    v_exp_f32 v68, v68
    v_exp_f32 v69, v69
    v_exp_f32 v70, v70
    v_exp_f32 v71, v71
    v_exp_f32 v72, v72
    v_mfma_f32_32x32x16_bf16 v[128:143], v[180:183], v[12:15], v[128:143]
    v_exp_f32 v73, v73
    v_exp_f32 v74, v74
    v_exp_f32 v75, v75
    v_exp_f32 v76, v76
    v_exp_f32 v77, v77
    v_exp_f32 v78, v78
    v_exp_f32 v79, v79
    v_cvt_pk_bf16_f32 v64, v64, v65
    v_cvt_pk_bf16_f32 v65, v66, v67
    v_cvt_pk_bf16_f32 v66, v68, v69
    v_cvt_pk_bf16_f32 v67, v70, v71
    v_cvt_pk_bf16_f32 v68, v72, v73
    v_cvt_pk_bf16_f32 v69, v74, v75
    v_cvt_pk_bf16_f32 v70, v76, v77
    v_cvt_pk_bf16_f32 v71, v78, v79
    s_waitcnt lgkmcnt(0)
    ds_read_b128 v[18:21], v7 offset:47104
    ds_read_b128 v[22:25], v7 offset:48128
    v_mfma_f32_32x32x16_bf16 v[192:207], v[228:231], v[64:67], v[192:207]
    v_mfma_f32_32x32x16_bf16 v[192:207], v[232:235], v[68:71], v[192:207]
    v_exp_f32 v80, v80
    v_mfma_f32_32x32x16_bf16 v[144:159], v[184:187], v[8:11], v[236:251]
    v_exp_f32 v81, v81
    v_exp_f32 v82, v82
    v_exp_f32 v83, v83
    v_exp_f32 v84, v84
    v_exp_f32 v85, v85
    v_exp_f32 v86, v86
    v_exp_f32 v87, v87
    v_exp_f32 v88, v88
    v_mfma_f32_32x32x16_bf16 v[144:159], v[188:191], v[12:15], v[144:159]
    v_exp_f32 v89, v89
    v_exp_f32 v90, v90
    v_exp_f32 v91, v91
    v_exp_f32 v92, v92
    v_exp_f32 v93, v93
    v_exp_f32 v94, v94
    v_exp_f32 v95, v95
    v_cvt_pk_bf16_f32 v80, v80, v81
    v_cvt_pk_bf16_f32 v81, v82, v83
    v_cvt_pk_bf16_f32 v82, v84, v85
    v_cvt_pk_bf16_f32 v83, v86, v87
    v_cvt_pk_bf16_f32 v84, v88, v89
    v_cvt_pk_bf16_f32 v85, v90, v91
    v_cvt_pk_bf16_f32 v86, v92, v93
    v_cvt_pk_bf16_f32 v87, v94, v95
    s_waitcnt lgkmcnt(0)
    v_mfma_f32_32x32x16_bf16 v[192:207], v[18:21], v[80:83], v[192:207]
    v_mfma_f32_32x32x16_bf16 v[192:207], v[22:25], v[84:87], v[192:207]
    s_waitcnt vmcnt(0)
    ds_write_b128 v6, v[212:215] offset:0
    ds_write_b128 v6, v[216:219] offset:8192
    ds_write_b128 v6, v[220:223] offset:16384
    ds_write_b128 v6, v[224:227] offset:24576
    s_waitcnt lgkmcnt(0)
    s_barrier
    s_mov_b32 s9, 2154496
    buffer_load_dwordx4 v[212:215], v6, s[16:19], s9 offen
    s_mov_b32 s9, 2285568
    buffer_load_dwordx4 v[216:219], v6, s[16:19], s9 offen
    s_mov_b32 s9, 2220032
    buffer_load_dwordx4 v[220:223], v6, s[16:19], s9 offen
    s_mov_b32 s9, 2351104
    buffer_load_dwordx4 v[224:227], v6, s[16:19], s9 offen
    ds_read_b128 v[160:163], v7 offset:0
    ds_read_b128 v[164:167], v7 offset:1024
    ds_read_b128 v[168:171], v7 offset:2048
    ds_read_b128 v[172:175], v7 offset:3072
    ds_read_b128 v[176:179], v7 offset:4096
    ds_read_b128 v[180:183], v7 offset:5120
    ds_read_b128 v[184:187], v7 offset:6144
    ds_read_b128 v[188:191], v7 offset:7168
    s_nop 7
    v_max3_f32 v209, v96, v97, v98
    v_max3_f32 v209, v209, v99, v100
    v_max3_f32 v209, v209, v101, v102
    v_max3_f32 v209, v209, v103, v104
    v_max3_f32 v209, v209, v105, v106
    v_max3_f32 v209, v209, v107, v108
    v_max3_f32 v209, v209, v109, v110
    v_max3_f32 v209, v209, v111, v112
    v_max3_f32 v209, v209, v113, v114
    v_max3_f32 v209, v209, v115, v116
    v_max3_f32 v209, v209, v117, v118
    v_max3_f32 v209, v209, v119, v120
    v_max3_f32 v209, v209, v121, v122
    v_max3_f32 v209, v209, v123, v124
    v_max3_f32 v209, v209, v125, v126
    v_max3_f32 v209, v209, v127, v128
    v_max3_f32 v209, v209, v129, v130
    v_max3_f32 v209, v209, v131, v132
    v_max3_f32 v209, v209, v133, v134
    v_max3_f32 v209, v209, v135, v136
    v_max3_f32 v209, v209, v137, v138
    v_max3_f32 v209, v209, v139, v140
    v_max3_f32 v209, v209, v141, v142
    v_max3_f32 v209, v209, v143, v144
    v_max3_f32 v209, v209, v145, v146
    v_max3_f32 v209, v209, v147, v148
    v_max3_f32 v209, v209, v149, v150
    v_max3_f32 v209, v209, v151, v152
    v_max3_f32 v209, v209, v153, v154
    v_max3_f32 v209, v209, v155, v156
    v_max3_f32 v209, v209, v157, v158
    v_max_f32 v209, v209, v159
    v_mov_b32 v210, v209
    s_nop 1
    v_permlane32_swap_b32 v209, v210
    s_nop 1
    v_max_f32 v209, v209, v210
    v_cmp_lt_f32 vcc, 8.0, v209
    s_cbranch_vccz K2_back5
    v_max_f32 v209, 0, v209
    v_sub_f32 v210, 0, v209
    v_exp_f32 v210, v210
    v_sub_f32 v96, v96, v209
    v_sub_f32 v97, v97, v209
    v_sub_f32 v98, v98, v209
    v_sub_f32 v99, v99, v209
    v_sub_f32 v100, v100, v209
    v_sub_f32 v101, v101, v209
    v_sub_f32 v102, v102, v209
    v_sub_f32 v103, v103, v209
    v_sub_f32 v104, v104, v209
    v_sub_f32 v105, v105, v209
    v_sub_f32 v106, v106, v209
    v_sub_f32 v107, v107, v209
    v_sub_f32 v108, v108, v209
    v_sub_f32 v109, v109, v209
    v_sub_f32 v110, v110, v209
    v_sub_f32 v111, v111, v209
    v_sub_f32 v112, v112, v209
    v_sub_f32 v113, v113, v209
    v_sub_f32 v114, v114, v209
    v_sub_f32 v115, v115, v209
    v_sub_f32 v116, v116, v209
    v_sub_f32 v117, v117, v209
    v_sub_f32 v118, v118, v209
    v_sub_f32 v119, v119, v209
    v_sub_f32 v120, v120, v209
    v_sub_f32 v121, v121, v209
    v_sub_f32 v122, v122, v209
    v_sub_f32 v123, v123, v209
    v_sub_f32 v124, v124, v209
    v_sub_f32 v125, v125, v209
    v_sub_f32 v126, v126, v209
    v_sub_f32 v127, v127, v209
    v_sub_f32 v128, v128, v209
    v_sub_f32 v129, v129, v209
    v_sub_f32 v130, v130, v209
    v_sub_f32 v131, v131, v209
    v_sub_f32 v132, v132, v209
    v_sub_f32 v133, v133, v209
    v_sub_f32 v134, v134, v209
    v_sub_f32 v135, v135, v209
    v_sub_f32 v136, v136, v209
    v_sub_f32 v137, v137, v209
    v_sub_f32 v138, v138, v209
    v_sub_f32 v139, v139, v209
    v_sub_f32 v140, v140, v209
    v_sub_f32 v141, v141, v209
    v_sub_f32 v142, v142, v209
    v_sub_f32 v143, v143, v209
    v_sub_f32 v144, v144, v209
    v_sub_f32 v145, v145, v209
    v_sub_f32 v146, v146, v209
    v_sub_f32 v147, v147, v209
    v_sub_f32 v148, v148, v209
    v_sub_f32 v149, v149, v209
    v_sub_f32 v150, v150, v209
    v_sub_f32 v151, v151, v209
    v_sub_f32 v152, v152, v209
    v_sub_f32 v153, v153, v209
    v_sub_f32 v154, v154, v209
    v_sub_f32 v155, v155, v209
    v_sub_f32 v156, v156, v209
    v_sub_f32 v157, v157, v209
    v_sub_f32 v158, v158, v209
    v_sub_f32 v159, v159, v209
    v_mul_f32 v192, v192, v210
    v_mul_f32 v193, v193, v210
    v_mul_f32 v194, v194, v210
    v_mul_f32 v195, v195, v210
    v_mul_f32 v196, v196, v210
    v_mul_f32 v197, v197, v210
    v_mul_f32 v198, v198, v210
    v_mul_f32 v199, v199, v210
    v_mul_f32 v200, v200, v210
    v_mul_f32 v201, v201, v210
    v_mul_f32 v202, v202, v210
    v_mul_f32 v203, v203, v210
    v_mul_f32 v204, v204, v210
    v_mul_f32 v205, v205, v210
    v_mul_f32 v206, v206, v210
    v_mul_f32 v207, v207, v210
    v_sub_f32 v236, v236, v209
    v_sub_f32 v237, v237, v209
    v_sub_f32 v238, v238, v209
    v_sub_f32 v239, v239, v209
    v_sub_f32 v240, v240, v209
    v_sub_f32 v241, v241, v209
    v_sub_f32 v242, v242, v209
    v_sub_f32 v243, v243, v209
    v_sub_f32 v244, v244, v209
    v_sub_f32 v245, v245, v209
    v_sub_f32 v246, v246, v209
    v_sub_f32 v247, v247, v209
    v_sub_f32 v248, v248, v209
    v_sub_f32 v249, v249, v209
    v_sub_f32 v250, v250, v209
    v_sub_f32 v251, v251, v209
K2_back5:
    s_waitcnt lgkmcnt(0)
    ds_read_b128 v[228:231], v16 offset:8192
    ds_read_b128 v[232:235], v16 offset:9216
    v_exp_f32 v96, v96
    v_mfma_f32_32x32x16_bf16 v[32:47], v[160:163], v[8:11], v[236:251]
    v_exp_f32 v97, v97
    v_exp_f32 v98, v98
    v_exp_f32 v99, v99
    v_exp_f32 v100, v100
    v_exp_f32 v101, v101
    v_exp_f32 v102, v102
    v_exp_f32 v103, v103
    v_exp_f32 v104, v104
    v_mfma_f32_32x32x16_bf16 v[32:47], v[164:167], v[12:15], v[32:47]
    v_exp_f32 v105, v105
    v_exp_f32 v106, v106
    v_exp_f32 v107, v107
    v_exp_f32 v108, v108
    v_exp_f32 v109, v109
    v_exp_f32 v110, v110
    v_exp_f32 v111, v111
    v_cvt_pk_bf16_f32 v96, v96, v97
    v_cvt_pk_bf16_f32 v97, v98, v99
    v_cvt_pk_bf16_f32 v98, v100, v101
    v_cvt_pk_bf16_f32 v99, v102, v103
    v_cvt_pk_bf16_f32 v100, v104, v105
    v_cvt_pk_bf16_f32 v101, v106, v107
    v_cvt_pk_bf16_f32 v102, v108, v109
    v_cvt_pk_bf16_f32 v103, v110, v111
    s_waitcnt lgkmcnt(0)
    ds_read_b128 v[18:21], v16 offset:10240
    ds_read_b128 v[22:25], v16 offset:11264
    v_mfma_f32_32x32x16_bf16 v[192:207], v[228:231], v[96:99], v[192:207]
    v_mfma_f32_32x32x16_bf16 v[192:207], v[232:235], v[100:103], v[192:207]
    v_exp_f32 v112, v112
    v_mfma_f32_32x32x16_bf16 v[48:63], v[168:171], v[8:11], v[236:251]
    v_exp_f32 v113, v113
    v_exp_f32 v114, v114
    v_exp_f32 v115, v115
    v_exp_f32 v116, v116
    v_exp_f32 v117, v117
    v_exp_f32 v118, v118
    v_exp_f32 v119, v119
    v_exp_f32 v120, v120
    v_mfma_f32_32x32x16_bf16 v[48:63], v[172:175], v[12:15], v[48:63]
    v_exp_f32 v121, v121
    v_exp_f32 v122, v122
    v_exp_f32 v123, v123
    v_exp_f32 v124, v124
    v_exp_f32 v125, v125
    v_exp_f32 v126, v126
    v_exp_f32 v127, v127
    v_cvt_pk_bf16_f32 v112, v112, v113
    v_cvt_pk_bf16_f32 v113, v114, v115
    v_cvt_pk_bf16_f32 v114, v116, v117
    v_cvt_pk_bf16_f32 v115, v118, v119
    v_cvt_pk_bf16_f32 v116, v120, v121
    v_cvt_pk_bf16_f32 v117, v122, v123
    v_cvt_pk_bf16_f32 v118, v124, v125
    v_cvt_pk_bf16_f32 v119, v126, v127
    s_waitcnt lgkmcnt(0)
    ds_read_b128 v[228:231], v16 offset:12288
    ds_read_b128 v[232:235], v16 offset:13312
    v_mfma_f32_32x32x16_bf16 v[192:207], v[18:21], v[112:115], v[192:207]
    v_mfma_f32_32x32x16_bf16 v[192:207], v[22:25], v[116:119], v[192:207]
    v_exp_f32 v128, v128
    v_mfma_f32_32x32x16_bf16 v[64:79], v[176:179], v[8:11], v[236:251]
    v_exp_f32 v129, v129
    v_exp_f32 v130, v130
    v_exp_f32 v131, v131
    v_exp_f32 v132, v132
    v_exp_f32 v133, v133
    v_exp_f32 v134, v134
    v_exp_f32 v135, v135
    v_exp_f32 v136, v136
    v_mfma_f32_32x32x16_bf16 v[64:79], v[180:183], v[12:15], v[64:79]
    v_exp_f32 v137, v137
    v_exp_f32 v138, v138
    v_exp_f32 v139, v139
    v_exp_f32 v140, v140
    v_exp_f32 v141, v141
    v_exp_f32 v142, v142
    v_exp_f32 v143, v143
    v_cvt_pk_bf16_f32 v128, v128, v129
    v_cvt_pk_bf16_f32 v129, v130, v131
    v_cvt_pk_bf16_f32 v130, v132, v133
    v_cvt_pk_bf16_f32 v131, v134, v135
    v_cvt_pk_bf16_f32 v132, v136, v137
    v_cvt_pk_bf16_f32 v133, v138, v139
    v_cvt_pk_bf16_f32 v134, v140, v141
    v_cvt_pk_bf16_f32 v135, v142, v143
    s_waitcnt lgkmcnt(0)
    ds_read_b128 v[18:21], v16 offset:14336
    ds_read_b128 v[22:25], v16 offset:15360
    v_mfma_f32_32x32x16_bf16 v[192:207], v[228:231], v[128:131], v[192:207]
    v_mfma_f32_32x32x16_bf16 v[192:207], v[232:235], v[132:135], v[192:207]
    v_exp_f32 v144, v144
    v_mfma_f32_32x32x16_bf16 v[80:95], v[184:187], v[8:11], v[236:251]
    v_exp_f32 v145, v145
    v_exp_f32 v146, v146
    v_exp_f32 v147, v147
    v_exp_f32 v148, v148
    v_exp_f32 v149, v149
    v_exp_f32 v150, v150
    v_exp_f32 v151, v151
    v_exp_f32 v152, v152
    v_mfma_f32_32x32x16_bf16 v[80:95], v[188:191], v[12:15], v[80:95]
    v_exp_f32 v153, v153
    v_exp_f32 v154, v154
    v_exp_f32 v155, v155
    v_exp_f32 v156, v156
    v_exp_f32 v157, v157
    v_exp_f32 v158, v158
    v_exp_f32 v159, v159
    v_cvt_pk_bf16_f32 v144, v144, v145
    v_cvt_pk_bf16_f32 v145, v146, v147
    v_cvt_pk_bf16_f32 v146, v148, v149
    v_cvt_pk_bf16_f32 v147, v150, v151
    v_cvt_pk_bf16_f32 v148, v152, v153
    v_cvt_pk_bf16_f32 v149, v154, v155
    v_cvt_pk_bf16_f32 v150, v156, v157
    v_cvt_pk_bf16_f32 v151, v158, v159
    s_waitcnt lgkmcnt(0)
    v_mfma_f32_32x32x16_bf16 v[192:207], v[18:21], v[144:147], v[192:207]
    v_mfma_f32_32x32x16_bf16 v[192:207], v[22:25], v[148:151], v[192:207]
    s_waitcnt vmcnt(0)
    ds_write_b128 v6, v[212:215] offset:32768
    ds_write_b128 v6, v[216:219] offset:40960
    ds_write_b128 v6, v[220:223] offset:49152
    ds_write_b128 v6, v[224:227] offset:57344
    s_waitcnt lgkmcnt(0)
    s_barrier
    ds_read_b128 v[160:163], v7 offset:32768
    ds_read_b128 v[164:167], v7 offset:33792
    ds_read_b128 v[168:171], v7 offset:34816
    ds_read_b128 v[172:175], v7 offset:35840
    ds_read_b128 v[176:179], v7 offset:36864
    ds_read_b128 v[180:183], v7 offset:37888
    ds_read_b128 v[184:187], v7 offset:38912
    ds_read_b128 v[188:191], v7 offset:39936
    s_nop 7
    v_max3_f32 v209, v32, v33, v34
    v_max3_f32 v209, v209, v35, v36
    v_max3_f32 v209, v209, v37, v38
    v_max3_f32 v209, v209, v39, v40
    v_max3_f32 v209, v209, v41, v42
    v_max3_f32 v209, v209, v43, v44
    v_max3_f32 v209, v209, v45, v46
    v_max3_f32 v209, v209, v47, v48
    v_max3_f32 v209, v209, v49, v50
    v_max3_f32 v209, v209, v51, v52
    v_max3_f32 v209, v209, v53, v54
    v_max3_f32 v209, v209, v55, v56
    v_max3_f32 v209, v209, v57, v58
    v_max3_f32 v209, v209, v59, v60
    v_max3_f32 v209, v209, v61, v62
    v_max3_f32 v209, v209, v63, v64
    v_max3_f32 v209, v209, v65, v66
    v_max3_f32 v209, v209, v67, v68
    v_max3_f32 v209, v209, v69, v70
    v_max3_f32 v209, v209, v71, v72
    v_max3_f32 v209, v209, v73, v74
    v_max3_f32 v209, v209, v75, v76
    v_max3_f32 v209, v209, v77, v78
    v_max3_f32 v209, v209, v79, v80
    v_max3_f32 v209, v209, v81, v82
    v_max3_f32 v209, v209, v83, v84
    v_max3_f32 v209, v209, v85, v86
    v_max3_f32 v209, v209, v87, v88
    v_max3_f32 v209, v209, v89, v90
    v_max3_f32 v209, v209, v91, v92
    v_max3_f32 v209, v209, v93, v94
    v_max_f32 v209, v209, v95
    v_mov_b32 v210, v209
    s_nop 1
    v_permlane32_swap_b32 v209, v210
    s_nop 1
    v_max_f32 v209, v209, v210
    v_cmp_lt_f32 vcc, 8.0, v209
    s_cbranch_vccz K2_back6
    v_max_f32 v209, 0, v209
    v_sub_f32 v210, 0, v209
    v_exp_f32 v210, v210
    v_sub_f32 v32, v32, v209
    v_sub_f32 v33, v33, v209
    v_sub_f32 v34, v34, v209
    v_sub_f32 v35, v35, v209
    v_sub_f32 v36, v36, v209
    v_sub_f32 v37, v37, v209
    v_sub_f32 v38, v38, v209
    v_sub_f32 v39, v39, v209
    v_sub_f32 v40, v40, v209
    v_sub_f32 v41, v41, v209
    v_sub_f32 v42, v42, v209
    v_sub_f32 v43, v43, v209
    v_sub_f32 v44, v44, v209
    v_sub_f32 v45, v45, v209
    v_sub_f32 v46, v46, v209
    v_sub_f32 v47, v47, v209
    v_sub_f32 v48, v48, v209
    v_sub_f32 v49, v49, v209
    v_sub_f32 v50, v50, v209
    v_sub_f32 v51, v51, v209
    v_sub_f32 v52, v52, v209
    v_sub_f32 v53, v53, v209
    v_sub_f32 v54, v54, v209
    v_sub_f32 v55, v55, v209
    v_sub_f32 v56, v56, v209
    v_sub_f32 v57, v57, v209
    v_sub_f32 v58, v58, v209
    v_sub_f32 v59, v59, v209
    v_sub_f32 v60, v60, v209
    v_sub_f32 v61, v61, v209
    v_sub_f32 v62, v62, v209
    v_sub_f32 v63, v63, v209
    v_sub_f32 v64, v64, v209
    v_sub_f32 v65, v65, v209
    v_sub_f32 v66, v66, v209
    v_sub_f32 v67, v67, v209
    v_sub_f32 v68, v68, v209
    v_sub_f32 v69, v69, v209
    v_sub_f32 v70, v70, v209
    v_sub_f32 v71, v71, v209
    v_sub_f32 v72, v72, v209
    v_sub_f32 v73, v73, v209
    v_sub_f32 v74, v74, v209
    v_sub_f32 v75, v75, v209
    v_sub_f32 v76, v76, v209
    v_sub_f32 v77, v77, v209
    v_sub_f32 v78, v78, v209
    v_sub_f32 v79, v79, v209
    v_sub_f32 v80, v80, v209
    v_sub_f32 v81, v81, v209
    v_sub_f32 v82, v82, v209
    v_sub_f32 v83, v83, v209
    v_sub_f32 v84, v84, v209
    v_sub_f32 v85, v85, v209
    v_sub_f32 v86, v86, v209
    v_sub_f32 v87, v87, v209
    v_sub_f32 v88, v88, v209
    v_sub_f32 v89, v89, v209
    v_sub_f32 v90, v90, v209
    v_sub_f32 v91, v91, v209
    v_sub_f32 v92, v92, v209
    v_sub_f32 v93, v93, v209
    v_sub_f32 v94, v94, v209
    v_sub_f32 v95, v95, v209
    v_mul_f32 v192, v192, v210
    v_mul_f32 v193, v193, v210
    v_mul_f32 v194, v194, v210
    v_mul_f32 v195, v195, v210
    v_mul_f32 v196, v196, v210
    v_mul_f32 v197, v197, v210
    v_mul_f32 v198, v198, v210
    v_mul_f32 v199, v199, v210
    v_mul_f32 v200, v200, v210
    v_mul_f32 v201, v201, v210
    v_mul_f32 v202, v202, v210
    v_mul_f32 v203, v203, v210
    v_mul_f32 v204, v204, v210
    v_mul_f32 v205, v205, v210
    v_mul_f32 v206, v206, v210
    v_mul_f32 v207, v207, v210
    v_sub_f32 v236, v236, v209
    v_sub_f32 v237, v237, v209
    v_sub_f32 v238, v238, v209
    v_sub_f32 v239, v239, v209
    v_sub_f32 v240, v240, v209
    v_sub_f32 v241, v241, v209
    v_sub_f32 v242, v242, v209
    v_sub_f32 v243, v243, v209
    v_sub_f32 v244, v244, v209
    v_sub_f32 v245, v245, v209
    v_sub_f32 v246, v246, v209
    v_sub_f32 v247, v247, v209
    v_sub_f32 v248, v248, v209
    v_sub_f32 v249, v249, v209
    v_sub_f32 v250, v250, v209
    v_sub_f32 v251, v251, v209
K2_back6:
    s_waitcnt lgkmcnt(0)
    ds_read_b128 v[228:231], v7 offset:8192
    ds_read_b128 v[232:235], v7 offset:9216
    v_exp_f32 v32, v32
    v_mfma_f32_32x32x16_bf16 v[96:111], v[160:163], v[8:11], v[236:251]
    v_exp_f32 v33, v33
    v_exp_f32 v34, v34
    v_exp_f32 v35, v35
    v_exp_f32 v36, v36
    v_exp_f32 v37, v37
    v_exp_f32 v38, v38
    v_exp_f32 v39, v39
    v_exp_f32 v40, v40
    v_mfma_f32_32x32x16_bf16 v[96:111], v[164:167], v[12:15], v[96:111]
    v_exp_f32 v41, v41
    v_exp_f32 v42, v42
    v_exp_f32 v43, v43
    v_exp_f32 v44, v44
    v_exp_f32 v45, v45
    v_exp_f32 v46, v46
    v_exp_f32 v47, v47
    v_cvt_pk_bf16_f32 v32, v32, v33
    v_cvt_pk_bf16_f32 v33, v34, v35
    v_cvt_pk_bf16_f32 v34, v36, v37
    v_cvt_pk_bf16_f32 v35, v38, v39
    v_cvt_pk_bf16_f32 v36, v40, v41
    v_cvt_pk_bf16_f32 v37, v42, v43
    v_cvt_pk_bf16_f32 v38, v44, v45
    v_cvt_pk_bf16_f32 v39, v46, v47
    s_waitcnt lgkmcnt(0)
    ds_read_b128 v[18:21], v7 offset:10240
    ds_read_b128 v[22:25], v7 offset:11264
    v_mfma_f32_32x32x16_bf16 v[192:207], v[228:231], v[32:35], v[192:207]
    v_mfma_f32_32x32x16_bf16 v[192:207], v[232:235], v[36:39], v[192:207]
    v_exp_f32 v48, v48
    v_mfma_f32_32x32x16_bf16 v[112:127], v[168:171], v[8:11], v[236:251]
    v_exp_f32 v49, v49
    v_exp_f32 v50, v50
    v_exp_f32 v51, v51
    v_exp_f32 v52, v52
    v_exp_f32 v53, v53
    v_exp_f32 v54, v54
    v_exp_f32 v55, v55
    v_exp_f32 v56, v56
    v_mfma_f32_32x32x16_bf16 v[112:127], v[172:175], v[12:15], v[112:127]
    v_exp_f32 v57, v57
    v_exp_f32 v58, v58
    v_exp_f32 v59, v59
    v_exp_f32 v60, v60
    v_exp_f32 v61, v61
    v_exp_f32 v62, v62
    v_exp_f32 v63, v63
    v_cvt_pk_bf16_f32 v48, v48, v49
    v_cvt_pk_bf16_f32 v49, v50, v51
    v_cvt_pk_bf16_f32 v50, v52, v53
    v_cvt_pk_bf16_f32 v51, v54, v55
    v_cvt_pk_bf16_f32 v52, v56, v57
    v_cvt_pk_bf16_f32 v53, v58, v59
    v_cvt_pk_bf16_f32 v54, v60, v61
    v_cvt_pk_bf16_f32 v55, v62, v63
    s_waitcnt lgkmcnt(0)
    ds_read_b128 v[228:231], v7 offset:12288
    ds_read_b128 v[232:235], v7 offset:13312
    v_mfma_f32_32x32x16_bf16 v[192:207], v[18:21], v[48:51], v[192:207]
    v_mfma_f32_32x32x16_bf16 v[192:207], v[22:25], v[52:55], v[192:207]
    v_exp_f32 v64, v64
    v_mfma_f32_32x32x16_bf16 v[128:143], v[176:179], v[8:11], v[236:251]
    v_exp_f32 v65, v65
    v_exp_f32 v66, v66
    v_exp_f32 v67, v67
    v_exp_f32 v68, v68
    v_exp_f32 v69, v69
    v_exp_f32 v70, v70
    v_exp_f32 v71, v71
    v_exp_f32 v72, v72
    v_mfma_f32_32x32x16_bf16 v[128:143], v[180:183], v[12:15], v[128:143]
    v_exp_f32 v73, v73
    v_exp_f32 v74, v74
    v_exp_f32 v75, v75
    v_exp_f32 v76, v76
    v_exp_f32 v77, v77
    v_exp_f32 v78, v78
    v_exp_f32 v79, v79
    v_cvt_pk_bf16_f32 v64, v64, v65
    v_cvt_pk_bf16_f32 v65, v66, v67
    v_cvt_pk_bf16_f32 v66, v68, v69
    v_cvt_pk_bf16_f32 v67, v70, v71
    v_cvt_pk_bf16_f32 v68, v72, v73
    v_cvt_pk_bf16_f32 v69, v74, v75
    v_cvt_pk_bf16_f32 v70, v76, v77
    v_cvt_pk_bf16_f32 v71, v78, v79
    s_waitcnt lgkmcnt(0)
    ds_read_b128 v[18:21], v7 offset:14336
    ds_read_b128 v[22:25], v7 offset:15360
    v_mfma_f32_32x32x16_bf16 v[192:207], v[228:231], v[64:67], v[192:207]
    v_mfma_f32_32x32x16_bf16 v[192:207], v[232:235], v[68:71], v[192:207]
    v_exp_f32 v80, v80
    v_mfma_f32_32x32x16_bf16 v[144:159], v[184:187], v[8:11], v[236:251]
    v_exp_f32 v81, v81
    v_exp_f32 v82, v82
    v_exp_f32 v83, v83
    v_exp_f32 v84, v84
    v_exp_f32 v85, v85
    v_exp_f32 v86, v86
    v_exp_f32 v87, v87
    v_exp_f32 v88, v88
    v_mfma_f32_32x32x16_bf16 v[144:159], v[188:191], v[12:15], v[144:159]
    v_exp_f32 v89, v89
    v_exp_f32 v90, v90
    v_exp_f32 v91, v91
    v_exp_f32 v92, v92
    v_exp_f32 v93, v93
    v_exp_f32 v94, v94
    v_exp_f32 v95, v95
    v_cvt_pk_bf16_f32 v80, v80, v81
    v_cvt_pk_bf16_f32 v81, v82, v83
    v_cvt_pk_bf16_f32 v82, v84, v85
    v_cvt_pk_bf16_f32 v83, v86, v87
    v_cvt_pk_bf16_f32 v84, v88, v89
    v_cvt_pk_bf16_f32 v85, v90, v91
    v_cvt_pk_bf16_f32 v86, v92, v93
    v_cvt_pk_bf16_f32 v87, v94, v95
    s_waitcnt lgkmcnt(0)
    v_mfma_f32_32x32x16_bf16 v[192:207], v[18:21], v[80:83], v[192:207]
    v_mfma_f32_32x32x16_bf16 v[192:207], v[22:25], v[84:87], v[192:207]
    s_waitcnt lgkmcnt(0)
    s_barrier
    s_nop 7
    v_max3_f32 v209, v96, v97, v98
    v_max3_f32 v209, v209, v99, v100
    v_max3_f32 v209, v209, v101, v102
    v_max3_f32 v209, v209, v103, v104
    v_max3_f32 v209, v209, v105, v106
    v_max3_f32 v209, v209, v107, v108
    v_max3_f32 v209, v209, v109, v110
    v_max3_f32 v209, v209, v111, v112
    v_max3_f32 v209, v209, v113, v114
    v_max3_f32 v209, v209, v115, v116
    v_max3_f32 v209, v209, v117, v118
    v_max3_f32 v209, v209, v119, v120
    v_max3_f32 v209, v209, v121, v122
    v_max3_f32 v209, v209, v123, v124
    v_max3_f32 v209, v209, v125, v126
    v_max3_f32 v209, v209, v127, v128
    v_max3_f32 v209, v209, v129, v130
    v_max3_f32 v209, v209, v131, v132
    v_max3_f32 v209, v209, v133, v134
    v_max3_f32 v209, v209, v135, v136
    v_max3_f32 v209, v209, v137, v138
    v_max3_f32 v209, v209, v139, v140
    v_max3_f32 v209, v209, v141, v142
    v_max3_f32 v209, v209, v143, v144
    v_max3_f32 v209, v209, v145, v146
    v_max3_f32 v209, v209, v147, v148
    v_max3_f32 v209, v209, v149, v150
    v_max3_f32 v209, v209, v151, v152
    v_max3_f32 v209, v209, v153, v154
    v_max3_f32 v209, v209, v155, v156
    v_max3_f32 v209, v209, v157, v158
    v_max_f32 v209, v209, v159
    v_mov_b32 v210, v209
    s_nop 1
    v_permlane32_swap_b32 v209, v210
    s_nop 1
    v_max_f32 v209, v209, v210
    v_cmp_lt_f32 vcc, 8.0, v209
    s_cbranch_vccz K2_back7
    v_max_f32 v209, 0, v209
    v_sub_f32 v210, 0, v209
    v_exp_f32 v210, v210
    v_sub_f32 v96, v96, v209
    v_sub_f32 v97, v97, v209
    v_sub_f32 v98, v98, v209
    v_sub_f32 v99, v99, v209
    v_sub_f32 v100, v100, v209
    v_sub_f32 v101, v101, v209
    v_sub_f32 v102, v102, v209
    v_sub_f32 v103, v103, v209
    v_sub_f32 v104, v104, v209
    v_sub_f32 v105, v105, v209
    v_sub_f32 v106, v106, v209
    v_sub_f32 v107, v107, v209
    v_sub_f32 v108, v108, v209
    v_sub_f32 v109, v109, v209
    v_sub_f32 v110, v110, v209
    v_sub_f32 v111, v111, v209
    v_sub_f32 v112, v112, v209
    v_sub_f32 v113, v113, v209
    v_sub_f32 v114, v114, v209
    v_sub_f32 v115, v115, v209
    v_sub_f32 v116, v116, v209
    v_sub_f32 v117, v117, v209
    v_sub_f32 v118, v118, v209
    v_sub_f32 v119, v119, v209
    v_sub_f32 v120, v120, v209
    v_sub_f32 v121, v121, v209
    v_sub_f32 v122, v122, v209
    v_sub_f32 v123, v123, v209
    v_sub_f32 v124, v124, v209
    v_sub_f32 v125, v125, v209
    v_sub_f32 v126, v126, v209
    v_sub_f32 v127, v127, v209
    v_sub_f32 v128, v128, v209
    v_sub_f32 v129, v129, v209
    v_sub_f32 v130, v130, v209
    v_sub_f32 v131, v131, v209
    v_sub_f32 v132, v132, v209
    v_sub_f32 v133, v133, v209
    v_sub_f32 v134, v134, v209
    v_sub_f32 v135, v135, v209
    v_sub_f32 v136, v136, v209
    v_sub_f32 v137, v137, v209
    v_sub_f32 v138, v138, v209
    v_sub_f32 v139, v139, v209
    v_sub_f32 v140, v140, v209
    v_sub_f32 v141, v141, v209
    v_sub_f32 v142, v142, v209
    v_sub_f32 v143, v143, v209
    v_sub_f32 v144, v144, v209
    v_sub_f32 v145, v145, v209
    v_sub_f32 v146, v146, v209
    v_sub_f32 v147, v147, v209
    v_sub_f32 v148, v148, v209
    v_sub_f32 v149, v149, v209
    v_sub_f32 v150, v150, v209
    v_sub_f32 v151, v151, v209
    v_sub_f32 v152, v152, v209
    v_sub_f32 v153, v153, v209
    v_sub_f32 v154, v154, v209
    v_sub_f32 v155, v155, v209
    v_sub_f32 v156, v156, v209
    v_sub_f32 v157, v157, v209
    v_sub_f32 v158, v158, v209
    v_sub_f32 v159, v159, v209
    v_mul_f32 v192, v192, v210
    v_mul_f32 v193, v193, v210
    v_mul_f32 v194, v194, v210
    v_mul_f32 v195, v195, v210
    v_mul_f32 v196, v196, v210
    v_mul_f32 v197, v197, v210
    v_mul_f32 v198, v198, v210
    v_mul_f32 v199, v199, v210
    v_mul_f32 v200, v200, v210
    v_mul_f32 v201, v201, v210
    v_mul_f32 v202, v202, v210
    v_mul_f32 v203, v203, v210
    v_mul_f32 v204, v204, v210
    v_mul_f32 v205, v205, v210
    v_mul_f32 v206, v206, v210
    v_mul_f32 v207, v207, v210
    v_sub_f32 v236, v236, v209
    v_sub_f32 v237, v237, v209
    v_sub_f32 v238, v238, v209
    v_sub_f32 v239, v239, v209
    v_sub_f32 v240, v240, v209
    v_sub_f32 v241, v241, v209
    v_sub_f32 v242, v242, v209
    v_sub_f32 v243, v243, v209
    v_sub_f32 v244, v244, v209
    v_sub_f32 v245, v245, v209
    v_sub_f32 v246, v246, v209
    v_sub_f32 v247, v247, v209
    v_sub_f32 v248, v248, v209
    v_sub_f32 v249, v249, v209
    v_sub_f32 v250, v250, v209
    v_sub_f32 v251, v251, v209
K2_back7:
    ds_read_b128 v[228:231], v7 offset:40960
    ds_read_b128 v[232:235], v7 offset:41984
    v_exp_f32 v96, v96
    v_exp_f32 v97, v97
    v_exp_f32 v98, v98
    v_exp_f32 v99, v99
    v_exp_f32 v100, v100
    v_exp_f32 v101, v101
    v_exp_f32 v102, v102
    v_exp_f32 v103, v103
    v_exp_f32 v104, v104
    v_exp_f32 v105, v105
    v_exp_f32 v106, v106
    v_exp_f32 v107, v107
    v_exp_f32 v108, v108
    v_exp_f32 v109, v109
    v_exp_f32 v110, v110
    v_exp_f32 v111, v111
    v_cvt_pk_bf16_f32 v96, v96, v97
    v_cvt_pk_bf16_f32 v97, v98, v99
    v_cvt_pk_bf16_f32 v98, v100, v101
    v_cvt_pk_bf16_f32 v99, v102, v103
    v_cvt_pk_bf16_f32 v100, v104, v105
    v_cvt_pk_bf16_f32 v101, v106, v107
    v_cvt_pk_bf16_f32 v102, v108, v109
    v_cvt_pk_bf16_f32 v103, v110, v111
    s_waitcnt lgkmcnt(0)
    ds_read_b128 v[18:21], v7 offset:43008
    ds_read_b128 v[22:25], v7 offset:44032
    v_mfma_f32_32x32x16_bf16 v[192:207], v[228:231], v[96:99], v[192:207]
    v_mfma_f32_32x32x16_bf16 v[192:207], v[232:235], v[100:103], v[192:207]
    v_exp_f32 v112, v112
    v_exp_f32 v113, v113
    v_exp_f32 v114, v114
    v_exp_f32 v115, v115
    v_exp_f32 v116, v116
    v_exp_f32 v117, v117
    v_exp_f32 v118, v118
    v_exp_f32 v119, v119
    v_exp_f32 v120, v120
    v_exp_f32 v121, v121
    v_exp_f32 v122, v122
    v_exp_f32 v123, v123
    v_exp_f32 v124, v124
    v_exp_f32 v125, v125
    v_exp_f32 v126, v126
    v_exp_f32 v127, v127
    v_cvt_pk_bf16_f32 v112, v112, v113
    v_cvt_pk_bf16_f32 v113, v114, v115
    v_cvt_pk_bf16_f32 v114, v116, v117
    v_cvt_pk_bf16_f32 v115, v118, v119
    v_cvt_pk_bf16_f32 v116, v120, v121
    v_cvt_pk_bf16_f32 v117, v122, v123
    v_cvt_pk_bf16_f32 v118, v124, v125
    v_cvt_pk_bf16_f32 v119, v126, v127
    s_waitcnt lgkmcnt(0)
    ds_read_b128 v[228:231], v7 offset:45056
    ds_read_b128 v[232:235], v7 offset:46080
    v_mfma_f32_32x32x16_bf16 v[192:207], v[18:21], v[112:115], v[192:207]
    v_mfma_f32_32x32x16_bf16 v[192:207], v[22:25], v[116:119], v[192:207]
    v_exp_f32 v128, v128
    v_exp_f32 v129, v129
    v_exp_f32 v130, v130
    v_exp_f32 v131, v131
    v_exp_f32 v132, v132
    v_exp_f32 v133, v133
    v_exp_f32 v134, v134
    v_exp_f32 v135, v135
    v_exp_f32 v136, v136
    v_exp_f32 v137, v137
    v_exp_f32 v138, v138
    v_exp_f32 v139, v139
    v_exp_f32 v140, v140
    v_exp_f32 v141, v141
    v_exp_f32 v142, v142
    v_exp_f32 v143, v143
    v_cvt_pk_bf16_f32 v128, v128, v129
    v_cvt_pk_bf16_f32 v129, v130, v131
    v_cvt_pk_bf16_f32 v130, v132, v133
    v_cvt_pk_bf16_f32 v131, v134, v135
    v_cvt_pk_bf16_f32 v132, v136, v137
    v_cvt_pk_bf16_f32 v133, v138, v139
    v_cvt_pk_bf16_f32 v134, v140, v141
    v_cvt_pk_bf16_f32 v135, v142, v143
    s_waitcnt lgkmcnt(0)
    ds_read_b128 v[18:21], v7 offset:47104
    ds_read_b128 v[22:25], v7 offset:48128
    v_mfma_f32_32x32x16_bf16 v[192:207], v[228:231], v[128:131], v[192:207]
    v_mfma_f32_32x32x16_bf16 v[192:207], v[232:235], v[132:135], v[192:207]
    v_exp_f32 v144, v144
    v_exp_f32 v145, v145
    v_exp_f32 v146, v146
    v_exp_f32 v147, v147
    v_exp_f32 v148, v148
    v_exp_f32 v149, v149
    v_exp_f32 v150, v150
    v_exp_f32 v151, v151
    v_exp_f32 v152, v152
    v_exp_f32 v153, v153
    v_exp_f32 v154, v154
    v_exp_f32 v155, v155
    v_exp_f32 v156, v156
    v_exp_f32 v157, v157
    v_exp_f32 v158, v158
    v_exp_f32 v159, v159
    v_cvt_pk_bf16_f32 v144, v144, v145
    v_cvt_pk_bf16_f32 v145, v146, v147
    v_cvt_pk_bf16_f32 v146, v148, v149
    v_cvt_pk_bf16_f32 v147, v150, v151
    v_cvt_pk_bf16_f32 v148, v152, v153
    v_cvt_pk_bf16_f32 v149, v154, v155
    v_cvt_pk_bf16_f32 v150, v156, v157
    v_cvt_pk_bf16_f32 v151, v158, v159
    s_waitcnt lgkmcnt(0)
    v_mfma_f32_32x32x16_bf16 v[192:207], v[18:21], v[144:147], v[192:207]
    v_mfma_f32_32x32x16_bf16 v[192:207], v[22:25], v[148:151], v[192:207]
    s_waitcnt lgkmcnt(0)
    s_barrier
    s_nop 15
    v_sub_f32 v208, 0, v236
    s_cmp_ge_u32 s4, 4
    s_cbranch_scc1 K2_hi
    s_barrier
    s_mul_i32 s10, s5, 4352
    v_lshlrev_b32 v7, 2, v2
    v_add_u32 v7, s10, v7
    ds_read_b32 v32, v7 offset:0
    ds_read_b32 v33, v7 offset:256
    ds_read_b32 v34, v7 offset:512
    ds_read_b32 v35, v7 offset:768
    ds_read_b32 v36, v7 offset:1024
    ds_read_b32 v37, v7 offset:1280
    ds_read_b32 v38, v7 offset:1536
    ds_read_b32 v39, v7 offset:1792
    ds_read_b32 v40, v7 offset:2048
    ds_read_b32 v41, v7 offset:2304
    ds_read_b32 v42, v7 offset:2560
    ds_read_b32 v43, v7 offset:2816
    ds_read_b32 v44, v7 offset:3072
    ds_read_b32 v45, v7 offset:3328
    ds_read_b32 v46, v7 offset:3584
    ds_read_b32 v47, v7 offset:3840
    ds_read_b32 v48, v7 offset:4096
    s_lshl_b32 s10, s7, 1
    v_lshrrev_b32 v50, 4, v3
    v_add_u32 v50, s10, v50
    v_lshlrev_b32 v51, 2, v50
    v_add_u32 v51, 11534336, v51
    buffer_load_dword v52, v51, s[16:19], 0 offen
    s_waitcnt lgkmcnt(0) vmcnt(0)
    v_max_f32 v53, v208, v32
    v_sub_f32 v54, v208, v53
    v_sub_f32 v55, v32, v53
    v_exp_f32 v54, v54
    v_exp_f32 v55, v55
    s_nop 0
    v_mul_f32 v192, v192, v54
    v_fmac_f32 v192, v33, v55
    v_mul_f32 v193, v193, v54
    v_fmac_f32 v193, v34, v55
    v_mul_f32 v194, v194, v54
    v_fmac_f32 v194, v35, v55
    v_mul_f32 v195, v195, v54
    v_fmac_f32 v195, v36, v55
    v_mul_f32 v196, v196, v54
    v_fmac_f32 v196, v37, v55
    v_mul_f32 v197, v197, v54
    v_fmac_f32 v197, v38, v55
    v_mul_f32 v198, v198, v54
    v_fmac_f32 v198, v39, v55
    v_mul_f32 v199, v199, v54
    v_fmac_f32 v199, v40, v55
    v_mul_f32 v200, v200, v54
    v_fmac_f32 v200, v41, v55
    v_mul_f32 v201, v201, v54
    v_fmac_f32 v201, v42, v55
    v_mul_f32 v202, v202, v54
    v_fmac_f32 v202, v43, v55
    v_mul_f32 v203, v203, v54
    v_fmac_f32 v203, v44, v55
    v_mul_f32 v204, v204, v54
    v_fmac_f32 v204, v45, v55
    v_mul_f32 v205, v205, v54
    v_fmac_f32 v205, v46, v55
    v_mul_f32 v206, v206, v54
    v_fmac_f32 v206, v47, v55
    v_mul_f32 v207, v207, v54
    v_fmac_f32 v207, v48, v55
    v_mov_b32 v56, v204
    v_mov_b32 v57, v56
    s_nop 1
    v_permlane32_swap_b32 v56, v57
    s_nop 1
    v_mul_f32 v52, 0xbfb8aa3b, v52
    v_exp_f32 v52, v52
    s_nop 0
    v_add_f32 v52, 1.0, v52
    v_mul_f32 v52, v52, v57
    v_rcp_f32 v52, v52
    s_nop 0
    v_mul_f32 v192, v192, v52
    v_mul_f32 v193, v193, v52
    v_mul_f32 v194, v194, v52
    v_mul_f32 v195, v195, v52
    v_mul_f32 v196, v196, v52
    v_mul_f32 v197, v197, v52
    v_mul_f32 v198, v198, v52
    v_mul_f32 v199, v199, v52
    v_mul_f32 v200, v200, v52
    v_mul_f32 v201, v201, v52
    v_mul_f32 v202, v202, v52
    v_mul_f32 v203, v203, v52
    v_mul_f32 v204, v204, v52
    v_mul_f32 v205, v205, v52
    v_mul_f32 v206, v206, v52
    v_mul_f32 v207, v207, v52
    v_lshrrev_b32 v58, 5, v50
    s_mov_b32 s10, 57344
    v_mul_lo_u32 v58, v58, s10
    v_and_b32 v59, 31, v50
    v_lshl_add_u32 v58, v59, 4, v58
    v_add_u32 v58, 7864320, v58
    v_and_b32 v59, 15, v3
    v_mul_u32_u24 v59, 28, v59
    v_lshl_add_u32 v59, v4, 2, v59
    v_cvt_pk_bf16_f32 v192, v192, v193
    v_cvt_pk_bf16_f32 v193, v194, v195
    v_add_u32 v60, 0, v59
    v_lshrrev_b32 v61, 3, v60
    v_lshlrev_b32 v61, 9, v61
    v_and_b32 v60, 7, v60
    v_lshl_add_u32 v61, v60, 1, v61
    v_add_u32 v61, v61, v58
    buffer_store_dwordx2 v[192:193], v61, s[16:19], 0 offen
    v_cvt_pk_bf16_f32 v196, v196, v197
    v_cvt_pk_bf16_f32 v197, v198, v199
    v_add_u32 v60, 8, v59
    v_lshrrev_b32 v61, 3, v60
    v_lshlrev_b32 v61, 9, v61
    v_and_b32 v60, 7, v60
    v_lshl_add_u32 v61, v60, 1, v61
    v_add_u32 v61, v61, v58
    buffer_store_dwordx2 v[196:197], v61, s[16:19], 0 offen
    v_cvt_pk_bf16_f32 v200, v200, v201
    v_cvt_pk_bf16_f32 v201, v202, v203
    v_add_u32 v60, 16, v59
    v_lshrrev_b32 v61, 3, v60
    v_lshlrev_b32 v61, 9, v61
    v_and_b32 v60, 7, v60
    v_lshl_add_u32 v61, v60, 1, v61
    v_add_u32 v61, v61, v58
    buffer_store_dwordx2 v[200:201], v61, s[16:19], 0 offen
    v_cvt_pk_bf16_f32 v204, v204, v205
    v_cvt_pk_bf16_f32 v205, v206, v207
    v_add_u32 v60, 24, v59
    v_lshrrev_b32 v61, 3, v60
    v_lshlrev_b32 v61, 9, v61
    v_and_b32 v60, 7, v60
    v_lshl_add_u32 v61, v60, 1, v61
    v_add_u32 v61, v61, v58
    s_andn2_b64 exec, exec, s[30:31]
    buffer_store_dwordx2 v[204:205], v61, s[16:19], 0 offen
    s_endpgm
K2_hi:
    s_mul_i32 s10, s5, 4352
    v_lshlrev_b32 v7, 2, v2
    v_add_u32 v7, s10, v7
    ds_write_b32 v7, v208 offset:0
    ds_write_b32 v7, v192 offset:256
    ds_write_b32 v7, v193 offset:512
    ds_write_b32 v7, v194 offset:768
    ds_write_b32 v7, v195 offset:1024
    ds_write_b32 v7, v196 offset:1280
    ds_write_b32 v7, v197 offset:1536
    ds_write_b32 v7, v198 offset:1792
    ds_write_b32 v7, v199 offset:2048
    ds_write_b32 v7, v200 offset:2304
    ds_write_b32 v7, v201 offset:2560
    ds_write_b32 v7, v202 offset:2816
    ds_write_b32 v7, v203 offset:3072
    ds_write_b32 v7, v204 offset:3328
    ds_write_b32 v7, v205 offset:3584
    ds_write_b32 v7, v206 offset:3840
    ds_write_b32 v7, v207 offset:4096
    s_waitcnt lgkmcnt(0)
    s_barrier
    s_and_b32 s10, s2, 3
    s_lshl_b32 s10, s10, 2
    s_add_u32 s10, s10, s5
    s_lshr_b32 s11, s2, 2
    s_lshl_b32 s12, s11, 5
    s_mul_i32 s13, s10, 56
    v_add_u32 v230, s12, v3
    s_movk_i32 s14, 1792
    v_mul_lo_u32 v231, v230, s14
    v_lshl_add_u32 v231, v4, 4, v231
    s_add_u32 s15, s13, 2359296
    buffer_load_dwordx4 v[8:11], v231, s[16:19], s15 offen
    buffer_load_dwordx4 v[12:15], v231, s[16:19], s15 offen offset:32
    s_add_u32 s15, s13, 2302848
    buffer_load_dwordx4 v[96:99], v231, s[16:19], s15 offen
    buffer_load_dwordx4 v[100:103], v231, s[16:19], s15 offen offset:32
    s_add_u32 s15, s13, 2360192
    buffer_load_dwordx4 v[104:107], v231, s[16:19], s15 offen
    buffer_load_dwordx4 v[108:111], v231, s[16:19], s15 offen offset:32
    s_mul_i32 s15, s10, 28
    v_add_u32 v232, s15, v3
    v_lshlrev_b32 v232, 12, v232
    v_lshl_add_u32 v232, v4, 3, v232
    s_lshl_b32 s15, s12, 1
    v_add_u32 v232, s15, v232
    s_mov_b32 s15, 6029248
    buffer_load_dwordx2 v[128:129], v232, s[16:19], s15 offen offset:0
    buffer_load_dwordx2 v[130:131], v232, s[16:19], s15 offen offset:16
    buffer_load_dwordx2 v[132:133], v232, s[16:19], s15 offen offset:32
    buffer_load_dwordx2 v[134:135], v232, s[16:19], s15 offen offset:48
    buffer_load_dwordx2 v[136:137], v232, s[16:19], s15 offen offset:64
    buffer_load_dwordx2 v[138:139], v232, s[16:19], s15 offen offset:80
    buffer_load_dwordx2 v[140:141], v232, s[16:19], s15 offen offset:96
    buffer_load_dwordx2 v[142:143], v232, s[16:19], s15 offen offset:112
    v_lshlrev_b32 v233, 2, v230
    v_add_u32 v233, 11534336, v233
    buffer_load_dword v234, v233, s[16:19], 0 offen
    s_waitcnt vmcnt(0)
    v_cndmask_b32 v14, v14, 0, s[30:31]
    v_cndmask_b32 v15, v15, 0, s[30:31]
    s_nop 1
    v_mfma_f32_32x32x16_bf16 v[32:47], v[96:99], v[8:11], 0
    v_mfma_f32_32x32x16_bf16 v[32:47], v[100:103], v[12:15], v[32:47]
    v_mfma_f32_32x32x16_bf16 v[48:63], v[104:107], v[8:11], 0
    v_mfma_f32_32x32x16_bf16 v[48:63], v[108:111], v[12:15], v[48:63]
    v_lshlrev_b32 v235, 2, v4
    v_sub_u32 v235, v3, v235
    v_add_u32 v235, 32, v235
    s_cmp_eq_u32 s11, 0
    s_cselect_b32 s15, 0x1000, 0
    v_add_u32 v236, s15, v235
    s_nop 15
    v_subrev_u32 v237, 0, v236
    v_and_b32 v237, 0xfffffff1, v237
    v_cmp_eq_u32 vcc, 0, v237
    v_mov_b32 v238, 0xf149f2ca
    s_nop 0
    v_cndmask_b32 v32, v238, v32, vcc
    v_subrev_u32 v237, 1, v236
    v_and_b32 v237, 0xfffffff1, v237
    v_cmp_eq_u32 vcc, 0, v237
    v_mov_b32 v238, 0xf149f2ca
    s_nop 0
    v_cndmask_b32 v33, v238, v33, vcc
    v_subrev_u32 v237, 2, v236
    v_and_b32 v237, 0xfffffff1, v237
    v_cmp_eq_u32 vcc, 0, v237
    v_mov_b32 v238, 0xf149f2ca
    s_nop 0
    v_cndmask_b32 v34, v238, v34, vcc
    v_subrev_u32 v237, 3, v236
    v_and_b32 v237, 0xfffffff1, v237
    v_cmp_eq_u32 vcc, 0, v237
    v_mov_b32 v238, 0xf149f2ca
    s_nop 0
    v_cndmask_b32 v35, v238, v35, vcc
    v_subrev_u32 v237, 8, v236
    v_and_b32 v237, 0xfffffff1, v237
    v_cmp_eq_u32 vcc, 0, v237
    v_mov_b32 v238, 0xf149f2ca
    s_nop 0
    v_cndmask_b32 v36, v238, v36, vcc
    v_subrev_u32 v237, 9, v236
    v_and_b32 v237, 0xfffffff1, v237
    v_cmp_eq_u32 vcc, 0, v237
    v_mov_b32 v238, 0xf149f2ca
    s_nop 0
    v_cndmask_b32 v37, v238, v37, vcc
    v_subrev_u32 v237, 10, v236
    v_and_b32 v237, 0xfffffff1, v237
    v_cmp_eq_u32 vcc, 0, v237
    v_mov_b32 v238, 0xf149f2ca
    s_nop 0
    v_cndmask_b32 v38, v238, v38, vcc
    v_subrev_u32 v237, 11, v236
    v_and_b32 v237, 0xfffffff1, v237
    v_cmp_eq_u32 vcc, 0, v237
    v_mov_b32 v238, 0xf149f2ca
    s_nop 0
    v_cndmask_b32 v39, v238, v39, vcc
    v_subrev_u32 v237, 16, v236
    v_and_b32 v237, 0xfffffff1, v237
    v_cmp_eq_u32 vcc, 0, v237
    v_mov_b32 v238, 0xf149f2ca
    s_nop 0
    v_cndmask_b32 v40, v238, v40, vcc
    v_subrev_u32 v237, 17, v236
    v_and_b32 v237, 0xfffffff1, v237
    v_cmp_eq_u32 vcc, 0, v237
    v_mov_b32 v238, 0xf149f2ca
    s_nop 0
    v_cndmask_b32 v41, v238, v41, vcc
    v_subrev_u32 v237, 18, v236
    v_and_b32 v237, 0xfffffff1, v237
    v_cmp_eq_u32 vcc, 0, v237
    v_mov_b32 v238, 0xf149f2ca
    s_nop 0
    v_cndmask_b32 v42, v238, v42, vcc
    v_subrev_u32 v237, 19, v236
    v_and_b32 v237, 0xfffffff1, v237
    v_cmp_eq_u32 vcc, 0, v237
    v_mov_b32 v238, 0xf149f2ca
    s_nop 0
    v_cndmask_b32 v43, v238, v43, vcc
    v_subrev_u32 v237, 24, v236
    v_and_b32 v237, 0xfffffff1, v237
    v_cmp_eq_u32 vcc, 0, v237
    v_mov_b32 v238, 0xf149f2ca
    s_nop 0
    v_cndmask_b32 v44, v238, v44, vcc
    v_subrev_u32 v237, 25, v236
    v_and_b32 v237, 0xfffffff1, v237
    v_cmp_eq_u32 vcc, 0, v237
    v_mov_b32 v238, 0xf149f2ca
    s_nop 0
    v_cndmask_b32 v45, v238, v45, vcc
    v_subrev_u32 v237, 26, v236
    v_and_b32 v237, 0xfffffff1, v237
    v_cmp_eq_u32 vcc, 0, v237
    v_mov_b32 v238, 0xf149f2ca
    s_nop 0
    v_cndmask_b32 v46, v238, v46, vcc
    v_subrev_u32 v237, 27, v236
    v_and_b32 v237, 0xfffffff1, v237
    v_cmp_eq_u32 vcc, 0, v237
    v_mov_b32 v238, 0xf149f2ca
    s_nop 0
    v_cndmask_b32 v47, v238, v47, vcc
    v_subrev_u32 v237, 32, v235
    v_and_b32 v237, 0xfffffff1, v237
    v_cmp_eq_u32 vcc, 0, v237
    v_mov_b32 v238, 0xf149f2ca
    s_nop 0
    v_cndmask_b32 v48, v238, v48, vcc
    v_subrev_u32 v237, 33, v235
    v_and_b32 v237, 0xfffffff1, v237
    v_cmp_eq_u32 vcc, 0, v237
    v_mov_b32 v238, 0xf149f2ca
    s_nop 0
    v_cndmask_b32 v49, v238, v49, vcc
    v_subrev_u32 v237, 34, v235
    v_and_b32 v237, 0xfffffff1, v237
    v_cmp_eq_u32 vcc, 0, v237
    v_mov_b32 v238, 0xf149f2ca
    s_nop 0
    v_cndmask_b32 v50, v238, v50, vcc
    v_subrev_u32 v237, 35, v235
    v_and_b32 v237, 0xfffffff1, v237
    v_cmp_eq_u32 vcc, 0, v237
    v_mov_b32 v238, 0xf149f2ca
    s_nop 0
    v_cndmask_b32 v51, v238, v51, vcc
    v_subrev_u32 v237, 40, v235
    v_and_b32 v237, 0xfffffff1, v237
    v_cmp_eq_u32 vcc, 0, v237
    v_mov_b32 v238, 0xf149f2ca
    s_nop 0
    v_cndmask_b32 v52, v238, v52, vcc
    v_subrev_u32 v237, 41, v235
    v_and_b32 v237, 0xfffffff1, v237
    v_cmp_eq_u32 vcc, 0, v237
    v_mov_b32 v238, 0xf149f2ca
    s_nop 0
    v_cndmask_b32 v53, v238, v53, vcc
    v_subrev_u32 v237, 42, v235
    v_and_b32 v237, 0xfffffff1, v237
    v_cmp_eq_u32 vcc, 0, v237
    v_mov_b32 v238, 0xf149f2ca
    s_nop 0
    v_cndmask_b32 v54, v238, v54, vcc
    v_subrev_u32 v237, 43, v235
    v_and_b32 v237, 0xfffffff1, v237
    v_cmp_eq_u32 vcc, 0, v237
    v_mov_b32 v238, 0xf149f2ca
    s_nop 0
    v_cndmask_b32 v55, v238, v55, vcc
    v_subrev_u32 v237, 48, v235
    v_and_b32 v237, 0xfffffff1, v237
    v_cmp_eq_u32 vcc, 0, v237
    v_mov_b32 v238, 0xf149f2ca
    s_nop 0
    v_cndmask_b32 v56, v238, v56, vcc
    v_subrev_u32 v237, 49, v235
    v_and_b32 v237, 0xfffffff1, v237
    v_cmp_eq_u32 vcc, 0, v237
    v_mov_b32 v238, 0xf149f2ca
    s_nop 0
    v_cndmask_b32 v57, v238, v57, vcc
    v_subrev_u32 v237, 50, v235
    v_and_b32 v237, 0xfffffff1, v237
    v_cmp_eq_u32 vcc, 0, v237
    v_mov_b32 v238, 0xf149f2ca
    s_nop 0
    v_cndmask_b32 v58, v238, v58, vcc
    v_subrev_u32 v237, 51, v235
    v_and_b32 v237, 0xfffffff1, v237
    v_cmp_eq_u32 vcc, 0, v237
    v_mov_b32 v238, 0xf149f2ca
    s_nop 0
    v_cndmask_b32 v59, v238, v59, vcc
    v_subrev_u32 v237, 56, v235
    v_and_b32 v237, 0xfffffff1, v237
    v_cmp_eq_u32 vcc, 0, v237
    v_mov_b32 v238, 0xf149f2ca
    s_nop 0
    v_cndmask_b32 v60, v238, v60, vcc
    v_subrev_u32 v237, 57, v235
    v_and_b32 v237, 0xfffffff1, v237
    v_cmp_eq_u32 vcc, 0, v237
    v_mov_b32 v238, 0xf149f2ca
    s_nop 0
    v_cndmask_b32 v61, v238, v61, vcc
    v_subrev_u32 v237, 58, v235
    v_and_b32 v237, 0xfffffff1, v237
    v_cmp_eq_u32 vcc, 0, v237
    v_mov_b32 v238, 0xf149f2ca
    s_nop 0
    v_cndmask_b32 v62, v238, v62, vcc
    v_subrev_u32 v237, 59, v235
    v_and_b32 v237, 0xfffffff1, v237
    v_cmp_eq_u32 vcc, 0, v237
    v_mov_b32 v238, 0xf149f2ca
    s_nop 0
    v_cndmask_b32 v63, v238, v63, vcc
    v_max3_f32 v209, v32, v33, v34
    v_max3_f32 v209, v209, v35, v36
    v_max3_f32 v209, v209, v37, v38
    v_max3_f32 v209, v209, v39, v40
    v_max3_f32 v209, v209, v41, v42
    v_max3_f32 v209, v209, v43, v44
    v_max3_f32 v209, v209, v45, v46
    v_max3_f32 v209, v209, v47, v48
    v_max3_f32 v209, v209, v49, v50
    v_max3_f32 v209, v209, v51, v52
    v_max3_f32 v209, v209, v53, v54
    v_max3_f32 v209, v209, v55, v56
    v_max3_f32 v209, v209, v57, v58
    v_max3_f32 v209, v209, v59, v60
    v_max3_f32 v209, v209, v61, v62
    v_max_f32 v209, v209, v63
    v_mov_b32 v210, v209
    s_nop 1
    v_permlane32_swap_b32 v209, v210
    s_nop 1
    v_max_f32 v209, v209, v210
    v_mul_f32 v209, s3, v209
    v_fma_f32 v32, v32, s3, -v209
    v_fma_f32 v33, v33, s3, -v209
    v_fma_f32 v34, v34, s3, -v209
    v_fma_f32 v35, v35, s3, -v209
    v_fma_f32 v36, v36, s3, -v209
    v_fma_f32 v37, v37, s3, -v209
    v_fma_f32 v38, v38, s3, -v209
    v_fma_f32 v39, v39, s3, -v209
    v_fma_f32 v40, v40, s3, -v209
    v_fma_f32 v41, v41, s3, -v209
    v_fma_f32 v42, v42, s3, -v209
    v_fma_f32 v43, v43, s3, -v209
    v_fma_f32 v44, v44, s3, -v209
    v_fma_f32 v45, v45, s3, -v209
    v_fma_f32 v46, v46, s3, -v209
    v_fma_f32 v47, v47, s3, -v209
    v_fma_f32 v48, v48, s3, -v209
    v_fma_f32 v49, v49, s3, -v209
    v_fma_f32 v50, v50, s3, -v209
    v_fma_f32 v51, v51, s3, -v209
    v_fma_f32 v52, v52, s3, -v209
    v_fma_f32 v53, v53, s3, -v209
    v_fma_f32 v54, v54, s3, -v209
    v_fma_f32 v55, v55, s3, -v209
    v_fma_f32 v56, v56, s3, -v209
    v_fma_f32 v57, v57, s3, -v209
    v_fma_f32 v58, v58, s3, -v209
    v_fma_f32 v59, v59, s3, -v209
    v_fma_f32 v60, v60, s3, -v209
    v_fma_f32 v61, v61, s3, -v209
    v_fma_f32 v62, v62, s3, -v209
    v_fma_f32 v63, v63, s3, -v209
    v_exp_f32 v32, v32
    v_exp_f32 v33, v33
    v_exp_f32 v34, v34
    v_exp_f32 v35, v35
    v_exp_f32 v36, v36
    v_exp_f32 v37, v37
    v_exp_f32 v38, v38
    v_exp_f32 v39, v39
    v_exp_f32 v40, v40
    v_exp_f32 v41, v41
    v_exp_f32 v42, v42
    v_exp_f32 v43, v43
    v_exp_f32 v44, v44
    v_exp_f32 v45, v45
    v_exp_f32 v46, v46
    v_exp_f32 v47, v47
    v_exp_f32 v48, v48
    v_exp_f32 v49, v49
    v_exp_f32 v50, v50
    v_exp_f32 v51, v51
    v_exp_f32 v52, v52
    v_exp_f32 v53, v53
    v_exp_f32 v54, v54
    v_exp_f32 v55, v55
    v_exp_f32 v56, v56
    v_exp_f32 v57, v57
    v_exp_f32 v58, v58
    v_exp_f32 v59, v59
    v_exp_f32 v60, v60
    v_exp_f32 v61, v61
    v_exp_f32 v62, v62
    v_exp_f32 v63, v63
    s_nop 0
    v_add_f32 v209, v32, v33
    v_add_f32 v209, v209, v34
    v_add_f32 v209, v209, v35
    v_add_f32 v209, v209, v36
    v_add_f32 v209, v209, v37
    v_add_f32 v209, v209, v38
    v_add_f32 v209, v209, v39
    v_add_f32 v209, v209, v40
    v_add_f32 v209, v209, v41
    v_add_f32 v209, v209, v42
    v_add_f32 v209, v209, v43
    v_add_f32 v209, v209, v44
    v_add_f32 v209, v209, v45
    v_add_f32 v209, v209, v46
    v_add_f32 v209, v209, v47
    v_add_f32 v209, v209, v48
    v_add_f32 v209, v209, v49
    v_add_f32 v209, v209, v50
    v_add_f32 v209, v209, v51
    v_add_f32 v209, v209, v52
    v_add_f32 v209, v209, v53
    v_add_f32 v209, v209, v54
    v_add_f32 v209, v209, v55
    v_add_f32 v209, v209, v56
    v_add_f32 v209, v209, v57
    v_add_f32 v209, v209, v58
    v_add_f32 v209, v209, v59
    v_add_f32 v209, v209, v60
    v_add_f32 v209, v209, v61
    v_add_f32 v209, v209, v62
    v_add_f32 v209, v209, v63
    v_mov_b32 v210, v209
    s_nop 1
    v_permlane32_swap_b32 v209, v210
    s_nop 1
    v_add_f32 v209, v209, v210
    v_cvt_pk_bf16_f32 v160, v32, v33
    v_cvt_pk_bf16_f32 v161, v34, v35
    v_cvt_pk_bf16_f32 v162, v36, v37
    v_cvt_pk_bf16_f32 v163, v38, v39
    v_cvt_pk_bf16_f32 v164, v40, v41
    v_cvt_pk_bf16_f32 v165, v42, v43
    v_cvt_pk_bf16_f32 v166, v44, v45
    v_cvt_pk_bf16_f32 v167, v46, v47
    v_cvt_pk_bf16_f32 v168, v48, v49
    v_cvt_pk_bf16_f32 v169, v50, v51
    v_cvt_pk_bf16_f32 v170, v52, v53
    v_cvt_pk_bf16_f32 v171, v54, v55
    v_cvt_pk_bf16_f32 v172, v56, v57
    v_cvt_pk_bf16_f32 v173, v58, v59
    v_cvt_pk_bf16_f32 v174, v60, v61
    v_cvt_pk_bf16_f32 v175, v62, v63
    s_nop 1
    v_mfma_f32_32x32x16_bf16 v[192:207], v[128:131], v[160:163], 0
    v_mfma_f32_32x32x16_bf16 v[192:207], v[132:135], v[164:167], v[192:207]
    v_mfma_f32_32x32x16_bf16 v[192:207], v[136:139], v[168:171], v[192:207]
    v_mfma_f32_32x32x16_bf16 v[192:207], v[140:143], v[172:175], v[192:207]
    v_mul_f32 v234, 0x3fb8aa3b, v234
    v_exp_f32 v234, v234
    s_nop 0
    v_add_f32 v234, 1.0, v234
    v_mul_f32 v234, v234, v209
    v_rcp_f32 v234, v234
    s_mul_i32 s15, s11, 57344
    s_add_u32 s15, s15, 7864320
    v_lshlrev_b32 v238, 4, v3
    s_mul_i32 s13, s10, 28
    s_add_u32 s13, s13, 448
    v_lshl_add_u32 v237, v4, 2, s13
    s_nop 15
    v_mul_f32 v192, v192, v234
    v_mul_f32 v193, v193, v234
    v_mul_f32 v194, v194, v234
    v_mul_f32 v195, v195, v234
    v_mul_f32 v196, v196, v234
    v_mul_f32 v197, v197, v234
    v_mul_f32 v198, v198, v234
    v_mul_f32 v199, v199, v234
    v_mul_f32 v200, v200, v234
    v_mul_f32 v201, v201, v234
    v_mul_f32 v202, v202, v234
    v_mul_f32 v203, v203, v234
    v_mul_f32 v204, v204, v234
    v_mul_f32 v205, v205, v234
    v_mul_f32 v206, v206, v234
    v_mul_f32 v207, v207, v234
    v_cvt_pk_bf16_f32 v192, v192, v193
    v_cvt_pk_bf16_f32 v193, v194, v195
    v_add_u32 v236, 0, v237
    v_lshrrev_b32 v235, 3, v236
    v_lshlrev_b32 v235, 9, v235
    v_and_b32 v236, 7, v236
    v_lshl_add_u32 v235, v236, 1, v235
    v_add_u32 v235, v235, v238
    buffer_store_dwordx2 v[192:193], v235, s[16:19], s15 offen
    v_cvt_pk_bf16_f32 v196, v196, v197
    v_cvt_pk_bf16_f32 v197, v198, v199
    v_add_u32 v236, 8, v237
    v_lshrrev_b32 v235, 3, v236
    v_lshlrev_b32 v235, 9, v235
    v_and_b32 v236, 7, v236
    v_lshl_add_u32 v235, v236, 1, v235
    v_add_u32 v235, v235, v238
    buffer_store_dwordx2 v[196:197], v235, s[16:19], s15 offen
    v_cvt_pk_bf16_f32 v200, v200, v201
    v_cvt_pk_bf16_f32 v201, v202, v203
    v_add_u32 v236, 16, v237
    v_lshrrev_b32 v235, 3, v236
    v_lshlrev_b32 v235, 9, v235
    v_and_b32 v236, 7, v236
    v_lshl_add_u32 v235, v236, 1, v235
    v_add_u32 v235, v235, v238
    buffer_store_dwordx2 v[200:201], v235, s[16:19], s15 offen
    v_cvt_pk_bf16_f32 v204, v204, v205
    v_cvt_pk_bf16_f32 v205, v206, v207
    v_add_u32 v236, 24, v237
    v_lshrrev_b32 v235, 3, v236
    v_lshlrev_b32 v235, 9, v235
    v_and_b32 v236, 7, v236
    v_lshl_add_u32 v235, v236, 1, v235
    v_add_u32 v235, v235, v238
    s_andn2_b64 exec, exec, s[30:31]
    buffer_store_dwordx2 v[204:205], v235, s[16:19], s15 offen
K2_end:
    s_endpgm
.globl k3_kernel
.p2align 8
.type k3_kernel,@function
k3_kernel:
    s_lshr_b32 s3, s2, 4
    s_and_b32 s33, s2, 7
    s_lshl_b32 s33, s33, 1
    s_bfe_u32 s34, s2, 0x10003
    s_or_b32 s33, s33, s34
    s_cmp_ge_u32 s3, 14
    s_cbranch_scc1 K3_end
    s_load_dwordx2 s[38:39], s[0:1], 32
    s_load_dwordx2 s[40:41], s[0:1], 56
    s_load_dwordx2 s[42:43], s[0:1], 72
    s_load_dwordx2 s[46:47], s[0:1], 88
    v_lshrrev_b32 v1, 6, v0
    v_and_b32 v2, 63, v0
    v_and_b32 v3, 31, v0
    v_bfe_u32 v4, v0, 5, 1
    s_waitcnt lgkmcnt(0)
    s_mov_b32 s16, s46
    s_and_b32 s17, s47, 0xffff
    s_mov_b32 s18, 11665408
    s_mov_b32 s19, 0x00020000
    s_mov_b32 s20, s42
    s_and_b32 s21, s43, 0xffff
    s_mov_b32 s22, 1835008
    s_mov_b32 s23, 0x00020000
    s_lshl_b32 s34, s33, 7
    v_lshl_add_u32 v5, v1, 5, v3
    v_add_u32 v5, s34, v5
    s_mov_b32 s35, 57344
    v_lshrrev_b32 v6, 5, v5
    v_mul_lo_u32 v6, v6, s35
    v_lshl_add_u32 v6, v2, 4, v6
    s_mov_b32 s36, 7864320
    buffer_load_dwordx4 v[16:19], v6, s[16:19], s36 offen
    s_mov_b32 s36, 7865344
    buffer_load_dwordx4 v[20:23], v6, s[16:19], s36 offen
    s_mov_b32 s36, 7866368
    buffer_load_dwordx4 v[24:27], v6, s[16:19], s36 offen
    s_mov_b32 s36, 7867392
    buffer_load_dwordx4 v[28:31], v6, s[16:19], s36 offen
    s_mov_b32 s36, 7868416
    buffer_load_dwordx4 v[32:35], v6, s[16:19], s36 offen
    s_mov_b32 s36, 7869440
    buffer_load_dwordx4 v[36:39], v6, s[16:19], s36 offen
    s_mov_b32 s36, 7870464
    buffer_load_dwordx4 v[40:43], v6, s[16:19], s36 offen
    s_mov_b32 s36, 7871488
    buffer_load_dwordx4 v[44:47], v6, s[16:19], s36 offen
    s_mov_b32 s36, 7872512
    buffer_load_dwordx4 v[48:51], v6, s[16:19], s36 offen
    s_mov_b32 s36, 7873536
    buffer_load_dwordx4 v[52:55], v6, s[16:19], s36 offen
    s_mov_b32 s36, 7874560
    buffer_load_dwordx4 v[56:59], v6, s[16:19], s36 offen
    s_mov_b32 s36, 7875584
    buffer_load_dwordx4 v[60:63], v6, s[16:19], s36 offen
    s_mov_b32 s36, 7876608
    buffer_load_dwordx4 v[64:67], v6, s[16:19], s36 offen
    s_mov_b32 s36, 7877632
    buffer_load_dwordx4 v[68:71], v6, s[16:19], s36 offen
    s_mov_b32 s36, 7878656
    buffer_load_dwordx4 v[72:75], v6, s[16:19], s36 offen
    s_mov_b32 s36, 7879680
    buffer_load_dwordx4 v[76:79], v6, s[16:19], s36 offen
    s_mov_b32 s36, 7880704
    buffer_load_dwordx4 v[80:83], v6, s[16:19], s36 offen
    s_mov_b32 s36, 7881728
    buffer_load_dwordx4 v[84:87], v6, s[16:19], s36 offen
    s_mov_b32 s36, 7882752
    buffer_load_dwordx4 v[88:91], v6, s[16:19], s36 offen
    s_mov_b32 s36, 7883776
    buffer_load_dwordx4 v[92:95], v6, s[16:19], s36 offen
    s_mov_b32 s36, 7884800
    buffer_load_dwordx4 v[96:99], v6, s[16:19], s36 offen
    s_mov_b32 s36, 7885824
    buffer_load_dwordx4 v[100:103], v6, s[16:19], s36 offen
    s_mov_b32 s36, 7886848
    buffer_load_dwordx4 v[104:107], v6, s[16:19], s36 offen
    s_mov_b32 s36, 7887872
    buffer_load_dwordx4 v[108:111], v6, s[16:19], s36 offen
    s_mov_b32 s36, 7888896
    buffer_load_dwordx4 v[112:115], v6, s[16:19], s36 offen
    s_mov_b32 s36, 7889920
    buffer_load_dwordx4 v[116:119], v6, s[16:19], s36 offen
    s_mov_b32 s36, 7890944
    buffer_load_dwordx4 v[120:123], v6, s[16:19], s36 offen
    s_mov_b32 s36, 7891968
    buffer_load_dwordx4 v[124:127], v6, s[16:19], s36 offen
    v_bfe_u32 v8, v2, 4, 1
    v_bfe_u32 v9, v2, 2, 2
    v_and_b32 v10, 3, v2
    v_lshl_add_u32 v7, v4, 3, v9
    v_lshlrev_b32 v7, 6, v7
    v_lshl_add_u32 v7, v8, 5, v7
    v_lshl_add_u32 v7, v10, 3, v7
    v_lshlrev_b32 v11, 4, v0
    s_movk_i32 s35, 896
    v_lshrrev_b32 v13, 2, v0
    v_mul_lo_u32 v13, v13, s35
    v_and_b32 v14, 3, v0
    v_lshl_add_u32 v13, v14, 4, v13
    s_lshl_b32 s37, s3, 6
    s_mov_b32 s12, s38
    s_and_b32 s13, s39, 0xffff
    s_mov_b32 s14, 401408
    s_mov_b32 s15, 0x00020000
    s_add_u32 s35, s37, 0
    buffer_load_dwordx4 v[144:147], v13, s[12:15], s35 offen
    s_add_u32 s35, s37, 57344
    buffer_load_dwordx4 v[148:151], v13, s[12:15], s35 offen
    s_add_u32 s35, s37, 114688
    buffer_load_dwordx4 v[152:155], v13, s[12:15], s35 offen
    s_add_u32 s35, s37, 172032
    buffer_load_dwordx4 v[156:159], v13, s[12:15], s35 offen
    s_add_u32 s35, s37, 229376
    buffer_load_dwordx4 v[160:163], v13, s[12:15], s35 offen
    s_add_u32 s35, s37, 286720
    buffer_load_dwordx4 v[164:167], v13, s[12:15], s35 offen
    s_add_u32 s35, s37, 344064
    buffer_load_dwordx4 v[168:171], v13, s[12:15], s35 offen
    s_mov_b32 s12, s40
    s_and_b32 s13, s41, 0xffff
    s_mov_b32 s14, 401408
    s_mov_b32 s15, 0x00020000
    s_add_u32 s35, s37, 0
    buffer_load_dwordx4 v[172:175], v13, s[12:15], s35 offen
    s_add_u32 s35, s37, 57344
    buffer_load_dwordx4 v[176:179], v13, s[12:15], s35 offen
    s_add_u32 s35, s37, 114688
    buffer_load_dwordx4 v[180:183], v13, s[12:15], s35 offen
    s_add_u32 s35, s37, 172032
    buffer_load_dwordx4 v[184:187], v13, s[12:15], s35 offen
    s_add_u32 s35, s37, 229376
    buffer_load_dwordx4 v[188:191], v13, s[12:15], s35 offen
    s_add_u32 s35, s37, 286720
    buffer_load_dwordx4 v[192:195], v13, s[12:15], s35 offen
    s_add_u32 s35, s37, 344064
    buffer_load_dwordx4 v[196:199], v13, s[12:15], s35 offen
    s_waitcnt vmcnt(13)
    ds_write_b128 v11, v[144:147] offset:0
    s_waitcnt vmcnt(12)
    ds_write_b128 v11, v[148:151] offset:4096
    s_waitcnt vmcnt(11)
    ds_write_b128 v11, v[152:155] offset:8192
    s_waitcnt vmcnt(10)
    ds_write_b128 v11, v[156:159] offset:12288
    s_waitcnt vmcnt(9)
    ds_write_b128 v11, v[160:163] offset:16384
    s_waitcnt vmcnt(8)
    ds_write_b128 v11, v[164:167] offset:20480
    s_waitcnt vmcnt(7)
    ds_write_b128 v11, v[168:171] offset:24576
    s_waitcnt vmcnt(6)
    ds_write_b128 v11, v[172:175] offset:28672
    s_waitcnt vmcnt(5)
    ds_write_b128 v11, v[176:179] offset:32768
    s_waitcnt vmcnt(4)
    ds_write_b128 v11, v[180:183] offset:36864
    s_waitcnt vmcnt(3)
    ds_write_b128 v11, v[184:187] offset:40960
    s_waitcnt vmcnt(2)
    ds_write_b128 v11, v[188:191] offset:45056
    s_waitcnt vmcnt(1)
    ds_write_b128 v11, v[192:195] offset:49152
    s_waitcnt vmcnt(0)
    ds_write_b128 v11, v[196:199] offset:53248
    s_waitcnt lgkmcnt(0)
    s_barrier
    ds_read_b64_tr_b16 v[208:209], v7 offset:0
    ds_read_b64_tr_b16 v[210:211], v7 offset:256
    ds_read_b64_tr_b16 v[212:213], v7 offset:1024
    ds_read_b64_tr_b16 v[214:215], v7 offset:1280
    s_waitcnt lgkmcnt(2)
    v_mfma_f32_32x32x16_bf16 v[128:143], v[208:211], v[16:19], 0
    s_mov_b32 s36, 7892992
    buffer_load_dwordx4 v[16:19], v6, s[16:19], s36 offen
    ds_read_b64_tr_b16 v[208:209], v7 offset:2048
    ds_read_b64_tr_b16 v[210:211], v7 offset:2304
    s_waitcnt lgkmcnt(2)
    v_mfma_f32_32x32x16_bf16 v[128:143], v[212:215], v[20:23], v[128:143]
    s_mov_b32 s36, 7894016
    buffer_load_dwordx4 v[20:23], v6, s[16:19], s36 offen
    ds_read_b64_tr_b16 v[212:213], v7 offset:3072
    ds_read_b64_tr_b16 v[214:215], v7 offset:3328
    s_waitcnt lgkmcnt(2)
    v_mfma_f32_32x32x16_bf16 v[128:143], v[208:211], v[24:27], v[128:143]
    s_mov_b32 s36, 7895040
    buffer_load_dwordx4 v[24:27], v6, s[16:19], s36 offen
    ds_read_b64_tr_b16 v[208:209], v7 offset:4096
    ds_read_b64_tr_b16 v[210:211], v7 offset:4352
    s_waitcnt lgkmcnt(2)
    v_mfma_f32_32x32x16_bf16 v[128:143], v[212:215], v[28:31], v[128:143]
    s_mov_b32 s36, 7896064
    buffer_load_dwordx4 v[28:31], v6, s[16:19], s36 offen
    ds_read_b64_tr_b16 v[212:213], v7 offset:5120
    ds_read_b64_tr_b16 v[214:215], v7 offset:5376
    s_waitcnt lgkmcnt(2)
    v_mfma_f32_32x32x16_bf16 v[128:143], v[208:211], v[32:35], v[128:143]
    s_mov_b32 s36, 7897088
    buffer_load_dwordx4 v[32:35], v6, s[16:19], s36 offen
    ds_read_b64_tr_b16 v[208:209], v7 offset:6144
    ds_read_b64_tr_b16 v[210:211], v7 offset:6400
    s_waitcnt lgkmcnt(2)
    v_mfma_f32_32x32x16_bf16 v[128:143], v[212:215], v[36:39], v[128:143]
    s_mov_b32 s36, 7898112
    buffer_load_dwordx4 v[36:39], v6, s[16:19], s36 offen
    ds_read_b64_tr_b16 v[212:213], v7 offset:7168
    ds_read_b64_tr_b16 v[214:215], v7 offset:7424
    s_waitcnt lgkmcnt(2)
    v_mfma_f32_32x32x16_bf16 v[128:143], v[208:211], v[40:43], v[128:143]
    s_mov_b32 s36, 7899136
    buffer_load_dwordx4 v[40:43], v6, s[16:19], s36 offen
    ds_read_b64_tr_b16 v[208:209], v7 offset:8192
    ds_read_b64_tr_b16 v[210:211], v7 offset:8448
    s_waitcnt lgkmcnt(2)
    v_mfma_f32_32x32x16_bf16 v[128:143], v[212:215], v[44:47], v[128:143]
    s_mov_b32 s36, 7900160
    buffer_load_dwordx4 v[44:47], v6, s[16:19], s36 offen
    ds_read_b64_tr_b16 v[212:213], v7 offset:9216
    ds_read_b64_tr_b16 v[214:215], v7 offset:9472
    s_waitcnt lgkmcnt(2)
    v_mfma_f32_32x32x16_bf16 v[128:143], v[208:211], v[48:51], v[128:143]
    s_mov_b32 s36, 7901184
    buffer_load_dwordx4 v[48:51], v6, s[16:19], s36 offen
    ds_read_b64_tr_b16 v[208:209], v7 offset:10240
    ds_read_b64_tr_b16 v[210:211], v7 offset:10496
    s_waitcnt lgkmcnt(2)
    v_mfma_f32_32x32x16_bf16 v[128:143], v[212:215], v[52:55], v[128:143]
    s_mov_b32 s36, 7902208
    buffer_load_dwordx4 v[52:55], v6, s[16:19], s36 offen
    ds_read_b64_tr_b16 v[212:213], v7 offset:11264
    ds_read_b64_tr_b16 v[214:215], v7 offset:11520
    s_waitcnt lgkmcnt(2)
    v_mfma_f32_32x32x16_bf16 v[128:143], v[208:211], v[56:59], v[128:143]
    s_mov_b32 s36, 7903232
    buffer_load_dwordx4 v[56:59], v6, s[16:19], s36 offen
    ds_read_b64_tr_b16 v[208:209], v7 offset:12288
    ds_read_b64_tr_b16 v[210:211], v7 offset:12544
    s_waitcnt lgkmcnt(2)
    v_mfma_f32_32x32x16_bf16 v[128:143], v[212:215], v[60:63], v[128:143]
    s_mov_b32 s36, 7904256
    buffer_load_dwordx4 v[60:63], v6, s[16:19], s36 offen
    ds_read_b64_tr_b16 v[212:213], v7 offset:13312
    ds_read_b64_tr_b16 v[214:215], v7 offset:13568
    s_waitcnt lgkmcnt(2)
    v_mfma_f32_32x32x16_bf16 v[128:143], v[208:211], v[64:67], v[128:143]
    s_mov_b32 s36, 7905280
    buffer_load_dwordx4 v[64:67], v6, s[16:19], s36 offen
    ds_read_b64_tr_b16 v[208:209], v7 offset:14336
    ds_read_b64_tr_b16 v[210:211], v7 offset:14592
    s_waitcnt lgkmcnt(2)
    v_mfma_f32_32x32x16_bf16 v[128:143], v[212:215], v[68:71], v[128:143]
    s_mov_b32 s36, 7906304
    buffer_load_dwordx4 v[68:71], v6, s[16:19], s36 offen
    ds_read_b64_tr_b16 v[212:213], v7 offset:15360
    ds_read_b64_tr_b16 v[214:215], v7 offset:15616
    s_waitcnt lgkmcnt(2)
    v_mfma_f32_32x32x16_bf16 v[128:143], v[208:211], v[72:75], v[128:143]
    s_mov_b32 s36, 7907328
    buffer_load_dwordx4 v[72:75], v6, s[16:19], s36 offen
    ds_read_b64_tr_b16 v[208:209], v7 offset:16384
    ds_read_b64_tr_b16 v[210:211], v7 offset:16640
    s_waitcnt lgkmcnt(2)
    v_mfma_f32_32x32x16_bf16 v[128:143], v[212:215], v[76:79], v[128:143]
    s_mov_b32 s36, 7908352
    buffer_load_dwordx4 v[76:79], v6, s[16:19], s36 offen
    ds_read_b64_tr_b16 v[212:213], v7 offset:17408
    ds_read_b64_tr_b16 v[214:215], v7 offset:17664
    s_waitcnt lgkmcnt(2)
    v_mfma_f32_32x32x16_bf16 v[128:143], v[208:211], v[80:83], v[128:143]
    s_mov_b32 s36, 7909376
    buffer_load_dwordx4 v[80:83], v6, s[16:19], s36 offen
    ds_read_b64_tr_b16 v[208:209], v7 offset:18432
    ds_read_b64_tr_b16 v[210:211], v7 offset:18688
    s_waitcnt lgkmcnt(2)
    v_mfma_f32_32x32x16_bf16 v[128:143], v[212:215], v[84:87], v[128:143]
    s_mov_b32 s36, 7910400
    buffer_load_dwordx4 v[84:87], v6, s[16:19], s36 offen
    ds_read_b64_tr_b16 v[212:213], v7 offset:19456
    ds_read_b64_tr_b16 v[214:215], v7 offset:19712
    s_waitcnt lgkmcnt(2)
    v_mfma_f32_32x32x16_bf16 v[128:143], v[208:211], v[88:91], v[128:143]
    s_mov_b32 s36, 7911424
    buffer_load_dwordx4 v[88:91], v6, s[16:19], s36 offen
    ds_read_b64_tr_b16 v[208:209], v7 offset:20480
    ds_read_b64_tr_b16 v[210:211], v7 offset:20736
    s_waitcnt lgkmcnt(2)
    v_mfma_f32_32x32x16_bf16 v[128:143], v[212:215], v[92:95], v[128:143]
    s_mov_b32 s36, 7912448
    buffer_load_dwordx4 v[92:95], v6, s[16:19], s36 offen
    ds_read_b64_tr_b16 v[212:213], v7 offset:21504
    ds_read_b64_tr_b16 v[214:215], v7 offset:21760
    s_waitcnt lgkmcnt(2)
    v_mfma_f32_32x32x16_bf16 v[128:143], v[208:211], v[96:99], v[128:143]
    s_mov_b32 s36, 7913472
    buffer_load_dwordx4 v[96:99], v6, s[16:19], s36 offen
    ds_read_b64_tr_b16 v[208:209], v7 offset:22528
    ds_read_b64_tr_b16 v[210:211], v7 offset:22784
    s_waitcnt lgkmcnt(2)
    v_mfma_f32_32x32x16_bf16 v[128:143], v[212:215], v[100:103], v[128:143]
    s_mov_b32 s36, 7914496
    buffer_load_dwordx4 v[100:103], v6, s[16:19], s36 offen
    ds_read_b64_tr_b16 v[212:213], v7 offset:23552
    ds_read_b64_tr_b16 v[214:215], v7 offset:23808
    s_waitcnt lgkmcnt(2)
    v_mfma_f32_32x32x16_bf16 v[128:143], v[208:211], v[104:107], v[128:143]
    s_mov_b32 s36, 7915520
    buffer_load_dwordx4 v[104:107], v6, s[16:19], s36 offen
    ds_read_b64_tr_b16 v[208:209], v7 offset:24576
    ds_read_b64_tr_b16 v[210:211], v7 offset:24832
    s_waitcnt lgkmcnt(2)
    v_mfma_f32_32x32x16_bf16 v[128:143], v[212:215], v[108:111], v[128:143]
    s_mov_b32 s36, 7916544
    buffer_load_dwordx4 v[108:111], v6, s[16:19], s36 offen
    ds_read_b64_tr_b16 v[212:213], v7 offset:25600
    ds_read_b64_tr_b16 v[214:215], v7 offset:25856
    s_waitcnt lgkmcnt(2)
    v_mfma_f32_32x32x16_bf16 v[128:143], v[208:211], v[112:115], v[128:143]
    s_mov_b32 s36, 7917568
    buffer_load_dwordx4 v[112:115], v6, s[16:19], s36 offen
    ds_read_b64_tr_b16 v[208:209], v7 offset:26624
    ds_read_b64_tr_b16 v[210:211], v7 offset:26880
    s_waitcnt lgkmcnt(2)
    v_mfma_f32_32x32x16_bf16 v[128:143], v[212:215], v[116:119], v[128:143]
    s_mov_b32 s36, 7918592
    buffer_load_dwordx4 v[116:119], v6, s[16:19], s36 offen
    ds_read_b64_tr_b16 v[212:213], v7 offset:27648
    ds_read_b64_tr_b16 v[214:215], v7 offset:27904
    s_waitcnt lgkmcnt(2)
    v_mfma_f32_32x32x16_bf16 v[128:143], v[208:211], v[120:123], v[128:143]
    s_mov_b32 s36, 7919616
    buffer_load_dwordx4 v[120:123], v6, s[16:19], s36 offen
    ds_read_b64_tr_b16 v[208:209], v7 offset:28672
    ds_read_b64_tr_b16 v[210:211], v7 offset:28928
    s_waitcnt lgkmcnt(2)
    v_mfma_f32_32x32x16_bf16 v[128:143], v[212:215], v[124:127], v[128:143]
    s_mov_b32 s36, 7920640
    buffer_load_dwordx4 v[124:127], v6, s[16:19], s36 offen
    s_waitcnt vmcnt(0)
    ds_read_b64_tr_b16 v[212:213], v7 offset:29696
    ds_read_b64_tr_b16 v[214:215], v7 offset:29952
    s_waitcnt lgkmcnt(2)
    v_mfma_f32_32x32x16_bf16 v[128:143], v[208:211], v[16:19], v[128:143]
    ds_read_b64_tr_b16 v[208:209], v7 offset:30720
    ds_read_b64_tr_b16 v[210:211], v7 offset:30976
    s_waitcnt lgkmcnt(2)
    v_mfma_f32_32x32x16_bf16 v[128:143], v[212:215], v[20:23], v[128:143]
    ds_read_b64_tr_b16 v[212:213], v7 offset:31744
    ds_read_b64_tr_b16 v[214:215], v7 offset:32000
    s_waitcnt lgkmcnt(2)
    v_mfma_f32_32x32x16_bf16 v[128:143], v[208:211], v[24:27], v[128:143]
    ds_read_b64_tr_b16 v[208:209], v7 offset:32768
    ds_read_b64_tr_b16 v[210:211], v7 offset:33024
    s_waitcnt lgkmcnt(2)
    v_mfma_f32_32x32x16_bf16 v[128:143], v[212:215], v[28:31], v[128:143]
    ds_read_b64_tr_b16 v[212:213], v7 offset:33792
    ds_read_b64_tr_b16 v[214:215], v7 offset:34048
    s_waitcnt lgkmcnt(2)
    v_mfma_f32_32x32x16_bf16 v[128:143], v[208:211], v[32:35], v[128:143]
    ds_read_b64_tr_b16 v[208:209], v7 offset:34816
    ds_read_b64_tr_b16 v[210:211], v7 offset:35072
    s_waitcnt lgkmcnt(2)
    v_mfma_f32_32x32x16_bf16 v[128:143], v[212:215], v[36:39], v[128:143]
    ds_read_b64_tr_b16 v[212:213], v7 offset:35840
    ds_read_b64_tr_b16 v[214:215], v7 offset:36096
    s_waitcnt lgkmcnt(2)
    v_mfma_f32_32x32x16_bf16 v[128:143], v[208:211], v[40:43], v[128:143]
    ds_read_b64_tr_b16 v[208:209], v7 offset:36864
    ds_read_b64_tr_b16 v[210:211], v7 offset:37120
    s_waitcnt lgkmcnt(2)
    v_mfma_f32_32x32x16_bf16 v[128:143], v[212:215], v[44:47], v[128:143]
    ds_read_b64_tr_b16 v[212:213], v7 offset:37888
    ds_read_b64_tr_b16 v[214:215], v7 offset:38144
    s_waitcnt lgkmcnt(2)
    v_mfma_f32_32x32x16_bf16 v[128:143], v[208:211], v[48:51], v[128:143]
    ds_read_b64_tr_b16 v[208:209], v7 offset:38912
    ds_read_b64_tr_b16 v[210:211], v7 offset:39168
    s_waitcnt lgkmcnt(2)
    v_mfma_f32_32x32x16_bf16 v[128:143], v[212:215], v[52:55], v[128:143]
    ds_read_b64_tr_b16 v[212:213], v7 offset:39936
    ds_read_b64_tr_b16 v[214:215], v7 offset:40192
    s_waitcnt lgkmcnt(2)
    v_mfma_f32_32x32x16_bf16 v[128:143], v[208:211], v[56:59], v[128:143]
    ds_read_b64_tr_b16 v[208:209], v7 offset:40960
    ds_read_b64_tr_b16 v[210:211], v7 offset:41216
    s_waitcnt lgkmcnt(2)
    v_mfma_f32_32x32x16_bf16 v[128:143], v[212:215], v[60:63], v[128:143]
    ds_read_b64_tr_b16 v[212:213], v7 offset:41984
    ds_read_b64_tr_b16 v[214:215], v7 offset:42240
    s_waitcnt lgkmcnt(2)
    v_mfma_f32_32x32x16_bf16 v[128:143], v[208:211], v[64:67], v[128:143]
    ds_read_b64_tr_b16 v[208:209], v7 offset:43008
    ds_read_b64_tr_b16 v[210:211], v7 offset:43264
    s_waitcnt lgkmcnt(2)
    v_mfma_f32_32x32x16_bf16 v[128:143], v[212:215], v[68:71], v[128:143]
    ds_read_b64_tr_b16 v[212:213], v7 offset:44032
    ds_read_b64_tr_b16 v[214:215], v7 offset:44288
    s_waitcnt lgkmcnt(2)
    v_mfma_f32_32x32x16_bf16 v[128:143], v[208:211], v[72:75], v[128:143]
    ds_read_b64_tr_b16 v[208:209], v7 offset:45056
    ds_read_b64_tr_b16 v[210:211], v7 offset:45312
    s_waitcnt lgkmcnt(2)
    v_mfma_f32_32x32x16_bf16 v[128:143], v[212:215], v[76:79], v[128:143]
    ds_read_b64_tr_b16 v[212:213], v7 offset:46080
    ds_read_b64_tr_b16 v[214:215], v7 offset:46336
    s_waitcnt lgkmcnt(2)
    v_mfma_f32_32x32x16_bf16 v[128:143], v[208:211], v[80:83], v[128:143]
    ds_read_b64_tr_b16 v[208:209], v7 offset:47104
    ds_read_b64_tr_b16 v[210:211], v7 offset:47360
    s_waitcnt lgkmcnt(2)
    v_mfma_f32_32x32x16_bf16 v[128:143], v[212:215], v[84:87], v[128:143]
    ds_read_b64_tr_b16 v[212:213], v7 offset:48128
    ds_read_b64_tr_b16 v[214:215], v7 offset:48384
    s_waitcnt lgkmcnt(2)
    v_mfma_f32_32x32x16_bf16 v[128:143], v[208:211], v[88:91], v[128:143]
    ds_read_b64_tr_b16 v[208:209], v7 offset:49152
    ds_read_b64_tr_b16 v[210:211], v7 offset:49408
    s_waitcnt lgkmcnt(2)
    v_mfma_f32_32x32x16_bf16 v[128:143], v[212:215], v[92:95], v[128:143]
    ds_read_b64_tr_b16 v[212:213], v7 offset:50176
    ds_read_b64_tr_b16 v[214:215], v7 offset:50432
    s_waitcnt lgkmcnt(2)
    v_mfma_f32_32x32x16_bf16 v[128:143], v[208:211], v[96:99], v[128:143]
    ds_read_b64_tr_b16 v[208:209], v7 offset:51200
    ds_read_b64_tr_b16 v[210:211], v7 offset:51456
    s_waitcnt lgkmcnt(2)
    v_mfma_f32_32x32x16_bf16 v[128:143], v[212:215], v[100:103], v[128:143]
    ds_read_b64_tr_b16 v[212:213], v7 offset:52224
    ds_read_b64_tr_b16 v[214:215], v7 offset:52480
    s_waitcnt lgkmcnt(2)
    v_mfma_f32_32x32x16_bf16 v[128:143], v[208:211], v[104:107], v[128:143]
    ds_read_b64_tr_b16 v[208:209], v7 offset:53248
    ds_read_b64_tr_b16 v[210:211], v7 offset:53504
    s_waitcnt lgkmcnt(2)
    v_mfma_f32_32x32x16_bf16 v[128:143], v[212:215], v[108:111], v[128:143]
    ds_read_b64_tr_b16 v[212:213], v7 offset:54272
    ds_read_b64_tr_b16 v[214:215], v7 offset:54528
    s_waitcnt lgkmcnt(2)
    v_mfma_f32_32x32x16_bf16 v[128:143], v[208:211], v[112:115], v[128:143]
    ds_read_b64_tr_b16 v[208:209], v7 offset:55296
    ds_read_b64_tr_b16 v[210:211], v7 offset:55552
    s_waitcnt lgkmcnt(2)
    v_mfma_f32_32x32x16_bf16 v[128:143], v[212:215], v[116:119], v[128:143]
    ds_read_b64_tr_b16 v[212:213], v7 offset:56320
    ds_read_b64_tr_b16 v[214:215], v7 offset:56576
    s_waitcnt lgkmcnt(2)
    v_mfma_f32_32x32x16_bf16 v[128:143], v[208:211], v[120:123], v[128:143]
    s_waitcnt lgkmcnt(0)
    v_mfma_f32_32x32x16_bf16 v[128:143], v[212:215], v[124:127], v[128:143]
    s_movk_i32 s35, 896
    v_mul_lo_u32 v13, v5, s35
    v_lshl_add_u32 v13, v4, 3, v13
    s_nop 15
    s_nop 3
    v_cvt_pk_bf16_f32 v128, v128, v129
    v_cvt_pk_bf16_f32 v129, v130, v131
    buffer_store_dwordx2 v[128:129], v13, s[20:23], s37 offen offset:0
    v_cvt_pk_bf16_f32 v132, v132, v133
    v_cvt_pk_bf16_f32 v133, v134, v135
    buffer_store_dwordx2 v[132:133], v13, s[20:23], s37 offen offset:16
    v_cvt_pk_bf16_f32 v136, v136, v137
    v_cvt_pk_bf16_f32 v137, v138, v139
    buffer_store_dwordx2 v[136:137], v13, s[20:23], s37 offen offset:32
    v_cvt_pk_bf16_f32 v140, v140, v141
    v_cvt_pk_bf16_f32 v141, v142, v143
    buffer_store_dwordx2 v[140:141], v13, s[20:23], s37 offen offset:48
K3_end:
    s_endpgm
.section .rodata,"a"
.p2align 6
.amdhsa_kernel k1_kernel
  .amdhsa_next_free_vgpr 256
  .amdhsa_next_free_sgpr 102
  .amdhsa_accum_offset 256
  .amdhsa_group_segment_fixed_size 0
  .amdhsa_kernarg_size 96
  .amdhsa_user_sgpr_count 2
  .amdhsa_user_sgpr_kernarg_segment_ptr 1
  .amdhsa_system_sgpr_workgroup_id_x 1
.end_amdhsa_kernel
.p2align 6
.amdhsa_kernel k2_kernel
  .amdhsa_next_free_vgpr 256
  .amdhsa_next_free_sgpr 102
  .amdhsa_accum_offset 256
  .amdhsa_group_segment_fixed_size 0
  .amdhsa_kernarg_size 96
  .amdhsa_user_sgpr_count 2
  .amdhsa_user_sgpr_kernarg_segment_ptr 1
  .amdhsa_system_sgpr_workgroup_id_x 1
.end_amdhsa_kernel
.p2align 6
.amdhsa_kernel k3_kernel
  .amdhsa_next_free_vgpr 256
  .amdhsa_next_free_sgpr 102
  .amdhsa_accum_offset 256
  .amdhsa_group_segment_fixed_size 0
  .amdhsa_kernarg_size 96
  .amdhsa_user_sgpr_count 2
  .amdhsa_user_sgpr_kernarg_segment_ptr 1
  .amdhsa_system_sgpr_workgroup_id_x 1
.end_amdhsa_kernel
```
